```python
import torch

def _softmax(x, axis=-1):
    return torch.softmax(x, dim=axis)
def _gelu(x):
    return torch.nn.functional.gelu(x, approximate="tanh")
def _silu(x):
    return torch.nn.functional.silu(x)
def _sigmoid(x):
    return torch.sigmoid(x)
def _layernorm(x, axis=-1, eps=1e-5):
    m = x.mean(dim=axis, keepdim=True)
    v = x.var(dim=axis, keepdim=True, unbiased=False)
    return (x - m) / torch.sqrt(v + eps)
def _scatter_add(tgt, idx, src, axis=0):
    return tgt.clone().index_add_(axis, idx, src)
def _segment_sum(src, seg, n):
    out = torch.zeros((n,) + src.shape[1:], dtype=src.dtype)
    return out.index_add_(0, seg, src)
def _pad(x, pw):
    flat = tuple(v for pair in reversed(pw) for v in pair)
    return torch.nn.functional.pad(x, flat)

kernel_name = 'interleave_layers__sliding_local_dilated__swiglu_ffn__prompt'

def setup_inputs():

    _w = (lambda a: (lambda t: t.to(torch.bfloat16) if t.is_floating_point() else t)(torch.as_tensor(a)))
    def _A_setup():
        B, S, D = 1, 2048, 448
        return {
            "x": _w((lambda *s: torch.randn(*s, dtype=torch.bfloat16) * 0.05)(B, S, D)),
            "wqkv": _w((lambda *s: torch.randn(*s, dtype=torch.bfloat16) * 0.05)(D, 3 * D)),
            "wo": _w((lambda *s: torch.randn(*s, dtype=torch.bfloat16) * 0.05)(D, D)),
        }
    _A_in = _A_setup()

    def _B_setup():
        B, S, D, F = 1, 2048, 448, 1792
        return {
            "x": _w((lambda *s: torch.randn(*s, dtype=torch.bfloat16) * 0.05)(B, S, D)),
            "w_gate": _w((lambda *s: torch.randn(*s, dtype=torch.bfloat16) * 0.05)(D, F)),
            "w_up": _w((lambda *s: torch.randn(*s, dtype=torch.bfloat16) * 0.05)(D, F)),
            "w_down": _w((lambda *s: torch.randn(*s, dtype=torch.bfloat16) * 0.05)(F, D)),
        }
    _B_in = _B_setup()

    return {
        "A_x": _A_in["x"],
        "A_wqkv": _A_in["wqkv"],
        "A_wo": _A_in["wo"],
        "B_x": _B_in["x"],
        "B_w_gate": _B_in["w_gate"],
        "B_w_up": _B_in["w_up"],
        "B_w_down": _B_in["w_down"],
    }

def reference(A_x, A_wqkv, A_wo, B_x, B_w_gate, B_w_up, B_w_down):
    def _A_ref(x, wqkv, wo):
        B, S, D = x.shape
        H = 16; Dh = D // H
        W, dil = 8, 2
        qkv = (lambda x, *d: x.permute(*d))((x @ wqkv).reshape(B, S, 3, H, Dh), 2, 0, 3, 1, 4)
        q, k, v = qkv[0], qkv[1], qkv[2]
        scale = Dh ** -0.5
        pos = torch.arange(S)
        off = torch.arange(W) * dil
        idx = pos[:, None] - off[None, :]
        mask = idx >= 0
        idx_c = torch.where(mask, idx, 0).reshape(-1)
        kg = k[:, :, idx_c, :].reshape(B, H, S, W, Dh)
        vg = v[:, :, idx_c, :].reshape(B, H, S, W, Dh)
        logits = torch.einsum("bhsd,bhswd->bhsw", q, kg) * scale
        logits = torch.where(mask[None, None, :, :], logits, -1e9)
        attn = _softmax(logits, axis=-1)
        o = torch.einsum("bhsw,bhswd->bhsd", attn, vg)
        return (lambda x, *d: x.permute(*d))(o, 0, 2, 1, 3).reshape(B, S, D) @ wo

    def _B_ref(x, w_gate, w_up, w_down):
        g = _silu(x @ w_gate)
        u = x @ w_up
        return (g * u) @ w_down

    x = A_x
    x = x + _A_ref(_layernorm(x, axis=-1), A_wqkv, A_wo)
    x = x + _B_ref(_layernorm(x, axis=-1), B_w_gate, B_w_up, B_w_down)
    x = x + _A_ref(_layernorm(x, axis=-1), A_wqkv, A_wo)
    x = x + _B_ref(_layernorm(x, axis=-1), B_w_gate, B_w_up, B_w_down)
    return x
```

```asm
; @launch grid=(256,1,1) block=(256,1,1) lds=163328
.amdgcn_target "amdgcn-amd-amdhsa--gfx950"
.text
.globl interleave_layers__sliding_local_dilated__swiglu_ffn__prompt_kernel
.p2align 8
.type interleave_layers__sliding_local_dilated__swiglu_ffn__prompt_kernel,@function
interleave_layers__sliding_local_dilated__swiglu_ffn__prompt_kernel:
    s_cmp_ge_u32 s2, 256
    s_cbranch_scc1 interleave_layers__sliding_local_dilated__swiglu_ffn__prompt_kernel_end
    s_load_dwordx16 s[72:87], s[0:1], 0
    s_load_dwordx4 s[88:91], s[0:1], 64
    s_getpc_b64 s[44:45]
Lpc:
    s_lshr_b32 s49, s2, 3
    s_and_b32 s45, s45, 0xffff
    s_mov_b32 s46, Lcode_end-Lpc
    s_mov_b32 s47, 0x20000
    s_lshl_b32 s51, s49, 2
    s_mov_b32 s57, 0xca875310
    s_mov_b32 s52, 0x87543102
    s_bitcmp1_b32 s49, 3
    s_cselect_b32 s57, 0xfdb9642e, s57
    s_cselect_b32 s52, 0xfdb9ec6a, s52
    s_bitcmp1_b32 s49, 4
    s_cselect_b32 s57, s52, s57
    s_lshr_b32 s51, s57, s51
    s_and_b32 s51, s51, 15
    s_lshl_b32 s48, s49, 12
    v_lshlrev_b32 v1, 4, v0
    buffer_load_dwordx4 v[216:219], v1, s[44:47], s48 offen
    s_and_b32 s48, s2, 7
    v_lshrrev_b32 v7, 6, v0
    s_nop 0
    v_readfirstlane_b32 s50, v7
    v_and_b32 v0, 63, v0
    v_lshlrev_b32 v1, 4, v0
    v_lshrrev_b32 v2, 4, v0
    v_and_b32 v3, 15, v0
    s_lshr_b32 s52, s49, 4
    s_mul_i32 s53, s49, 37
    s_lshr_b32 s53, s53, 8
    s_mul_i32 s54, s53, 7
    s_sub_u32 s54, s49, s54
    s_lshl_b32 s57, s48, 4
    s_lshl_b32 s5, s52, 3
    s_add_u32 s57, s57, s5
    v_lshrrev_b32 v8, 3, v0
    v_and_b32 v9, 7, v0
    v_mul_u32_u24 v12, 896, v8
    v_lshrrev_b32 v13, 1, v8
    v_xor_b32 v13, v13, v9
    v_lshl_add_u32 v232, v13, 4, v12
    v_xor_b32 v233, 64, v232
    v_add_u32 v233, 7168, v233
    s_lshl_b32 s44, s50, 1
    s_add_u32 s44, s44, s57
    s_mul_i32 s44, s44, 14336
    v_add_u32 v208, s44, v232
    v_add_u32 v209, s44, v233
    v_add_u32 v210, 12288, v208
    v_add_u32 v211, 11264, v209
    v_subrev_u32 v209, 1024, v209
    s_lshl_b32 s30, s50, 10
    s_lshl_b32 s45, s50, 12
    s_add_u32 s45, s45, 91648
    s_mul_i32 s46, s50, 3072
    v_lshrrev_b32 v13, 2, v3
    v_lshl_add_u32 v13, v2, 3, v13
    v_and_b32 v14, 1, v2
    v_lshlrev_b32 v14, 1, v14
    v_and_b32 v15, 3, v3
    v_xor_b32 v14, v14, v15
    v_mul_u32_u24 v234, 2688, v13
    v_lshl_add_u32 v234, v14, 4, v234
    s_mul_i32 s5, s51, 56
    s_lshr_b32 s6, s50, 1
    s_mul_i32 s6, s6, 86016
    s_add_u32 s5, s5, s6
    v_add_u32 v234, s5, v234
    s_sub_u32 s5, s57, 1
    s_max_i32 s5, s5, 0
    s_mul_i32 s5, s5, 14336
    s_bitcmp1_b32 s50, 0
    s_cselect_b64 vcc, -1, 0
    s_cselect_b32 s20, -1, 0xffffff00
    v_cndmask_b32 v255, v232, v233, vcc
    v_add_u32 v255, s5, v255
    s_mov_b32 s5, 896
    s_cselect_b32 s5, 0, s5
    v_add_u32 v212, s5, v234
    s_mov_b32 s5, 768
    s_cselect_b32 s5, 10624, s5
    v_add_u32 v213, s5, v234
    s_mov_b32 s5, 8704
    s_cselect_b32 s5, 10496, s5
    v_add_u32 v214, s5, v234
    s_lshl1_add_u32 s22, s51, s52
    s_add_u32 s22, s22, s48
    s_mul_i32 s5, s22, 37
    s_lshr_b32 s5, s5, 8
    s_mul_i32 s5, s5, 7
    s_sub_u32 s22, s22, s5
    s_lshl_b32 s22, s22, 7
    s_add_u32 s23, s22, 128
    s_cmp_eq_u32 s23, 896
    s_cselect_b32 s23, 0, s23
    s_add_u32 s24, s23, 128
    s_cmp_eq_u32 s24, 896
    s_cselect_b32 s24, 0, s24
    s_add_u32 s25, s24, 128
    s_cmp_eq_u32 s25, 896
    s_cselect_b32 s25, 0, s25
    s_add_u32 s26, s25, 128
    s_cmp_eq_u32 s26, 896
    s_cselect_b32 s26, 0, s26
    s_add_u32 s27, s26, 128
    s_cmp_eq_u32 s27, 896
    s_cselect_b32 s27, 0, s27
    s_add_u32 s28, s27, 128
    s_cmp_eq_u32 s28, 896
    s_cselect_b32 s28, 0, s28
    s_lshl_b32 s58, s48, 9
    s_add_u32 s58, s58, 41943040
    s_lshl_b32 s56, s49, 2
    s_add_u32 s56, s56, s50
    s_lshl_b32 s56, s56, 2
    s_add_u32 s56, s56, s58
    s_lshl_b32 s60, s53, 2
    s_add_u32 s60, s60, s50
    s_lshl_b32 s59, s48, 7
    s_lshl_b32 s5, s54, 3
    s_add_u32 s59, s59, s5
    s_lshl2_add_u32 s59, s50, s59
    s_add_u32 s59, s59, 41947128
    s_lshr_b32 s5, s60, 1
    s_cmp_eq_u32 s5, 7
    s_cselect_b32 s59, s59, 2146435072
    s_lshl_b32 s5, s48, 4
    s_add_u32 s60, s60, s5
    v_mov_b32 v248, 0
    v_mov_b32 v249, 0
    v_mov_b32 v250, 0
    v_mov_b32 v251, 0
    s_mov_b32 s62, 1048577
    s_mov_b32 s63, 0x10000100
    s_mov_b32 s64, 2097154
    s_mov_b32 s65, 0x20000200
    s_mov_b32 s66, 4194308
    s_mov_b32 s67, 0x40000400
    s_mov_b32 s68, 8388616
    s_mov_b32 s69, 0x80000800
    s_waitcnt lgkmcnt(0)
    s_mov_b32 s8, s72
    s_and_b32 s9, s73, 0xffff
    s_mov_b32 s10, 1835008
    s_mov_b32 s11, 0x20000
    s_mov_b32 s12, s74
    s_and_b32 s13, s75, 0xffff
    s_mov_b32 s14, 1204224
    s_mov_b32 s15, 0x20000
    s_add_u32 m0, s45, 32768
    s_nop 0
    buffer_load_dwordx4 v208, s[8:11], s22 offen offset:0 lds
    buffer_load_dwordx4 v209, s[8:11], s22 offen offset:1024 lds
    buffer_load_dwordx4 v210, s[8:11], s22 offen offset:2048 lds
    buffer_load_dwordx4 v211, s[8:11], s22 offen offset:3072 lds
    s_cmp_lt_u32 s50, 2
    s_cselect_b32 s5, s22, s23
    s_add_u32 m0, s30, 140800
    s_mov_b32 exec_lo, s20
    buffer_load_dwordx4 v255, s[8:11], s5 offen lds
    s_mov_b32 exec_lo, -1
    s_mul_i32 s29, s22, 1344
    s_add_u32 m0, s46, 0
    s_nop 0
    buffer_load_dwordx4 v212, s[12:15], s29 offen offset:0 lds
    buffer_load_dwordx4 v213, s[12:15], s29 offen offset:1024 lds
    s_mov_b32 s36, s90
    s_and_b32 s37, s91, 0xffff
    s_mov_b32 s38, 134217728
    s_mov_b32 s39, 0x20000
    s_mov_b32 s96, s88
    s_and_b32 s97, s89, 0xffff
    s_mov_b32 s98, 256
    s_mov_b32 s99, 0x20000
    s_cmp_eq_u32 s50, 0
    s_cselect_b32 s5, s56, 2146435072
    buffer_store_dwordx4 v[248:251], off, s[36:39], s5
    s_add_u32 s5, s58, 16384
    v_lshl_add_u32 v252, v0, 3, s5
    s_mov_b32 exec_lo, 0
    v_mov_b32 v252, 41963520
    s_mov_b32 exec_lo, -1
    buffer_load_dwordx2 v[246:247], v252, s[36:39], 0 offen sc1
    s_mov_b32 s16, s76
    s_and_b32 s17, s77, 0xffff
    s_mov_b32 s18, 401408
    s_mov_b32 s19, 0x20000
    s_mov_b32 s32, s86
    s_and_b32 s33, s87, 0xffff
    s_mov_b32 s34, 1835008
    s_mov_b32 s35, 0x20000
    s_and_b32 s85, s85, 0xffff
    s_mov_b32 s86, 1605632
    s_mov_b32 s87, 0x20000
    s_bitcmp1_b32 s50, 0
    s_cselect_b64 s[40:41], s[82:83], s[80:81]
    s_mov_b32 s40, s40
    s_and_b32 s41, s41, 0xffff
    s_mov_b32 s42, 1605632
    s_mov_b32 s43, 0x20000
    s_mov_b32 s70, 0x00f0000f
    s_mov_b32 s71, 0xf0000f00
    s_and_b32 s72, s50, 1
    v_lshl_add_u32 v28, s72, 6, v0
    v_min_u32 v28, 111, v28
    v_mov_b32 v29, 0xf149f2ca
    v_mov_b32 v32, 0xffff
    v_mov_b32 v33, 0xffff0000
    v_subrev_u32 v30, 32, v28
    v_and_b32 v30, 0xfffffff1, v30
    v_cmp_eq_u32 vcc, 0, v30
    v_mov_b32 v36, 0x3f803f80
    s_nop 0
    v_cndmask_b32 v16, v29, 0, vcc
    v_cndmask_b32 v24, 0, v32, vcc
    v_subrev_u32 v30, 33, v28
    v_and_b32 v30, 0xfffffff1, v30
    v_cmp_eq_u32 vcc, 0, v30
    v_mov_b32 v37, 0x3f803f80
    s_nop 0
    v_cndmask_b32 v17, v29, 0, vcc
    v_cndmask_b32 v24, v24, v33, vcc
    v_subrev_u32 v30, 34, v28
    v_and_b32 v30, 0xfffffff1, v30
    v_cmp_eq_u32 vcc, 0, v30
    v_mov_b32 v38, 0x3f803f80
    s_nop 0
    v_cndmask_b32 v18, v29, 0, vcc
    v_cndmask_b32 v25, 0, v32, vcc
    v_subrev_u32 v30, 35, v28
    v_and_b32 v30, 0xfffffff1, v30
    v_cmp_eq_u32 vcc, 0, v30
    v_mov_b32 v39, 0x3f803f80
    s_nop 0
    v_cndmask_b32 v19, v29, 0, vcc
    v_cndmask_b32 v25, v25, v33, vcc
    v_lshlrev_b32 v31, 4, v28
    v_add_u32 v31, 87552, v31
    ds_write_b128 v31, v[16:19]
    ds_write_b64 v31, v[24:25] offset:2048
    ds_write_b64 v31, v[24:25] offset:2184
    v_lshrrev_b32 v30, 2, v3
    v_xor_b32 v30, v30, v2
    v_and_b32 v30, 1, v30
    v_cmp_eq_u32 vcc, 0, v30
    v_min_u32 v31, 6, v8
    v_lshlrev_b32 v31, 11, v31
    v_cndmask_b32 v204, 0, v36, vcc
    v_cndmask_b32 v205, 0, v36, vcc
    v_cndmask_b32 v206, 0, v36, vcc
    v_cndmask_b32 v207, 0, v36, vcc
    v_lshl_add_u32 v31, v9, 4, v31
    v_add_u32 v31, 140800, v31
    ds_write_b128 v31, v[36:39]
    v_lshrrev_b32 v34, 1, v3
    v_xor_b32 v35, v34, v2
    v_lshlrev_b32 v35, 4, v35
    v_lshl_add_u32 v35, v3, 7, v35
    v_add_u32 v240, 140800, v35
    v_xor_b32 v241, 64, v240
    v_lshrrev_b32 v35, 1, v2
    v_xor_b32 v34, v34, v35
    v_and_b32 v35, 31, v0
    v_lshl_add_u32 v35, v35, 7, s45
    v_lshl_add_u32 v236, v34, 4, v35
    v_xor_b32 v237, 32, v236
    v_xor_b32 v238, 64, v236
    v_xor_b32 v239, 96, v236
    s_and_b32 s72, s50, 1
    s_lshr_b32 s73, s50, 1
    v_lshrrev_b32 v12, 2, v3
    v_lshlrev_b32 v9, 6, v12
    v_and_b32 v12, 3, v3
    v_lshl_add_u32 v9, v12, 3, v9
    v_lshrrev_b32 v12, 1, v2
    v_lshl_add_u32 v8, v12, 8, v9
    v_xor_b32 v12, v12, v2
    v_and_b32 v12, 1, v12
    v_lshl_add_u32 v8, v12, 5, v8
    v_lshl_add_u32 v10, v2, 8, v9
    v_xor_b32 v12, s72, v2
    v_and_b32 v12, 1, v12
    v_lshl_add_u32 v10, v12, 5, v10
    v_add_u32 v9, 43008, v8
    s_lshl_b32 s74, s73, 10
    v_add_u32 v10, s74, v10
    v_add_u32 v11, 43008, v10
    v_and_b32 v12, 4, v3
    v_lshlrev_b32 v4, 7, v12
    v_lshl_add_u32 v4, v2, 6, v4
    v_and_b32 v12, 8, v3
    v_add_u32 v4, v4, v12
    v_and_b32 v12, 3, v3
    v_lshl_add_u32 v4, v12, 1, v4
    s_mul_i32 s75, s73, 12288
    s_lshl_b32 s74, s72, 8
    s_sub_u32 s74, s74, s75
    s_add_u32 s74, s74, 162304
    v_add_u32 v4, s74, v4
    s_lshl_b32 s74, s72, 9
    s_add_u32 s75, s74, s75
    s_add_u32 s75, s75, 148992
    s_lshl_b32 s74, s50, 11
    s_add_u32 s74, s74, 148992
    v_add_u32 v14, s74, v1
    v_lshrrev_b32 v12, 1, v2
    v_lshlrev_b32 v15, 4, v3
    buffer_load_dwordx4 v214, s[12:15], s29 offen offset:2048 lds
    v_lshl_add_u32 v13, v12, 8, v15
    v_add_u32 v13, s74, v13
    v_lshl_add_u32 v15, v12, 3, v15
    v_and_b32 v12, 1, v2
    v_lshl_add_u32 v15, v12, 8, v15
    v_add_u32 v15, s75, v15
    v_add_u32 v12, 132608, v1
    v_mov_b32 v149, 0
    v_mov_b32 v150, 0
    v_mov_b32 v151, 0
    s_add_u32 m0, s45, 0
    s_nop 0
    buffer_load_dwordx4 v208, s[8:11], s23 offen offset:0 lds
    v_mov_b32 v153, 0
    v_mov_b32 v154, 0
    v_mov_b32 v155, 0
    s_lshl_b32 s72, s50, 7
    s_add_u32 s72, s72, 159296
    v_and_b32 v160, 31, v0
    v_lshl_add_u32 v242, v160, 2, s72
    v_lshrrev_b32 v161, 3, v0
    v_and_b32 v161, 4, v161
    v_sub_u32 v160, v160, v161
    buffer_load_dwordx4 v209, s[8:11], s23 offen offset:1024 lds
    v_lshlrev_b32 v169, 4, v160
    v_add_u32 v169, 87680, v169
    v_lshlrev_b32 v160, 2, v160
    v_subrev_u32 v161, 8, v160
    v_and_b32 v160, 56, v160
    v_and_b32 v161, 56, v161
    v_xor_b32 v162, 32, v160
    v_xor_b32 v163, 32, v161
    v_sub_u32 v164, v242, v160
    v_sub_u32 v165, v242, v161
    buffer_load_dwordx4 v210, s[8:11], s23 offen offset:2048 lds
    v_sub_u32 v166, v242, v162
    v_sub_u32 v167, v242, v163
    v_lshlrev_b32 v243, 2, v3
    v_add_u32 v243, 159232, v243
    v_lshlrev_b32 v170, 2, v0
    v_add_u32 v170, 86016, v170
    s_lshr_b32 s72, s50, 1
    s_lshl_b32 s72, s72, 2
    s_and_b32 s73, s50, 1
    s_add_u32 s72, s72, s73
    s_lshl_b32 s72, s72, 6
    s_add_u32 s72, s72, 86272
    v_and_b32 v171, 1, v2
    buffer_load_dwordx4 v211, s[8:11], s23 offen offset:3072 lds
    v_lshl_add_u32 v171, v171, 5, v3
    v_lshl_add_u32 v171, v171, 2, s72
    v_lshl_add_u32 v244, v2, 4, s72
    v_add_u32 v245, 155136, v1
    v_cmp_eq_u32 vcc, 0, v3
    s_mov_b32 s76, 0xffff
    s_mov_b32 s77, 0
    v_cndmask_b32 v244, v245, v244, vcc
    s_mov_b32 s78, 0xaaaaaaaa
    s_mov_b32 s79, 0xaaaaaaaa
    s_mov_b32 s80, 0xcccccccc
    s_mov_b32 s81, 0xcccccccc
    s_mov_b32 s90, 0
    s_mov_b32 s91, -1
    s_add_u32 s72, s50, s57
    s_cmp_eq_u32 s72, 0
    s_cselect_b32 s72, 256, 0
    v_add_u32 v235, s72, v169
    s_cmp_lt_u32 s50, 2
    s_cselect_b32 s5, s24, s25
    s_add_u32 m0, s30, 144896
    s_mov_b32 exec_lo, s20
    buffer_load_dwordx4 v255, s[8:11], s5 offen lds
    s_mov_b32 exec_lo, -1
    v_lshrrev_b32 v245, 3, v0
    v_and_b32 v5, 6, v245
    v_and_b32 v7, 7, v0
    v_xor_b32 v5, v5, v7
    v_mul_u32_u24 v245, 896, v245
    v_lshl_add_u32 v245, v5, 4, v245
    s_lshl_b32 s5, s54, 7
    s_mul_i32 s6, s50, 28672
    s_add_u32 s5, s5, s6
    s_cmp_lt_u32 s49, 28
    s_cselect_b32 s5, s5, 2146435072
    v_add_u32 v245, s5, v245
    s_cmp_eq_u32 s48, 7
    s_cselect_b32 s92, 3, s48
    s_lshr_b32 s3, s50, 1
    s_lshl3_add_u32 s3, s92, s3
    s_mul_i32 s3, s3, 28672
    s_lshl_b32 s92, s49, 7
    s_add_u32 s3, s3, s92
    v_lshrrev_b32 v253, 3, v0
    v_and_b32 v7, 2, v253
    v_and_b32 v5, 7, v0
    v_xor_b32 v7, v7, v5
    s_and_b32 s92, s50, 1
    s_lshl_b32 s92, s92, 2
    v_xor_b32 v7, s92, v7
    v_mul_u32_u24 v253, 3584, v253
    v_lshl_add_u32 v253, v7, 4, v253
    s_mov_b32 s94, 14336
    s_and_b32 s92, s50, 1
    s_mul_i32 s92, s92, 14336
    s_lshr_b32 s93, s50, 1
    s_lshl_b32 s93, s93, 10
    s_add_u32 s92, s92, s93
    s_add_u32 s47, s92, 91648
    v_min_u32 v222, 55, v0
    v_lshlrev_b32 v222, 7, v222
    v_lshrrev_b32 v28, 1, v2
    v_lshlrev_b32 v233, 10, v28
    v_lshrrev_b32 v28, 2, v3
    v_lshl_add_u32 v233, v28, 7, v233
    v_and_b32 v28, 1, v3
    v_lshl_add_u32 v233, v28, 4, v233
    v_bfe_u32 v28, v3, 1, 1
    v_lshl_add_u32 v233, v28, 3, v233
    v_and_b32 v28, 1, v2
    v_mad_u32_u24 v223, v28, s94, v233
    v_lshl_add_u32 v233, v28, 5, v233
    v_lshrrev_b32 v29, 3, v3
    v_lshl_add_u32 v28, v28, 1, v29
    v_xor_b32 v28, s50, v28
    v_lshl_add_u32 v223, v28, 5, v223
    v_add_u32 v223, 91648, v223
    s_add_u32 s92, s46, 61440
    v_add_u32 v233, s92, v233
    v_lshrrev_b32 v28, 3, v0
    v_and_b32 v29, 7, v0
    v_mul_u32_u24 v28, 896, v28
    v_lshl_add_u32 v232, v29, 4, v28
    s_bitcmp1_b32 0xdee01ff, s49
    s_cbranch_scc1 LclsN
    s_cmp_ge_u32 s49, 28
    s_cbranch_scc1 LclsI
    s_lshl_b32 s1, 1, s49
    s_sub_u32 s1, s1, 1
    s_and_b32 s1, s1, 0x211fe00
    s_bcnt1_i32_b32 s1, s1
    s_lshl2_add_u32 s1, s1, s50
    s_waitcnt vmcnt(11)
    ds_read_b128 a[112:115], v236 offset:32768
    ds_read_b128 a[116:119], v237 offset:32768
    ds_read_b128 a[120:123], v238 offset:32768
    ds_read_b128 a[124:127], v239 offset:32768
    s_waitcnt lgkmcnt(3)
    v_mfma_f32_4x4x4_16b_bf16 v[176:179], a[112:113], a[112:113], 0
    s_add_u32 m0, s45, 16384
    s_nop 0
    buffer_load_dwordx4 v208, s[8:11], s24 offen offset:0 lds
    v_mfma_f32_4x4x4_16b_bf16 v[180:183], a[114:115], a[114:115], 0
    v_mfma_f32_16x16x32_bf16 v[188:191], v[204:207], a[112:115], 0
    s_waitcnt lgkmcnt(2)
    v_mfma_f32_4x4x4_16b_bf16 v[176:179], a[116:117], a[116:117], v[176:179]
    buffer_load_dwordx4 v209, s[8:11], s24 offen offset:1024 lds
    v_mfma_f32_4x4x4_16b_bf16 v[180:183], a[118:119], a[118:119], v[180:183]
    v_mfma_f32_16x16x32_bf16 v[188:191], v[204:207], a[116:119], v[188:191]
    s_waitcnt lgkmcnt(1)
    v_mfma_f32_4x4x4_16b_bf16 v[176:179], a[120:121], a[120:121], v[176:179]
    buffer_load_dwordx4 v210, s[8:11], s24 offen offset:2048 lds
    v_mfma_f32_4x4x4_16b_bf16 v[180:183], a[122:123], a[122:123], v[180:183]
    v_mfma_f32_16x16x32_bf16 v[188:191], v[204:207], a[120:123], v[188:191]
    s_waitcnt lgkmcnt(0)
    v_mfma_f32_4x4x4_16b_bf16 v[176:179], a[124:125], a[124:125], v[176:179]
    buffer_load_dwordx4 v211, s[8:11], s24 offen offset:3072 lds
    v_mfma_f32_4x4x4_16b_bf16 v[180:183], a[126:127], a[126:127], v[180:183]
    v_mfma_f32_16x16x32_bf16 v[188:191], v[204:207], a[124:127], v[188:191]
    s_waitcnt vmcnt(9)
    s_barrier
    ds_read_b64_tr_b16 v[68:69], v8 offset:3072
    ds_read_b64_tr_b16 v[70:71], v8 offset:2048
    ds_read_b64_tr_b16 v[72:73], v8 offset:0
    ds_read_b64_tr_b16 v[74:75], v8 offset:4096
    ds_read_b64_tr_b16 v[76:77], v8 offset:1024
    ds_read_b64_tr_b16 v[78:79], v8 offset:5120
    s_waitcnt lgkmcnt(4)
    v_mfma_f32_32x32x16_bf16 v[16:31], v[68:71], a[112:115], 0
    v_readlane_b32 s0, v246, 32
    v_readlane_b32 s61, v247, 32
    s_getreg_b32 s5, hwreg(HW_REG_XCC_ID, 0, 4)
    s_add_u32 s0, s0, 1
    s_xor_b32 s61, s61, 0x5bd1e995
    s_add_u32 s61, s61, s5
    v_mov_b32 v246, s0
    v_mov_b32 v247, s61
    s_cmp_lt_u32 s50, 2
    s_cselect_b32 s5, s26, s27
    s_add_u32 m0, s30, 148992
    s_mov_b32 exec_lo, s20
    buffer_load_dwordx4 v255, s[8:11], s5 offen lds
    s_mov_b32 exec_lo, -1
    v_mfma_f32_16x16x32_bf16 v[196:199], v[204:207], v[68:71], 0
    ds_read_b128 a[104:107], v240 offset:0
    ds_read_b128 a[108:111], v241 offset:0
    ds_read_b64_tr_b16 v[80:81], v8 offset:3584
    ds_read_b64_tr_b16 v[82:83], v8 offset:2560
    s_waitcnt lgkmcnt(6)
    v_mfma_f32_32x32x16_bf16 v[32:47], v[72:75], a[112:115], 0
    s_mul_i32 s29, s23, 1344
    s_add_u32 m0, s46, 12288
    s_nop 0
    buffer_load_dwordx4 v212, s[12:15], s29 offen offset:0 lds
    s_waitcnt lgkmcnt(4)
    v_mfma_f32_32x32x16_bf16 v[48:63], a[112:115], v[76:79], 0
    ds_read_b128 v[192:195], v240 offset:2048
    ds_read_b128 v[200:203], v241 offset:2048
    ds_read_b64_tr_b16 v[84:85], v8 offset:512
    ds_read_b64_tr_b16 v[86:87], v8 offset:4608
    s_waitcnt lgkmcnt(4)
    v_mfma_f32_32x32x16_bf16 v[16:31], v[80:83], a[116:119], v[16:31]
    s_add_u32 m0, s46, 12288
    s_nop 0
    buffer_load_dwordx4 v213, s[12:15], s29 offen offset:1024 lds
    ds_read_b64_tr_b16 v[88:89], v8 offset:1536
    ds_read_b64_tr_b16 v[90:91], v8 offset:5632
    v_mfma_f32_16x16x32_bf16 v[196:199], v[204:207], v[80:83], v[196:199]
    ds_read_b64_tr_b16 v[92:93], v10 offset:0
    ds_read_b64_tr_b16 v[94:95], v10 offset:4096
    ds_read_b64_tr_b16 v[96:97], v8 offset:9216
    ds_read_b64_tr_b16 v[98:99], v8 offset:8192
    s_waitcnt lgkmcnt(6)
    v_mfma_f32_32x32x16_bf16 v[32:47], v[84:87], a[116:119], v[32:47]
    s_add_u32 m0, s46, 12288
    s_nop 0
    buffer_load_dwordx4 v214, s[12:15], s29 offen offset:2048 lds
    ds_read_b64_tr_b16 v[68:69], v8 offset:6144
    s_waitcnt lgkmcnt(5)
    v_mfma_f32_32x32x16_bf16 v[48:63], a[116:119], v[88:91], v[48:63]
    ds_read_b64_tr_b16 v[70:71], v8 offset:10240
    ds_read_b64_tr_b16 v[72:73], v8 offset:7168
    ds_read_b64_tr_b16 v[74:75], v8 offset:11264
    ds_read_b64_tr_b16 v[76:77], v8 offset:9728
    s_waitcnt lgkmcnt(7)
    v_mfma_f32_16x16x32_bf16 v[64:67], v[92:95], a[104:107], 0
    s_waitcnt vmcnt(9)
    ds_read_b128 a[128:131], v236 offset:0
    ds_read_b128 a[132:135], v237 offset:0
    ds_read_b128 a[136:139], v238 offset:0
    ds_read_b128 a[140:143], v239 offset:0
    s_waitcnt lgkmcnt(9)
    v_mfma_f32_32x32x16_bf16 v[16:31], v[96:99], a[120:123], v[16:31]
    s_add_u32 m0, s45, 32768
    s_nop 0
    buffer_load_dwordx4 v208, s[8:11], s25 offen offset:0 lds
    ds_read_b64_tr_b16 v[78:79], v8 offset:8704
    v_mfma_f32_16x16x32_bf16 v[196:199], v[204:207], v[96:99], v[196:199]
    buffer_load_dwordx4 v209, s[8:11], s25 offen offset:1024 lds
    s_waitcnt lgkmcnt(8)
    v_mfma_f32_32x32x16_bf16 v[32:47], v[68:71], a[120:123], v[32:47]
    ds_read_b64_tr_b16 v[80:81], v8 offset:6656
    ds_read_b64_tr_b16 v[82:83], v8 offset:10752
    ds_read_b64_tr_b16 v[84:85], v8 offset:7680
    ds_read_b64_tr_b16 v[86:87], v8 offset:11776
    s_waitcnt lgkmcnt(10)
    v_mfma_f32_32x32x16_bf16 v[48:63], a[120:123], v[72:75], v[48:63]
    buffer_load_dwordx4 v210, s[8:11], s25 offen offset:2048 lds
    ds_read_b64_tr_b16 v[88:89], v10 offset:6144
    ds_read_b64_tr_b16 v[90:91], v10 offset:10240
    s_waitcnt lgkmcnt(6)
    v_mfma_f32_32x32x16_bf16 v[16:31], v[76:79], a[124:127], v[16:31]
    buffer_load_dwordx4 v211, s[8:11], s25 offen offset:3072 lds
    ds_read_b128 v[124:127], v235 offset:640
    ds_read_b128 v[128:131], v235 offset:512
    v_mfma_f32_16x16x32_bf16 v[196:199], v[204:207], v[76:79], v[196:199]
    s_andn2_b32 s30, s30, 2048
    s_add_u32 m0, s30, 153088
    s_mov_b32 exec_lo, s20
    buffer_load_dwordx4 v255, s[8:11], s28 offen lds
    s_mov_b32 exec_lo, -1
    s_waitcnt lgkmcnt(4)
    v_mfma_f32_32x32x16_bf16 v[32:47], v[80:83], a[124:127], v[32:47]
    ds_read_b128 v[132:135], v169 offset:384
    ds_read_b128 v[136:139], v169 offset:256
    ds_read_b128 v[140:143], v169 offset:128
    ds_read_b128 v[144:147], v169 offset:0
    v_mfma_f32_32x32x16_bf16 v[48:63], a[124:127], v[84:87], v[48:63]
    s_waitcnt lgkmcnt(6)
    v_mfma_f32_16x16x32_bf16 v[64:67], v[88:91], a[108:111], v[64:67]
    s_waitcnt vmcnt(9)
    ds_read_b128 a[144:147], v236 offset:16384
    ds_read_b128 a[148:151], v237 offset:16384
    ds_read_b128 a[152:155], v238 offset:16384
    ds_read_b128 a[156:159], v239 offset:16384
    v_mfma_f32_4x4x4_16b_bf16 v[176:179], a[128:129], a[128:129], v[176:179]
    s_add_u32 m0, s45, 0
    s_nop 0
    buffer_load_dwordx4 v208, s[8:11], s26 offen offset:0 lds
    v_mfma_f32_4x4x4_16b_bf16 v[180:183], a[130:131], a[130:131], v[180:183]
    v_mfma_f32_16x16x32_bf16 v[188:191], v[204:207], a[128:131], v[188:191]
    v_mfma_f32_4x4x4_16b_bf16 v[176:179], a[132:133], a[132:133], v[176:179]
    buffer_load_dwordx4 v209, s[8:11], s26 offen offset:1024 lds
    v_mfma_f32_4x4x4_16b_bf16 v[180:183], a[134:135], a[134:135], v[180:183]
    v_mfma_f32_16x16x32_bf16 v[188:191], v[204:207], a[132:135], v[188:191]
    v_mfma_f32_4x4x4_16b_bf16 v[176:179], a[136:137], a[136:137], v[176:179]
    buffer_load_dwordx4 v210, s[8:11], s26 offen offset:2048 lds
    v_mfma_f32_4x4x4_16b_bf16 v[180:183], a[138:139], a[138:139], v[180:183]
    v_mfma_f32_16x16x32_bf16 v[188:191], v[204:207], a[136:139], v[188:191]
    v_mfma_f32_4x4x4_16b_bf16 v[176:179], a[140:141], a[140:141], v[176:179]
    buffer_load_dwordx4 v211, s[8:11], s26 offen offset:3072 lds
    v_mfma_f32_4x4x4_16b_bf16 v[180:183], a[142:143], a[142:143], v[180:183]
    v_mfma_f32_16x16x32_bf16 v[188:191], v[204:207], a[140:143], v[188:191]
    v_mfma_f32_16x16x32_bf16 v[184:187], a[104:107], a[104:107], 0
    v_mfma_f32_16x16x32_bf16 v[184:187], a[108:111], a[108:111], v[184:187]
    s_waitcnt lgkmcnt(3)
    v_mfma_f32_16x16x32_bf16 v[184:187], v[192:195], v[192:195], v[184:187]
    s_waitcnt vmcnt(9)
    s_barrier
    v_mfma_f32_16x16x32_bf16 v[184:187], v[200:203], v[200:203], v[184:187]
    s_mul_i32 s29, s24, 1344
    s_add_u32 m0, s46, 24576
    s_nop 0
    buffer_load_dwordx4 v212, s[12:15], s29 offen offset:0 lds
    v_mfma_f32_4x4x4_16b_bf16 v[176:179], a[144:145], a[144:145], v[176:179]
    ds_read_b64_tr_b16 v[92:93], v8 offset:15360
    v_mfma_f32_4x4x4_16b_bf16 v[180:183], a[146:147], a[146:147], v[180:183]
    ds_read_b64_tr_b16 v[94:95], v8 offset:14336
    v_mfma_f32_16x16x32_bf16 v[188:191], v[204:207], a[144:147], v[188:191]
    ds_read_b128 v[224:227], v240 offset:4096
    ds_read_b128 v[228:231], v241 offset:4096
    s_waitcnt lgkmcnt(5)
    v_mfma_f32_4x4x4_16b_bf16 v[176:179], a[148:149], a[148:149], v[176:179]
    s_add_u32 m0, s46, 24576
    s_nop 0
    buffer_load_dwordx4 v213, s[12:15], s29 offen offset:1024 lds
    v_mfma_f32_4x4x4_16b_bf16 v[180:183], a[150:151], a[150:151], v[180:183]
    ds_read_b64_tr_b16 v[96:97], v8 offset:12288
    v_mfma_f32_16x16x32_bf16 v[188:191], v[204:207], a[148:151], v[188:191]
    ds_read_b128 a[224:227], v240 offset:6144
    ds_read_b128 a[228:231], v241 offset:6144
    v_mfma_f32_4x4x4_16b_bf16 v[176:179], a[152:153], a[152:153], v[176:179]
    ds_read_b64_tr_b16 v[98:99], v8 offset:16384
    v_mfma_f32_4x4x4_16b_bf16 v[180:183], a[154:155], a[154:155], v[180:183]
    ds_read_b64_tr_b16 v[68:69], v8 offset:13312
    v_mfma_f32_16x16x32_bf16 v[188:191], v[204:207], a[152:155], v[188:191]
    s_add_u32 m0, s46, 24576
    s_nop 0
    buffer_load_dwordx4 v214, s[12:15], s29 offen offset:2048 lds
    s_waitcnt lgkmcnt(9)
    v_mfma_f32_4x4x4_16b_bf16 v[176:179], a[156:157], a[156:157], v[176:179]
    ds_read_b64_tr_b16 v[70:71], v8 offset:17408
    v_mfma_f32_4x4x4_16b_bf16 v[180:183], a[158:159], a[158:159], v[180:183]
    ds_read_b64_tr_b16 v[72:73], v8 offset:15872
    v_mfma_f32_16x16x32_bf16 v[188:191], v[204:207], a[156:159], v[188:191]
    ds_read_b128 a[232:235], v240 offset:8192
    ds_read_b128 a[236:239], v241 offset:8192
    s_waitcnt lgkmcnt(11)
    v_mfma_f32_32x32x16_bf16 v[16:31], v[92:95], a[128:131], v[16:31]
    ds_read_b128 a[240:243], v240 offset:10240
    ds_read_b128 a[244:247], v241 offset:10240
    ds_read_b64_tr_b16 v[74:75], v8 offset:14848
    ds_read_b64_tr_b16 v[76:77], v8 offset:12800
    v_mfma_f32_16x16x32_bf16 v[196:199], v[204:207], v[92:95], v[196:199]
    ds_read_b64_tr_b16 v[78:79], v8 offset:16896
    ds_read_b64_tr_b16 v[80:81], v8 offset:13824
    s_waitcnt lgkmcnt(11)
    v_mfma_f32_32x32x16_bf16 v[32:47], v[96:99], a[128:131], v[32:47]
    ds_read_b64_tr_b16 v[82:83], v8 offset:17920
    ds_read_b64_tr_b16 v[84:85], v10 offset:12288
    ds_read_b64_tr_b16 v[86:87], v10 offset:16384
    ds_read_b64_tr_b16 v[88:89], v8 offset:21504
    s_waitcnt lgkmcnt(13)
    v_mfma_f32_32x32x16_bf16 v[48:63], a[128:131], v[68:71], v[48:63]
    ds_read_b64_tr_b16 v[90:91], v8 offset:20480
    ds_read_b64_tr_b16 v[92:93], v8 offset:18432
    ds_read_b64_tr_b16 v[94:95], v8 offset:22528
    ds_read_b64_tr_b16 v[96:97], v8 offset:19456
    s_waitcnt lgkmcnt(11)
    v_mfma_f32_32x32x16_bf16 v[16:31], v[72:75], a[132:135], v[16:31]
    ds_read_b64_tr_b16 v[98:99], v8 offset:23552
    ds_read_b64_tr_b16 v[68:69], v8 offset:22016
    ds_read_b64_tr_b16 v[70:71], v8 offset:20992
    v_mfma_f32_16x16x32_bf16 v[196:199], v[204:207], v[72:75], v[196:199]
    ds_read_b64_tr_b16 v[72:73], v8 offset:18944
    ds_read_b64_tr_b16 v[74:75], v8 offset:23040
    s_waitcnt lgkmcnt(12)
    v_mfma_f32_32x32x16_bf16 v[32:47], v[76:79], a[132:135], v[32:47]
    ds_read_b64_tr_b16 v[76:77], v8 offset:19968
    ds_read_b64_tr_b16 v[78:79], v8 offset:24064
    v_mfma_f32_32x32x16_bf16 v[48:63], a[132:135], v[80:83], v[48:63]
    ds_read_b64_tr_b16 v[80:81], v10 offset:18432
    ds_read_b64_tr_b16 v[82:83], v10 offset:22528
    s_waitcnt lgkmcnt(12)
    v_mfma_f32_16x16x32_bf16 v[64:67], v[84:87], v[192:195], v[64:67]
    s_waitcnt vmcnt(8)
    ds_read_b128 a[160:163], v236 offset:32768
    ds_read_b128 a[164:167], v237 offset:32768
    ds_read_b128 a[168:171], v238 offset:32768
    ds_read_b128 a[172:175], v239 offset:32768
    v_mfma_f32_32x32x16_bf16 v[16:31], v[88:91], a[136:139], v[16:31]
    s_add_u32 m0, s45, 16384
    s_nop 0
    buffer_load_dwordx4 v208, s[8:11], s27 offen offset:0 lds
    v_mfma_f32_16x16x32_bf16 v[196:199], v[204:207], v[88:91], v[196:199]
    buffer_load_dwordx4 v209, s[8:11], s27 offen offset:1024 lds
    s_waitcnt lgkmcnt(12)
    v_mfma_f32_32x32x16_bf16 v[32:47], v[92:95], a[136:139], v[32:47]
    v_mfma_f32_32x32x16_bf16 v[48:63], a[136:139], v[96:99], v[48:63]
    buffer_load_dwordx4 v210, s[8:11], s27 offen offset:2048 lds
    s_waitcnt lgkmcnt(8)
    v_mfma_f32_32x32x16_bf16 v[16:31], v[68:71], a[140:143], v[16:31]
    buffer_load_dwordx4 v211, s[8:11], s27 offen offset:3072 lds
    v_mfma_f32_16x16x32_bf16 v[196:199], v[204:207], v[68:71], v[196:199]
    v_mfma_f32_32x32x16_bf16 v[32:47], v[72:75], a[140:143], v[32:47]
    s_waitcnt lgkmcnt(3)
    v_mfma_f32_32x32x16_bf16 v[48:63], a[140:143], v[76:79], v[48:63]
    v_mfma_f32_16x16x32_bf16 v[64:67], v[80:83], v[200:203], v[64:67]
    s_waitcnt vmcnt(7)
    ds_read_b128 a[176:179], v236 offset:0
    ds_read_b128 a[180:183], v237 offset:0
    ds_read_b128 a[184:187], v238 offset:0
    ds_read_b128 a[188:191], v239 offset:0
    v_mfma_f32_4x4x4_16b_bf16 v[176:179], a[160:161], a[160:161], v[176:179]
    s_waitcnt lgkmcnt(4)
    s_add_u32 m0, s45, 32768
    s_nop 0
    buffer_load_dwordx4 v208, s[8:11], s28 offen offset:0 lds
    v_mfma_f32_4x4x4_16b_bf16 v[180:183], a[162:163], a[162:163], v[180:183]
    v_mfma_f32_16x16x32_bf16 v[188:191], v[204:207], a[160:163], v[188:191]
    v_mfma_f32_4x4x4_16b_bf16 v[176:179], a[164:165], a[164:165], v[176:179]
    buffer_load_dwordx4 v209, s[8:11], s28 offen offset:1024 lds
    v_mfma_f32_4x4x4_16b_bf16 v[180:183], a[166:167], a[166:167], v[180:183]
    v_mfma_f32_16x16x32_bf16 v[188:191], v[204:207], a[164:167], v[188:191]
    v_mfma_f32_4x4x4_16b_bf16 v[176:179], a[168:169], a[168:169], v[176:179]
    buffer_load_dwordx4 v210, s[8:11], s28 offen offset:2048 lds
    v_mfma_f32_4x4x4_16b_bf16 v[180:183], a[170:171], a[170:171], v[180:183]
    v_mfma_f32_16x16x32_bf16 v[188:191], v[204:207], a[168:171], v[188:191]
    v_mfma_f32_4x4x4_16b_bf16 v[176:179], a[172:173], a[172:173], v[176:179]
    buffer_load_dwordx4 v211, s[8:11], s28 offen offset:3072 lds
    v_mfma_f32_4x4x4_16b_bf16 v[180:183], a[174:175], a[174:175], v[180:183]
    v_mfma_f32_16x16x32_bf16 v[188:191], v[204:207], a[172:175], v[188:191]
    v_mfma_f32_16x16x32_bf16 v[184:187], v[224:227], v[224:227], v[184:187]
    v_mov_b32 v156, -1
    v_mov_b32 v157, -1
    v_mov_b32 v158, -1
    v_mov_b32 v159, -1
    s_lshl_b32 s44, 1, s49
    s_sub_u32 s44, s44, 1
    s_and_b32 s44, s44, 0xf211fe00
    s_bcnt1_i32_b32 s44, s44
    s_lshl2_add_u32 s44, s44, s50
    s_mul_i32 s44, s44, 9216
    s_lshl_b32 s5, s48, 21
    s_add_u32 s44, s44, s5
    buffer_store_dwordx4 v[156:159], v1, s[36:39], s44 offen offset:0
    v_mfma_f32_16x16x32_bf16 v[184:187], v[228:231], v[228:231], v[184:187]
    s_waitcnt lgkmcnt(3)
    v_mfma_f32_16x16x32_bf16 v[184:187], a[224:227], a[224:227], v[184:187]
    s_waitcnt vmcnt(9)
    s_barrier
    buffer_store_dwordx4 v[156:159], v1, s[36:39], s44 offen offset:1024
    v_mfma_f32_16x16x32_bf16 v[184:187], a[228:231], a[228:231], v[184:187]
    ds_read_b128 a[248:251], v240 offset:12288
    ds_read_b128 a[252:255], v241 offset:12288
    v_mfma_f32_4x4x4_16b_bf16 v[176:179], a[176:177], a[176:177], v[176:179]
    buffer_store_dwordx4 v[156:159], v1, s[36:39], s44 offen offset:2048
    v_mfma_f32_4x4x4_16b_bf16 v[180:183], a[178:179], a[178:179], v[180:183]
    ds_read_b64_tr_b16 v[84:85], v8 offset:27648
    v_mfma_f32_16x16x32_bf16 v[188:191], v[204:207], a[176:179], v[188:191]
    ds_read_b64_tr_b16 v[86:87], v8 offset:26624
    ds_read_b64_tr_b16 v[88:89], v8 offset:24576
    s_waitcnt lgkmcnt(6)
    v_mfma_f32_4x4x4_16b_bf16 v[176:179], a[180:181], a[180:181], v[176:179]
    buffer_store_dwordx4 v[156:159], v1, s[36:39], s44 offen offset:3072
    v_mfma_f32_4x4x4_16b_bf16 v[180:183], a[182:183], a[182:183], v[180:183]
    ds_read_b64_tr_b16 v[90:91], v8 offset:28672
    v_mfma_f32_16x16x32_bf16 v[188:191], v[204:207], a[180:183], v[188:191]
    ds_read_b64_tr_b16 v[92:93], v8 offset:25600
    ds_read_b64_tr_b16 v[94:95], v8 offset:29696
    v_mfma_f32_4x4x4_16b_bf16 v[176:179], a[184:185], a[184:185], v[176:179]
    s_add_u32 s44, s44, 4096
    buffer_store_dwordx4 v[156:159], v1, s[36:39], s44 offen offset:0
    v_mfma_f32_4x4x4_16b_bf16 v[180:183], a[186:187], a[186:187], v[180:183]
    v_mfma_f32_16x16x32_bf16 v[188:191], v[204:207], a[184:187], v[188:191]
    ds_read_b64_tr_b16 v[96:97], v8 offset:28160
    ds_read_b64_tr_b16 v[98:99], v8 offset:27136
    s_waitcnt lgkmcnt(10)
    v_mfma_f32_4x4x4_16b_bf16 v[176:179], a[188:189], a[188:189], v[176:179]
    buffer_store_dwordx4 v[156:159], v1, s[36:39], s44 offen offset:1024
    v_mfma_f32_4x4x4_16b_bf16 v[180:183], a[190:191], a[190:191], v[180:183]
    v_mfma_f32_16x16x32_bf16 v[188:191], v[204:207], a[188:191], v[188:191]
    ds_read_b64_tr_b16 v[68:69], v8 offset:25088
    ds_read_b64_tr_b16 v[70:71], v8 offset:29184
    s_waitcnt lgkmcnt(8)
    v_mfma_f32_32x32x16_bf16 v[16:31], v[84:87], a[144:147], v[16:31]
    buffer_store_dwordx4 v[156:159], v1, s[36:39], s44 offen offset:2048
    ds_read_b64_tr_b16 v[72:73], v8 offset:26112
    ds_read_b64_tr_b16 v[74:75], v8 offset:30208
    v_mfma_f32_16x16x32_bf16 v[196:199], v[204:207], v[84:87], v[196:199]
    buffer_store_dwordx4 v[156:159], v1, s[36:39], s44 offen offset:3072
    s_waitcnt lgkmcnt(6)
    v_mfma_f32_32x32x16_bf16 v[32:47], v[88:91], a[144:147], v[32:47]
    ds_read_b64_tr_b16 v[76:77], v10 offset:24576
    ds_read_b64_tr_b16 v[78:79], v10 offset:28672
    ds_read_b64_tr_b16 v[80:81], v8 offset:33792
    ds_read_b64_tr_b16 v[82:83], v8 offset:32768
    v_mfma_f32_32x32x16_bf16 v[48:63], a[144:147], v[92:95], v[48:63]
    s_add_u32 s44, s44, 4096
    buffer_store_dwordx4 v[156:159], v1, s[36:39], s44 offen offset:0
    ds_read_b64_tr_b16 v[84:85], v8 offset:30720
    ds_read_b64_tr_b16 v[86:87], v8 offset:34816
    s_waitcnt lgkmcnt(8)
    v_mfma_f32_32x32x16_bf16 v[16:31], v[96:99], a[148:151], v[16:31]
    ds_read_b64_tr_b16 v[88:89], v8 offset:31744
    ds_read_b64_tr_b16 v[90:91], v8 offset:35840
    ds_read_b64_tr_b16 v[92:93], v8 offset:34304
    ds_read_b64_tr_b16 v[94:95], v8 offset:33280
    v_mfma_f32_16x16x32_bf16 v[196:199], v[204:207], v[96:99], v[196:199]
    s_mul_i32 s29, s25, 1344
    s_add_u32 m0, s46, 36864
    s_nop 0
    buffer_load_dwordx4 v212, s[12:15], s29 offen offset:0 lds
    v_mfma_f32_32x32x16_bf16 v[32:47], v[68:71], a[148:151], v[32:47]
    ds_read_b64_tr_b16 v[96:97], v8 offset:31232
    ds_read_b64_tr_b16 v[98:99], v8 offset:35328
    ds_read_b64_tr_b16 v[68:69], v8 offset:32256
    ds_read_b64_tr_b16 v[70:71], v8 offset:36352
    s_waitcnt lgkmcnt(10)
    v_mfma_f32_32x32x16_bf16 v[48:63], a[148:151], v[72:75], v[48:63]
    s_add_u32 m0, s46, 36864
    s_nop 0
    buffer_load_dwordx4 v213, s[12:15], s29 offen offset:1024 lds
    ds_read_b64_tr_b16 v[72:73], v10 offset:30720
    v_mfma_f32_16x16x32_bf16 v[64:67], v[76:79], v[224:227], v[64:67]
    s_waitcnt vmcnt(15)
    ds_read_b128 a[192:195], v236 offset:16384
    ds_read_b128 a[196:199], v237 offset:16384
    ds_read_b128 a[200:203], v238 offset:16384
    ds_read_b128 a[204:207], v239 offset:16384
    v_mfma_f32_32x32x16_bf16 v[16:31], v[80:83], a[152:155], v[16:31]
    s_add_u32 m0, s46, 36864
    s_nop 0
    buffer_load_dwordx4 v214, s[12:15], s29 offen offset:2048 lds
    ds_read_b64_tr_b16 v[74:75], v10 offset:34816
    v_mfma_f32_16x16x32_bf16 v[196:199], v[204:207], v[80:83], v[196:199]
    s_waitcnt lgkmcnt(12)
    v_mfma_f32_32x32x16_bf16 v[32:47], v[84:87], a[152:155], v[32:47]
    s_mul_i32 s29, s26, 1344
    s_add_u32 m0, s46, 49152
    s_nop 0
    buffer_load_dwordx4 v212, s[12:15], s29 offen offset:0 lds
    v_mfma_f32_32x32x16_bf16 v[48:63], a[152:155], v[88:91], v[48:63]
    s_waitcnt lgkmcnt(8)
    v_mfma_f32_32x32x16_bf16 v[16:31], v[92:95], a[156:159], v[16:31]
    s_add_u32 m0, s46, 49152
    s_nop 0
    buffer_load_dwordx4 v213, s[12:15], s29 offen offset:1024 lds
    v_mfma_f32_16x16x32_bf16 v[196:199], v[204:207], v[92:95], v[196:199]
    v_mfma_f32_32x32x16_bf16 v[32:47], v[96:99], a[156:159], v[32:47]
    s_add_u32 m0, s46, 49152
    s_nop 0
    buffer_load_dwordx4 v214, s[12:15], s29 offen offset:2048 lds
    s_waitcnt lgkmcnt(0)
    v_mfma_f32_32x32x16_bf16 v[48:63], a[156:159], v[68:71], v[48:63]
    v_mfma_f32_16x16x32_bf16 v[64:67], v[72:75], v[228:231], v[64:67]
    s_waitcnt vmcnt(15)
    ds_read_b128 a[208:211], v236 offset:32768
    ds_read_b128 a[212:215], v237 offset:32768
    ds_read_b128 a[216:219], v238 offset:32768
    ds_read_b128 a[220:223], v239 offset:32768
    v_mfma_f32_4x4x4_16b_bf16 v[176:179], a[192:193], a[192:193], v[176:179]
    s_mul_i32 s29, s27, 1344
    s_add_u32 m0, s46, 61440
    s_nop 0
    buffer_load_dwordx4 v212, s[12:15], s29 offen offset:0 lds
    v_mfma_f32_4x4x4_16b_bf16 v[180:183], a[194:195], a[194:195], v[180:183]
    v_mfma_f32_16x16x32_bf16 v[188:191], v[204:207], a[192:195], v[188:191]
    v_mfma_f32_4x4x4_16b_bf16 v[176:179], a[196:197], a[196:197], v[176:179]
    v_mfma_f32_4x4x4_16b_bf16 v[180:183], a[198:199], a[198:199], v[180:183]
    v_mfma_f32_16x16x32_bf16 v[188:191], v[204:207], a[196:199], v[188:191]
    s_add_u32 m0, s46, 61440
    s_nop 0
    buffer_load_dwordx4 v213, s[12:15], s29 offen offset:1024 lds
    v_mfma_f32_4x4x4_16b_bf16 v[176:179], a[200:201], a[200:201], v[176:179]
    v_mfma_f32_4x4x4_16b_bf16 v[180:183], a[202:203], a[202:203], v[180:183]
    v_mfma_f32_16x16x32_bf16 v[188:191], v[204:207], a[200:203], v[188:191]
    v_mfma_f32_4x4x4_16b_bf16 v[176:179], a[204:205], a[204:205], v[176:179]
    s_add_u32 m0, s46, 61440
    s_nop 0
    buffer_load_dwordx4 v214, s[12:15], s29 offen offset:2048 lds
    v_mfma_f32_4x4x4_16b_bf16 v[180:183], a[206:207], a[206:207], v[180:183]
    v_mfma_f32_16x16x32_bf16 v[188:191], v[204:207], a[204:207], v[188:191]
    v_mfma_f32_16x16x32_bf16 v[184:187], a[232:235], a[232:235], v[184:187]
    v_mfma_f32_16x16x32_bf16 v[184:187], a[236:239], a[236:239], v[184:187]
    v_mfma_f32_16x16x32_bf16 v[184:187], a[240:243], a[240:243], v[184:187]
    v_mfma_f32_16x16x32_bf16 v[184:187], a[244:247], a[244:247], v[184:187]
    v_mfma_f32_16x16x32_bf16 v[184:187], a[248:251], a[248:251], v[184:187]
    s_waitcnt vmcnt(6) lgkmcnt(0)
    s_barrier
    v_mfma_f32_16x16x32_bf16 v[184:187], a[252:255], a[252:255], v[184:187]
    s_lshl_b32 s5, s49, 3
    s_add_u32 s5, s5, s58
    s_add_u32 s5, s5, 16384
    s_cmp_eq_u32 s50, 0
    s_cselect_b32 s5, s5, 2146435072
    buffer_store_dwordx2 v[246:247], off, s[36:39], s5
    v_mfma_f32_4x4x4_16b_bf16 v[176:179], a[208:209], a[208:209], v[176:179]
    ds_read_b64_tr_b16 v[76:77], v8 offset:39936
    v_mfma_f32_4x4x4_16b_bf16 v[180:183], a[210:211], a[210:211], v[180:183]
    ds_read_b64_tr_b16 v[78:79], v8 offset:38912
    v_mfma_f32_16x16x32_bf16 v[188:191], v[204:207], a[208:211], v[188:191]
    ds_read_b64_tr_b16 v[80:81], v8 offset:36864
    ds_read_b64_tr_b16 v[82:83], v8 offset:40960
    v_mfma_f32_4x4x4_16b_bf16 v[176:179], a[212:213], a[212:213], v[176:179]
    s_mul_i32 s29, s28, 1344
    s_add_u32 m0, s46, 73728
    s_nop 0
    buffer_load_dwordx4 v212, s[12:15], s29 offen offset:0 lds
    v_mfma_f32_4x4x4_16b_bf16 v[180:183], a[214:215], a[214:215], v[180:183]
    v_mfma_f32_16x16x32_bf16 v[188:191], v[204:207], a[212:215], v[188:191]
    ds_read_b64_tr_b16 v[84:85], v8 offset:37888
    ds_read_b64_tr_b16 v[86:87], v8 offset:41984
    v_mfma_f32_4x4x4_16b_bf16 v[176:179], a[216:217], a[216:217], v[176:179]
    v_mfma_f32_4x4x4_16b_bf16 v[180:183], a[218:219], a[218:219], v[180:183]
    v_mfma_f32_16x16x32_bf16 v[188:191], v[204:207], a[216:219], v[188:191]
    s_add_u32 m0, s46, 73728
    s_nop 0
    buffer_load_dwordx4 v213, s[12:15], s29 offen offset:1024 lds
    v_mfma_f32_4x4x4_16b_bf16 v[176:179], a[220:221], a[220:221], v[176:179]
    ds_read_b64_tr_b16 v[88:89], v8 offset:40448
    v_mfma_f32_4x4x4_16b_bf16 v[180:183], a[222:223], a[222:223], v[180:183]
    ds_read_b64_tr_b16 v[90:91], v8 offset:39424
    v_mfma_f32_16x16x32_bf16 v[188:191], v[204:207], a[220:223], v[188:191]
    ds_read_b64_tr_b16 v[92:93], v8 offset:37376
    ds_read_b64_tr_b16 v[94:95], v8 offset:41472
    s_waitcnt lgkmcnt(6)
    v_mfma_f32_32x32x16_bf16 v[16:31], v[76:79], a[160:163], v[16:31]
    s_add_u32 m0, s46, 73728
    s_nop 0
    buffer_load_dwordx4 v214, s[12:15], s29 offen offset:2048 lds
    ds_read_b64_tr_b16 v[96:97], v8 offset:38400
    v_mfma_f32_16x16x32_bf16 v[196:199], v[204:207], v[76:79], v[196:199]
    ds_read_b64_tr_b16 v[98:99], v8 offset:42496
    ds_read_b64_tr_b16 v[68:69], v10 offset:36864
    v_mfma_f32_32x32x16_bf16 v[32:47], v[80:83], a[160:163], v[32:47]
    ds_read_b64_tr_b16 v[70:71], v10 offset:40960
    ds_read_b64_tr_b16 v[72:73], v9 offset:3072
    ds_read_b64_tr_b16 v[74:75], v9 offset:2048
    ds_read_b64_tr_b16 v[76:77], v9 offset:0
    v_cndmask_b32 v176, v176, v177, s[78:79]
    s_waitcnt lgkmcnt(11)
    v_mfma_f32_32x32x16_bf16 v[48:63], a[160:163], v[84:87], v[48:63]
    s_add_u32 m0, s47, 0
    s_nop 0
    buffer_load_dwordx4 v253, s[40:43], s3 offen lds
    ds_read_b64_tr_b16 v[78:79], v9 offset:4096
    s_waitcnt lgkmcnt(8)
    v_mfma_f32_32x32x16_bf16 v[16:31], v[88:91], a[164:167], v[16:31]
    ds_read_b64_tr_b16 v[80:81], v9 offset:1024
    ds_read_b64_tr_b16 v[82:83], v9 offset:5120
    ds_read_b64_tr_b16 v[84:85], v9 offset:3584
    ds_read_b64_tr_b16 v[86:87], v9 offset:2560
    v_mfma_f32_16x16x32_bf16 v[196:199], v[204:207], v[88:91], v[196:199]
    s_add_u32 m0, s47, 2048
    s_add_u32 s3, s3, 57344
    buffer_load_dwordx4 v253, s[40:43], s3 offen lds
    v_mfma_f32_32x32x16_bf16 v[32:47], v[92:95], a[164:167], v[32:47]
    ds_read_b64_tr_b16 v[88:89], v9 offset:512
    ds_read_b64_tr_b16 v[90:91], v9 offset:4608
    ds_read_b64_tr_b16 v[92:93], v9 offset:1536
    ds_read_b64_tr_b16 v[94:95], v9 offset:5632
    v_cndmask_b32 v178, v178, v179, s[78:79]
    s_waitcnt lgkmcnt(10)
    v_mfma_f32_32x32x16_bf16 v[48:63], a[164:167], v[96:99], v[48:63]
    ds_read_b64_tr_b16 v[96:97], v11 offset:0
    ds_read_b64_tr_b16 v[98:99], v11 offset:4096
    v_cndmask_b32 v180, v180, v181, s[78:79]
    v_cndmask_b32 v182, v182, v183, s[78:79]
    v_cndmask_b32 v101, 0, v184, s[62:63]
    v_mfma_f32_16x16x32_bf16 v[64:67], v[68:71], a[224:227], v[64:67]
    s_add_u32 m0, s47, 4096
    s_add_u32 s3, s3, 57344
    buffer_load_dwordx4 v253, s[40:43], s3 offen lds
    v_mfma_f32_32x32x16_bf16 v[16:31], v[72:75], a[168:171], v[16:31]
    v_cndmask_b32 v101, v101, v185, s[64:65]
    v_cndmask_b32 v101, v101, v186, s[66:67]
    v_cndmask_b32 v101, v101, v187, s[68:69]
    v_add_f32 v176, v176, v180
    v_add_f32 v178, v178, v182
    v_cndmask_b32 v102, 0, v184, s[76:77]
    v_cndmask_b32 v100, v176, v178, s[80:81]
    v_mfma_f32_16x16x32_bf16 v[196:199], v[204:207], v[72:75], v[196:199]
    v_mov_b32 v104, v101
    v_mov_b32 v105, v102
    v_mov_b32 v106, v100
    s_waitcnt lgkmcnt(8)
    v_mfma_f32_32x32x16_bf16 v[32:47], v[76:79], a[168:171], v[32:47]
    s_waitcnt vmcnt(10)
    s_barrier
    s_add_u32 m0, s47, 6144
    s_add_u32 s3, s3, 57344
    buffer_load_dwordx4 v253, s[40:43], s3 offen lds
    v_mfma_f32_32x32x16_bf16 v[48:63], a[168:171], v[80:83], v[48:63]
    ds_read_b64_tr_b16 v[68:69], v9 offset:9216
    ds_read_b64_tr_b16 v[70:71], v9 offset:8192
    ds_read_b64_tr_b16 v[72:73], v9 offset:6144
    ds_read_b64_tr_b16 v[74:75], v9 offset:10240
    v_permlane32_swap_b32 v101, v104
    s_waitcnt lgkmcnt(8)
    v_mfma_f32_32x32x16_bf16 v[16:31], v[84:87], a[172:175], v[16:31]
    s_add_u32 m0, s47, 8192
    s_add_u32 s3, s3, 57344
    s_sub_u32 s6, s3, 1605632
    s_cselect_b32 s3, s3, s6
    buffer_load_dwordx4 v253, s[40:43], s3 offen lds
    v_mfma_f32_16x16x32_bf16 v[196:199], v[204:207], v[84:87], v[196:199]
    ds_read_b64_tr_b16 v[76:77], v9 offset:7168
    ds_read_b64_tr_b16 v[78:79], v9 offset:11264
    v_mfma_f32_32x32x16_bf16 v[32:47], v[88:91], a[172:175], v[32:47]
    ds_read_b64_tr_b16 v[80:81], v9 offset:9728
    ds_read_b64_tr_b16 v[82:83], v9 offset:8704
    ds_read_b64_tr_b16 v[84:85], v9 offset:6656
    ds_read_b64_tr_b16 v[86:87], v9 offset:10752
    v_permlane32_swap_b32 v102, v105
    s_waitcnt lgkmcnt(8)
    v_mfma_f32_32x32x16_bf16 v[48:63], a[172:175], v[92:95], v[48:63]
    s_add_u32 m0, s47, 10240
    s_add_u32 s3, s3, 57344
    buffer_load_dwordx4 v253, s[40:43], s3 offen lds
    v_permlane32_swap_b32 v100, v106
    v_mfma_f32_16x16x32_bf16 v[64:67], v[96:99], a[228:231], v[64:67]
    ds_read_b64_tr_b16 v[88:89], v9 offset:7680
    ds_read_b64_tr_b16 v[90:91], v9 offset:11776
    v_mfma_f32_32x32x16_bf16 v[16:31], v[68:71], a[176:179], v[16:31]
    ds_read_b64_tr_b16 v[92:93], v11 offset:6144
    ds_read_b64_tr_b16 v[94:95], v11 offset:10240
    ds_read_b64_tr_b16 v[96:97], v9 offset:15360
    ds_read_b64_tr_b16 v[98:99], v9 offset:14336
    v_add_f32 v101, v101, v104
    v_mfma_f32_16x16x32_bf16 v[196:199], v[204:207], v[68:71], v[196:199]
    s_add_u32 m0, s47, 12288
    s_add_u32 s3, s3, 57344
    buffer_load_dwordx4 v253, s[40:43], s3 offen lds
    s_waitcnt lgkmcnt(10)
    v_mfma_f32_32x32x16_bf16 v[32:47], v[72:75], a[176:179], v[32:47]
    ds_read_b64_tr_b16 v[68:69], v9 offset:12288
    ds_read_b64_tr_b16 v[70:71], v9 offset:16384
    ds_read_b64_tr_b16 v[72:73], v9 offset:13312
    ds_read_b64_tr_b16 v[74:75], v9 offset:17408
    v_mfma_f32_32x32x16_bf16 v[48:63], a[176:179], v[76:79], v[48:63]
    ds_read_b64_tr_b16 v[76:77], v9 offset:15872
    ds_read_b64_tr_b16 v[78:79], v9 offset:14848
    v_add_f32 v102, v102, v105
    v_add_f32 v100, v100, v106
    v_mov_b32 v104, v101
    v_mov_b32 v105, v102
    s_waitcnt lgkmcnt(12)
    v_mfma_f32_32x32x16_bf16 v[16:31], v[80:83], a[180:183], v[16:31]
    s_add_u32 m0, s47, 28672
    s_add_u32 s3, s3, 57344
    buffer_load_dwordx4 v253, s[40:43], s3 offen lds
    v_permlane16_swap_b32 v101, v104
    v_mfma_f32_16x16x32_bf16 v[196:199], v[204:207], v[80:83], v[196:199]
    ds_read_b64_tr_b16 v[80:81], v9 offset:12800
    ds_read_b64_tr_b16 v[82:83], v9 offset:16896
    v_mfma_f32_32x32x16_bf16 v[32:47], v[84:87], a[180:183], v[32:47]
    ds_read_b64_tr_b16 v[84:85], v9 offset:13824
    ds_read_b64_tr_b16 v[86:87], v9 offset:17920
    v_permlane16_swap_b32 v102, v105
    v_add_f32 v101, v101, v104
    v_add_f32 v102, v102, v105
    v_mul_f32 v148, 0xbb124925, v188
    s_waitcnt lgkmcnt(10)
    v_mfma_f32_32x32x16_bf16 v[48:63], a[180:183], v[88:91], v[48:63]
    s_add_u32 m0, s47, 30720
    s_add_u32 s3, s3, 57344
    s_sub_u32 s6, s3, 1605632
    s_cselect_b32 s3, s3, s6
    buffer_load_dwordx4 v253, s[40:43], s3 offen lds
    v_mfma_f32_16x16x32_bf16 v[64:67], v[92:95], a[232:235], v[64:67]
    ds_read_b64_tr_b16 v[88:89], v11 offset:12288
    ds_read_b64_tr_b16 v[90:91], v11 offset:16384
    v_mfma_f32_32x32x16_bf16 v[16:31], v[96:99], a[184:187], v[16:31]
    v_mul_f32 v152, 0xbb124925, v102
    v_mul_f32 v104, 0x3b124925, v100
    v_mul_f32 v105, 0x3b124925, v101
    v_fma_f32 v104, -v148, v148, v104
    v_fma_f32 v105, -v152, v152, v105
    v_max_f32 v104, 0, v104
    v_max_f32 v105, 0, v105
    v_mfma_f32_16x16x32_bf16 v[196:199], v[204:207], v[96:99], v[196:199]
    s_add_u32 m0, s47, 32768
    s_add_u32 s3, s3, 57344
    buffer_load_dwordx4 v253, s[40:43], s3 offen lds
    s_waitcnt lgkmcnt(8)
    v_mfma_f32_32x32x16_bf16 v[32:47], v[68:71], a[184:187], v[32:47]
    s_waitcnt vmcnt(14)
    s_barrier
    ds_read_b64_tr_b16 v[92:93], v9 offset:21504
    ds_read_b64_tr_b16 v[94:95], v9 offset:20480
    v_cvt_pk_bf16_f32 v148, v148, v148
    v_mfma_f32_32x32x16_bf16 v[48:63], a[184:187], v[72:75], v[48:63]
    ds_read_b64_tr_b16 v[96:97], v9 offset:18432
    ds_read_b64_tr_b16 v[98:99], v9 offset:22528
    ds_read_b64_tr_b16 v[68:69], v9 offset:19456
    ds_read_b64_tr_b16 v[70:71], v9 offset:23552
    v_cvt_pk_bf16_f32 v152, v152, v152
    s_waitcnt lgkmcnt(10)
    v_mfma_f32_32x32x16_bf16 v[16:31], v[76:79], a[188:191], v[16:31]
    s_add_u32 m0, s47, 34816
    s_add_u32 s3, s3, 57344
    buffer_load_dwordx4 v253, s[40:43], s3 offen lds
    v_cvt_pk_bf16_f32 v104, v104, v104
    v_mfma_f32_16x16x32_bf16 v[196:199], v[204:207], v[76:79], v[196:199]
    ds_read_b64_tr_b16 v[72:73], v9 offset:22016
    ds_read_b64_tr_b16 v[74:75], v9 offset:20992
    v_mfma_f32_32x32x16_bf16 v[32:47], v[80:83], a[188:191], v[32:47]
    ds_read_b64_tr_b16 v[76:77], v9 offset:18944
    ds_read_b64_tr_b16 v[78:79], v9 offset:23040
    ds_read_b64_tr_b16 v[80:81], v9 offset:19968
    ds_read_b64_tr_b16 v[82:83], v9 offset:24064
    v_cvt_pk_bf16_f32 v105, v105, v105
    s_waitcnt lgkmcnt(10)
    v_mfma_f32_32x32x16_bf16 v[48:63], a[188:191], v[84:87], v[48:63]
    s_add_u32 m0, s47, 36864
    s_add_u32 s3, s3, 57344
    buffer_load_dwordx4 v253, s[40:43], s3 offen lds
    v_lshlrev_b32 v104, 16, v104
    v_mfma_f32_16x16x32_bf16 v[64:67], v[88:91], a[236:239], v[64:67]
    ds_read_b64_tr_b16 v[84:85], v11 offset:18432
    ds_read_b64_tr_b16 v[86:87], v11 offset:22528
    v_mfma_f32_32x32x16_bf16 v[16:31], v[92:95], a[192:195], v[16:31]
    ds_read_b64_tr_b16 v[88:89], v9 offset:27648
    ds_read_b64_tr_b16 v[90:91], v9 offset:26624
    v_lshlrev_b32 v105, 16, v105
    v_add_f32 v104, 0x3727c5ac, v104
    v_add_f32 v105, 0x3727c5ac, v105
    v_cvt_pk_bf16_f32 v104, v104, v104
    v_mfma_f32_16x16x32_bf16 v[196:199], v[204:207], v[92:95], v[196:199]
    s_add_u32 m0, s47, 38912
    s_add_u32 s3, s3, 57344
    s_sub_u32 s6, s3, 1605632
    s_cselect_b32 s3, s3, s6
    buffer_load_dwordx4 v253, s[40:43], s3 offen lds
    s_waitcnt lgkmcnt(10)
    v_mfma_f32_32x32x16_bf16 v[32:47], v[96:99], a[192:195], v[32:47]
    ds_read_b64_tr_b16 v[92:93], v9 offset:24576
    ds_read_b64_tr_b16 v[94:95], v9 offset:28672
    ds_read_b64_tr_b16 v[96:97], v9 offset:25600
    ds_read_b64_tr_b16 v[98:99], v9 offset:29696
    v_mfma_f32_32x32x16_bf16 v[48:63], a[192:195], v[68:71], v[48:63]
    ds_read_b64_tr_b16 v[68:69], v9 offset:28160
    ds_read_b64_tr_b16 v[70:71], v9 offset:27136
    v_cvt_pk_bf16_f32 v105, v105, v105
    v_lshlrev_b32 v104, 16, v104
    v_lshlrev_b32 v105, 16, v105
    s_waitcnt lgkmcnt(12)
    v_mfma_f32_32x32x16_bf16 v[16:31], v[72:75], a[196:199], v[16:31]
    s_add_u32 m0, s47, 40960
    s_add_u32 s3, s3, 57344
    buffer_load_dwordx4 v253, s[40:43], s3 offen lds
    v_mfma_f32_16x16x32_bf16 v[196:199], v[204:207], v[72:75], v[196:199]
    ds_read_b64_tr_b16 v[72:73], v9 offset:25088
    ds_read_b64_tr_b16 v[74:75], v9 offset:29184
    v_mfma_f32_32x32x16_bf16 v[32:47], v[76:79], a[196:199], v[32:47]
    ds_read_b64_tr_b16 v[76:77], v9 offset:26112
    ds_read_b64_tr_b16 v[78:79], v9 offset:30208
    v_sqrt_f32 v104, v104
    v_sqrt_f32 v105, v105
    s_waitcnt lgkmcnt(10)
    v_mfma_f32_32x32x16_bf16 v[48:63], a[196:199], v[80:83], v[48:63]
    ds_read_b64_tr_b16 v[80:81], v11 offset:24576
    ds_read_b64_tr_b16 v[82:83], v11 offset:28672
    v_cvt_pk_bf16_f32 v104, v104, v104
    v_cvt_pk_bf16_f32 v105, v105, v105
    v_lshlrev_b32 v104, 16, v104
    v_mfma_f32_16x16x32_bf16 v[64:67], v[84:87], a[240:243], v[64:67]
    v_lshlrev_b32 v105, 16, v105
    v_rcp_f32 v168, v104
    v_mfma_f32_32x32x16_bf16 v[16:31], v[88:91], a[200:203], v[16:31]
    v_rcp_f32 v101, v105
    ds_write_b32 v242, v168 offset:1024
    ds_write_b32 v243, v101 offset:1024
    v_cndmask_b32 v152, v152, 0, s[90:91]
    v_mul_f32 v168, 0x3e8b97f6, v168
    v_mfma_f32_16x16x32_bf16 v[196:199], v[204:207], v[88:91], v[196:199]
    s_waitcnt lgkmcnt(10)
    v_mfma_f32_32x32x16_bf16 v[32:47], v[92:95], a[200:203], v[32:47]
    s_waitcnt vmcnt(0) lgkmcnt(0)
    s_barrier
    ds_read_b64_tr_b16 v[84:85], v11 offset:30720
    ds_read_b64_tr_b16 v[86:87], v11 offset:34816
    v_mfma_f32_32x32x16_bf16 v[48:63], a[200:203], v[96:99], v[48:63]
    ds_read_b64_tr_b16 v[88:89], v11 offset:36864
    ds_read_b64_tr_b16 v[90:91], v11 offset:40960
    ds_read_b64_tr_b16 v[92:93], v9 offset:33792
    ds_read_b64_tr_b16 v[94:95], v9 offset:32768
    ds_read_b64_tr_b16 a[0:1], v223 offset:0
    ds_read_b64_tr_b16 a[2:3], v223 offset:512
    v_mfma_f32_32x32x16_bf16 v[16:31], v[68:71], a[204:207], v[16:31]
    ds_read_b64_tr_b16 v[96:97], v9 offset:34304
    ds_read_b64_tr_b16 v[98:99], v9 offset:33280
    ds_read_b64_tr_b16 a[4:5], v223 offset:2048
    ds_read_b64_tr_b16 a[6:7], v223 offset:2560
    v_mfma_f32_16x16x32_bf16 v[196:199], v[204:207], v[68:71], v[196:199]
    ds_read_b64_tr_b16 v[68:69], v9 offset:39936
    ds_read_b64_tr_b16 v[70:71], v9 offset:38912
    ds_read_b64_tr_b16 a[8:9], v223 offset:4096
    ds_read_b64_tr_b16 a[10:11], v223 offset:4608
    v_mfma_f32_32x32x16_bf16 v[32:47], v[72:75], a[204:207], v[32:47]
    ds_read_b64_tr_b16 v[72:73], v9 offset:40448
    ds_read_b64_tr_b16 v[74:75], v9 offset:39424
    ds_read_b64_tr_b16 a[12:13], v223 offset:6144
    ds_read_b64_tr_b16 a[14:15], v223 offset:6656
    s_waitcnt lgkmcnt(15)
    v_mfma_f32_32x32x16_bf16 v[48:63], a[204:207], v[76:79], v[48:63]
    ds_read_b64_tr_b16 v[76:77], v9 offset:30720
    ds_read_b64_tr_b16 v[78:79], v9 offset:34816
    ds_read_b64_tr_b16 a[16:17], v223 offset:8192
    ds_read_b64_tr_b16 a[18:19], v223 offset:8704
    v_mfma_f32_16x16x32_bf16 v[64:67], v[80:83], a[244:247], v[64:67]
    ds_read_b64_tr_b16 v[80:81], v9 offset:31744
    ds_read_b64_tr_b16 v[82:83], v9 offset:35840
    ds_read_b64_tr_b16 a[20:21], v223 offset:10240
    ds_read_b64_tr_b16 a[22:23], v223 offset:10752
    v_mfma_f32_16x16x32_bf16 v[64:67], v[84:87], a[248:251], v[64:67]
    ds_read_b64_tr_b16 v[84:85], v9 offset:31232
    ds_read_b64_tr_b16 v[86:87], v9 offset:35328
    ds_read_b64_tr_b16 a[24:25], v223 offset:12288
    ds_read_b64_tr_b16 a[26:27], v223 offset:12800
    s_waitcnt lgkmcnt(15)
    v_mfma_f32_16x16x32_bf16 v[64:67], v[88:91], a[252:255], v[64:67]
    ds_read_b64_tr_b16 v[88:89], v9 offset:32256
    ds_read_b64_tr_b16 a[28:29], v223 offset:28672
    ds_read_b64_tr_b16 a[30:31], v223 offset:29184
    v_mfma_f32_32x32x16_bf16 v[16:31], v[92:95], a[208:211], v[16:31]
    ds_read_b64_tr_b16 v[90:91], v9 offset:36352
    ds_read_b64_tr_b16 a[32:33], v223 offset:30720
    ds_read_b64_tr_b16 a[34:35], v223 offset:31232
    ds_read_b32 v160, v164 offset:1024
    v_mfma_f32_16x16x32_bf16 v[196:199], v[204:207], v[92:95], v[196:199]
    ds_read_b64_tr_b16 v[92:93], v9 offset:36864
    ds_read_b64_tr_b16 v[94:95], v9 offset:40960
    ds_read_b64_tr_b16 a[36:37], v223 offset:32768
    ds_read_b64_tr_b16 a[38:39], v223 offset:33280
    v_mfma_f32_32x32x16_bf16 v[16:31], v[96:99], a[212:215], v[16:31]
    ds_read_b64_tr_b16 a[40:41], v223 offset:34816
    ds_read_b64_tr_b16 a[42:43], v223 offset:35328
    ds_read_b32 v161, v165 offset:1024
    ds_read_b32 v162, v166 offset:1024
    v_mfma_f32_16x16x32_bf16 v[196:199], v[204:207], v[96:99], v[196:199]
    ds_read_b64_tr_b16 v[96:97], v9 offset:37888
    ds_read_b64_tr_b16 v[98:99], v9 offset:41984
    ds_read_b64_tr_b16 a[44:45], v223 offset:36864
    ds_read_b64_tr_b16 a[46:47], v223 offset:37376
    v_mfma_f32_32x32x16_bf16 v[16:31], v[68:71], a[216:219], v[16:31]
    buffer_load_dwordx2 v[246:247], v252, s[36:39], 0 offen sc1
    ds_read_b64_tr_b16 a[48:49], v223 offset:38912
    ds_read_b64_tr_b16 a[50:51], v223 offset:39424
    v_mfma_f32_16x16x32_bf16 v[196:199], v[204:207], v[68:71], v[196:199]
    ds_read_b64_tr_b16 v[68:69], v9 offset:37376
    ds_read_b64_tr_b16 v[70:71], v9 offset:41472
    ds_read_b64_tr_b16 a[52:53], v223 offset:40960
    ds_read_b64_tr_b16 a[54:55], v223 offset:41472
    s_waitcnt lgkmcnt(15)
    v_mfma_f32_32x32x16_bf16 v[16:31], v[72:75], a[220:223], v[16:31]
    ds_read_b32 v163, v167 offset:1024
    v_and_b32 v108, 0xffff0000, v64
    v_and_b32 v109, 0xffff0000, v65
    v_and_b32 v110, 0xffff0000, v66
    v_and_b32 v111, 0xffff0000, v67
    v_mfma_f32_16x16x32_bf16 v[196:199], v[204:207], v[72:75], v[196:199]
    ds_read_b64_tr_b16 v[72:73], v9 offset:38400
    ds_read_b64_tr_b16 v[74:75], v9 offset:42496
    v_mfma_f32_32x32x16_bf16 v[32:47], v[76:79], a[208:211], v[32:47]
    v_sub_f32 v104, v64, v108
    v_sub_f32 v105, v65, v109
    v_sub_f32 v106, v66, v110
    v_sub_f32 v107, v67, v111
    v_and_b32 v100, 0xffff0000, v104
    v_and_b32 v101, 0xffff0000, v105
    v_and_b32 v102, 0xffff0000, v106
    v_mfma_f32_32x32x16_bf16 v[48:63], a[208:211], v[80:83], v[48:63]
    v_and_b32 v103, 0xffff0000, v107
    v_sub_f32 v104, v104, v100
    v_sub_f32 v105, v105, v101
    v_sub_f32 v106, v106, v102
    v_sub_f32 v107, v107, v103
    v_lshrrev_b32 v108, 16, v108
    v_lshrrev_b32 v109, 16, v109
    v_mfma_f32_32x32x16_bf16 v[32:47], v[84:87], a[212:215], v[32:47]
    v_lshrrev_b32 v110, 16, v110
    v_lshrrev_b32 v111, 16, v111
    v_or_b32 v100, v100, v108
    v_or_b32 v101, v101, v109
    v_or_b32 v102, v102, v110
    v_or_b32 v103, v103, v111
    v_lshrrev_b32 v104, 16, v104
    v_mfma_f32_32x32x16_bf16 v[48:63], a[212:215], v[88:91], v[48:63]
    v_lshrrev_b32 v105, 16, v105
    v_lshrrev_b32 v106, 16, v106
    v_lshrrev_b32 v107, 16, v107
    ds_write_b128 v244, v[100:103]
    v_mfma_f32_32x32x16_bf16 v[32:47], v[92:95], a[216:219], v[32:47]
    ds_write_b128 v244, v[104:107] offset:128
    v_and_b32 v199, 0xffff0000, v196
    v_mul_f32 v164, v160, v168
    v_sub_f32 v198, v196, v199
    s_waitcnt lgkmcnt(15)
    v_mul_f32 v165, v161, v168
    v_and_b32 v197, 0xffff0000, v198
    v_sub_f32 v198, v198, v197
    v_mul_f32 v166, v162, v168
    v_lshrrev_b32 v199, 16, v199
    v_or_b32 v197, v197, v199
    s_waitcnt lgkmcnt(4)
    v_mul_f32 v167, v163, v168
    v_lshrrev_b32 v198, 16, v198
    v_cndmask_b32 v196, v197, v198, s[90:91]
    ds_write_b32 v170, v196
    s_waitcnt lgkmcnt(0)
    s_barrier
    s_add_u32 m0, s45, 0
    s_mov_b32 s5, 0
    buffer_load_dwordx4 v245, s[16:19], s5 offen offset:0 lds
    v_mfma_f32_32x32x16_bf16 v[48:63], a[216:219], v[96:99], v[48:63]
    ds_read_b32 v76, v170 offset:256
    ds_read_b32 v80, v170 offset:512
    ds_read_b32 v84, v171
    ds_read_b32 v88, v170 offset:0
    v_mfma_f32_32x32x16_bf16 v[32:47], v[68:71], a[220:223], v[32:47]
    s_mov_b32 s5, 6144
    buffer_load_dwordx4 v245, s[16:19], s5 offen offset:1024 lds
    v_mfma_f32_32x32x16_bf16 v[48:63], a[220:223], v[72:75], v[48:63]
    s_waitcnt lgkmcnt(3)
    v_mfma_f32_32x32x16_bf16 v[32:47], v[76:79], v[148:151], v[32:47]
    s_mov_b32 s5, 12288
    buffer_load_dwordx4 v245, s[16:19], s5 offen offset:2048 lds
    s_waitcnt lgkmcnt(0)
    v_mfma_f32_32x32x16_bf16 v[48:63], v[148:151], v[80:83], v[48:63]
    s_nop 7
    v_cvt_pk_bf16_f32 v32, v32, v33
    v_cvt_pk_bf16_f32 v33, v34, v35
    v_cvt_pk_bf16_f32 v34, v36, v37
    v_cvt_pk_bf16_f32 v35, v38, v39
    v_cvt_pk_bf16_f32 v36, v40, v41
    v_cvt_pk_bf16_f32 v37, v42, v43
    v_mfma_f32_16x16x32_bf16 v[64:67], v[84:87], v[152:155], v[64:67]
    s_mov_b32 s5, 18432
    buffer_load_dwordx4 v245, s[16:19], s5 offen offset:3072 lds
    v_mfma_f32_32x32x16_bf16 v[16:31], v[88:91], v[148:151], v[16:31]
    v_cvt_pk_bf16_f32 v38, v44, v45
    v_cvt_pk_bf16_f32 v39, v46, v47
    s_mov_b32 exec_lo, 0xffff0000
    s_mov_b32 exec_hi, 0xffff0000
    ds_write_b128 v13, v[32:35] offset:2048
    ds_write_b128 v13, v[36:39] offset:2560
    s_mov_b64 exec, -1
    s_add_u32 m0, s45, 16384
    s_mov_b32 s5, 114688
    buffer_load_dwordx4 v245, s[16:19], s5 offen offset:0 lds
    v_cvt_pk_bf16_f32 v48, v48, v49
    v_cvt_pk_bf16_f32 v49, v50, v51
    v_cvt_pk_bf16_f32 v50, v52, v53
    v_cvt_pk_bf16_f32 v51, v54, v55
    v_cvt_pk_bf16_f32 v52, v56, v57
    v_cvt_pk_bf16_f32 v53, v58, v59
    v_cvt_pk_bf16_f32 v54, v60, v61
    v_cvt_pk_bf16_f32 v55, v62, v63
    ds_write_b128 v14, v[52:55] offset:3072
    s_mov_b32 s5, 120832
    buffer_load_dwordx4 v245, s[16:19], s5 offen offset:1024 lds
    v_cvt_pk_bf16_f32 v64, v64, v65
    v_cvt_pk_bf16_f32 v65, v66, v67
    ds_write_b64 v15, v[64:65]
    ds_write_b16 v4, v64
    ds_write_b16_d16_hi v4, v64 offset:16
    ds_write_b16 v4, v65 offset:32
    ds_write_b16_d16_hi v4, v65 offset:48
    s_waitcnt lgkmcnt(0)
    s_barrier
    ds_read_b128 v[40:43], v13
    s_mov_b32 s5, 126976
    buffer_load_dwordx4 v245, s[16:19], s5 offen offset:2048 lds
    ds_read_b128 v[44:47], v13 offset:512
    v_cvt_pk_bf16_f32 v16, v16, v17
    v_cvt_pk_bf16_f32 v17, v18, v19
    v_cvt_pk_bf16_f32 v18, v20, v21
    v_cvt_pk_bf16_f32 v19, v22, v23
    ds_read_b128 v[56:59], v14 offset:1024
    ds_read_b128 v[68:71], v169 offset:2432
    v_mfma_f32_32x32x16_bf16 v[132:147], v[32:35], v[16:19], v[132:147]
    s_mov_b32 s5, 133120
    buffer_load_dwordx4 v245, s[16:19], s5 offen offset:3072 lds
    v_cvt_pk_bf16_f32 v20, v24, v25
    v_cvt_pk_bf16_f32 v21, v26, v27
    v_cvt_pk_bf16_f32 v22, v28, v29
    v_cvt_pk_bf16_f32 v23, v30, v31
    v_cndmask_b32 v22, v22, 0, s[90:91]
    v_cndmask_b32 v23, v23, 0, s[90:91]
    ds_read_b128 v[72:75], v169 offset:2176
    ds_read_b128 v[76:79], v169 offset:2688
    v_mfma_f32_32x32x16_bf16 v[132:147], v[36:39], v[20:23], v[132:147]
    s_add_u32 m0, s45, 32768
    s_mov_b32 s5, 229376
    buffer_load_dwordx4 v245, s[16:19], s5 offen offset:0 lds
    v_and_b32 v30, 1, v2
    v_and_b32 v29, 0x1ff, v13
    v_lshl_add_u32 v30, v30, 14, v29
    s_waitcnt lgkmcnt(5)
    v_mfma_f32_32x32x16_bf16 v[116:131], v[40:43], v[16:19], v[116:131]
    s_lshl2_add_u32 s72, s52, s50
    s_mov_b32 s5, 235520
    buffer_load_dwordx4 v245, s[16:19], s5 offen offset:1024 lds
    s_lshl_b32 s72, s72, 15
    s_lshl_b32 s73, s51, 10
    s_add_u32 s72, s72, s73
    s_waitcnt lgkmcnt(4)
    v_mfma_f32_32x32x16_bf16 v[116:131], v[44:47], v[20:23], v[116:131]
    v_max3_f32 v24, v132, v133, v140
    s_mov_b32 s5, 241664
    buffer_load_dwordx4 v245, s[16:19], s5 offen offset:2048 lds
    v_max3_f32 v25, v134, v135, v142
    v_max3_f32 v26, v136, v137, v144
    v_max3_f32 v27, v138, v139, v146
    v_max_f32 v24, v24, v141
    v_max_f32 v25, v25, v143
    v_max_f32 v26, v26, v145
    v_max_f32 v27, v27, v147
    s_nop 1
    v_max3_f32 v24, v24, v124, v125
    v_max3_f32 v25, v25, v126, v127
    v_max3_f32 v26, v26, v128, v129
    v_max3_f32 v27, v27, v130, v131
    v_mul_f32 v24, v24, v164
    s_mov_b32 s5, 247808
    buffer_load_dwordx4 v245, s[16:19], s5 offen offset:3072 lds
    v_mul_f32 v25, v25, v165
    v_mul_f32 v26, v26, v166
    v_mul_f32 v27, v27, v167
    v_max3_f32 v28, v24, v25, v26
    v_max_f32 v28, v28, v27
    v_max_f32 v29, v28, v27
    s_nop 1
    v_permlane32_swap_b32 v28, v29
    v_max_f32 v28, v28, v29
    v_sub_f32 v24, v24, v28
    v_sub_f32 v25, v25, v28
    v_sub_f32 v26, v26, v28
    v_sub_f32 v27, v27, v28
    s_lshl_b32 s5, s50, 11
    s_add_u32 m0, s5, 140800
    s_mul_i32 s5, s50, 14336
    s_sub_u32 s46, 344064, s5
    buffer_load_dwordx4 v245, s[16:19], s46 offen offset:0 lds
    v_exp_f32 v24, v24
    v_exp_f32 v25, v25
    v_exp_f32 v26, v26
    v_exp_f32 v27, v27
    v_add_f32 v28, v24, v25
    v_add_f32 v29, v26, v27
    v_add_f32 v28, v28, v29
    v_mov_b32 v29, v28
    s_add_u32 s46, s46, 6144
    buffer_load_dwordx4 v245, s[16:19], s46 offen offset:1024 lds
    v_mul_f32 v24, v24, v160
    v_mul_f32 v25, v25, v161
    v_permlane32_swap_b32 v28, v29
    v_add_f32 v28, v28, v29
    v_rcp_f32 v28, v28
    v_mul_f32 v26, v26, v162
    v_mul_f32 v27, v27, v163
    v_mul_f32 v24, v24, v28
    v_mul_f32 v25, v25, v28
    v_mul_f32 v26, v26, v28
    v_mul_f32 v27, v27, v28
    v_cvt_pk_bf16_f32 v24, v24, v24
    v_cvt_pk_bf16_f32 v25, v25, v25
    v_cvt_pk_bf16_f32 v26, v26, v26
    v_cvt_pk_bf16_f32 v27, v27, v27
    s_waitcnt lgkmcnt(2)
    v_and_b32 v68, v24, v68
    v_and_b32 v69, v25, v69
    v_and_b32 v70, v26, v70
    v_and_b32 v71, v27, v71
    s_waitcnt lgkmcnt(1)
    v_and_b32 v72, v24, v72
    v_and_b32 v73, v25, v73
    v_mfma_f32_32x32x16_bf16 v[100:115], v[48:51], v[68:71], 0
    v_and_b32 v74, v26, v74
    v_and_b32 v75, v27, v75
    s_waitcnt lgkmcnt(0)
    v_and_b32 v76, v24, v76
    v_and_b32 v77, v25, v77
    v_mfma_f32_32x32x16_bf16 v[100:115], v[52:55], v[72:75], v[100:115]
    v_and_b32 v78, v26, v78
    v_and_b32 v79, v27, v79
    s_nop 1
    v_mfma_f32_32x32x16_bf16 v[100:115], v[56:59], v[76:79], v[100:115]
    s_mov_b32 s4, 0
    s_waitcnt vmcnt(14)
    v_xor_b32 v246, s0, v246
    v_xor_b32 v247, s61, v247
    v_or_b32 v246, v246, v247
    v_cmp_ne_u32 vcc, 0, v246
    s_nop 0
    s_cmp_eq_u32 vcc_lo, 0
    s_cbranch_scc0 Lvfs_1
Lvfd_3:
    s_lshl_b32 s5, s4, 26
    s_lshl_b32 s55, s48, 21
    s_add_u32 s55, s55, s5
    s_mul_i32 s20, s48, 917504
    s_add_u32 s20, s20, s5
    s_add_u32 s20, s20, 16777216
    s_add_u32 s21, s55, 516096
    s_add_u32 s72, s72, s55
    v_cvt_pk_bf16_f32 v100, v100, v101
    v_cvt_pk_bf16_f32 v101, v102, v103
    v_cvt_pk_bf16_f32 v102, v104, v105
    v_cvt_pk_bf16_f32 v103, v106, v107
    v_cvt_pk_bf16_f32 v104, v108, v109
    v_cvt_pk_bf16_f32 v105, v110, v111
    v_cvt_pk_bf16_f32 v106, v112, v113
    v_cvt_pk_bf16_f32 v107, v114, v115
    v_cndmask_b32 v106, v106, 0, s[90:91]
    v_cndmask_b32 v107, v107, 0, s[90:91]
    s_cmp_eq_u32 s4, 0
    s_cbranch_scc0 Lslow_6
    buffer_store_dwordx4 v[100:103], v30, s[36:39], s72 offen
    buffer_store_dwordx4 v[104:107], v30, s[36:39], s72 offen offset:512
Lsdone_7:
    s_cmp_eq_u32 s4, 0
    s_cbranch_scc0 Lss_8
Lssd_10:
    s_lshl2_add_u32 s5, s54, s50
    s_mul_i32 s5, s5, 896
    s_add_u32 s5, s5, 41975808
    v_min_u32 v254, 27, v0
    v_lshl_add_u32 v254, v254, 5, s5
    buffer_load_dword v220, v254, s[36:39], 0 offen sc1
    v_and_b32 v5, 1, v2
    v_lshrrev_b32 v7, 1, v2
    v_lshl_add_u32 v5, v5, 1, v7
    v_lshlrev_b32 v7, 4, v3
    v_lshl_add_u32 v5, v5, 8, v7
    s_and_b32 s75, s60, 15
    s_lshl_b32 s77, s75, 14
    s_add_u32 s77, s77, s55
    s_add_u32 s78, s77, 4096
    s_add_u32 s79, s77, 8192
    s_add_u32 s80, s77, 12288
    v_and_b32 v4, 1, v2
    v_lshrrev_b32 v7, 1, v2
    v_lshl_add_u32 v4, v4, 1, v7
    v_mul_u32_u24 v7, 896, v3
    v_lshl_add_u32 v4, v4, 4, v7
    s_mul_i32 s72, s60, 14336
    s_lshl_b32 s73, s54, 7
    s_add_u32 s76, s72, s73
    buffer_load_dwordx4 v[164:167], v4, s[8:11], s76 offen
    buffer_load_dwordx4 v[168:171], v4, s[8:11], s76 offen offset:64
    s_mul_i32 s72, s75, 14336
    s_lshl_b32 s73, s54, 11
    s_add_u32 s72, s72, s73
    s_add_u32 s72, s72, s55
    s_add_u32 s72, s72, 262144
    s_cmp_eq_u32 s48, 7
    s_cselect_b32 s5, 3, s48
    s_cmp_lt_u32 s54, s5
    s_cselect_b32 s6, 7, 0
    s_sub_u32 s5, s6, s5
    s_lshl_b32 s5, s5, 11
    s_add_u32 s72, s72, s5
    s_lshl_b32 s74, s75, 7
    s_add_u32 s73, s73, s74
    s_add_u32 s73, s73, s55
    s_add_u32 s73, s73, 491520
    v_mov_b32 v80, v2
    v_lshrrev_b32 v81, 2, v3
    v_and_b32 v82, 2, v80
    v_add_u32 v80, v80, v82
    v_lshl_add_u32 v82, v80, 2, v81
    v_lshlrev_b32 v83, 7, v82
    v_bfe_u32 v82, v82, 1, 2
    v_lshl_add_u32 v83, v82, 5, v83
    v_and_b32 v81, 3, v3
    v_lshl_add_u32 v83, v81, 3, v83
    v_add_u32 v8, 91648, v83
    v_xor_b32 v9, 32, v8
    v_xor_b32 v10, 64, v8
    v_xor_b32 v11, 96, v8
    v_cmp_eq_u32 vcc, 3, v2
    s_nop 1
    v_cndmask_b32 v80, v2, 1, vcc
    v_lshrrev_b32 v81, 2, v3
    v_and_b32 v82, 2, v80
    v_add_u32 v80, v80, v82
    v_lshl_add_u32 v82, v80, 2, v81
    v_lshlrev_b32 v83, 7, v82
    v_bfe_u32 v82, v82, 1, 2
    v_lshl_add_u32 v83, v82, 5, v83
    v_and_b32 v81, 3, v3
    v_lshl_add_u32 v83, v81, 3, v83
    v_add_u32 v12, 91648, v83
    v_xor_b32 v13, 32, v12
    v_xor_b32 v14, 64, v12
    v_xor_b32 v15, 96, v12
    s_waitcnt vmcnt(5)
    s_barrier
    ds_read_b64_tr_b16 v[96:97], v8 offset:0
    ds_read_b64_tr_b16 v[98:99], v12 offset:1024
    ds_read_b64_tr_b16 v[100:101], v9 offset:0
    ds_read_b64_tr_b16 v[102:103], v13 offset:1024
    ds_read_b64_tr_b16 v[104:105], v10 offset:0
    ds_read_b64_tr_b16 v[106:107], v14 offset:1024
    ds_read_b64_tr_b16 v[108:109], v11 offset:0
    ds_read_b64_tr_b16 v[110:111], v15 offset:1024
    buffer_load_dwordx4 v[16:19], v1, s[36:39], s77 offen offset:0 sc1
    ds_read_b64_tr_b16 v[112:113], v10 offset:3584
    ds_read_b64_tr_b16 v[114:115], v14 offset:4608
    buffer_load_dwordx4 v[20:23], v1, s[36:39], s77 offen offset:1024 sc1
    ds_read_b64_tr_b16 v[116:117], v11 offset:3584
    ds_read_b64_tr_b16 v[118:119], v15 offset:4608
    buffer_load_dwordx4 v[24:27], v1, s[36:39], s77 offen offset:2048 sc1
    ds_read_b64_tr_b16 v[120:121], v8 offset:3584
    ds_read_b64_tr_b16 v[122:123], v12 offset:4608
    buffer_load_dwordx4 v[28:31], v1, s[36:39], s77 offen offset:3072 sc1
    ds_read_b64_tr_b16 v[124:125], v9 offset:3584
    ds_read_b64_tr_b16 v[126:127], v13 offset:4608
    buffer_load_dwordx4 v[32:35], v1, s[36:39], s78 offen offset:0 sc1
    ds_read_b64_tr_b16 v[128:129], v8 offset:7168
    ds_read_b64_tr_b16 v[130:131], v12 offset:8192
    buffer_load_dwordx4 v[36:39], v1, s[36:39], s78 offen offset:1024 sc1
    ds_read_b64_tr_b16 v[132:133], v9 offset:7168
    ds_read_b64_tr_b16 v[134:135], v13 offset:8192
    buffer_load_dwordx4 v[40:43], v1, s[36:39], s78 offen offset:2048 sc1
    ds_read_b64_tr_b16 v[136:137], v10 offset:7168
    ds_read_b64_tr_b16 v[138:139], v14 offset:8192
    buffer_load_dwordx4 v[44:47], v1, s[36:39], s78 offen offset:3072 sc1
    ds_read_b64_tr_b16 v[140:141], v11 offset:7168
    ds_read_b64_tr_b16 v[142:143], v15 offset:8192
    buffer_load_dwordx4 v[48:51], v1, s[36:39], s79 offen offset:0 sc1
    ds_read_b64_tr_b16 v[144:145], v10 offset:10752
    ds_read_b64_tr_b16 v[146:147], v14 offset:11776
    ds_read_b64_tr_b16 v[148:149], v11 offset:10752
    ds_read_b64_tr_b16 v[150:151], v15 offset:11776
    ds_read_b64_tr_b16 v[152:153], v8 offset:10752
    ds_read_b64_tr_b16 v[154:155], v12 offset:11776
    ds_read_b64_tr_b16 v[156:157], v9 offset:10752
    ds_read_b64_tr_b16 v[158:159], v13 offset:11776
    ds_read_b64_tr_b16 v[160:161], v8 offset:14336
    ds_read_b64_tr_b16 v[162:163], v12 offset:15360
    s_waitcnt vmcnt(10)
    v_permlane16_swap_b32 v164, v166
    v_permlane16_swap_b32 v165, v167
    s_waitcnt vmcnt(9)
    v_permlane16_swap_b32 v168, v170
    v_permlane16_swap_b32 v169, v171
    v_lshlrev_b32 v80, 16, v164
    v_and_b32 v81, 0xffff0000, v164
    v_lshlrev_b32 v82, 16, v165
    v_and_b32 v83, 0xffff0000, v165
    v_lshlrev_b32 v84, 16, v166
    v_and_b32 v85, 0xffff0000, v166
    v_lshlrev_b32 v86, 16, v167
    v_and_b32 v87, 0xffff0000, v167
    v_lshlrev_b32 v88, 16, v168
    v_and_b32 v89, 0xffff0000, v168
    v_lshlrev_b32 v90, 16, v169
    v_and_b32 v91, 0xffff0000, v169
    v_lshlrev_b32 v92, 16, v170
    v_and_b32 v93, 0xffff0000, v170
    v_lshlrev_b32 v94, 16, v171
    v_and_b32 v95, 0xffff0000, v171
    v_mov_b32 v164, 0x3f803f80
    v_mov_b32 v165, 0x3f803f80
    v_mov_b32 v166, 0x3f803f80
    v_mov_b32 v167, 0x3f803f80
    v_lshlrev_b32 v168, 3, v3
    s_waitcnt vmcnt(6)
    v_max3_u32 v7, v16, v20, v24
    v_cmp_eq_u32 vcc, -1, v7
    s_nop 0
    s_cbranch_vccnz Lsc_11
Lscd_13:
    s_waitcnt lgkmcnt(15)
    v_mfma_f32_16x16x32_bf16 v[80:83], v[96:99], v[16:19], v[80:83]
    ds_read_b64_tr_b16 v[96:97], v9 offset:14336
    ds_read_b64_tr_b16 v[98:99], v13 offset:15360
    v_mfma_f32_16x16x32_bf16 v[84:87], v[100:103], v[16:19], v[84:87]
    ds_read_b64_tr_b16 v[100:101], v10 offset:14336
    ds_read_b64_tr_b16 v[102:103], v14 offset:15360
    v_mfma_f32_16x16x32_bf16 v[88:91], v[104:107], v[16:19], v[88:91]
    buffer_load_dwordx4 v[52:55], v1, s[36:39], s79 offen offset:1024 sc1
    ds_read_b64_tr_b16 v[104:105], v11 offset:14336
    ds_read_b64_tr_b16 v[106:107], v15 offset:15360
    v_mfma_f32_16x16x32_bf16 v[92:95], v[108:111], v[16:19], v[92:95]
    ds_read_b64_tr_b16 v[108:109], v10 offset:17920
    ds_read_b64_tr_b16 v[110:111], v14 offset:18944
    v_mfma_f32_16x16x32_bf16 v[80:83], v[112:115], v[20:23], v[80:83]
    buffer_load_dwordx4 v[56:59], v1, s[36:39], s79 offen offset:2048 sc1
    ds_read_b64_tr_b16 v[112:113], v11 offset:17920
    ds_read_b64_tr_b16 v[114:115], v15 offset:18944
    v_mfma_f32_16x16x32_bf16 v[84:87], v[116:119], v[20:23], v[84:87]
    ds_read_b64_tr_b16 v[116:117], v8 offset:17920
    ds_read_b64_tr_b16 v[118:119], v12 offset:18944
    v_mfma_f32_16x16x32_bf16 v[88:91], v[120:123], v[20:23], v[88:91]
    buffer_load_dwordx4 v[60:63], v1, s[36:39], s79 offen offset:3072 sc1
    ds_read_b64_tr_b16 v[120:121], v9 offset:17920
    ds_read_b64_tr_b16 v[122:123], v13 offset:18944
    s_waitcnt lgkmcnt(15)
    v_mfma_f32_16x16x32_bf16 v[92:95], v[124:127], v[20:23], v[92:95]
    ds_read_b64_tr_b16 v[124:125], v8 offset:21504
    ds_read_b64_tr_b16 v[126:127], v12 offset:22528
    v_mfma_f32_16x16x32_bf16 v[80:83], v[128:131], v[24:27], v[80:83]
    buffer_load_dwordx4 v[64:67], v1, s[36:39], s80 offen offset:0 sc1
    ds_read_b64_tr_b16 v[128:129], v9 offset:21504
    ds_read_b64_tr_b16 v[130:131], v13 offset:22528
    v_mfma_f32_16x16x32_bf16 v[84:87], v[132:135], v[24:27], v[84:87]
    s_waitcnt vmcnt(7)
    v_max3_u32 v7, v28, v32, v36
    v_cmp_eq_u32 vcc, -1, v7
    ds_read_b64_tr_b16 v[132:133], v10 offset:21504
    ds_read_b64_tr_b16 v[134:135], v14 offset:22528
    v_mfma_f32_16x16x32_bf16 v[88:91], v[136:139], v[24:27], v[88:91]
    buffer_load_dwordx4 v[68:71], v1, s[36:39], s80 offen offset:1024 sc1
    ds_read_b64_tr_b16 v[136:137], v11 offset:21504
    ds_read_b64_tr_b16 v[138:139], v15 offset:22528
    v_mfma_f32_16x16x32_bf16 v[92:95], v[140:143], v[24:27], v[92:95]
    s_cbranch_vccnz Lsc_23
Lscd_25:
    ds_read_b64_tr_b16 v[140:141], v10 offset:25088
    ds_read_b64_tr_b16 v[142:143], v14 offset:26112
    v_mfma_f32_16x16x32_bf16 v[80:83], v[144:147], v[28:31], v[80:83]
    buffer_load_dwordx4 v[72:75], v1, s[36:39], s80 offen offset:2048 sc1
    ds_read_b64_tr_b16 v[144:145], v11 offset:25088
    ds_read_b64_tr_b16 v[146:147], v15 offset:26112
    v_mfma_f32_16x16x32_bf16 v[84:87], v[148:151], v[28:31], v[84:87]
    ds_read_b64_tr_b16 v[148:149], v8 offset:25088
    ds_read_b64_tr_b16 v[150:151], v12 offset:26112
    v_mfma_f32_16x16x32_bf16 v[88:91], v[152:155], v[28:31], v[88:91]
    buffer_load_dwordx4 v[76:79], v1, s[36:39], s80 offen offset:3072 sc1
    ds_read_b64_tr_b16 v[152:153], v9 offset:25088
    ds_read_b64_tr_b16 v[154:155], v13 offset:26112
    s_waitcnt lgkmcnt(15)
    v_mfma_f32_16x16x32_bf16 v[92:95], v[156:159], v[28:31], v[92:95]
    ds_read_b64_tr_b16 v[156:157], v8 offset:28672
    ds_read_b64_tr_b16 v[158:159], v12 offset:29696
    v_mfma_f32_16x16x32_bf16 v[80:83], v[160:163], v[32:35], v[80:83]
    ds_read_b64_tr_b16 v[160:161], v9 offset:28672
    ds_read_b64_tr_b16 v[162:163], v13 offset:29696
    v_mfma_f32_16x16x32_bf16 v[84:87], v[96:99], v[32:35], v[84:87]
    ds_read_b64_tr_b16 v[96:97], v10 offset:28672
    ds_read_b64_tr_b16 v[98:99], v14 offset:29696
    v_mfma_f32_16x16x32_bf16 v[88:91], v[100:103], v[32:35], v[88:91]
    s_waitcnt lgkmcnt(6)
    s_barrier
    s_add_u32 m0, s47, 0
    s_add_u32 s3, s3, 57344
    buffer_load_dwordx4 v253, s[40:43], s3 offen lds
    v_mfma_f32_16x16x32_bf16 v[92:95], v[104:107], v[32:35], v[92:95]
    ds_read_b64_tr_b16 v[100:101], v11 offset:28672
    ds_read_b64_tr_b16 v[102:103], v15 offset:29696
    ds_read_b64_tr_b16 v[104:105], v10 offset:32256
    ds_read_b64_tr_b16 v[106:107], v14 offset:33280
    v_mfma_f32_16x16x32_bf16 v[80:83], v[108:111], v[36:39], v[80:83]
    s_add_u32 m0, s47, 2048
    s_add_u32 s3, s3, 57344
    buffer_load_dwordx4 v253, s[40:43], s3 offen lds
    ds_read_b64_tr_b16 v[108:109], v11 offset:32256
    ds_read_b64_tr_b16 v[110:111], v15 offset:33280
    v_mfma_f32_16x16x32_bf16 v[84:87], v[112:115], v[36:39], v[84:87]
    s_waitcnt vmcnt(9)
    v_max3_u32 v7, v40, v44, v48
    s_waitcnt vmcnt(7)
    v_max3_u32 v7, v7, v52, v56
    v_cmp_eq_u32 vcc, -1, v7
    v_mfma_f32_16x16x32_bf16 v[88:91], v[116:119], v[36:39], v[88:91]
    s_add_u32 m0, s47, 4096
    s_add_u32 s3, s3, 57344
    s_sub_u32 s6, s3, 1605632
    s_cselect_b32 s3, s3, s6
    buffer_load_dwordx4 v253, s[40:43], s3 offen lds
    v_mfma_f32_16x16x32_bf16 v[92:95], v[120:123], v[36:39], v[92:95]
    s_cbranch_vccnz Lsc_37
Lscd_39:
    ds_read_b64_tr_b16 v[112:113], v8 offset:32256
    ds_read_b64_tr_b16 v[114:115], v12 offset:33280
    ds_read_b64_tr_b16 v[116:117], v9 offset:32256
    v_mfma_f32_16x16x32_bf16 v[80:83], v[124:127], v[40:43], v[80:83]
    s_add_u32 m0, s47, 6144
    s_add_u32 s3, s3, 57344
    buffer_load_dwordx4 v253, s[40:43], s3 offen lds
    ds_read_b64_tr_b16 v[118:119], v13 offset:33280
    ds_read_b64_tr_b16 v[120:121], v8 offset:35840
    v_mfma_f32_16x16x32_bf16 v[84:87], v[128:131], v[40:43], v[84:87]
    ds_read_b64_tr_b16 v[122:123], v12 offset:36864
    ds_read_b64_tr_b16 v[124:125], v9 offset:35840
    ds_read_b64_tr_b16 v[126:127], v13 offset:36864
    ds_read_b64_tr_b16 v[128:129], v10 offset:35840
    v_mfma_f32_16x16x32_bf16 v[88:91], v[132:135], v[40:43], v[88:91]
    s_add_u32 m0, s47, 8192
    s_add_u32 s3, s3, 57344
    buffer_load_dwordx4 v253, s[40:43], s3 offen lds
    ds_read_b64_tr_b16 v[130:131], v14 offset:36864
    ds_read_b64_tr_b16 v[132:133], v11 offset:35840
    v_mfma_f32_16x16x32_bf16 v[92:95], v[136:139], v[40:43], v[92:95]
    ds_read_b64_tr_b16 v[134:135], v15 offset:36864
    ds_read_b64_tr_b16 v[136:137], v10 offset:39424
    ds_read_b64_tr_b16 v[138:139], v14 offset:40448
    v_mfma_f32_16x16x32_bf16 v[80:83], v[140:143], v[44:47], v[80:83]
    s_add_u32 m0, s47, 10240
    s_add_u32 s3, s3, 57344
    buffer_load_dwordx4 v253, s[40:43], s3 offen lds
    ds_read_b64_tr_b16 v[140:141], v11 offset:39424
    ds_read_b64_tr_b16 v[142:143], v15 offset:40448
    v_mfma_f32_16x16x32_bf16 v[84:87], v[144:147], v[44:47], v[84:87]
    ds_read_b64_tr_b16 v[144:145], v8 offset:39424
    ds_read_b64_tr_b16 v[146:147], v12 offset:40448
    v_mfma_f32_16x16x32_bf16 v[88:91], v[148:151], v[44:47], v[88:91]
    s_add_u32 m0, s47, 12288
    s_add_u32 s3, s3, 57344
    s_sub_u32 s6, s3, 1605632
    s_cselect_b32 s3, s3, s6
    buffer_load_dwordx4 v253, s[40:43], s3 offen lds
    s_waitcnt lgkmcnt(15)
    v_mfma_f32_16x16x32_bf16 v[92:95], v[152:155], v[44:47], v[92:95]
    ds_read_b64_tr_b16 v[148:149], v9 offset:39424
    ds_read_b64_tr_b16 v[150:151], v13 offset:40448
    ds_read_b64_tr_b16 v[152:153], v8 offset:43008
    v_mfma_f32_16x16x32_bf16 v[80:83], v[156:159], v[48:51], v[80:83]
    ds_read_b64_tr_b16 v[154:155], v12 offset:44032
    ds_read_b64_tr_b16 v[156:157], v9 offset:43008
    ds_read_b64_tr_b16 v[158:159], v13 offset:44032
    v_mfma_f32_16x16x32_bf16 v[84:87], v[160:163], v[48:51], v[84:87]
    ds_read_b64_tr_b16 v[160:161], v10 offset:43008
    ds_read_b64_tr_b16 v[162:163], v14 offset:44032
    v_mfma_f32_16x16x32_bf16 v[88:91], v[96:99], v[48:51], v[88:91]
    ds_read_b64_tr_b16 v[96:97], v11 offset:43008
    ds_read_b64_tr_b16 v[98:99], v15 offset:44032
    v_mfma_f32_16x16x32_bf16 v[92:95], v[100:103], v[48:51], v[92:95]
    ds_read_b64_tr_b16 v[100:101], v10 offset:46592
    ds_read_b64_tr_b16 v[102:103], v14 offset:47616
    v_mfma_f32_16x16x32_bf16 v[80:83], v[104:107], v[52:55], v[80:83]
    ds_read_b64_tr_b16 v[104:105], v11 offset:46592
    ds_read_b64_tr_b16 v[106:107], v15 offset:47616
    v_mfma_f32_16x16x32_bf16 v[84:87], v[108:111], v[52:55], v[84:87]
    ds_read_b64_tr_b16 v[108:109], v8 offset:46592
    ds_read_b64_tr_b16 v[110:111], v12 offset:47616
    v_mfma_f32_16x16x32_bf16 v[88:91], v[112:115], v[52:55], v[88:91]
    ds_read_b64_tr_b16 v[112:113], v9 offset:46592
    ds_read_b64_tr_b16 v[114:115], v13 offset:47616
    s_waitcnt lgkmcnt(15)
    v_mfma_f32_16x16x32_bf16 v[92:95], v[116:119], v[52:55], v[92:95]
    ds_read_b64_tr_b16 v[116:117], v8 offset:50176
    ds_read_b64_tr_b16 v[118:119], v12 offset:51200
    v_mfma_f32_16x16x32_bf16 v[80:83], v[120:123], v[56:59], v[80:83]
    ds_read_b64_tr_b16 v[120:121], v9 offset:50176
    ds_read_b64_tr_b16 v[122:123], v13 offset:51200
    v_mfma_f32_16x16x32_bf16 v[84:87], v[124:127], v[56:59], v[84:87]
    s_waitcnt vmcnt(9)
    v_max3_u32 v7, v60, v64, v68
    s_waitcnt vmcnt(7)
    v_max3_u32 v7, v7, v72, v76
    v_cmp_eq_u32 vcc, -1, v7
    v_mfma_f32_16x16x32_bf16 v[88:91], v[128:131], v[56:59], v[88:91]
    ds_read_b64_tr_b16 v[124:125], v10 offset:50176
    ds_read_b64_tr_b16 v[126:127], v14 offset:51200
    ds_read_b64_tr_b16 v[128:129], v11 offset:50176
    ds_read_b64_tr_b16 v[130:131], v15 offset:51200
    v_mfma_f32_16x16x32_bf16 v[92:95], v[132:135], v[56:59], v[92:95]
    s_cbranch_vccnz Lsc_50
Lscd_52:
    ds_read_b64_tr_b16 v[132:133], v10 offset:53760
    ds_read_b64_tr_b16 v[134:135], v14 offset:54784
    v_mfma_f32_16x16x32_bf16 v[80:83], v[136:139], v[60:63], v[80:83]
    ds_read_b64_tr_b16 v[136:137], v11 offset:53760
    ds_read_b64_tr_b16 v[138:139], v15 offset:54784
    v_mfma_f32_16x16x32_bf16 v[84:87], v[140:143], v[60:63], v[84:87]
    ds_read_b64_tr_b16 v[140:141], v8 offset:53760
    ds_read_b64_tr_b16 v[142:143], v12 offset:54784
    v_mfma_f32_16x16x32_bf16 v[88:91], v[144:147], v[60:63], v[88:91]
    ds_read_b64_tr_b16 v[144:145], v9 offset:53760
    ds_read_b64_tr_b16 v[146:147], v13 offset:54784
    s_waitcnt lgkmcnt(15)
    v_mfma_f32_16x16x32_bf16 v[92:95], v[148:151], v[60:63], v[92:95]
    v_mfma_f32_16x16x32_bf16 v[80:83], v[152:155], v[64:67], v[80:83]
    s_waitcnt lgkmcnt(0)
    s_barrier
    s_add_u32 m0, s47, 28672
    s_add_u32 s3, s3, 57344
    buffer_load_dwordx4 v253, s[40:43], s3 offen lds
    v_mfma_f32_16x16x32_bf16 v[84:87], v[156:159], v[64:67], v[84:87]
    v_mfma_f32_16x16x32_bf16 v[88:91], v[160:163], v[64:67], v[88:91]
    s_add_u32 m0, s47, 30720
    s_add_u32 s3, s3, 57344
    buffer_load_dwordx4 v253, s[40:43], s3 offen lds
    v_mfma_f32_16x16x32_bf16 v[92:95], v[96:99], v[64:67], v[92:95]
    v_mfma_f32_16x16x32_bf16 v[80:83], v[100:103], v[68:71], v[80:83]
    s_add_u32 m0, s47, 32768
    s_add_u32 s3, s3, 57344
    buffer_load_dwordx4 v253, s[40:43], s3 offen lds
    v_mfma_f32_16x16x32_bf16 v[84:87], v[104:107], v[68:71], v[84:87]
    v_mfma_f32_16x16x32_bf16 v[88:91], v[108:111], v[68:71], v[88:91]
    s_add_u32 m0, s47, 34816
    s_add_u32 s3, s3, 57344
    s_sub_u32 s6, s3, 1605632
    s_cselect_b32 s3, s3, s6
    buffer_load_dwordx4 v253, s[40:43], s3 offen lds
    v_mfma_f32_16x16x32_bf16 v[92:95], v[112:115], v[68:71], v[92:95]
    v_mfma_f32_16x16x32_bf16 v[80:83], v[116:119], v[72:75], v[80:83]
    s_add_u32 m0, s47, 36864
    s_add_u32 s3, s3, 57344
    buffer_load_dwordx4 v253, s[40:43], s3 offen lds
    v_mfma_f32_16x16x32_bf16 v[84:87], v[120:123], v[72:75], v[84:87]
    v_mfma_f32_16x16x32_bf16 v[88:91], v[124:127], v[72:75], v[88:91]
    s_add_u32 m0, s47, 38912
    s_add_u32 s3, s3, 57344
    buffer_load_dwordx4 v253, s[40:43], s3 offen lds
    v_mfma_f32_16x16x32_bf16 v[92:95], v[128:131], v[72:75], v[92:95]
    v_mfma_f32_16x16x32_bf16 v[80:83], v[132:135], v[76:79], v[80:83]
    s_add_u32 m0, s47, 40960
    s_add_u32 s3, s3, 57344
    buffer_load_dwordx4 v253, s[40:43], s3 offen lds
    v_mfma_f32_16x16x32_bf16 v[84:87], v[136:139], v[76:79], v[84:87]
    v_mfma_f32_16x16x32_bf16 v[88:91], v[140:143], v[76:79], v[88:91]
    v_mfma_f32_16x16x32_bf16 v[92:95], v[144:147], v[76:79], v[92:95]
    s_nop 1
    v_cvt_pk_bf16_f32 v16, v80, v81
    v_cvt_pk_bf16_f32 v17, v82, v83
    s_nop 1
    v_cvt_pk_bf16_f32 v18, v84, v85
    v_cvt_pk_bf16_f32 v19, v86, v87
    v_cvt_pk_bf16_f32 v20, v88, v89
    v_cvt_pk_bf16_f32 v21, v90, v91
    v_cvt_pk_bf16_f32 v22, v92, v93
    v_cvt_pk_bf16_f32 v23, v94, v95
    v_permlane16_swap_b32 v16, v18
    v_permlane16_swap_b32 v17, v19
    v_permlane16_swap_b32 v20, v22
    v_permlane16_swap_b32 v21, v23
    s_cmp_eq_u32 s4, 0
    s_cbranch_scc0 Lslow_58
    buffer_store_dwordx4 v[16:19], v5, s[36:39], s72 offen
    buffer_store_dwordx4 v[20:23], v5, s[36:39], s72 offen offset:1024
Lsdone_59:
    v_mfma_f32_16x16x32_bf16 v[28:31], v[16:19], v[16:19], 0
    v_mfma_f32_16x16x32_bf16 v[24:27], v[164:167], v[16:19], 0
    v_mfma_f32_16x16x32_bf16 v[28:31], v[20:23], v[20:23], v[28:31]
    v_mfma_f32_16x16x32_bf16 v[24:27], v[164:167], v[20:23], v[24:27]
    s_nop 7
    v_cndmask_b32 v25, 0, v28, s[62:63]
    v_cndmask_b32 v25, v25, v29, s[64:65]
    v_cndmask_b32 v25, v25, v30, s[66:67]
    v_cndmask_b32 v25, v25, v31, s[68:69]
    s_mov_b64 exec, s[70:71]
    s_cmp_eq_u32 s4, 0
    s_cbranch_scc0 Lslow_60
    buffer_store_dwordx2 v[24:25], v168, s[36:39], s73 offen
Lsdone_61:
    s_mov_b64 exec, -1
    s_cmp_eq_u32 s4, 0
    s_cbranch_scc0 Lss_62
Lssd_64:
    v_cmp_ne_u32 vcc, s0, v220
    s_nop 0
    s_cbranch_vccnz Lmc_65
Lmcd_67:
    s_mul_i32 s5, s50, 57344
    s_mul_i32 s6, s54, 229376
    s_add_u32 s5, s5, s6
    s_and_b32 s6, s50, 1
    s_lshl_b32 s6, s6, 12
    s_add_u32 s5, s5, s6
    s_add_u32 s5, s5, 48234496
    s_lshl_b32 s6, s53, 14
    s_add_u32 s41, s5, s6
    s_add_u32 s42, s41, 8192
    s_cmp_eq_u32 s53, 3
    s_cselect_b32 s42, s5, s42
    s_add_u32 s43, s42, 8192
    s_add_u32 s44, s43, 8192
    s_cmp_eq_u32 s53, 2
    s_cselect_b32 s44, s5, s44
    s_add_u32 s45, s44, 8192
    s_add_u32 s46, s45, 8192
    s_cmp_eq_u32 s53, 1
    s_cselect_b32 s46, s5, s46
    s_add_u32 s47, s46, 8192
    s_xor_b32 s3, s41, 4096
    buffer_load_dwordx4 a[112:115], v1, s[36:39], s3 offen offset:0
    s_xor_b32 s3, s42, 4096
    buffer_load_dwordx4 a[144:147], v1, s[36:39], s3 offen offset:0
    s_xor_b32 s3, s41, 4096
    buffer_load_dwordx4 a[120:123], v1, s[36:39], s3 offen offset:1024
    s_xor_b32 s3, s42, 4096
    buffer_load_dwordx4 a[152:155], v1, s[36:39], s3 offen offset:1024
    s_lshr_b32 s86, s50, 1
    s_mul_i32 s86, s86, 14336
    s_and_b32 s87, s50, 1
    s_lshl_b32 s84, s87, 12
    s_add_u32 s84, s84, s86
    s_mul_i32 s85, s87, 3072
    s_add_u32 s85, s85, s86
    s_add_u32 s85, s85, 8192
    s_add_u32 s86, s55, 170496
    s_cmp_lt_u32 s53, 2
    s_cselect_b32 s31, 28672, 0
    s_add_u32 s86, s86, s31
    s_lshl_b32 s31, s31, 1
    s_lshr_b32 s87, s54, 1
    s_sub_u32 s80, s87, 0
    s_and_b32 s80, s80, 3
    s_mul_i32 s72, s80, 57344
    s_add_u32 s72, s72, s86
    s_sub_u32 s81, s87, 1
    s_and_b32 s81, s81, 3
    s_mul_i32 s73, s81, 57344
    s_add_u32 s73, s73, s86
    s_sub_u32 s82, s87, 2
    s_and_b32 s82, s82, 3
    s_mul_i32 s74, s82, 57344
    s_waitcnt vmcnt(7)
    s_barrier
    s_add_u32 s74, s74, s86
    ds_read_b64_tr_b16 a[56:57], v223 offset:0
    s_sub_u32 s83, s87, 3
    ds_read_b64_tr_b16 a[58:59], v223 offset:512
    s_and_b32 s83, s83, 3
    s_mul_i32 s75, s83, 57344
    ds_read_b64_tr_b16 a[60:61], v223 offset:2048
    s_add_u32 s75, s75, s86
    ds_read_b64_tr_b16 a[62:63], v223 offset:2560
    v_bfe_u32 v133, v0, 2, 3
    v_min_u32 v133, 6, v133
    ds_read_b64_tr_b16 a[64:65], v223 offset:4096
    v_and_b32 v132, 3, v0
    v_lshlrev_b32 v133, 11, v133
    ds_read_b64_tr_b16 a[66:67], v223 offset:4608
    v_lshl_add_u32 v133, v132, 7, v133
    ds_read_b64_tr_b16 a[68:69], v223 offset:6144
    v_lshrrev_b32 v9, 1, v2
    v_lshl_add_u32 v133, v9, 30, v133
    ds_read_b64_tr_b16 a[70:71], v223 offset:6656
    s_lshl_b32 s86, s80, 9
    s_add_u32 s95, s55, 491520
    ds_read_b64_tr_b16 a[72:73], v223 offset:8192
    s_add_u32 s86, s86, s95
    ds_read_b64_tr_b16 a[74:75], v223 offset:8704
    v_add_u32 v133, s86, v133
    s_lshl_b32 s87, s50, 9
    ds_read_b64_tr_b16 a[76:77], v223 offset:10240
    s_add_u32 s95, s95, s87
    v_lshlrev_b32 v131, 3, v0
    ds_read_b64_tr_b16 a[78:79], v223 offset:10752
    v_and_b32 v132, 1, v2
    ds_read_b64_tr_b16 a[80:81], v223 offset:12288
    v_lshlrev_b32 v8, 4, v3
    v_lshl_add_u32 v8, v9, 8, v8
    ds_read_b64_tr_b16 a[82:83], v223 offset:12800
    v_mul_u32_u24 v132, 14336, v132
    v_add_u32 v5, v8, v132
    ds_read_b64_tr_b16 a[84:85], v223 offset:28672
    v_add_u32 v8, 91648, v5
    ds_read_b64_tr_b16 a[86:87], v223 offset:29184
    s_lshl2_add_u32 s87, s49, s50
    s_lshl_b32 s87, s87, 10
    ds_read_b64_tr_b16 a[88:89], v223 offset:30720
    v_add_u32 v10, s87, v1
    ds_read_b64_tr_b16 a[90:91], v223 offset:31232
    s_add_u32 s76, s20, 0
    s_lshl_b32 s80, s80, 10
    ds_read_b64_tr_b16 a[92:93], v223 offset:32768
    s_add_u32 s80, s80, 148992
    s_add_u32 s77, s20, 229376
    ds_read_b64_tr_b16 a[94:95], v223 offset:33280
    s_lshl_b32 s81, s81, 10
    ds_read_b64_tr_b16 a[96:97], v223 offset:34816
    s_add_u32 s81, s81, 148992
    s_add_u32 s78, s20, 458752
    ds_read_b64_tr_b16 a[98:99], v223 offset:35328
    s_lshl_b32 s82, s82, 10
    s_add_u32 s82, s82, 148992
    ds_read_b64_tr_b16 a[100:101], v223 offset:36864
    s_add_u32 s79, s20, 688128
    ds_read_b64_tr_b16 a[102:103], v223 offset:37376
    s_cmp_eq_u32 s4, 0
    s_cselect_b32 s79, s55, s79
    s_lshl_b32 s83, s83, 10
    ds_read_b64_tr_b16 a[104:105], v223 offset:38912
    s_add_u32 s83, s83, 148992
    v_mov_b32 v46, 0
    ds_read_b64_tr_b16 a[106:107], v223 offset:39424
    v_mov_b32 v47, 0
    ds_read_b64_tr_b16 a[108:109], v223 offset:40960
    v_mov_b32 v50, 0
    v_mov_b32 v51, 0
    ds_read_b64_tr_b16 a[110:111], v223 offset:41472
    v_and_b32 v11, 0x1f0, v1
    s_waitcnt lgkmcnt(0)
    s_barrier
    s_nop 0
    s_branch Lffn0
LclsI:
    s_lshl_b32 s1, 1, s49
    s_sub_u32 s1, s1, 1
    s_and_b32 s1, s1, 0xf0000000
    s_bcnt1_i32_b32 s1, s1
    s_lshl2_add_u32 s1, s1, s50
    s_waitcnt vmcnt(11)
    ds_read_b128 a[112:115], v236 offset:32768
    ds_read_b128 a[116:119], v237 offset:32768
    ds_read_b128 a[120:123], v238 offset:32768
    ds_read_b128 a[124:127], v239 offset:32768
    s_waitcnt lgkmcnt(3)
    v_mfma_f32_4x4x4_16b_bf16 v[176:179], a[112:113], a[112:113], 0
    s_add_u32 m0, s45, 16384
    s_nop 0
    buffer_load_dwordx4 v208, s[8:11], s24 offen offset:0 lds
    v_mfma_f32_4x4x4_16b_bf16 v[180:183], a[114:115], a[114:115], 0
    v_mfma_f32_16x16x32_bf16 v[188:191], v[204:207], a[112:115], 0
    s_waitcnt lgkmcnt(2)
    v_mfma_f32_4x4x4_16b_bf16 v[176:179], a[116:117], a[116:117], v[176:179]
    buffer_load_dwordx4 v209, s[8:11], s24 offen offset:1024 lds
    v_mfma_f32_4x4x4_16b_bf16 v[180:183], a[118:119], a[118:119], v[180:183]
    v_mfma_f32_16x16x32_bf16 v[188:191], v[204:207], a[116:119], v[188:191]
    s_waitcnt lgkmcnt(1)
    v_mfma_f32_4x4x4_16b_bf16 v[176:179], a[120:121], a[120:121], v[176:179]
    buffer_load_dwordx4 v210, s[8:11], s24 offen offset:2048 lds
    v_mfma_f32_4x4x4_16b_bf16 v[180:183], a[122:123], a[122:123], v[180:183]
    v_mfma_f32_16x16x32_bf16 v[188:191], v[204:207], a[120:123], v[188:191]
    s_waitcnt lgkmcnt(0)
    v_mfma_f32_4x4x4_16b_bf16 v[176:179], a[124:125], a[124:125], v[176:179]
    buffer_load_dwordx4 v211, s[8:11], s24 offen offset:3072 lds
    v_mfma_f32_4x4x4_16b_bf16 v[180:183], a[126:127], a[126:127], v[180:183]
    v_mfma_f32_16x16x32_bf16 v[188:191], v[204:207], a[124:127], v[188:191]
    s_waitcnt vmcnt(9)
    s_barrier
    ds_read_b64_tr_b16 v[68:69], v8 offset:3072
    ds_read_b64_tr_b16 v[70:71], v8 offset:2048
    ds_read_b64_tr_b16 v[72:73], v8 offset:0
    ds_read_b64_tr_b16 v[74:75], v8 offset:4096
    ds_read_b64_tr_b16 v[76:77], v8 offset:1024
    ds_read_b64_tr_b16 v[78:79], v8 offset:5120
    s_waitcnt lgkmcnt(4)
    v_mfma_f32_32x32x16_bf16 v[16:31], v[68:71], a[112:115], 0
    v_readlane_b32 s0, v246, 32
    v_readlane_b32 s61, v247, 32
    s_getreg_b32 s5, hwreg(HW_REG_XCC_ID, 0, 4)
    s_add_u32 s0, s0, 1
    s_xor_b32 s61, s61, 0x5bd1e995
    s_add_u32 s61, s61, s5
    v_mov_b32 v246, s0
    v_mov_b32 v247, s61
    s_cmp_lt_u32 s50, 2
    s_cselect_b32 s5, s26, s27
    s_add_u32 m0, s30, 148992
    s_mov_b32 exec_lo, s20
    buffer_load_dwordx4 v255, s[8:11], s5 offen lds
    s_mov_b32 exec_lo, -1
    v_mfma_f32_16x16x32_bf16 v[196:199], v[204:207], v[68:71], 0
    ds_read_b128 a[104:107], v240 offset:0
    ds_read_b128 a[108:111], v241 offset:0
    ds_read_b64_tr_b16 v[80:81], v8 offset:3584
    ds_read_b64_tr_b16 v[82:83], v8 offset:2560
    s_waitcnt lgkmcnt(6)
    v_mfma_f32_32x32x16_bf16 v[32:47], v[72:75], a[112:115], 0
    s_mul_i32 s29, s23, 1344
    s_add_u32 m0, s46, 12288
    s_nop 0
    buffer_load_dwordx4 v212, s[12:15], s29 offen offset:0 lds
    s_waitcnt lgkmcnt(4)
    v_mfma_f32_32x32x16_bf16 v[48:63], a[112:115], v[76:79], 0
    ds_read_b128 v[192:195], v240 offset:2048
    ds_read_b128 v[200:203], v241 offset:2048
    ds_read_b64_tr_b16 v[84:85], v8 offset:512
    ds_read_b64_tr_b16 v[86:87], v8 offset:4608
    s_waitcnt lgkmcnt(4)
    v_mfma_f32_32x32x16_bf16 v[16:31], v[80:83], a[116:119], v[16:31]
    s_add_u32 m0, s46, 12288
    s_nop 0
    buffer_load_dwordx4 v213, s[12:15], s29 offen offset:1024 lds
    ds_read_b64_tr_b16 v[88:89], v8 offset:1536
    ds_read_b64_tr_b16 v[90:91], v8 offset:5632
    v_mfma_f32_16x16x32_bf16 v[196:199], v[204:207], v[80:83], v[196:199]
    ds_read_b64_tr_b16 v[92:93], v10 offset:0
    ds_read_b64_tr_b16 v[94:95], v10 offset:4096
    ds_read_b64_tr_b16 v[96:97], v8 offset:9216
    ds_read_b64_tr_b16 v[98:99], v8 offset:8192
    s_waitcnt lgkmcnt(6)
    v_mfma_f32_32x32x16_bf16 v[32:47], v[84:87], a[116:119], v[32:47]
    s_add_u32 m0, s46, 12288
    s_nop 0
    buffer_load_dwordx4 v214, s[12:15], s29 offen offset:2048 lds
    ds_read_b64_tr_b16 v[68:69], v8 offset:6144
    s_waitcnt lgkmcnt(5)
    v_mfma_f32_32x32x16_bf16 v[48:63], a[116:119], v[88:91], v[48:63]
    s_lshl3_add_u32 s5, s1, s48
    s_add_u32 s5, s5, 576
    s_mul_i32 s6, s5, 9363
    s_lshr_b32 s6, s6, 20
    s_mul_i32 s6, s6, 1605504
    s_mul_i32 s5, s5, 14336
    s_sub_u32 s5, s5, s6
    s_add_u32 m0, s46, 73728
    s_nop 0
    buffer_load_dwordx4 v232, s[84:87], s5 offen lds
    s_add_u32 m0, m0, 1024
    s_add_u32 s5, s5, 7168
    buffer_load_dwordx4 v232, s[84:87], s5 offen lds
    ds_read_b64_tr_b16 v[70:71], v8 offset:10240
    s_waitcnt lgkmcnt(4)
    v_mfma_f32_16x16x32_bf16 v[64:67], v[92:95], a[104:107], 0
    s_waitcnt vmcnt(11)
    ds_read_b128 a[128:131], v236 offset:0
    ds_read_b128 a[132:135], v237 offset:0
    ds_read_b128 a[136:139], v238 offset:0
    ds_read_b128 a[140:143], v239 offset:0
    s_lshl3_add_u32 s5, s1, s48
    s_add_u32 s5, s5, 704
    s_mul_i32 s6, s5, 9363
    s_lshr_b32 s6, s6, 20
    s_mul_i32 s6, s6, 1605504
    s_mul_i32 s5, s5, 14336
    s_sub_u32 s5, s5, s6
    s_add_u32 m0, s46, 61440
    s_nop 0
    buffer_load_dwordx4 v232, s[84:87], s5 offen lds
    s_add_u32 m0, m0, 1024
    s_add_u32 s5, s5, 7168
    buffer_load_dwordx4 v232, s[84:87], s5 offen lds
    ds_read_b64_tr_b16 v[72:73], v8 offset:7168
    ds_read_b64_tr_b16 v[74:75], v8 offset:11264
    s_waitcnt lgkmcnt(8)
    v_mfma_f32_32x32x16_bf16 v[16:31], v[96:99], a[120:123], v[16:31]
    ds_read_b64_tr_b16 v[76:77], v8 offset:9728
    ds_read_b64_tr_b16 v[78:79], v8 offset:8704
    ds_read_b64_tr_b16 v[80:81], v8 offset:6656
    ds_read_b64_tr_b16 v[82:83], v8 offset:10752
    v_mfma_f32_16x16x32_bf16 v[196:199], v[204:207], v[96:99], v[196:199]
    s_add_u32 m0, s45, 32768
    s_nop 0
    buffer_load_dwordx4 v208, s[8:11], s25 offen offset:0 lds
    s_waitcnt lgkmcnt(10)
    v_mfma_f32_32x32x16_bf16 v[32:47], v[68:71], a[120:123], v[32:47]
    ds_read_b64_tr_b16 v[84:85], v8 offset:7680
    ds_read_b64_tr_b16 v[86:87], v8 offset:11776
    ds_read_b64_tr_b16 v[88:89], v10 offset:6144
    ds_read_b64_tr_b16 v[90:91], v10 offset:10240
    s_waitcnt lgkmcnt(8)
    v_mfma_f32_32x32x16_bf16 v[48:63], a[120:123], v[72:75], v[48:63]
    buffer_load_dwordx4 v209, s[8:11], s25 offen offset:1024 lds
    ds_read_b128 v[124:127], v235 offset:640
    ds_read_b128 v[128:131], v235 offset:512
    s_waitcnt lgkmcnt(6)
    v_mfma_f32_32x32x16_bf16 v[16:31], v[76:79], a[124:127], v[16:31]
    buffer_load_dwordx4 v210, s[8:11], s25 offen offset:2048 lds
    ds_read_b128 v[132:135], v169 offset:384
    ds_read_b128 v[136:139], v169 offset:256
    v_mfma_f32_16x16x32_bf16 v[196:199], v[204:207], v[76:79], v[196:199]
    buffer_load_dwordx4 v211, s[8:11], s25 offen offset:3072 lds
    v_mfma_f32_32x32x16_bf16 v[32:47], v[80:83], a[124:127], v[32:47]
    ds_read_b128 v[140:143], v169 offset:128
    ds_read_b128 v[144:147], v169 offset:0
    s_waitcnt lgkmcnt(6)
    v_mfma_f32_32x32x16_bf16 v[48:63], a[124:127], v[84:87], v[48:63]
    s_andn2_b32 s30, s30, 2048
    s_add_u32 m0, s30, 153088
    s_mov_b32 exec_lo, s20
    buffer_load_dwordx4 v255, s[8:11], s28 offen lds
    s_mov_b32 exec_lo, -1
    v_mfma_f32_16x16x32_bf16 v[64:67], v[88:91], a[108:111], v[64:67]
    s_waitcnt vmcnt(13)
    ds_read_b128 a[144:147], v236 offset:16384
    ds_read_b128 a[148:151], v237 offset:16384
    ds_read_b128 a[152:155], v238 offset:16384
    ds_read_b128 a[156:159], v239 offset:16384
    v_mfma_f32_4x4x4_16b_bf16 v[176:179], a[128:129], a[128:129], v[176:179]
    s_add_u32 m0, s45, 0
    s_nop 0
    buffer_load_dwordx4 v208, s[8:11], s26 offen offset:0 lds
    v_mfma_f32_4x4x4_16b_bf16 v[180:183], a[130:131], a[130:131], v[180:183]
    v_mfma_f32_16x16x32_bf16 v[188:191], v[204:207], a[128:131], v[188:191]
    v_mfma_f32_4x4x4_16b_bf16 v[176:179], a[132:133], a[132:133], v[176:179]
    buffer_load_dwordx4 v209, s[8:11], s26 offen offset:1024 lds
    v_mfma_f32_4x4x4_16b_bf16 v[180:183], a[134:135], a[134:135], v[180:183]
    v_mfma_f32_16x16x32_bf16 v[188:191], v[204:207], a[132:135], v[188:191]
    v_mfma_f32_4x4x4_16b_bf16 v[176:179], a[136:137], a[136:137], v[176:179]
    buffer_load_dwordx4 v210, s[8:11], s26 offen offset:2048 lds
    v_mfma_f32_4x4x4_16b_bf16 v[180:183], a[138:139], a[138:139], v[180:183]
    v_mfma_f32_16x16x32_bf16 v[188:191], v[204:207], a[136:139], v[188:191]
    v_mfma_f32_4x4x4_16b_bf16 v[176:179], a[140:141], a[140:141], v[176:179]
    buffer_load_dwordx4 v211, s[8:11], s26 offen offset:3072 lds
    v_mfma_f32_4x4x4_16b_bf16 v[180:183], a[142:143], a[142:143], v[180:183]
    v_mfma_f32_16x16x32_bf16 v[188:191], v[204:207], a[140:143], v[188:191]
    v_mfma_f32_16x16x32_bf16 v[184:187], a[104:107], a[104:107], 0
    v_mfma_f32_16x16x32_bf16 v[184:187], a[108:111], a[108:111], v[184:187]
    s_waitcnt lgkmcnt(3)
    v_mfma_f32_16x16x32_bf16 v[184:187], v[192:195], v[192:195], v[184:187]
    s_waitcnt vmcnt(13)
    s_barrier
    v_mfma_f32_16x16x32_bf16 v[184:187], v[200:203], v[200:203], v[184:187]
    s_mul_i32 s29, s24, 1344
    s_add_u32 m0, s46, 24576
    s_nop 0
    buffer_load_dwordx4 v212, s[12:15], s29 offen offset:0 lds
    v_mfma_f32_4x4x4_16b_bf16 v[176:179], a[144:145], a[144:145], v[176:179]
    ds_read_b64_tr_b16 v[92:93], v8 offset:15360
    v_mfma_f32_4x4x4_16b_bf16 v[180:183], a[146:147], a[146:147], v[180:183]
    ds_read_b64_tr_b16 v[94:95], v8 offset:14336
    v_mfma_f32_16x16x32_bf16 v[188:191], v[204:207], a[144:147], v[188:191]
    ds_read_b128 v[224:227], v240 offset:4096
    ds_read_b128 v[228:231], v241 offset:4096
    s_waitcnt lgkmcnt(5)
    v_mfma_f32_4x4x4_16b_bf16 v[176:179], a[148:149], a[148:149], v[176:179]
    s_add_u32 m0, s46, 24576
    s_nop 0
    buffer_load_dwordx4 v213, s[12:15], s29 offen offset:1024 lds
    v_mfma_f32_4x4x4_16b_bf16 v[180:183], a[150:151], a[150:151], v[180:183]
    ds_read_b64_tr_b16 v[96:97], v8 offset:12288
    v_mfma_f32_16x16x32_bf16 v[188:191], v[204:207], a[148:151], v[188:191]
    ds_read_b128 a[224:227], v240 offset:6144
    ds_read_b128 a[228:231], v241 offset:6144
    v_mfma_f32_4x4x4_16b_bf16 v[176:179], a[152:153], a[152:153], v[176:179]
    ds_read_b64_tr_b16 v[98:99], v8 offset:16384
    v_mfma_f32_4x4x4_16b_bf16 v[180:183], a[154:155], a[154:155], v[180:183]
    ds_read_b64_tr_b16 v[68:69], v8 offset:13312
    v_mfma_f32_16x16x32_bf16 v[188:191], v[204:207], a[152:155], v[188:191]
    s_add_u32 m0, s46, 24576
    s_nop 0
    buffer_load_dwordx4 v214, s[12:15], s29 offen offset:2048 lds
    s_waitcnt lgkmcnt(9)
    v_mfma_f32_4x4x4_16b_bf16 v[176:179], a[156:157], a[156:157], v[176:179]
    ds_read_b64_tr_b16 v[70:71], v8 offset:17408
    v_mfma_f32_4x4x4_16b_bf16 v[180:183], a[158:159], a[158:159], v[180:183]
    ds_read_b64_tr_b16 v[72:73], v8 offset:15872
    v_mfma_f32_16x16x32_bf16 v[188:191], v[204:207], a[156:159], v[188:191]
    ds_read_b128 a[232:235], v240 offset:8192
    ds_read_b128 a[236:239], v241 offset:8192
    s_waitcnt lgkmcnt(11)
    v_mfma_f32_32x32x16_bf16 v[16:31], v[92:95], a[128:131], v[16:31]
    ds_read_b128 a[240:243], v240 offset:10240
    ds_read_b128 a[244:247], v241 offset:10240
    ds_read_b64_tr_b16 v[74:75], v8 offset:14848
    ds_read_b64_tr_b16 v[76:77], v8 offset:12800
    v_mfma_f32_16x16x32_bf16 v[196:199], v[204:207], v[92:95], v[196:199]
    ds_read_b64_tr_b16 v[78:79], v8 offset:16896
    ds_read_b64_tr_b16 v[80:81], v8 offset:13824
    s_waitcnt lgkmcnt(11)
    v_mfma_f32_32x32x16_bf16 v[32:47], v[96:99], a[128:131], v[32:47]
    ds_read_b64_tr_b16 v[82:83], v8 offset:17920
    ds_read_b64_tr_b16 v[84:85], v10 offset:12288
    ds_read_b64_tr_b16 v[86:87], v10 offset:16384
    ds_read_b64_tr_b16 v[88:89], v8 offset:21504
    s_waitcnt lgkmcnt(13)
    v_mfma_f32_32x32x16_bf16 v[48:63], a[128:131], v[68:71], v[48:63]
    ds_read_b64_tr_b16 v[90:91], v8 offset:20480
    ds_read_b64_tr_b16 v[92:93], v8 offset:18432
    ds_read_b64_tr_b16 v[94:95], v8 offset:22528
    ds_read_b64_tr_b16 v[96:97], v8 offset:19456
    s_waitcnt lgkmcnt(11)
    v_mfma_f32_32x32x16_bf16 v[16:31], v[72:75], a[132:135], v[16:31]
    ds_read_b64_tr_b16 v[98:99], v8 offset:23552
    ds_read_b64_tr_b16 v[68:69], v8 offset:22016
    ds_read_b64_tr_b16 v[70:71], v8 offset:20992
    v_mfma_f32_16x16x32_bf16 v[196:199], v[204:207], v[72:75], v[196:199]
    ds_read_b64_tr_b16 v[72:73], v8 offset:18944
    ds_read_b64_tr_b16 v[74:75], v8 offset:23040
    s_waitcnt lgkmcnt(12)
    v_mfma_f32_32x32x16_bf16 v[32:47], v[76:79], a[132:135], v[32:47]
    ds_read_b64_tr_b16 v[76:77], v8 offset:19968
    ds_read_b64_tr_b16 v[78:79], v8 offset:24064
    v_mfma_f32_32x32x16_bf16 v[48:63], a[132:135], v[80:83], v[48:63]
    ds_read_b64_tr_b16 v[80:81], v10 offset:18432
    ds_read_b64_tr_b16 v[82:83], v10 offset:22528
    s_waitcnt lgkmcnt(12)
    v_mfma_f32_16x16x32_bf16 v[64:67], v[84:87], v[192:195], v[64:67]
    s_waitcnt vmcnt(8)
    ds_read_b128 a[160:163], v236 offset:32768
    ds_read_b128 a[164:167], v237 offset:32768
    ds_read_b128 a[168:171], v238 offset:32768
    ds_read_b128 a[172:175], v239 offset:32768
    v_mfma_f32_32x32x16_bf16 v[16:31], v[88:91], a[136:139], v[16:31]
    s_add_u32 m0, s45, 16384
    s_nop 0
    buffer_load_dwordx4 v208, s[8:11], s27 offen offset:0 lds
    v_mfma_f32_16x16x32_bf16 v[196:199], v[204:207], v[88:91], v[196:199]
    buffer_load_dwordx4 v209, s[8:11], s27 offen offset:1024 lds
    s_waitcnt lgkmcnt(12)
    v_mfma_f32_32x32x16_bf16 v[32:47], v[92:95], a[136:139], v[32:47]
    v_mfma_f32_32x32x16_bf16 v[48:63], a[136:139], v[96:99], v[48:63]
    buffer_load_dwordx4 v210, s[8:11], s27 offen offset:2048 lds
    s_waitcnt lgkmcnt(8)
    v_mfma_f32_32x32x16_bf16 v[16:31], v[68:71], a[140:143], v[16:31]
    buffer_load_dwordx4 v211, s[8:11], s27 offen offset:3072 lds
    v_mfma_f32_16x16x32_bf16 v[196:199], v[204:207], v[68:71], v[196:199]
    v_mfma_f32_32x32x16_bf16 v[32:47], v[72:75], a[140:143], v[32:47]
    s_waitcnt lgkmcnt(3)
    v_mfma_f32_32x32x16_bf16 v[48:63], a[140:143], v[76:79], v[48:63]
    v_mfma_f32_16x16x32_bf16 v[64:67], v[80:83], v[200:203], v[64:67]
    s_waitcnt vmcnt(7)
    ds_read_b128 a[176:179], v236 offset:0
    ds_read_b128 a[180:183], v237 offset:0
    ds_read_b128 a[184:187], v238 offset:0
    ds_read_b128 a[188:191], v239 offset:0
    v_mfma_f32_4x4x4_16b_bf16 v[176:179], a[160:161], a[160:161], v[176:179]
    s_waitcnt lgkmcnt(4)
    s_add_u32 m0, s45, 32768
    s_nop 0
    buffer_load_dwordx4 v208, s[8:11], s28 offen offset:0 lds
    v_mfma_f32_4x4x4_16b_bf16 v[180:183], a[162:163], a[162:163], v[180:183]
    v_mfma_f32_16x16x32_bf16 v[188:191], v[204:207], a[160:163], v[188:191]
    v_mfma_f32_4x4x4_16b_bf16 v[176:179], a[164:165], a[164:165], v[176:179]
    buffer_load_dwordx4 v209, s[8:11], s28 offen offset:1024 lds
    v_mfma_f32_4x4x4_16b_bf16 v[180:183], a[166:167], a[166:167], v[180:183]
    v_mfma_f32_16x16x32_bf16 v[188:191], v[204:207], a[164:167], v[188:191]
    v_mfma_f32_4x4x4_16b_bf16 v[176:179], a[168:169], a[168:169], v[176:179]
    buffer_load_dwordx4 v210, s[8:11], s28 offen offset:2048 lds
    v_mfma_f32_4x4x4_16b_bf16 v[180:183], a[170:171], a[170:171], v[180:183]
    v_mfma_f32_16x16x32_bf16 v[188:191], v[204:207], a[168:171], v[188:191]
    v_mfma_f32_4x4x4_16b_bf16 v[176:179], a[172:173], a[172:173], v[176:179]
    buffer_load_dwordx4 v211, s[8:11], s28 offen offset:3072 lds
    v_mfma_f32_4x4x4_16b_bf16 v[180:183], a[174:175], a[174:175], v[180:183]
    v_mfma_f32_16x16x32_bf16 v[188:191], v[204:207], a[172:175], v[188:191]
    v_mfma_f32_16x16x32_bf16 v[184:187], v[224:227], v[224:227], v[184:187]
    v_mov_b32 v156, -1
    v_mov_b32 v157, -1
    v_mov_b32 v158, -1
    v_mov_b32 v159, -1
    s_lshl_b32 s44, 1, s49
    s_sub_u32 s44, s44, 1
    s_and_b32 s44, s44, 0xf211fe00
    s_bcnt1_i32_b32 s44, s44
    s_lshl2_add_u32 s44, s44, s50
    s_mul_i32 s44, s44, 9216
    s_lshl_b32 s5, s48, 21
    s_add_u32 s44, s44, s5
    buffer_store_dwordx4 v[156:159], v1, s[36:39], s44 offen offset:0
    v_mfma_f32_16x16x32_bf16 v[184:187], v[228:231], v[228:231], v[184:187]
    s_waitcnt lgkmcnt(3)
    v_mfma_f32_16x16x32_bf16 v[184:187], a[224:227], a[224:227], v[184:187]
    s_waitcnt vmcnt(9)
    s_barrier
    buffer_store_dwordx4 v[156:159], v1, s[36:39], s44 offen offset:1024
    v_mfma_f32_16x16x32_bf16 v[184:187], a[228:231], a[228:231], v[184:187]
    ds_read_b128 a[248:251], v240 offset:12288
    ds_read_b128 a[252:255], v241 offset:12288
    v_mfma_f32_4x4x4_16b_bf16 v[176:179], a[176:177], a[176:177], v[176:179]
    buffer_store_dwordx4 v[156:159], v1, s[36:39], s44 offen offset:2048
    v_mfma_f32_4x4x4_16b_bf16 v[180:183], a[178:179], a[178:179], v[180:183]
    ds_read_b64_tr_b16 v[84:85], v8 offset:27648
    v_mfma_f32_16x16x32_bf16 v[188:191], v[204:207], a[176:179], v[188:191]
    ds_read_b64_tr_b16 v[86:87], v8 offset:26624
    ds_read_b64_tr_b16 v[88:89], v8 offset:24576
    s_waitcnt lgkmcnt(6)
    v_mfma_f32_4x4x4_16b_bf16 v[176:179], a[180:181], a[180:181], v[176:179]
    buffer_store_dwordx4 v[156:159], v1, s[36:39], s44 offen offset:3072
    v_mfma_f32_4x4x4_16b_bf16 v[180:183], a[182:183], a[182:183], v[180:183]
    ds_read_b64_tr_b16 v[90:91], v8 offset:28672
    v_mfma_f32_16x16x32_bf16 v[188:191], v[204:207], a[180:183], v[188:191]
    ds_read_b64_tr_b16 v[92:93], v8 offset:25600
    ds_read_b64_tr_b16 v[94:95], v8 offset:29696
    v_mfma_f32_4x4x4_16b_bf16 v[176:179], a[184:185], a[184:185], v[176:179]
    s_add_u32 s44, s44, 4096
    buffer_store_dwordx4 v[156:159], v1, s[36:39], s44 offen offset:0
    v_mfma_f32_4x4x4_16b_bf16 v[180:183], a[186:187], a[186:187], v[180:183]
    v_mfma_f32_16x16x32_bf16 v[188:191], v[204:207], a[184:187], v[188:191]
    ds_read_b64_tr_b16 v[96:97], v8 offset:28160
    ds_read_b64_tr_b16 v[98:99], v8 offset:27136
    s_waitcnt lgkmcnt(10)
    v_mfma_f32_4x4x4_16b_bf16 v[176:179], a[188:189], a[188:189], v[176:179]
    buffer_store_dwordx4 v[156:159], v1, s[36:39], s44 offen offset:1024
    v_mfma_f32_4x4x4_16b_bf16 v[180:183], a[190:191], a[190:191], v[180:183]
    v_mfma_f32_16x16x32_bf16 v[188:191], v[204:207], a[188:191], v[188:191]
    ds_read_b64_tr_b16 v[68:69], v8 offset:25088
    ds_read_b64_tr_b16 v[70:71], v8 offset:29184
    s_waitcnt lgkmcnt(8)
    v_mfma_f32_32x32x16_bf16 v[16:31], v[84:87], a[144:147], v[16:31]
    buffer_store_dwordx4 v[156:159], v1, s[36:39], s44 offen offset:2048
    ds_read_b64_tr_b16 v[72:73], v8 offset:26112
    ds_read_b64_tr_b16 v[74:75], v8 offset:30208
    v_mfma_f32_16x16x32_bf16 v[196:199], v[204:207], v[84:87], v[196:199]
    buffer_store_dwordx4 v[156:159], v1, s[36:39], s44 offen offset:3072
    s_waitcnt lgkmcnt(6)
    v_mfma_f32_32x32x16_bf16 v[32:47], v[88:91], a[144:147], v[32:47]
    ds_read_b64_tr_b16 v[76:77], v10 offset:24576
    ds_read_b64_tr_b16 v[78:79], v10 offset:28672
    ds_read_b64_tr_b16 v[80:81], v8 offset:33792
    ds_read_b64_tr_b16 v[82:83], v8 offset:32768
    v_mfma_f32_32x32x16_bf16 v[48:63], a[144:147], v[92:95], v[48:63]
    s_add_u32 s44, s44, 4096
    buffer_store_dwordx4 v[156:159], v1, s[36:39], s44 offen offset:0
    ds_read_b64_tr_b16 a[8:9], v233 offset:12288
    ds_read_b64_tr_b16 a[10:11], v233 offset:12800
    ds_read_b64_tr_b16 a[12:13], v233 offset:12352
    ds_read_b64_tr_b16 a[14:15], v233 offset:12864
    s_waitcnt lgkmcnt(10)
    v_mfma_f32_32x32x16_bf16 v[16:31], v[96:99], a[148:151], v[16:31]
    s_lshl3_add_u32 s5, s1, s48
    s_add_u32 s5, s5, 576
    s_and_b32 s6, s5, 3
    s_mul_i32 s6, s6, -1024
    s_lshl_b32 s5, s5, 11
    s_add_u32 s6, s6, 48234496
    s_add_u32 s5, s5, s6
    s_waitcnt lgkmcnt(2)
    buffer_store_dwordx4 a[8:11], v1, s[36:39], s5 offen sc1
    s_add_u32 s5, s5, 4096
    s_waitcnt lgkmcnt(0)
    buffer_store_dwordx4 a[12:15], v1, s[36:39], s5 offen sc1
    ds_read_b64_tr_b16 a[0:1], v233 offset:0
    ds_read_b64_tr_b16 a[2:3], v233 offset:512
    ds_read_b64_tr_b16 a[4:5], v233 offset:64
    ds_read_b64_tr_b16 a[6:7], v233 offset:576
    v_mfma_f32_16x16x32_bf16 v[196:199], v[204:207], v[96:99], v[196:199]
    s_lshl3_add_u32 s5, s1, s48
    s_add_u32 s5, s5, 704
    s_and_b32 s6, s5, 3
    s_mul_i32 s6, s6, -1024
    s_lshl_b32 s5, s5, 11
    s_add_u32 s6, s6, 48234496
    s_add_u32 s5, s5, s6
    s_waitcnt lgkmcnt(2)
    buffer_store_dwordx4 a[0:3], v1, s[36:39], s5 offen sc1
    s_add_u32 s5, s5, 4096
    s_waitcnt lgkmcnt(0)
    buffer_store_dwordx4 a[4:7], v1, s[36:39], s5 offen sc1
    v_mfma_f32_32x32x16_bf16 v[32:47], v[68:71], a[148:151], v[32:47]
    ds_read_b64_tr_b16 v[84:85], v8 offset:30720
    ds_read_b64_tr_b16 v[86:87], v8 offset:34816
    ds_read_b64_tr_b16 v[88:89], v8 offset:31744
    ds_read_b64_tr_b16 v[90:91], v8 offset:35840
    v_mfma_f32_32x32x16_bf16 v[48:63], a[148:151], v[72:75], v[48:63]
    s_mul_i32 s29, s25, 1344
    s_add_u32 m0, s46, 36864
    s_nop 0
    buffer_load_dwordx4 v212, s[12:15], s29 offen offset:0 lds
    ds_read_b64_tr_b16 v[92:93], v8 offset:34304
    v_mfma_f32_16x16x32_bf16 v[64:67], v[76:79], v[224:227], v[64:67]
    s_waitcnt vmcnt(18)
    ds_read_b128 a[192:195], v236 offset:16384
    ds_read_b128 a[196:199], v237 offset:16384
    ds_read_b128 a[200:203], v238 offset:16384
    ds_read_b128 a[204:207], v239 offset:16384
    v_mfma_f32_32x32x16_bf16 v[16:31], v[80:83], a[152:155], v[16:31]
    s_add_u32 m0, s46, 36864
    s_nop 0
    buffer_load_dwordx4 v213, s[12:15], s29 offen offset:1024 lds
    ds_read_b64_tr_b16 v[94:95], v8 offset:33280
    ds_read_b64_tr_b16 v[96:97], v8 offset:31232
    v_mfma_f32_16x16x32_bf16 v[196:199], v[204:207], v[80:83], v[196:199]
    ds_read_b64_tr_b16 v[98:99], v8 offset:35328
    ds_read_b64_tr_b16 v[68:69], v8 offset:32256
    s_waitcnt lgkmcnt(9)
    v_mfma_f32_32x32x16_bf16 v[32:47], v[84:87], a[152:155], v[32:47]
    s_add_u32 m0, s46, 36864
    s_nop 0
    buffer_load_dwordx4 v214, s[12:15], s29 offen offset:2048 lds
    ds_read_b64_tr_b16 v[70:71], v8 offset:36352
    v_mfma_f32_32x32x16_bf16 v[48:63], a[152:155], v[88:91], v[48:63]
    ds_read_b64_tr_b16 v[72:73], v10 offset:30720
    ds_read_b64_tr_b16 v[74:75], v10 offset:34816
    s_waitcnt lgkmcnt(6)
    v_mfma_f32_32x32x16_bf16 v[16:31], v[92:95], a[156:159], v[16:31]
    s_mul_i32 s29, s26, 1344
    s_add_u32 m0, s46, 49152
    s_nop 0
    buffer_load_dwordx4 v212, s[12:15], s29 offen offset:0 lds
    v_mfma_f32_16x16x32_bf16 v[196:199], v[204:207], v[92:95], v[196:199]
    s_waitcnt lgkmcnt(2)
    v_mfma_f32_32x32x16_bf16 v[32:47], v[96:99], a[156:159], v[32:47]
    s_add_u32 m0, s46, 49152
    s_nop 0
    buffer_load_dwordx4 v213, s[12:15], s29 offen offset:1024 lds
    v_mfma_f32_32x32x16_bf16 v[48:63], a[156:159], v[68:71], v[48:63]
    s_waitcnt lgkmcnt(0)
    v_mfma_f32_16x16x32_bf16 v[64:67], v[72:75], v[228:231], v[64:67]
    s_waitcnt vmcnt(18)
    ds_read_b128 a[208:211], v236 offset:32768
    ds_read_b128 a[212:215], v237 offset:32768
    ds_read_b128 a[216:219], v238 offset:32768
    ds_read_b128 a[220:223], v239 offset:32768
    s_add_u32 m0, s46, 49152
    s_nop 0
    buffer_load_dwordx4 v214, s[12:15], s29 offen offset:2048 lds
    v_mfma_f32_4x4x4_16b_bf16 v[176:179], a[192:193], a[192:193], v[176:179]
    v_mfma_f32_4x4x4_16b_bf16 v[180:183], a[194:195], a[194:195], v[180:183]
    v_mfma_f32_16x16x32_bf16 v[188:191], v[204:207], a[192:195], v[188:191]
    v_mfma_f32_4x4x4_16b_bf16 v[176:179], a[196:197], a[196:197], v[176:179]
    s_mul_i32 s29, s27, 1344
    s_add_u32 m0, s46, 61440
    s_nop 0
    buffer_load_dwordx4 v212, s[12:15], s29 offen offset:0 lds
    v_mfma_f32_4x4x4_16b_bf16 v[180:183], a[198:199], a[198:199], v[180:183]
    v_mfma_f32_16x16x32_bf16 v[188:191], v[204:207], a[196:199], v[188:191]
    v_mfma_f32_4x4x4_16b_bf16 v[176:179], a[200:201], a[200:201], v[176:179]
    v_mfma_f32_4x4x4_16b_bf16 v[180:183], a[202:203], a[202:203], v[180:183]
    v_mfma_f32_16x16x32_bf16 v[188:191], v[204:207], a[200:203], v[188:191]
    s_add_u32 m0, s46, 61440
    s_nop 0
    buffer_load_dwordx4 v213, s[12:15], s29 offen offset:1024 lds
    v_mfma_f32_4x4x4_16b_bf16 v[176:179], a[204:205], a[204:205], v[176:179]
    v_mfma_f32_4x4x4_16b_bf16 v[180:183], a[206:207], a[206:207], v[180:183]
    v_mfma_f32_16x16x32_bf16 v[188:191], v[204:207], a[204:207], v[188:191]
    v_mfma_f32_16x16x32_bf16 v[184:187], a[232:235], a[232:235], v[184:187]
    s_add_u32 m0, s46, 61440
    s_nop 0
    buffer_load_dwordx4 v214, s[12:15], s29 offen offset:2048 lds
    v_mfma_f32_16x16x32_bf16 v[184:187], a[236:239], a[236:239], v[184:187]
    v_mfma_f32_16x16x32_bf16 v[184:187], a[240:243], a[240:243], v[184:187]
    v_mfma_f32_16x16x32_bf16 v[184:187], a[244:247], a[244:247], v[184:187]
    s_waitcnt lgkmcnt(3)
    v_mfma_f32_16x16x32_bf16 v[184:187], a[248:251], a[248:251], v[184:187]
    s_waitcnt vmcnt(6) lgkmcnt(0)
    s_barrier
    v_mfma_f32_16x16x32_bf16 v[184:187], a[252:255], a[252:255], v[184:187]
    s_lshl_b32 s5, s49, 3
    s_add_u32 s5, s5, s58
    s_add_u32 s5, s5, 16384
    s_cmp_eq_u32 s50, 0
    s_cselect_b32 s5, s5, 2146435072
    buffer_store_dwordx2 v[246:247], off, s[36:39], s5
    v_mfma_f32_4x4x4_16b_bf16 v[176:179], a[208:209], a[208:209], v[176:179]
    ds_read_b64_tr_b16 v[76:77], v8 offset:39936
    v_mfma_f32_4x4x4_16b_bf16 v[180:183], a[210:211], a[210:211], v[180:183]
    s_lshl3_add_u32 s5, s1, s48
    s_add_u32 s5, s5, 576
    s_lshl_b32 s5, s5, 5
    s_add_u32 s5, s5, 41975808
    v_mov_b32 v7, s0
    buffer_store_dword v7, off, s[36:39], s5 sc1
    v_mfma_f32_16x16x32_bf16 v[188:191], v[204:207], a[208:211], v[188:191]
    ds_read_b64_tr_b16 v[78:79], v8 offset:38912
    ds_read_b64_tr_b16 v[80:81], v8 offset:36864
    v_mfma_f32_4x4x4_16b_bf16 v[176:179], a[212:213], a[212:213], v[176:179]
    s_lshl3_add_u32 s5, s1, s48
    s_add_u32 s5, s5, 704
    s_lshl_b32 s5, s5, 5
    s_add_u32 s5, s5, 41975808
    v_mov_b32 v7, s0
    buffer_store_dword v7, off, s[36:39], s5 sc1
    v_mfma_f32_4x4x4_16b_bf16 v[180:183], a[214:215], a[214:215], v[180:183]
    ds_read_b64_tr_b16 v[82:83], v8 offset:40960
    v_mfma_f32_16x16x32_bf16 v[188:191], v[204:207], a[212:215], v[188:191]
    ds_read_b64_tr_b16 v[84:85], v8 offset:37888
    ds_read_b64_tr_b16 v[86:87], v8 offset:41984
    v_mfma_f32_4x4x4_16b_bf16 v[176:179], a[216:217], a[216:217], v[176:179]
    v_mfma_f32_4x4x4_16b_bf16 v[180:183], a[218:219], a[218:219], v[180:183]
    v_mfma_f32_16x16x32_bf16 v[188:191], v[204:207], a[216:219], v[188:191]
    s_mul_i32 s29, s28, 1344
    s_add_u32 m0, s46, 73728
    s_nop 0
    buffer_load_dwordx4 v212, s[12:15], s29 offen offset:0 lds
    v_mfma_f32_4x4x4_16b_bf16 v[176:179], a[220:221], a[220:221], v[176:179]
    ds_read_b64_tr_b16 v[88:89], v8 offset:40448
    v_mfma_f32_4x4x4_16b_bf16 v[180:183], a[222:223], a[222:223], v[180:183]
    ds_read_b64_tr_b16 v[90:91], v8 offset:39424
    v_mfma_f32_16x16x32_bf16 v[188:191], v[204:207], a[220:223], v[188:191]
    ds_read_b64_tr_b16 v[92:93], v8 offset:37376
    ds_read_b64_tr_b16 v[94:95], v8 offset:41472
    s_waitcnt lgkmcnt(8)
    v_mfma_f32_32x32x16_bf16 v[16:31], v[76:79], a[160:163], v[16:31]
    s_add_u32 m0, s46, 73728
    s_nop 0
    buffer_load_dwordx4 v213, s[12:15], s29 offen offset:1024 lds
    ds_read_b64_tr_b16 v[96:97], v8 offset:38400
    v_mfma_f32_16x16x32_bf16 v[196:199], v[204:207], v[76:79], v[196:199]
    ds_read_b64_tr_b16 v[98:99], v8 offset:42496
    ds_read_b64_tr_b16 v[68:69], v10 offset:36864
    s_waitcnt lgkmcnt(7)
    v_mfma_f32_32x32x16_bf16 v[32:47], v[80:83], a[160:163], v[32:47]
    s_add_u32 m0, s46, 73728
    s_nop 0
    buffer_load_dwordx4 v214, s[12:15], s29 offen offset:2048 lds
    ds_read_b64_tr_b16 v[70:71], v10 offset:40960
    v_mfma_f32_32x32x16_bf16 v[48:63], a[160:163], v[84:87], v[48:63]
    ds_read_b64_tr_b16 v[72:73], v9 offset:3072
    ds_read_b64_tr_b16 v[74:75], v9 offset:2048
    ds_read_b64_tr_b16 v[76:77], v9 offset:0
    ds_read_b64_tr_b16 v[78:79], v9 offset:4096
    v_cndmask_b32 v176, v176, v177, s[78:79]
    s_waitcnt lgkmcnt(8)
    v_mfma_f32_32x32x16_bf16 v[16:31], v[88:91], a[164:167], v[16:31]
    s_cmp_eq_u32 s48, 7
    s_cselect_b32 s5, 3, s48
    s_lshr_b32 s6, s1, 1
    s_lshl_b32 s5, s5, 5
    s_add_u32 s5, s5, s6
    s_add_u32 s5, s5, 108
    s_sub_u32 s6, s5, 224
    s_cselect_b32 s5, s5, s6
    s_mul_i32 s5, s5, 7168
    buffer_load_dword v221, v222, s[40:43], s5 offen
    v_mfma_f32_16x16x32_bf16 v[196:199], v[204:207], v[88:91], v[196:199]
    ds_read_b64_tr_b16 v[80:81], v9 offset:1024
    ds_read_b64_tr_b16 v[82:83], v9 offset:5120
    v_mfma_f32_32x32x16_bf16 v[32:47], v[92:95], a[164:167], v[32:47]
    ds_read_b64_tr_b16 v[84:85], v9 offset:3584
    ds_read_b64_tr_b16 v[86:87], v9 offset:2560
    ds_read_b64_tr_b16 v[88:89], v9 offset:512
    ds_read_b64_tr_b16 v[90:91], v9 offset:4608
    v_cndmask_b32 v178, v178, v179, s[78:79]
    s_waitcnt lgkmcnt(8)
    v_mfma_f32_32x32x16_bf16 v[48:63], a[164:167], v[96:99], v[48:63]
    ds_read_b64_tr_b16 v[92:93], v9 offset:1536
    ds_read_b64_tr_b16 v[94:95], v9 offset:5632
    ds_read_b64_tr_b16 v[96:97], v11 offset:0
    ds_read_b64_tr_b16 v[98:99], v11 offset:4096
    v_mfma_f32_16x16x32_bf16 v[64:67], v[68:71], a[224:227], v[64:67]
    v_cndmask_b32 v180, v180, v181, s[78:79]
    v_cndmask_b32 v182, v182, v183, s[78:79]
    v_cndmask_b32 v101, 0, v184, s[62:63]
    v_mfma_f32_32x32x16_bf16 v[16:31], v[72:75], a[168:171], v[16:31]
    v_cndmask_b32 v101, v101, v185, s[64:65]
    v_cndmask_b32 v101, v101, v186, s[66:67]
    v_cndmask_b32 v101, v101, v187, s[68:69]
    v_add_f32 v176, v176, v180
    v_add_f32 v178, v178, v182
    v_cndmask_b32 v102, 0, v184, s[76:77]
    v_cndmask_b32 v100, v176, v178, s[80:81]
    v_mfma_f32_16x16x32_bf16 v[196:199], v[204:207], v[72:75], v[196:199]
    v_mov_b32 v104, v101
    v_mov_b32 v105, v102
    v_mov_b32 v106, v100
    s_waitcnt lgkmcnt(8)
    v_mfma_f32_32x32x16_bf16 v[32:47], v[76:79], a[168:171], v[32:47]
    s_waitcnt vmcnt(10)
    s_barrier
    ds_read_b64_tr_b16 v[68:69], v9 offset:9216
    ds_read_b64_tr_b16 v[70:71], v9 offset:8192
    v_permlane32_swap_b32 v101, v104
    v_mfma_f32_32x32x16_bf16 v[48:63], a[168:171], v[80:83], v[48:63]
    s_cmp_eq_u32 s48, 7
    s_cselect_b32 s5, 3, s48
    s_lshr_b32 s6, s1, 1
    s_lshl_b32 s5, s5, 5
    s_add_u32 s5, s5, s6
    s_add_u32 s5, s5, 116
    s_sub_u32 s6, s5, 224
    s_cselect_b32 s5, s5, s6
    s_mul_i32 s5, s5, 7168
    buffer_load_dword v221, v222, s[40:43], s5 offen
    s_waitcnt lgkmcnt(6)
    v_mfma_f32_32x32x16_bf16 v[16:31], v[84:87], a[172:175], v[16:31]
    ds_read_b64_tr_b16 v[72:73], v9 offset:6144
    ds_read_b64_tr_b16 v[74:75], v9 offset:10240
    ds_read_b64_tr_b16 v[76:77], v9 offset:7168
    ds_read_b64_tr_b16 v[78:79], v9 offset:11264
    v_mfma_f32_16x16x32_bf16 v[196:199], v[204:207], v[84:87], v[196:199]
    ds_read_b64_tr_b16 v[80:81], v9 offset:9728
    ds_read_b64_tr_b16 v[82:83], v9 offset:8704
    v_mfma_f32_32x32x16_bf16 v[32:47], v[88:91], a[172:175], v[32:47]
    ds_read_b64_tr_b16 v[84:85], v9 offset:6656
    ds_read_b64_tr_b16 v[86:87], v9 offset:10752
    ds_read_b64_tr_b16 v[88:89], v9 offset:7680
    ds_read_b64_tr_b16 v[90:91], v9 offset:11776
    v_permlane32_swap_b32 v102, v105
    s_waitcnt lgkmcnt(10)
    v_mfma_f32_32x32x16_bf16 v[48:63], a[172:175], v[92:95], v[48:63]
    ds_read_b64_tr_b16 v[92:93], v11 offset:6144
    ds_read_b64_tr_b16 v[94:95], v11 offset:10240
    v_permlane32_swap_b32 v100, v106
    v_add_f32 v101, v101, v104
    v_add_f32 v102, v102, v105
    v_mfma_f32_16x16x32_bf16 v[64:67], v[96:99], a[228:231], v[64:67]
    ds_read_b64_tr_b16 v[96:97], v9 offset:15360
    ds_read_b64_tr_b16 v[98:99], v9 offset:14336
    v_mfma_f32_32x32x16_bf16 v[16:31], v[68:71], a[176:179], v[16:31]
    v_add_f32 v100, v100, v106
    v_mov_b32 v104, v101
    v_mov_b32 v105, v102
    s_nop 0
    v_permlane16_swap_b32 v101, v104
    v_permlane16_swap_b32 v102, v105
    v_add_f32 v101, v101, v104
    v_add_f32 v102, v102, v105
    v_mfma_f32_16x16x32_bf16 v[196:199], v[204:207], v[68:71], v[196:199]
    ds_read_b64_tr_b16 v[68:69], v9 offset:12288
    ds_read_b64_tr_b16 v[70:71], v9 offset:16384
    s_waitcnt lgkmcnt(12)
    v_mfma_f32_32x32x16_bf16 v[32:47], v[72:75], a[176:179], v[32:47]
    ds_read_b64_tr_b16 v[72:73], v9 offset:13312
    ds_read_b64_tr_b16 v[74:75], v9 offset:17408
    v_mul_f32 v148, 0xbb124925, v188
    v_mul_f32 v152, 0xbb124925, v102
    v_mul_f32 v104, 0x3b124925, v100
    v_mfma_f32_32x32x16_bf16 v[48:63], a[176:179], v[76:79], v[48:63]
    ds_read_b64_tr_b16 v[76:77], v9 offset:15872
    ds_read_b64_tr_b16 v[78:79], v9 offset:14848
    v_mul_f32 v105, 0x3b124925, v101
    v_fma_f32 v104, -v148, v148, v104
    v_fma_f32 v105, -v152, v152, v105
    v_max_f32 v104, 0, v104
    s_waitcnt lgkmcnt(12)
    v_mfma_f32_32x32x16_bf16 v[16:31], v[80:83], a[180:183], v[16:31]
    v_max_f32 v105, 0, v105
    v_cvt_pk_bf16_f32 v148, v148, v148
    v_cvt_pk_bf16_f32 v152, v152, v152
    v_cvt_pk_bf16_f32 v104, v104, v104
    v_cvt_pk_bf16_f32 v105, v105, v105
    v_lshlrev_b32 v104, 16, v104
    v_mfma_f32_16x16x32_bf16 v[196:199], v[204:207], v[80:83], v[196:199]
    ds_read_b64_tr_b16 v[80:81], v9 offset:12800
    ds_read_b64_tr_b16 v[82:83], v9 offset:16896
    v_mfma_f32_32x32x16_bf16 v[32:47], v[84:87], a[180:183], v[32:47]
    ds_read_b64_tr_b16 v[84:85], v9 offset:13824
    ds_read_b64_tr_b16 v[86:87], v9 offset:17920
    v_lshlrev_b32 v105, 16, v105
    v_add_f32 v104, 0x3727c5ac, v104
    v_add_f32 v105, 0x3727c5ac, v105
    v_cvt_pk_bf16_f32 v104, v104, v104
    s_waitcnt lgkmcnt(10)
    v_mfma_f32_32x32x16_bf16 v[48:63], a[180:183], v[88:91], v[48:63]
    ds_read_b64_tr_b16 v[88:89], v11 offset:12288
    ds_read_b64_tr_b16 v[90:91], v11 offset:16384
    v_cvt_pk_bf16_f32 v105, v105, v105
    v_lshlrev_b32 v104, 16, v104
    v_lshlrev_b32 v105, 16, v105
    v_mfma_f32_16x16x32_bf16 v[64:67], v[92:95], a[232:235], v[64:67]
    v_sqrt_f32 v104, v104
    v_mfma_f32_32x32x16_bf16 v[16:31], v[96:99], a[184:187], v[16:31]
    v_sqrt_f32 v105, v105
    v_cvt_pk_bf16_f32 v104, v104, v104
    v_cvt_pk_bf16_f32 v105, v105, v105
    v_lshlrev_b32 v104, 16, v104
    v_lshlrev_b32 v105, 16, v105
    v_mfma_f32_16x16x32_bf16 v[196:199], v[204:207], v[96:99], v[196:199]
    v_rcp_f32 v168, v104
    s_waitcnt lgkmcnt(8)
    v_mfma_f32_32x32x16_bf16 v[32:47], v[68:71], a[184:187], v[32:47]
    s_waitcnt vmcnt(8)
    s_barrier
    ds_read_b64_tr_b16 v[92:93], v9 offset:21504
    ds_read_b64_tr_b16 v[94:95], v9 offset:20480
    v_mfma_f32_32x32x16_bf16 v[48:63], a[184:187], v[72:75], v[48:63]
    buffer_load_dwordx2 v[246:247], v252, s[36:39], 0 offen sc1
    ds_read_b64_tr_b16 v[96:97], v9 offset:18432
    ds_read_b64_tr_b16 v[98:99], v9 offset:22528
    s_waitcnt lgkmcnt(8)
    v_mfma_f32_32x32x16_bf16 v[16:31], v[76:79], a[188:191], v[16:31]
    ds_read_b64_tr_b16 v[68:69], v9 offset:19456
    ds_read_b64_tr_b16 v[70:71], v9 offset:23552
    ds_read_b64_tr_b16 v[72:73], v9 offset:22016
    ds_read_b64_tr_b16 v[74:75], v9 offset:20992
    v_mfma_f32_16x16x32_bf16 v[196:199], v[204:207], v[76:79], v[196:199]
    s_cmp_eq_u32 s48, 7
    s_cselect_b32 s5, 3, s48
    s_lshr_b32 s6, s1, 1
    s_lshl_b32 s5, s5, 5
    s_add_u32 s5, s5, s6
    s_add_u32 s5, s5, 124
    s_sub_u32 s6, s5, 224
    s_cselect_b32 s5, s5, s6
    s_mul_i32 s5, s5, 7168
    buffer_load_dword v221, v222, s[40:43], s5 offen
    v_mfma_f32_32x32x16_bf16 v[32:47], v[80:83], a[188:191], v[32:47]
    ds_read_b64_tr_b16 v[76:77], v9 offset:18944
    ds_read_b64_tr_b16 v[78:79], v9 offset:23040
    ds_read_b64_tr_b16 v[80:81], v9 offset:19968
    ds_read_b64_tr_b16 v[82:83], v9 offset:24064
    s_waitcnt lgkmcnt(10)
    v_mfma_f32_32x32x16_bf16 v[48:63], a[188:191], v[84:87], v[48:63]
    ds_read_b64_tr_b16 v[84:85], v11 offset:18432
    ds_read_b64_tr_b16 v[86:87], v11 offset:22528
    v_rcp_f32 v101, v105
    v_mfma_f32_16x16x32_bf16 v[64:67], v[88:91], a[236:239], v[64:67]
    ds_read_b64_tr_b16 v[88:89], v9 offset:27648
    ds_read_b64_tr_b16 v[90:91], v9 offset:26624
    v_mfma_f32_32x32x16_bf16 v[16:31], v[92:95], a[192:195], v[16:31]
    ds_write_b32 v242, v168 offset:1024
    ds_write_b32 v243, v101 offset:1024
    v_cndmask_b32 v152, v152, 0, s[90:91]
    v_mul_f32 v168, 0x3e8b97f6, v168
    v_mfma_f32_16x16x32_bf16 v[196:199], v[204:207], v[92:95], v[196:199]
    ds_read_b64_tr_b16 v[92:93], v9 offset:24576
    ds_read_b64_tr_b16 v[94:95], v9 offset:28672
    s_waitcnt lgkmcnt(14)
    v_mfma_f32_32x32x16_bf16 v[32:47], v[96:99], a[192:195], v[32:47]
    ds_read_b64_tr_b16 v[96:97], v9 offset:25600
    ds_read_b64_tr_b16 v[98:99], v9 offset:29696
    v_mfma_f32_32x32x16_bf16 v[48:63], a[192:195], v[68:71], v[48:63]
    ds_read_b64_tr_b16 v[68:69], v9 offset:28160
    ds_read_b64_tr_b16 v[70:71], v9 offset:27136
    s_waitcnt lgkmcnt(14)
    v_mfma_f32_32x32x16_bf16 v[16:31], v[72:75], a[196:199], v[16:31]
    v_mfma_f32_16x16x32_bf16 v[196:199], v[204:207], v[72:75], v[196:199]
    ds_read_b64_tr_b16 v[72:73], v9 offset:25088
    ds_read_b64_tr_b16 v[74:75], v9 offset:29184
    v_mfma_f32_32x32x16_bf16 v[32:47], v[76:79], a[196:199], v[32:47]
    ds_read_b64_tr_b16 v[76:77], v9 offset:26112
    ds_read_b64_tr_b16 v[78:79], v9 offset:30208
    s_waitcnt lgkmcnt(12)
    v_mfma_f32_32x32x16_bf16 v[48:63], a[196:199], v[80:83], v[48:63]
    ds_read_b64_tr_b16 v[80:81], v11 offset:24576
    ds_read_b64_tr_b16 v[82:83], v11 offset:28672
    v_mfma_f32_16x16x32_bf16 v[64:67], v[84:87], a[240:243], v[64:67]
    v_mfma_f32_32x32x16_bf16 v[16:31], v[88:91], a[200:203], v[16:31]
    v_mfma_f32_16x16x32_bf16 v[196:199], v[204:207], v[88:91], v[196:199]
    s_waitcnt lgkmcnt(8)
    v_mfma_f32_32x32x16_bf16 v[32:47], v[92:95], a[200:203], v[32:47]
    s_waitcnt vmcnt(4) lgkmcnt(0)
    s_barrier
    ds_read_b64_tr_b16 v[84:85], v11 offset:30720
    ds_read_b64_tr_b16 v[86:87], v11 offset:34816
    v_mfma_f32_32x32x16_bf16 v[48:63], a[200:203], v[96:99], v[48:63]
    s_cmp_eq_u32 s48, 7
    s_cselect_b32 s5, 3, s48
    s_lshr_b32 s6, s1, 1
    s_lshl_b32 s5, s5, 5
    s_add_u32 s5, s5, s6
    s_add_u32 s5, s5, 132
    s_sub_u32 s6, s5, 224
    s_cselect_b32 s5, s5, s6
    s_mul_i32 s5, s5, 7168
    buffer_load_dword v221, v222, s[40:43], s5 offen
    v_mfma_f32_32x32x16_bf16 v[16:31], v[68:71], a[204:207], v[16:31]
    ds_read_b64_tr_b16 v[88:89], v11 offset:36864
    ds_read_b64_tr_b16 v[90:91], v11 offset:40960
    ds_read_b64_tr_b16 v[92:93], v9 offset:33792
    ds_read_b64_tr_b16 v[94:95], v9 offset:32768
    v_mfma_f32_16x16x32_bf16 v[196:199], v[204:207], v[68:71], v[196:199]
    ds_read_b64_tr_b16 v[96:97], v9 offset:34304
    ds_read_b64_tr_b16 v[98:99], v9 offset:33280
    v_mfma_f32_32x32x16_bf16 v[32:47], v[72:75], a[204:207], v[32:47]
    ds_read_b64_tr_b16 v[68:69], v9 offset:39936
    ds_read_b64_tr_b16 v[70:71], v9 offset:38912
    ds_read_b64_tr_b16 v[72:73], v9 offset:40448
    ds_read_b64_tr_b16 v[74:75], v9 offset:39424
    s_waitcnt lgkmcnt(10)
    v_mfma_f32_32x32x16_bf16 v[48:63], a[204:207], v[76:79], v[48:63]
    ds_read_b64_tr_b16 v[76:77], v9 offset:30720
    ds_read_b64_tr_b16 v[78:79], v9 offset:34816
    ds_read_b32 v160, v164 offset:1024
    ds_read_b32 v161, v165 offset:1024
    v_mfma_f32_16x16x32_bf16 v[64:67], v[80:83], a[244:247], v[64:67]
    ds_read_b64_tr_b16 v[80:81], v9 offset:31744
    ds_read_b64_tr_b16 v[82:83], v9 offset:35840
    v_mfma_f32_16x16x32_bf16 v[64:67], v[84:87], a[248:251], v[64:67]
    ds_read_b64_tr_b16 v[84:85], v9 offset:31232
    ds_read_b64_tr_b16 v[86:87], v9 offset:35328
    s_waitcnt lgkmcnt(14)
    v_mfma_f32_16x16x32_bf16 v[64:67], v[88:91], a[252:255], v[64:67]
    ds_read_b64_tr_b16 v[88:89], v9 offset:32256
    v_mfma_f32_32x32x16_bf16 v[16:31], v[92:95], a[208:211], v[16:31]
    ds_read_b64_tr_b16 v[90:91], v9 offset:36352
    ds_read_b32 v162, v166 offset:1024
    ds_read_b32 v163, v167 offset:1024
    v_mfma_f32_16x16x32_bf16 v[196:199], v[204:207], v[92:95], v[196:199]
    ds_read_b64_tr_b16 v[92:93], v9 offset:36864
    ds_read_b64_tr_b16 v[94:95], v9 offset:40960
    s_waitcnt lgkmcnt(15)
    v_mfma_f32_32x32x16_bf16 v[16:31], v[96:99], a[212:215], v[16:31]
    v_and_b32 v108, 0xffff0000, v64
    v_and_b32 v109, 0xffff0000, v65
    v_and_b32 v110, 0xffff0000, v66
    v_and_b32 v111, 0xffff0000, v67
    v_sub_f32 v104, v64, v108
    v_sub_f32 v105, v65, v109
    v_mfma_f32_16x16x32_bf16 v[196:199], v[204:207], v[96:99], v[196:199]
    ds_read_b64_tr_b16 v[96:97], v9 offset:37888
    ds_read_b64_tr_b16 v[98:99], v9 offset:41984
    v_mfma_f32_32x32x16_bf16 v[16:31], v[68:71], a[216:219], v[16:31]
    v_sub_f32 v106, v66, v110
    v_sub_f32 v107, v67, v111
    v_and_b32 v100, 0xffff0000, v104
    v_and_b32 v101, 0xffff0000, v105
    v_and_b32 v102, 0xffff0000, v106
    v_and_b32 v103, 0xffff0000, v107
    v_sub_f32 v104, v104, v100
    v_mfma_f32_16x16x32_bf16 v[196:199], v[204:207], v[68:71], v[196:199]
    ds_read_b64_tr_b16 v[68:69], v9 offset:37376
    ds_read_b64_tr_b16 v[70:71], v9 offset:41472
    s_waitcnt lgkmcnt(15)
    v_mfma_f32_32x32x16_bf16 v[16:31], v[72:75], a[220:223], v[16:31]
    v_sub_f32 v105, v105, v101
    v_sub_f32 v106, v106, v102
    v_sub_f32 v107, v107, v103
    v_lshrrev_b32 v108, 16, v108
    v_lshrrev_b32 v109, 16, v109
    v_lshrrev_b32 v110, 16, v110
    v_mfma_f32_16x16x32_bf16 v[196:199], v[204:207], v[72:75], v[196:199]
    ds_read_b64_tr_b16 v[72:73], v9 offset:38400
    ds_read_b64_tr_b16 v[74:75], v9 offset:42496
    v_mfma_f32_32x32x16_bf16 v[32:47], v[76:79], a[208:211], v[32:47]
    v_lshrrev_b32 v111, 16, v111
    v_or_b32 v100, v100, v108
    v_or_b32 v101, v101, v109
    v_or_b32 v102, v102, v110
    v_or_b32 v103, v103, v111
    v_lshrrev_b32 v104, 16, v104
    v_lshrrev_b32 v105, 16, v105
    s_waitcnt lgkmcnt(12)
    v_mfma_f32_32x32x16_bf16 v[48:63], a[208:211], v[80:83], v[48:63]
    v_lshrrev_b32 v106, 16, v106
    v_lshrrev_b32 v107, 16, v107
    ds_write_b128 v244, v[100:103]
    v_mfma_f32_32x32x16_bf16 v[32:47], v[84:87], a[212:215], v[32:47]
    ds_write_b128 v244, v[104:107] offset:128
    v_and_b32 v199, 0xffff0000, v196
    v_mul_f32 v164, v160, v168
    v_sub_f32 v198, v196, v199
    s_waitcnt lgkmcnt(8)
    v_mfma_f32_32x32x16_bf16 v[48:63], a[212:215], v[88:91], v[48:63]
    v_mul_f32 v165, v161, v168
    v_and_b32 v197, 0xffff0000, v198
    v_sub_f32 v198, v198, v197
    v_mul_f32 v166, v162, v168
    v_lshrrev_b32 v199, 16, v199
    v_or_b32 v197, v197, v199
    v_mfma_f32_32x32x16_bf16 v[32:47], v[92:95], a[216:219], v[32:47]
    v_mul_f32 v167, v163, v168
    v_lshrrev_b32 v198, 16, v198
    v_cndmask_b32 v196, v197, v198, s[90:91]
    ds_write_b32 v170, v196
    s_waitcnt lgkmcnt(0)
    s_barrier
    v_mfma_f32_32x32x16_bf16 v[48:63], a[216:219], v[96:99], v[48:63]
    ds_read_b32 v76, v170 offset:256
    ds_read_b32 v80, v170 offset:512
    ds_read_b32 v84, v171
    ds_read_b32 v88, v170 offset:0
    v_mfma_f32_32x32x16_bf16 v[32:47], v[68:71], a[220:223], v[32:47]
    v_mfma_f32_32x32x16_bf16 v[48:63], a[220:223], v[72:75], v[48:63]
    s_waitcnt lgkmcnt(3)
    v_mfma_f32_32x32x16_bf16 v[32:47], v[76:79], v[148:151], v[32:47]
    s_waitcnt lgkmcnt(0)
    v_mfma_f32_32x32x16_bf16 v[48:63], v[148:151], v[80:83], v[48:63]
    s_nop 9
    v_cvt_pk_bf16_f32 v32, v32, v33
    v_cvt_pk_bf16_f32 v33, v34, v35
    v_cvt_pk_bf16_f32 v34, v36, v37
    v_cvt_pk_bf16_f32 v35, v38, v39
    v_cvt_pk_bf16_f32 v36, v40, v41
    v_cvt_pk_bf16_f32 v37, v42, v43
    v_mfma_f32_16x16x32_bf16 v[64:67], v[84:87], v[152:155], v[64:67]
    v_cvt_pk_bf16_f32 v38, v44, v45
    v_cvt_pk_bf16_f32 v39, v46, v47
    v_mfma_f32_32x32x16_bf16 v[16:31], v[88:91], v[148:151], v[16:31]
    s_mov_b32 exec_lo, 0xffff0000
    s_mov_b32 exec_hi, 0xffff0000
    ds_write_b128 v13, v[32:35] offset:2048
    ds_write_b128 v13, v[36:39] offset:2560
    s_mov_b64 exec, -1
    v_cvt_pk_bf16_f32 v48, v48, v49
    v_cvt_pk_bf16_f32 v49, v50, v51
    v_cvt_pk_bf16_f32 v50, v52, v53
    v_cvt_pk_bf16_f32 v51, v54, v55
    v_cvt_pk_bf16_f32 v52, v56, v57
    v_cvt_pk_bf16_f32 v53, v58, v59
    v_cvt_pk_bf16_f32 v54, v60, v61
    v_cvt_pk_bf16_f32 v55, v62, v63
    ds_write_b128 v14, v[52:55] offset:3072
    v_cvt_pk_bf16_f32 v64, v64, v65
    v_cvt_pk_bf16_f32 v65, v66, v67
    ds_write_b64 v15, v[64:65]
    ds_write_b16 v4, v64
    ds_write_b16_d16_hi v4, v64 offset:16
    ds_write_b16 v4, v65 offset:32
    ds_write_b16_d16_hi v4, v65 offset:48
    s_waitcnt lgkmcnt(0)
    s_barrier
    ds_read_b128 v[40:43], v13
    ds_read_b128 v[44:47], v13 offset:512
    v_cvt_pk_bf16_f32 v16, v16, v17
    v_cvt_pk_bf16_f32 v17, v18, v19
    v_cvt_pk_bf16_f32 v18, v20, v21
    v_cvt_pk_bf16_f32 v19, v22, v23
    ds_read_b128 v[56:59], v14 offset:1024
    ds_read_b128 v[68:71], v169 offset:2432
    v_mfma_f32_32x32x16_bf16 v[132:147], v[32:35], v[16:19], v[132:147]
    v_cvt_pk_bf16_f32 v20, v24, v25
    v_cvt_pk_bf16_f32 v21, v26, v27
    v_cvt_pk_bf16_f32 v22, v28, v29
    v_cvt_pk_bf16_f32 v23, v30, v31
    v_cndmask_b32 v22, v22, 0, s[90:91]
    v_cndmask_b32 v23, v23, 0, s[90:91]
    ds_read_b128 v[72:75], v169 offset:2176
    ds_read_b128 v[76:79], v169 offset:2688
    v_mfma_f32_32x32x16_bf16 v[132:147], v[36:39], v[20:23], v[132:147]
    v_and_b32 v30, 1, v2
    v_and_b32 v29, 0x1ff, v13
    v_lshl_add_u32 v30, v30, 14, v29
    s_waitcnt lgkmcnt(5)
    v_mfma_f32_32x32x16_bf16 v[116:131], v[40:43], v[16:19], v[116:131]
    s_lshl2_add_u32 s72, s52, s50
    s_lshl_b32 s72, s72, 15
    s_lshl_b32 s73, s51, 10
    s_add_u32 s72, s72, s73
    s_waitcnt lgkmcnt(4)
    v_mfma_f32_32x32x16_bf16 v[116:131], v[44:47], v[20:23], v[116:131]
    s_nop 0
    v_max3_f32 v24, v132, v133, v140
    v_max3_f32 v25, v134, v135, v142
    v_max3_f32 v26, v136, v137, v144
    v_max3_f32 v27, v138, v139, v146
    v_max_f32 v24, v24, v141
    v_max_f32 v25, v25, v143
    v_max_f32 v26, v26, v145
    v_max_f32 v27, v27, v147
    s_nop 2
    v_max3_f32 v24, v24, v124, v125
    v_max3_f32 v25, v25, v126, v127
    v_max3_f32 v26, v26, v128, v129
    v_max3_f32 v27, v27, v130, v131
    v_mul_f32 v24, v24, v164
    v_mul_f32 v25, v25, v165
    v_mul_f32 v26, v26, v166
    v_mul_f32 v27, v27, v167
    v_max3_f32 v28, v24, v25, v26
    v_max_f32 v28, v28, v27
    v_max_f32 v29, v28, v27
    s_nop 1
    v_permlane32_swap_b32 v28, v29
    v_max_f32 v28, v28, v29
    v_sub_f32 v24, v24, v28
    v_sub_f32 v25, v25, v28
    v_sub_f32 v26, v26, v28
    v_sub_f32 v27, v27, v28
    v_exp_f32 v24, v24
    v_exp_f32 v25, v25
    v_exp_f32 v26, v26
    v_exp_f32 v27, v27
    v_add_f32 v28, v24, v25
    v_add_f32 v29, v26, v27
    v_add_f32 v28, v28, v29
    v_mov_b32 v29, v28
    v_mul_f32 v24, v24, v160
    v_mul_f32 v25, v25, v161
    v_permlane32_swap_b32 v28, v29
    v_add_f32 v28, v28, v29
    v_rcp_f32 v28, v28
    v_mul_f32 v26, v26, v162
    v_mul_f32 v27, v27, v163
    v_mul_f32 v24, v24, v28
    v_mul_f32 v25, v25, v28
    v_mul_f32 v26, v26, v28
    v_mul_f32 v27, v27, v28
    v_cvt_pk_bf16_f32 v24, v24, v24
    v_cvt_pk_bf16_f32 v25, v25, v25
    v_cvt_pk_bf16_f32 v26, v26, v26
    v_cvt_pk_bf16_f32 v27, v27, v27
    s_waitcnt lgkmcnt(2)
    v_and_b32 v68, v24, v68
    v_and_b32 v69, v25, v69
    v_and_b32 v70, v26, v70
    v_and_b32 v71, v27, v71
    s_waitcnt lgkmcnt(1)
    v_and_b32 v72, v24, v72
    v_and_b32 v73, v25, v73
    v_mfma_f32_32x32x16_bf16 v[100:115], v[48:51], v[68:71], 0
    v_and_b32 v74, v26, v74
    v_and_b32 v75, v27, v75
    s_waitcnt lgkmcnt(0)
    v_and_b32 v76, v24, v76
    v_and_b32 v77, v25, v77
    v_mfma_f32_32x32x16_bf16 v[100:115], v[52:55], v[72:75], v[100:115]
    v_and_b32 v78, v26, v78
    v_and_b32 v79, v27, v79
    s_nop 1
    v_mfma_f32_32x32x16_bf16 v[100:115], v[56:59], v[76:79], v[100:115]
    s_mov_b32 s4, 0
    s_waitcnt vmcnt(2)
    v_xor_b32 v246, s0, v246
    v_xor_b32 v247, s61, v247
    v_or_b32 v246, v246, v247
    v_cmp_ne_u32 vcc, 0, v246
    s_nop 0
    s_cmp_eq_u32 vcc_lo, 0
    s_cbranch_scc0 Lvfs_68
Lvfd_70:
    s_lshl_b32 s5, s4, 26
    s_lshl_b32 s55, s48, 21
    s_add_u32 s55, s55, s5
    s_mul_i32 s20, s48, 917504
    s_add_u32 s20, s20, s5
    s_add_u32 s20, s20, 16777216
    s_add_u32 s21, s55, 516096
    s_add_u32 s72, s72, s55
    v_cvt_pk_bf16_f32 v100, v100, v101
    v_cvt_pk_bf16_f32 v101, v102, v103
    v_cvt_pk_bf16_f32 v102, v104, v105
    v_cvt_pk_bf16_f32 v103, v106, v107
    v_cvt_pk_bf16_f32 v104, v108, v109
    v_cvt_pk_bf16_f32 v105, v110, v111
    v_cvt_pk_bf16_f32 v106, v112, v113
    v_cvt_pk_bf16_f32 v107, v114, v115
    v_cndmask_b32 v106, v106, 0, s[90:91]
    v_cndmask_b32 v107, v107, 0, s[90:91]
    s_cmp_eq_u32 s4, 0
    s_cbranch_scc0 Lslow_73
    buffer_store_dwordx4 v[100:103], v30, s[36:39], s72 offen
    buffer_store_dwordx4 v[104:107], v30, s[36:39], s72 offen offset:512
Lsdone_74:
    s_branch Lidle0
    s_nop 0
LclsN:
    s_lshl_b32 s1, 1, s49
    s_sub_u32 s1, s1, 1
    s_and_b32 s1, s1, 0xdee01ff
    s_bcnt1_i32_b32 s1, s1
    s_lshl2_add_u32 s1, s1, s50
    s_waitcnt vmcnt(11)
    ds_read_b128 a[112:115], v236 offset:32768
    ds_read_b128 a[116:119], v237 offset:32768
    ds_read_b128 a[120:123], v238 offset:32768
    ds_read_b128 a[124:127], v239 offset:32768
    s_waitcnt lgkmcnt(3)
    v_mfma_f32_4x4x4_16b_bf16 v[176:179], a[112:113], a[112:113], 0
    s_add_u32 m0, s45, 16384
    s_nop 0
    buffer_load_dwordx4 v208, s[8:11], s24 offen offset:0 lds
    v_mfma_f32_4x4x4_16b_bf16 v[180:183], a[114:115], a[114:115], 0
    v_mfma_f32_16x16x32_bf16 v[188:191], v[204:207], a[112:115], 0
    s_waitcnt lgkmcnt(2)
    v_mfma_f32_4x4x4_16b_bf16 v[176:179], a[116:117], a[116:117], v[176:179]
    buffer_load_dwordx4 v209, s[8:11], s24 offen offset:1024 lds
    v_mfma_f32_4x4x4_16b_bf16 v[180:183], a[118:119], a[118:119], v[180:183]
    v_mfma_f32_16x16x32_bf16 v[188:191], v[204:207], a[116:119], v[188:191]
    s_waitcnt lgkmcnt(1)
    v_mfma_f32_4x4x4_16b_bf16 v[176:179], a[120:121], a[120:121], v[176:179]
    buffer_load_dwordx4 v210, s[8:11], s24 offen offset:2048 lds
    v_mfma_f32_4x4x4_16b_bf16 v[180:183], a[122:123], a[122:123], v[180:183]
    v_mfma_f32_16x16x32_bf16 v[188:191], v[204:207], a[120:123], v[188:191]
    s_waitcnt lgkmcnt(0)
    v_mfma_f32_4x4x4_16b_bf16 v[176:179], a[124:125], a[124:125], v[176:179]
    buffer_load_dwordx4 v211, s[8:11], s24 offen offset:3072 lds
    v_mfma_f32_4x4x4_16b_bf16 v[180:183], a[126:127], a[126:127], v[180:183]
    v_mfma_f32_16x16x32_bf16 v[188:191], v[204:207], a[124:127], v[188:191]
    s_waitcnt vmcnt(9)
    s_barrier
    ds_read_b64_tr_b16 v[68:69], v8 offset:3072
    ds_read_b64_tr_b16 v[70:71], v8 offset:2048
    ds_read_b64_tr_b16 v[72:73], v8 offset:0
    ds_read_b64_tr_b16 v[74:75], v8 offset:4096
    ds_read_b64_tr_b16 v[76:77], v8 offset:1024
    ds_read_b64_tr_b16 v[78:79], v8 offset:5120
    s_waitcnt lgkmcnt(4)
    v_mfma_f32_32x32x16_bf16 v[16:31], v[68:71], a[112:115], 0
    v_readlane_b32 s0, v246, 32
    v_readlane_b32 s61, v247, 32
    s_getreg_b32 s5, hwreg(HW_REG_XCC_ID, 0, 4)
    s_add_u32 s0, s0, 1
    s_xor_b32 s61, s61, 0x5bd1e995
    s_add_u32 s61, s61, s5
    v_mov_b32 v246, s0
    v_mov_b32 v247, s61
    s_cmp_lt_u32 s50, 2
    s_cselect_b32 s5, s26, s27
    s_add_u32 m0, s30, 148992
    s_mov_b32 exec_lo, s20
    buffer_load_dwordx4 v255, s[8:11], s5 offen lds
    s_mov_b32 exec_lo, -1
    v_mfma_f32_16x16x32_bf16 v[196:199], v[204:207], v[68:71], 0
    s_andn2_b32 s30, s30, 2048
    s_add_u32 m0, s30, 153088
    s_mov_b32 exec_lo, s20
    buffer_load_dwordx4 v255, s[8:11], s28 offen lds
    s_mov_b32 exec_lo, -1
    ds_read_b64_tr_b16 v[80:81], v8 offset:3584
    ds_read_b64_tr_b16 v[82:83], v8 offset:2560
    s_waitcnt lgkmcnt(4)
    v_mfma_f32_32x32x16_bf16 v[32:47], v[72:75], a[112:115], 0
    ds_read_b128 a[104:107], v240 offset:0
    ds_read_b128 a[108:111], v241 offset:0
    ds_read_b128 v[192:195], v240 offset:2048
    ds_read_b128 v[200:203], v241 offset:2048
    s_waitcnt lgkmcnt(6)
    v_mfma_f32_32x32x16_bf16 v[48:63], a[112:115], v[76:79], 0
    s_mul_i32 s29, s23, 1344
    s_add_u32 m0, s46, 12288
    s_nop 0
    buffer_load_dwordx4 v212, s[12:15], s29 offen offset:0 lds
    ds_read_b64_tr_b16 v[84:85], v8 offset:512
    ds_read_b64_tr_b16 v[86:87], v8 offset:4608
    s_waitcnt lgkmcnt(6)
    v_mfma_f32_32x32x16_bf16 v[16:31], v[80:83], a[116:119], v[16:31]
    ds_read_b64_tr_b16 v[88:89], v8 offset:1536
    ds_read_b64_tr_b16 v[90:91], v8 offset:5632
    ds_read_b64_tr_b16 v[92:93], v10 offset:0
    ds_read_b64_tr_b16 v[94:95], v10 offset:4096
    v_mfma_f32_16x16x32_bf16 v[196:199], v[204:207], v[80:83], v[196:199]
    s_add_u32 m0, s46, 12288
    s_nop 0
    buffer_load_dwordx4 v213, s[12:15], s29 offen offset:1024 lds
    ds_read_b64_tr_b16 v[96:97], v8 offset:9216
    ds_read_b64_tr_b16 v[98:99], v8 offset:8192
    s_waitcnt lgkmcnt(6)
    v_mfma_f32_32x32x16_bf16 v[32:47], v[84:87], a[116:119], v[32:47]
    ds_read_b64_tr_b16 v[68:69], v8 offset:6144
    ds_read_b64_tr_b16 v[70:71], v8 offset:10240
    ds_read_b64_tr_b16 v[72:73], v8 offset:7168
    ds_read_b64_tr_b16 v[74:75], v8 offset:11264
    s_waitcnt lgkmcnt(8)
    v_mfma_f32_32x32x16_bf16 v[48:63], a[116:119], v[88:91], v[48:63]
    s_add_u32 m0, s46, 12288
    s_nop 0
    buffer_load_dwordx4 v214, s[12:15], s29 offen offset:2048 lds
    ds_read_b64_tr_b16 v[76:77], v8 offset:9728
    s_waitcnt lgkmcnt(7)
    v_mfma_f32_16x16x32_bf16 v[64:67], v[92:95], a[104:107], 0
    s_waitcnt vmcnt(10)
    ds_read_b128 a[128:131], v236 offset:0
    ds_read_b128 a[132:135], v237 offset:0
    ds_read_b128 a[136:139], v238 offset:0
    ds_read_b128 a[140:143], v239 offset:0
    s_lshl_b32 s5, s49, 3
    s_add_u32 s5, s5, s58
    s_add_u32 s5, s5, 16384
    s_cmp_eq_u32 s50, 0
    s_cselect_b32 s5, s5, 2146435072
    buffer_store_dwordx2 v[246:247], off, s[36:39], s5
    s_waitcnt lgkmcnt(9)
    v_mfma_f32_32x32x16_bf16 v[16:31], v[96:99], a[120:123], v[16:31]
    ds_read_b64_tr_b16 v[78:79], v8 offset:8704
    ds_read_b64_tr_b16 v[80:81], v8 offset:6656
    ds_read_b64_tr_b16 v[82:83], v8 offset:10752
    ds_read_b64_tr_b16 v[84:85], v8 offset:7680
    v_mfma_f32_16x16x32_bf16 v[196:199], v[204:207], v[96:99], v[196:199]
    s_lshl3_add_u32 s5, s1, s48
    s_mul_i32 s6, s5, 9363
    s_lshr_b32 s6, s6, 20
    s_mul_i32 s6, s6, 1605504
    s_mul_i32 s5, s5, 14336
    s_sub_u32 s5, s5, s6
    s_add_u32 m0, s46, 73728
    s_nop 0
    buffer_load_dwordx4 v232, s[84:87], s5 offen lds
    s_add_u32 m0, m0, 1024
    s_add_u32 s5, s5, 7168
    buffer_load_dwordx4 v232, s[84:87], s5 offen lds
    s_waitcnt lgkmcnt(9)
    v_mfma_f32_32x32x16_bf16 v[32:47], v[68:71], a[120:123], v[32:47]
    ds_read_b64_tr_b16 v[86:87], v8 offset:11776
    ds_read_b64_tr_b16 v[88:89], v10 offset:6144
    ds_read_b64_tr_b16 v[90:91], v10 offset:10240
    ds_read_b128 v[124:127], v235 offset:640
    v_mfma_f32_32x32x16_bf16 v[48:63], a[120:123], v[72:75], v[48:63]
    ds_read_b128 v[128:131], v235 offset:512
    ds_read_b128 v[132:135], v169 offset:384
    ds_read_b128 v[136:139], v169 offset:256
    ds_read_b128 v[140:143], v169 offset:128
    s_waitcnt lgkmcnt(9)
    v_mfma_f32_32x32x16_bf16 v[16:31], v[76:79], a[124:127], v[16:31]
    s_cmp_eq_u32 s48, 7
    s_cselect_b32 s5, 3, s48
    s_lshr_b32 s6, s1, 1
    s_lshl_b32 s5, s5, 5
    s_add_u32 s5, s5, s6
    s_add_u32 s5, s5, 0
    s_sub_u32 s6, s5, 224
    s_cselect_b32 s5, s5, s6
    s_mul_i32 s5, s5, 7168
    buffer_load_dword v221, v222, s[40:43], s5 offen
    v_mfma_f32_16x16x32_bf16 v[196:199], v[204:207], v[76:79], v[196:199]
    ds_read_b128 v[144:147], v169 offset:0
    v_mfma_f32_32x32x16_bf16 v[32:47], v[80:83], a[124:127], v[32:47]
    s_waitcnt lgkmcnt(6)
    v_mfma_f32_32x32x16_bf16 v[48:63], a[124:127], v[84:87], v[48:63]
    s_cmp_eq_u32 s48, 7
    s_cselect_b32 s5, 3, s48
    s_lshr_b32 s6, s1, 1
    s_lshl_b32 s5, s5, 5
    s_add_u32 s5, s5, s6
    s_add_u32 s5, s5, 36
    s_sub_u32 s6, s5, 224
    s_cselect_b32 s5, s5, s6
    s_mul_i32 s5, s5, 7168
    buffer_load_dword v221, v222, s[40:43], s5 offen
    v_mfma_f32_16x16x32_bf16 v[64:67], v[88:91], a[108:111], v[64:67]
    s_waitcnt vmcnt(10)
    ds_read_b128 a[144:147], v236 offset:16384
    ds_read_b128 a[148:151], v237 offset:16384
    ds_read_b128 a[152:155], v238 offset:16384
    ds_read_b128 a[156:159], v239 offset:16384
    v_mfma_f32_4x4x4_16b_bf16 v[176:179], a[128:129], a[128:129], v[176:179]
    v_mfma_f32_4x4x4_16b_bf16 v[180:183], a[130:131], a[130:131], v[180:183]
    v_mfma_f32_16x16x32_bf16 v[188:191], v[204:207], a[128:131], v[188:191]
    s_cmp_eq_u32 s48, 7
    s_cselect_b32 s5, 3, s48
    s_lshr_b32 s6, s1, 1
    s_lshl_b32 s5, s5, 5
    s_add_u32 s5, s5, s6
    s_add_u32 s5, s5, 72
    s_sub_u32 s6, s5, 224
    s_cselect_b32 s5, s5, s6
    s_mul_i32 s5, s5, 7168
    buffer_load_dword v221, v222, s[40:43], s5 offen
    v_mfma_f32_4x4x4_16b_bf16 v[176:179], a[132:133], a[132:133], v[176:179]
    v_mfma_f32_4x4x4_16b_bf16 v[180:183], a[134:135], a[134:135], v[180:183]
    s_add_u32 m0, s45, 32768
    s_nop 0
    buffer_load_dwordx4 v208, s[8:11], s25 offen offset:0 lds
    v_mfma_f32_16x16x32_bf16 v[188:191], v[204:207], a[132:135], v[188:191]
    v_mfma_f32_4x4x4_16b_bf16 v[176:179], a[136:137], a[136:137], v[176:179]
    buffer_load_dwordx4 v209, s[8:11], s25 offen offset:1024 lds
    v_mfma_f32_4x4x4_16b_bf16 v[180:183], a[138:139], a[138:139], v[180:183]
    v_mfma_f32_16x16x32_bf16 v[188:191], v[204:207], a[136:139], v[188:191]
    v_mfma_f32_4x4x4_16b_bf16 v[176:179], a[140:141], a[140:141], v[176:179]
    buffer_load_dwordx4 v210, s[8:11], s25 offen offset:2048 lds
    v_mfma_f32_4x4x4_16b_bf16 v[180:183], a[142:143], a[142:143], v[180:183]
    v_mfma_f32_16x16x32_bf16 v[188:191], v[204:207], a[140:143], v[188:191]
    v_mfma_f32_16x16x32_bf16 v[184:187], a[104:107], a[104:107], 0
    buffer_load_dwordx4 v211, s[8:11], s25 offen offset:3072 lds
    v_mfma_f32_16x16x32_bf16 v[184:187], a[108:111], a[108:111], v[184:187]
    s_waitcnt lgkmcnt(3)
    v_mfma_f32_16x16x32_bf16 v[184:187], v[192:195], v[192:195], v[184:187]
    s_waitcnt vmcnt(10)
    s_barrier
    s_add_u32 m0, s45, 0
    s_nop 0
    buffer_load_dwordx4 v208, s[8:11], s26 offen offset:0 lds
    v_mfma_f32_16x16x32_bf16 v[184:187], v[200:203], v[200:203], v[184:187]
    ds_read_b128 v[224:227], v240 offset:4096
    ds_read_b128 v[228:231], v241 offset:4096
    v_mfma_f32_4x4x4_16b_bf16 v[176:179], a[144:145], a[144:145], v[176:179]
    buffer_load_dwordx4 v209, s[8:11], s26 offen offset:1024 lds
    v_mfma_f32_4x4x4_16b_bf16 v[180:183], a[146:147], a[146:147], v[180:183]
    ds_read_b64_tr_b16 v[92:93], v8 offset:15360
    v_mfma_f32_16x16x32_bf16 v[188:191], v[204:207], a[144:147], v[188:191]
    ds_read_b128 a[224:227], v240 offset:6144
    ds_read_b128 a[228:231], v241 offset:6144
    s_waitcnt lgkmcnt(6)
    v_mfma_f32_4x4x4_16b_bf16 v[176:179], a[148:149], a[148:149], v[176:179]
    buffer_load_dwordx4 v210, s[8:11], s26 offen offset:2048 lds
    ds_read_b64_tr_b16 v[94:95], v8 offset:14336
    v_mfma_f32_4x4x4_16b_bf16 v[180:183], a[150:151], a[150:151], v[180:183]
    ds_read_b64_tr_b16 v[96:97], v8 offset:12288
    v_mfma_f32_16x16x32_bf16 v[188:191], v[204:207], a[148:151], v[188:191]
    ds_read_b128 a[232:235], v240 offset:8192
    ds_read_b128 a[236:239], v241 offset:8192
    v_mfma_f32_4x4x4_16b_bf16 v[176:179], a[152:153], a[152:153], v[176:179]
    buffer_load_dwordx4 v211, s[8:11], s26 offen offset:3072 lds
    v_mfma_f32_4x4x4_16b_bf16 v[180:183], a[154:155], a[154:155], v[180:183]
    ds_read_b64_tr_b16 v[98:99], v8 offset:16384
    v_mfma_f32_16x16x32_bf16 v[188:191], v[204:207], a[152:155], v[188:191]
    ds_read_b128 a[240:243], v240 offset:10240
    ds_read_b128 a[244:247], v241 offset:10240
    s_waitcnt lgkmcnt(12)
    v_mfma_f32_4x4x4_16b_bf16 v[176:179], a[156:157], a[156:157], v[176:179]
    ds_read_b64_tr_b16 v[68:69], v8 offset:13312
    v_mfma_f32_4x4x4_16b_bf16 v[180:183], a[158:159], a[158:159], v[180:183]
    ds_read_b64_tr_b16 v[70:71], v8 offset:17408
    v_mfma_f32_16x16x32_bf16 v[188:191], v[204:207], a[156:159], v[188:191]
    s_mul_i32 s29, s24, 1344
    s_add_u32 m0, s46, 24576
    s_nop 0
    buffer_load_dwordx4 v212, s[12:15], s29 offen offset:0 lds
    s_waitcnt lgkmcnt(8)
    v_mfma_f32_32x32x16_bf16 v[16:31], v[92:95], a[128:131], v[16:31]
    ds_read_b128 a[248:251], v240 offset:12288
    ds_read_b128 a[252:255], v241 offset:12288
    ds_read_b64_tr_b16 v[72:73], v8 offset:15872
    ds_read_b64_tr_b16 v[74:75], v8 offset:14848
    v_mfma_f32_16x16x32_bf16 v[196:199], v[204:207], v[92:95], v[196:199]
    s_add_u32 m0, s46, 24576
    s_nop 0
    buffer_load_dwordx4 v213, s[12:15], s29 offen offset:1024 lds
    s_waitcnt lgkmcnt(8)
    v_mfma_f32_32x32x16_bf16 v[32:47], v[96:99], a[128:131], v[32:47]
    ds_read_b64_tr_b16 v[76:77], v8 offset:12800
    ds_read_b64_tr_b16 v[78:79], v8 offset:16896
    ds_read_b64_tr_b16 v[80:81], v8 offset:13824
    ds_read_b64_tr_b16 v[82:83], v8 offset:17920
    s_waitcnt lgkmcnt(8)
    v_mfma_f32_32x32x16_bf16 v[48:63], a[128:131], v[68:71], v[48:63]
    s_add_u32 m0, s46, 24576
    s_nop 0
    buffer_load_dwordx4 v214, s[12:15], s29 offen offset:2048 lds
    ds_read_b64_tr_b16 v[84:85], v10 offset:12288
    s_waitcnt lgkmcnt(5)
    v_mfma_f32_32x32x16_bf16 v[16:31], v[72:75], a[132:135], v[16:31]
    ds_read_b64_tr_b16 v[86:87], v10 offset:16384
    ds_read_b64_tr_b16 v[88:89], v8 offset:21504
    ds_read_b64_tr_b16 v[90:91], v8 offset:20480
    ds_read_b64_tr_b16 v[92:93], v8 offset:18432
    v_mfma_f32_16x16x32_bf16 v[196:199], v[204:207], v[72:75], v[196:199]
    ds_read_b64_tr_b16 v[94:95], v8 offset:22528
    ds_read_b64_tr_b16 v[96:97], v8 offset:19456
    s_waitcnt lgkmcnt(7)
    v_mfma_f32_32x32x16_bf16 v[32:47], v[76:79], a[132:135], v[32:47]
    ds_read_b64_tr_b16 v[98:99], v8 offset:23552
    ds_read_b64_tr_b16 v[68:69], v8 offset:22016
    ds_read_b64_tr_b16 v[70:71], v8 offset:20992
    ds_read_b64_tr_b16 v[72:73], v8 offset:18944
    v_mfma_f32_32x32x16_bf16 v[48:63], a[132:135], v[80:83], v[48:63]
    ds_read_b64_tr_b16 v[74:75], v8 offset:23040
    ds_read_b64_tr_b16 v[76:77], v8 offset:19968
    ds_read_b64_tr_b16 v[78:79], v8 offset:24064
    ds_read_b64_tr_b16 v[80:81], v10 offset:18432
    s_waitcnt lgkmcnt(11)
    v_mfma_f32_16x16x32_bf16 v[64:67], v[84:87], v[192:195], v[64:67]
    s_waitcnt vmcnt(7)
    ds_read_b128 a[160:163], v236 offset:32768
    ds_read_b128 a[164:167], v237 offset:32768
    ds_read_b128 a[168:171], v238 offset:32768
    ds_read_b128 a[172:175], v239 offset:32768
    v_mfma_f32_32x32x16_bf16 v[16:31], v[88:91], a[136:139], v[16:31]
    s_add_u32 m0, s45, 16384
    s_nop 0
    buffer_load_dwordx4 v208, s[8:11], s27 offen offset:0 lds
    ds_read_b64_tr_b16 v[82:83], v10 offset:22528
    v_mfma_f32_16x16x32_bf16 v[196:199], v[204:207], v[88:91], v[196:199]
    buffer_load_dwordx4 v209, s[8:11], s27 offen offset:1024 lds
    s_waitcnt lgkmcnt(12)
    v_mfma_f32_32x32x16_bf16 v[32:47], v[92:95], a[136:139], v[32:47]
    v_mfma_f32_32x32x16_bf16 v[48:63], a[136:139], v[96:99], v[48:63]
    buffer_load_dwordx4 v210, s[8:11], s27 offen offset:2048 lds
    s_waitcnt lgkmcnt(8)
    v_mfma_f32_32x32x16_bf16 v[16:31], v[68:71], a[140:143], v[16:31]
    buffer_load_dwordx4 v211, s[8:11], s27 offen offset:3072 lds
    v_mfma_f32_16x16x32_bf16 v[196:199], v[204:207], v[68:71], v[196:199]
    v_mfma_f32_32x32x16_bf16 v[32:47], v[72:75], a[140:143], v[32:47]
    s_waitcnt lgkmcnt(0)
    v_mfma_f32_32x32x16_bf16 v[48:63], a[140:143], v[76:79], v[48:63]
    v_mfma_f32_16x16x32_bf16 v[64:67], v[80:83], v[200:203], v[64:67]
    s_waitcnt vmcnt(7)
    ds_read_b128 a[176:179], v236 offset:0
    ds_read_b128 a[180:183], v237 offset:0
    ds_read_b128 a[184:187], v238 offset:0
    ds_read_b128 a[188:191], v239 offset:0
    v_mfma_f32_4x4x4_16b_bf16 v[176:179], a[160:161], a[160:161], v[176:179]
    s_add_u32 m0, s45, 32768
    s_nop 0
    buffer_load_dwordx4 v208, s[8:11], s28 offen offset:0 lds
    v_mfma_f32_4x4x4_16b_bf16 v[180:183], a[162:163], a[162:163], v[180:183]
    v_mfma_f32_16x16x32_bf16 v[188:191], v[204:207], a[160:163], v[188:191]
    v_mfma_f32_4x4x4_16b_bf16 v[176:179], a[164:165], a[164:165], v[176:179]
    buffer_load_dwordx4 v209, s[8:11], s28 offen offset:1024 lds
    v_mfma_f32_4x4x4_16b_bf16 v[180:183], a[166:167], a[166:167], v[180:183]
    v_mfma_f32_16x16x32_bf16 v[188:191], v[204:207], a[164:167], v[188:191]
    v_mfma_f32_4x4x4_16b_bf16 v[176:179], a[168:169], a[168:169], v[176:179]
    buffer_load_dwordx4 v210, s[8:11], s28 offen offset:2048 lds
    v_mfma_f32_4x4x4_16b_bf16 v[180:183], a[170:171], a[170:171], v[180:183]
    v_mfma_f32_16x16x32_bf16 v[188:191], v[204:207], a[168:171], v[188:191]
    v_mfma_f32_4x4x4_16b_bf16 v[176:179], a[172:173], a[172:173], v[176:179]
    buffer_load_dwordx4 v211, s[8:11], s28 offen offset:3072 lds
    v_mfma_f32_4x4x4_16b_bf16 v[180:183], a[174:175], a[174:175], v[180:183]
    v_mfma_f32_16x16x32_bf16 v[188:191], v[204:207], a[172:175], v[188:191]
    v_mfma_f32_16x16x32_bf16 v[184:187], v[224:227], v[224:227], v[184:187]
    v_mfma_f32_16x16x32_bf16 v[184:187], v[228:231], v[228:231], v[184:187]
    s_waitcnt lgkmcnt(3)
    v_mfma_f32_16x16x32_bf16 v[184:187], a[224:227], a[224:227], v[184:187]
    s_waitcnt vmcnt(8)
    s_barrier
    v_mfma_f32_16x16x32_bf16 v[184:187], a[228:231], a[228:231], v[184:187]
    ds_read_b64_tr_b16 a[8:9], v233 offset:12288
    ds_read_b64_tr_b16 a[10:11], v233 offset:12800
    ds_read_b64_tr_b16 a[12:13], v233 offset:12352
    ds_read_b64_tr_b16 a[14:15], v233 offset:12864
    v_mfma_f32_4x4x4_16b_bf16 v[176:179], a[176:177], a[176:177], v[176:179]
    ds_read_b64_tr_b16 v[84:85], v8 offset:27648
    v_mfma_f32_4x4x4_16b_bf16 v[180:183], a[178:179], a[178:179], v[180:183]
    ds_read_b64_tr_b16 v[86:87], v8 offset:26624
    v_mfma_f32_16x16x32_bf16 v[188:191], v[204:207], a[176:179], v[188:191]
    ds_read_b64_tr_b16 v[88:89], v8 offset:24576
    ds_read_b64_tr_b16 v[90:91], v8 offset:28672
    s_waitcnt lgkmcnt(9)
    v_mfma_f32_4x4x4_16b_bf16 v[176:179], a[180:181], a[180:181], v[176:179]
    s_lshl3_add_u32 s5, s1, s48
    s_and_b32 s6, s5, 3
    s_mul_i32 s6, s6, -1024
    s_lshl_b32 s5, s5, 11
    s_add_u32 s6, s6, 48234496
    s_add_u32 s5, s5, s6
    s_waitcnt lgkmcnt(6)
    buffer_store_dwordx4 a[8:11], v1, s[36:39], s5 offen sc1
    s_add_u32 s5, s5, 4096
    s_waitcnt lgkmcnt(4)
    buffer_store_dwordx4 a[12:15], v1, s[36:39], s5 offen sc1
    v_mfma_f32_4x4x4_16b_bf16 v[180:183], a[182:183], a[182:183], v[180:183]
    v_mfma_f32_16x16x32_bf16 v[188:191], v[204:207], a[180:183], v[188:191]
    ds_read_b64_tr_b16 v[92:93], v8 offset:25600
    ds_read_b64_tr_b16 v[94:95], v8 offset:29696
    v_mfma_f32_4x4x4_16b_bf16 v[176:179], a[184:185], a[184:185], v[176:179]
    v_mfma_f32_4x4x4_16b_bf16 v[180:183], a[186:187], a[186:187], v[180:183]
    v_mfma_f32_16x16x32_bf16 v[188:191], v[204:207], a[184:187], v[188:191]
    s_mul_i32 s29, s25, 1344
    s_add_u32 m0, s46, 36864
    s_nop 0
    buffer_load_dwordx4 v212, s[12:15], s29 offen offset:0 lds
    v_mfma_f32_4x4x4_16b_bf16 v[176:179], a[188:189], a[188:189], v[176:179]
    ds_read_b64_tr_b16 v[96:97], v8 offset:28160
    v_mfma_f32_4x4x4_16b_bf16 v[180:183], a[190:191], a[190:191], v[180:183]
    ds_read_b64_tr_b16 v[98:99], v8 offset:27136
    v_mfma_f32_16x16x32_bf16 v[188:191], v[204:207], a[188:191], v[188:191]
    ds_read_b64_tr_b16 v[68:69], v8 offset:25088
    ds_read_b64_tr_b16 v[70:71], v8 offset:29184
    s_waitcnt lgkmcnt(6)
    v_mfma_f32_32x32x16_bf16 v[16:31], v[84:87], a[144:147], v[16:31]
    s_add_u32 m0, s46, 36864
    s_nop 0
    buffer_load_dwordx4 v213, s[12:15], s29 offen offset:1024 lds
    ds_read_b64_tr_b16 v[72:73], v8 offset:26112
    v_mfma_f32_16x16x32_bf16 v[196:199], v[204:207], v[84:87], v[196:199]
    ds_read_b64_tr_b16 v[74:75], v8 offset:30208
    ds_read_b64_tr_b16 v[76:77], v10 offset:24576
    v_mfma_f32_32x32x16_bf16 v[32:47], v[88:91], a[144:147], v[32:47]
    s_add_u32 m0, s46, 36864
    s_nop 0
    buffer_load_dwordx4 v214, s[12:15], s29 offen offset:2048 lds
    ds_read_b64_tr_b16 v[78:79], v10 offset:28672
    ds_read_b64_tr_b16 v[80:81], v8 offset:33792
    s_waitcnt lgkmcnt(9)
    v_mfma_f32_32x32x16_bf16 v[48:63], a[144:147], v[92:95], v[48:63]
    ds_read_b64_tr_b16 v[82:83], v8 offset:32768
    ds_read_b64_tr_b16 v[84:85], v8 offset:30720
    ds_read_b64_tr_b16 v[86:87], v8 offset:34816
    ds_read_b64_tr_b16 v[88:89], v8 offset:31744
    s_waitcnt lgkmcnt(9)
    v_mfma_f32_32x32x16_bf16 v[16:31], v[96:99], a[148:151], v[16:31]
    ds_read_b64_tr_b16 v[90:91], v8 offset:35840
    ds_read_b64_tr_b16 v[92:93], v8 offset:34304
    ds_read_b64_tr_b16 v[94:95], v8 offset:33280
    v_mfma_f32_16x16x32_bf16 v[196:199], v[204:207], v[96:99], v[196:199]
    ds_read_b64_tr_b16 v[96:97], v8 offset:31232
    ds_read_b64_tr_b16 v[98:99], v8 offset:35328
    v_mfma_f32_32x32x16_bf16 v[32:47], v[68:71], a[148:151], v[32:47]
    ds_read_b64_tr_b16 v[68:69], v8 offset:32256
    ds_read_b64_tr_b16 v[70:71], v8 offset:36352
    s_waitcnt lgkmcnt(10)
    v_mfma_f32_32x32x16_bf16 v[48:63], a[148:151], v[72:75], v[48:63]
    ds_read_b64_tr_b16 v[72:73], v10 offset:30720
    ds_read_b64_tr_b16 v[74:75], v10 offset:34816
    v_mfma_f32_16x16x32_bf16 v[64:67], v[76:79], v[224:227], v[64:67]
    s_waitcnt vmcnt(9)
    ds_read_b128 a[192:195], v236 offset:16384
    ds_read_b128 a[196:199], v237 offset:16384
    ds_read_b128 a[200:203], v238 offset:16384
    ds_read_b128 a[204:207], v239 offset:16384
    v_mfma_f32_32x32x16_bf16 v[16:31], v[80:83], a[152:155], v[16:31]
    s_mul_i32 s29, s26, 1344
    s_add_u32 m0, s46, 49152
    s_nop 0
    buffer_load_dwordx4 v212, s[12:15], s29 offen offset:0 lds
    v_mfma_f32_16x16x32_bf16 v[196:199], v[204:207], v[80:83], v[196:199]
    s_waitcnt lgkmcnt(12)
    v_mfma_f32_32x32x16_bf16 v[32:47], v[84:87], a[152:155], v[32:47]
    s_add_u32 m0, s46, 49152
    s_nop 0
    buffer_load_dwordx4 v213, s[12:15], s29 offen offset:1024 lds
    v_mfma_f32_32x32x16_bf16 v[48:63], a[152:155], v[88:91], v[48:63]
    s_waitcnt lgkmcnt(8)
    v_mfma_f32_32x32x16_bf16 v[16:31], v[92:95], a[156:159], v[16:31]
    s_add_u32 m0, s46, 49152
    s_nop 0
    buffer_load_dwordx4 v214, s[12:15], s29 offen offset:2048 lds
    v_mfma_f32_16x16x32_bf16 v[196:199], v[204:207], v[92:95], v[196:199]
    v_mfma_f32_32x32x16_bf16 v[32:47], v[96:99], a[156:159], v[32:47]
    s_waitcnt lgkmcnt(3)
    v_mfma_f32_32x32x16_bf16 v[48:63], a[156:159], v[68:71], v[48:63]
    v_mfma_f32_16x16x32_bf16 v[64:67], v[72:75], v[228:231], v[64:67]
    s_waitcnt vmcnt(8)
    ds_read_b128 a[208:211], v236 offset:32768
    ds_read_b128 a[212:215], v237 offset:32768
    ds_read_b128 a[216:219], v238 offset:32768
    ds_read_b128 a[220:223], v239 offset:32768
    v_mfma_f32_4x4x4_16b_bf16 v[176:179], a[192:193], a[192:193], v[176:179]
    s_mul_i32 s29, s27, 1344
    s_add_u32 m0, s46, 61440
    s_nop 0
    buffer_load_dwordx4 v212, s[12:15], s29 offen offset:0 lds
    v_mfma_f32_4x4x4_16b_bf16 v[180:183], a[194:195], a[194:195], v[180:183]
    v_mfma_f32_16x16x32_bf16 v[188:191], v[204:207], a[192:195], v[188:191]
    s_waitcnt lgkmcnt(5)
    v_mfma_f32_4x4x4_16b_bf16 v[176:179], a[196:197], a[196:197], v[176:179]
    v_mfma_f32_4x4x4_16b_bf16 v[180:183], a[198:199], a[198:199], v[180:183]
    v_mfma_f32_16x16x32_bf16 v[188:191], v[204:207], a[196:199], v[188:191]
    s_add_u32 m0, s46, 61440
    s_nop 0
    buffer_load_dwordx4 v213, s[12:15], s29 offen offset:1024 lds
    v_mfma_f32_4x4x4_16b_bf16 v[176:179], a[200:201], a[200:201], v[176:179]
    v_mfma_f32_4x4x4_16b_bf16 v[180:183], a[202:203], a[202:203], v[180:183]
    v_mfma_f32_16x16x32_bf16 v[188:191], v[204:207], a[200:203], v[188:191]
    s_waitcnt lgkmcnt(4)
    v_mfma_f32_4x4x4_16b_bf16 v[176:179], a[204:205], a[204:205], v[176:179]
    s_add_u32 m0, s46, 61440
    s_nop 0
    buffer_load_dwordx4 v214, s[12:15], s29 offen offset:2048 lds
    v_mfma_f32_4x4x4_16b_bf16 v[180:183], a[206:207], a[206:207], v[180:183]
    v_mfma_f32_16x16x32_bf16 v[188:191], v[204:207], a[204:207], v[188:191]
    v_mfma_f32_16x16x32_bf16 v[184:187], a[232:235], a[232:235], v[184:187]
    v_mfma_f32_16x16x32_bf16 v[184:187], a[236:239], a[236:239], v[184:187]
    v_mfma_f32_16x16x32_bf16 v[184:187], a[240:243], a[240:243], v[184:187]
    v_mfma_f32_16x16x32_bf16 v[184:187], a[244:247], a[244:247], v[184:187]
    v_mfma_f32_16x16x32_bf16 v[184:187], a[248:251], a[248:251], v[184:187]
    s_waitcnt vmcnt(6) lgkmcnt(0)
    s_barrier
    v_mfma_f32_16x16x32_bf16 v[184:187], a[252:255], a[252:255], v[184:187]
    s_lshl3_add_u32 s5, s1, s48
    s_lshl_b32 s5, s5, 5
    s_add_u32 s5, s5, 41975808
    v_mov_b32 v7, s0
    buffer_store_dword v7, off, s[36:39], s5 sc1
    v_mfma_f32_4x4x4_16b_bf16 v[176:179], a[208:209], a[208:209], v[176:179]
    ds_read_b64_tr_b16 v[76:77], v8 offset:39936
    v_mfma_f32_4x4x4_16b_bf16 v[180:183], a[210:211], a[210:211], v[180:183]
    ds_read_b64_tr_b16 v[78:79], v8 offset:38912
    v_mfma_f32_16x16x32_bf16 v[188:191], v[204:207], a[208:211], v[188:191]
    ds_read_b64_tr_b16 v[80:81], v8 offset:36864
    ds_read_b64_tr_b16 v[82:83], v8 offset:40960
    v_mfma_f32_4x4x4_16b_bf16 v[176:179], a[212:213], a[212:213], v[176:179]
    s_mul_i32 s29, s28, 1344
    s_add_u32 m0, s46, 73728
    s_nop 0
    buffer_load_dwordx4 v212, s[12:15], s29 offen offset:0 lds
    v_mfma_f32_4x4x4_16b_bf16 v[180:183], a[214:215], a[214:215], v[180:183]
    v_mfma_f32_16x16x32_bf16 v[188:191], v[204:207], a[212:215], v[188:191]
    ds_read_b64_tr_b16 v[84:85], v8 offset:37888
    ds_read_b64_tr_b16 v[86:87], v8 offset:41984
    v_mfma_f32_4x4x4_16b_bf16 v[176:179], a[216:217], a[216:217], v[176:179]
    v_mfma_f32_4x4x4_16b_bf16 v[180:183], a[218:219], a[218:219], v[180:183]
    v_mfma_f32_16x16x32_bf16 v[188:191], v[204:207], a[216:219], v[188:191]
    s_add_u32 m0, s46, 73728
    s_nop 0
    buffer_load_dwordx4 v213, s[12:15], s29 offen offset:1024 lds
    v_mfma_f32_4x4x4_16b_bf16 v[176:179], a[220:221], a[220:221], v[176:179]
    ds_read_b64_tr_b16 v[88:89], v8 offset:40448
    v_mfma_f32_4x4x4_16b_bf16 v[180:183], a[222:223], a[222:223], v[180:183]
    ds_read_b64_tr_b16 v[90:91], v8 offset:39424
    v_mfma_f32_16x16x32_bf16 v[188:191], v[204:207], a[220:223], v[188:191]
    ds_read_b64_tr_b16 v[92:93], v8 offset:37376
    ds_read_b64_tr_b16 v[94:95], v8 offset:41472
    s_waitcnt lgkmcnt(6)
    v_mfma_f32_32x32x16_bf16 v[16:31], v[76:79], a[160:163], v[16:31]
    s_add_u32 m0, s46, 73728
    s_nop 0
    buffer_load_dwordx4 v214, s[12:15], s29 offen offset:2048 lds
    ds_read_b64_tr_b16 v[96:97], v8 offset:38400
    v_mfma_f32_16x16x32_bf16 v[196:199], v[204:207], v[76:79], v[196:199]
    ds_read_b64_tr_b16 v[98:99], v8 offset:42496
    ds_read_b64_tr_b16 v[68:69], v10 offset:36864
    v_mfma_f32_32x32x16_bf16 v[32:47], v[80:83], a[160:163], v[32:47]
    ds_read_b64_tr_b16 v[70:71], v10 offset:40960
    ds_read_b64_tr_b16 v[72:73], v9 offset:3072
    ds_read_b64_tr_b16 v[74:75], v9 offset:2048
    ds_read_b64_tr_b16 v[76:77], v9 offset:0
    v_cndmask_b32 v176, v176, v177, s[78:79]
    s_waitcnt lgkmcnt(11)
    v_mfma_f32_32x32x16_bf16 v[48:63], a[160:163], v[84:87], v[48:63]
    s_add_u32 m0, s47, 0
    s_nop 0
    buffer_load_dwordx4 v253, s[40:43], s3 offen lds
    ds_read_b64_tr_b16 v[78:79], v9 offset:4096
    s_waitcnt lgkmcnt(8)
    v_mfma_f32_32x32x16_bf16 v[16:31], v[88:91], a[164:167], v[16:31]
    ds_read_b64_tr_b16 v[80:81], v9 offset:1024
    ds_read_b64_tr_b16 v[82:83], v9 offset:5120
    ds_read_b64_tr_b16 v[84:85], v9 offset:3584
    ds_read_b64_tr_b16 v[86:87], v9 offset:2560
    v_mfma_f32_16x16x32_bf16 v[196:199], v[204:207], v[88:91], v[196:199]
    s_add_u32 m0, s47, 2048
    s_add_u32 s3, s3, 57344
    buffer_load_dwordx4 v253, s[40:43], s3 offen lds
    v_mfma_f32_32x32x16_bf16 v[32:47], v[92:95], a[164:167], v[32:47]
    ds_read_b64_tr_b16 v[88:89], v9 offset:512
    ds_read_b64_tr_b16 v[90:91], v9 offset:4608
    ds_read_b64_tr_b16 v[92:93], v9 offset:1536
    ds_read_b64_tr_b16 v[94:95], v9 offset:5632
    v_cndmask_b32 v178, v178, v179, s[78:79]
    s_waitcnt lgkmcnt(10)
    v_mfma_f32_32x32x16_bf16 v[48:63], a[164:167], v[96:99], v[48:63]
    ds_read_b64_tr_b16 v[96:97], v11 offset:0
    ds_read_b64_tr_b16 v[98:99], v11 offset:4096
    v_cndmask_b32 v180, v180, v181, s[78:79]
    v_cndmask_b32 v182, v182, v183, s[78:79]
    v_cndmask_b32 v101, 0, v184, s[62:63]
    v_mfma_f32_16x16x32_bf16 v[64:67], v[68:71], a[224:227], v[64:67]
    s_add_u32 m0, s47, 4096
    s_add_u32 s3, s3, 57344
    buffer_load_dwordx4 v253, s[40:43], s3 offen lds
    v_mfma_f32_32x32x16_bf16 v[16:31], v[72:75], a[168:171], v[16:31]
    v_cndmask_b32 v101, v101, v185, s[64:65]
    v_cndmask_b32 v101, v101, v186, s[66:67]
    v_cndmask_b32 v101, v101, v187, s[68:69]
    v_add_f32 v176, v176, v180
    v_add_f32 v178, v178, v182
    v_cndmask_b32 v102, 0, v184, s[76:77]
    v_cndmask_b32 v100, v176, v178, s[80:81]
    v_mfma_f32_16x16x32_bf16 v[196:199], v[204:207], v[72:75], v[196:199]
    v_mov_b32 v104, v101
    v_mov_b32 v105, v102
    v_mov_b32 v106, v100
    s_waitcnt lgkmcnt(8)
    v_mfma_f32_32x32x16_bf16 v[32:47], v[76:79], a[168:171], v[32:47]
    s_waitcnt vmcnt(10)
    s_barrier
    s_add_u32 m0, s47, 6144
    s_add_u32 s3, s3, 57344
    buffer_load_dwordx4 v253, s[40:43], s3 offen lds
    v_mfma_f32_32x32x16_bf16 v[48:63], a[168:171], v[80:83], v[48:63]
    ds_read_b64_tr_b16 v[68:69], v9 offset:9216
    ds_read_b64_tr_b16 v[70:71], v9 offset:8192
    ds_read_b64_tr_b16 v[72:73], v9 offset:6144
    ds_read_b64_tr_b16 v[74:75], v9 offset:10240
    v_permlane32_swap_b32 v101, v104
    s_waitcnt lgkmcnt(8)
    v_mfma_f32_32x32x16_bf16 v[16:31], v[84:87], a[172:175], v[16:31]
    s_add_u32 m0, s47, 8192
    s_add_u32 s3, s3, 57344
    s_sub_u32 s6, s3, 1605632
    s_cselect_b32 s3, s3, s6
    buffer_load_dwordx4 v253, s[40:43], s3 offen lds
    v_mfma_f32_16x16x32_bf16 v[196:199], v[204:207], v[84:87], v[196:199]
    ds_read_b64_tr_b16 v[76:77], v9 offset:7168
    ds_read_b64_tr_b16 v[78:79], v9 offset:11264
    v_mfma_f32_32x32x16_bf16 v[32:47], v[88:91], a[172:175], v[32:47]
    ds_read_b64_tr_b16 v[80:81], v9 offset:9728
    ds_read_b64_tr_b16 v[82:83], v9 offset:8704
    ds_read_b64_tr_b16 v[84:85], v9 offset:6656
    ds_read_b64_tr_b16 v[86:87], v9 offset:10752
    v_permlane32_swap_b32 v102, v105
    s_waitcnt lgkmcnt(8)
    v_mfma_f32_32x32x16_bf16 v[48:63], a[172:175], v[92:95], v[48:63]
    s_add_u32 m0, s47, 10240
    s_add_u32 s3, s3, 57344
    buffer_load_dwordx4 v253, s[40:43], s3 offen lds
    v_permlane32_swap_b32 v100, v106
    v_mfma_f32_16x16x32_bf16 v[64:67], v[96:99], a[228:231], v[64:67]
    ds_read_b64_tr_b16 v[88:89], v9 offset:7680
    ds_read_b64_tr_b16 v[90:91], v9 offset:11776
    v_mfma_f32_32x32x16_bf16 v[16:31], v[68:71], a[176:179], v[16:31]
    ds_read_b64_tr_b16 v[92:93], v11 offset:6144
    ds_read_b64_tr_b16 v[94:95], v11 offset:10240
    ds_read_b64_tr_b16 v[96:97], v9 offset:15360
    ds_read_b64_tr_b16 v[98:99], v9 offset:14336
    v_add_f32 v101, v101, v104
    v_mfma_f32_16x16x32_bf16 v[196:199], v[204:207], v[68:71], v[196:199]
    s_add_u32 m0, s47, 12288
    s_add_u32 s3, s3, 57344
    buffer_load_dwordx4 v253, s[40:43], s3 offen lds
    s_waitcnt lgkmcnt(10)
    v_mfma_f32_32x32x16_bf16 v[32:47], v[72:75], a[176:179], v[32:47]
    ds_read_b64_tr_b16 v[68:69], v9 offset:12288
    ds_read_b64_tr_b16 v[70:71], v9 offset:16384
    ds_read_b64_tr_b16 v[72:73], v9 offset:13312
    ds_read_b64_tr_b16 v[74:75], v9 offset:17408
    v_mfma_f32_32x32x16_bf16 v[48:63], a[176:179], v[76:79], v[48:63]
    ds_read_b64_tr_b16 v[76:77], v9 offset:15872
    ds_read_b64_tr_b16 v[78:79], v9 offset:14848
    v_add_f32 v102, v102, v105
    v_add_f32 v100, v100, v106
    v_mov_b32 v104, v101
    v_mov_b32 v105, v102
    s_waitcnt lgkmcnt(12)
    v_mfma_f32_32x32x16_bf16 v[16:31], v[80:83], a[180:183], v[16:31]
    s_add_u32 m0, s47, 28672
    s_add_u32 s3, s3, 57344
    buffer_load_dwordx4 v253, s[40:43], s3 offen lds
    v_permlane16_swap_b32 v101, v104
    v_mfma_f32_16x16x32_bf16 v[196:199], v[204:207], v[80:83], v[196:199]
    ds_read_b64_tr_b16 v[80:81], v9 offset:12800
    ds_read_b64_tr_b16 v[82:83], v9 offset:16896
    v_mfma_f32_32x32x16_bf16 v[32:47], v[84:87], a[180:183], v[32:47]
    ds_read_b64_tr_b16 v[84:85], v9 offset:13824
    ds_read_b64_tr_b16 v[86:87], v9 offset:17920
    v_permlane16_swap_b32 v102, v105
    v_add_f32 v101, v101, v104
    v_add_f32 v102, v102, v105
    v_mul_f32 v148, 0xbb124925, v188
    s_waitcnt lgkmcnt(10)
    v_mfma_f32_32x32x16_bf16 v[48:63], a[180:183], v[88:91], v[48:63]
    s_add_u32 m0, s47, 30720
    s_add_u32 s3, s3, 57344
    s_sub_u32 s6, s3, 1605632
    s_cselect_b32 s3, s3, s6
    buffer_load_dwordx4 v253, s[40:43], s3 offen lds
    v_mfma_f32_16x16x32_bf16 v[64:67], v[92:95], a[232:235], v[64:67]
    ds_read_b64_tr_b16 v[88:89], v11 offset:12288
    ds_read_b64_tr_b16 v[90:91], v11 offset:16384
    v_mfma_f32_32x32x16_bf16 v[16:31], v[96:99], a[184:187], v[16:31]
    v_mul_f32 v152, 0xbb124925, v102
    v_mul_f32 v104, 0x3b124925, v100
    v_mul_f32 v105, 0x3b124925, v101
    v_fma_f32 v104, -v148, v148, v104
    v_fma_f32 v105, -v152, v152, v105
    v_max_f32 v104, 0, v104
    v_max_f32 v105, 0, v105
    v_mfma_f32_16x16x32_bf16 v[196:199], v[204:207], v[96:99], v[196:199]
    s_add_u32 m0, s47, 32768
    s_add_u32 s3, s3, 57344
    buffer_load_dwordx4 v253, s[40:43], s3 offen lds
    s_waitcnt lgkmcnt(8)
    v_mfma_f32_32x32x16_bf16 v[32:47], v[68:71], a[184:187], v[32:47]
    s_waitcnt vmcnt(14)
    s_barrier
    ds_read_b64_tr_b16 v[92:93], v9 offset:21504
    ds_read_b64_tr_b16 v[94:95], v9 offset:20480
    v_cvt_pk_bf16_f32 v148, v148, v148
    v_mfma_f32_32x32x16_bf16 v[48:63], a[184:187], v[72:75], v[48:63]
    ds_read_b64_tr_b16 v[96:97], v9 offset:18432
    ds_read_b64_tr_b16 v[98:99], v9 offset:22528
    ds_read_b64_tr_b16 v[68:69], v9 offset:19456
    ds_read_b64_tr_b16 v[70:71], v9 offset:23552
    v_cvt_pk_bf16_f32 v152, v152, v152
    s_waitcnt lgkmcnt(10)
    v_mfma_f32_32x32x16_bf16 v[16:31], v[76:79], a[188:191], v[16:31]
    s_add_u32 m0, s47, 34816
    s_add_u32 s3, s3, 57344
    buffer_load_dwordx4 v253, s[40:43], s3 offen lds
    v_cvt_pk_bf16_f32 v104, v104, v104
    v_mfma_f32_16x16x32_bf16 v[196:199], v[204:207], v[76:79], v[196:199]
    ds_read_b64_tr_b16 v[72:73], v9 offset:22016
    ds_read_b64_tr_b16 v[74:75], v9 offset:20992
    v_mfma_f32_32x32x16_bf16 v[32:47], v[80:83], a[188:191], v[32:47]
    ds_read_b64_tr_b16 v[76:77], v9 offset:18944
    ds_read_b64_tr_b16 v[78:79], v9 offset:23040
    ds_read_b64_tr_b16 v[80:81], v9 offset:19968
    ds_read_b64_tr_b16 v[82:83], v9 offset:24064
    v_cvt_pk_bf16_f32 v105, v105, v105
    s_waitcnt lgkmcnt(10)
    v_mfma_f32_32x32x16_bf16 v[48:63], a[188:191], v[84:87], v[48:63]
    s_add_u32 m0, s47, 36864
    s_add_u32 s3, s3, 57344
    buffer_load_dwordx4 v253, s[40:43], s3 offen lds
    v_lshlrev_b32 v104, 16, v104
    v_mfma_f32_16x16x32_bf16 v[64:67], v[88:91], a[236:239], v[64:67]
    ds_read_b64_tr_b16 v[84:85], v11 offset:18432
    ds_read_b64_tr_b16 v[86:87], v11 offset:22528
    v_mfma_f32_32x32x16_bf16 v[16:31], v[92:95], a[192:195], v[16:31]
    ds_read_b64_tr_b16 v[88:89], v9 offset:27648
    ds_read_b64_tr_b16 v[90:91], v9 offset:26624
    v_lshlrev_b32 v105, 16, v105
    v_add_f32 v104, 0x3727c5ac, v104
    v_add_f32 v105, 0x3727c5ac, v105
    v_cvt_pk_bf16_f32 v104, v104, v104
    v_mfma_f32_16x16x32_bf16 v[196:199], v[204:207], v[92:95], v[196:199]
    s_add_u32 m0, s47, 38912
    s_add_u32 s3, s3, 57344
    s_sub_u32 s6, s3, 1605632
    s_cselect_b32 s3, s3, s6
    buffer_load_dwordx4 v253, s[40:43], s3 offen lds
    s_waitcnt lgkmcnt(10)
    v_mfma_f32_32x32x16_bf16 v[32:47], v[96:99], a[192:195], v[32:47]
    ds_read_b64_tr_b16 v[92:93], v9 offset:24576
    ds_read_b64_tr_b16 v[94:95], v9 offset:28672
    ds_read_b64_tr_b16 v[96:97], v9 offset:25600
    ds_read_b64_tr_b16 v[98:99], v9 offset:29696
    v_mfma_f32_32x32x16_bf16 v[48:63], a[192:195], v[68:71], v[48:63]
    ds_read_b64_tr_b16 v[68:69], v9 offset:28160
    ds_read_b64_tr_b16 v[70:71], v9 offset:27136
    v_cvt_pk_bf16_f32 v105, v105, v105
    v_lshlrev_b32 v104, 16, v104
    v_lshlrev_b32 v105, 16, v105
    s_waitcnt lgkmcnt(12)
    v_mfma_f32_32x32x16_bf16 v[16:31], v[72:75], a[196:199], v[16:31]
    s_add_u32 m0, s47, 40960
    s_add_u32 s3, s3, 57344
    buffer_load_dwordx4 v253, s[40:43], s3 offen lds
    v_mfma_f32_16x16x32_bf16 v[196:199], v[204:207], v[72:75], v[196:199]
    ds_read_b64_tr_b16 v[72:73], v9 offset:25088
    ds_read_b64_tr_b16 v[74:75], v9 offset:29184
    v_mfma_f32_32x32x16_bf16 v[32:47], v[76:79], a[196:199], v[32:47]
    ds_read_b64_tr_b16 v[76:77], v9 offset:26112
    ds_read_b64_tr_b16 v[78:79], v9 offset:30208
    v_sqrt_f32 v104, v104
    v_sqrt_f32 v105, v105
    s_waitcnt lgkmcnt(10)
    v_mfma_f32_32x32x16_bf16 v[48:63], a[196:199], v[80:83], v[48:63]
    s_mul_i32 s5, s48, 7
    s_add_u32 s5, s5, s1
    s_add_u32 s5, s5, 0
    s_sub_u32 s6, s5, 56
    s_cselect_b32 s5, s5, s6
    s_mul_i32 s5, s5, 7168
    s_cmp_lt_u32 s1, 56
    s_cselect_b32 s5, s5, 2146435072
    buffer_load_dword v221, v222, s[16:19], s5 offen
    v_mfma_f32_16x16x32_bf16 v[64:67], v[84:87], a[240:243], v[64:67]
    ds_read_b64_tr_b16 v[80:81], v11 offset:24576
    ds_read_b64_tr_b16 v[82:83], v11 offset:28672
    v_mfma_f32_32x32x16_bf16 v[16:31], v[88:91], a[200:203], v[16:31]
    v_cvt_pk_bf16_f32 v104, v104, v104
    v_cvt_pk_bf16_f32 v105, v105, v105
    v_lshlrev_b32 v104, 16, v104
    v_lshlrev_b32 v105, 16, v105
    v_rcp_f32 v168, v104
    v_mfma_f32_16x16x32_bf16 v[196:199], v[204:207], v[88:91], v[196:199]
    v_rcp_f32 v101, v105
    s_waitcnt lgkmcnt(8)
    v_mfma_f32_32x32x16_bf16 v[32:47], v[92:95], a[200:203], v[32:47]
    ds_write_b32 v242, v168 offset:1024
    ds_write_b32 v243, v101 offset:1024
    v_cndmask_b32 v152, v152, 0, s[90:91]
    v_mul_f32 v168, 0x3e8b97f6, v168
    s_waitcnt vmcnt(1) lgkmcnt(0)
    s_barrier
    v_mfma_f32_32x32x16_bf16 v[48:63], a[200:203], v[96:99], v[48:63]
    buffer_load_dwordx2 v[246:247], v252, s[36:39], 0 offen sc1
    ds_read_b64_tr_b16 v[84:85], v11 offset:30720
    ds_read_b64_tr_b16 v[86:87], v11 offset:34816
    ds_read_b64_tr_b16 a[0:1], v223 offset:0
    ds_read_b64_tr_b16 a[2:3], v223 offset:512
    v_mfma_f32_32x32x16_bf16 v[16:31], v[68:71], a[204:207], v[16:31]
    ds_read_b64_tr_b16 v[88:89], v11 offset:36864
    ds_read_b64_tr_b16 v[90:91], v11 offset:40960
    ds_read_b64_tr_b16 v[92:93], v9 offset:33792
    ds_read_b64_tr_b16 v[94:95], v9 offset:32768
    ds_read_b64_tr_b16 a[4:5], v223 offset:2048
    ds_read_b64_tr_b16 a[6:7], v223 offset:2560
    v_mfma_f32_16x16x32_bf16 v[196:199], v[204:207], v[68:71], v[196:199]
    s_cmp_eq_u32 s48, 7
    s_cselect_b32 s5, 3, s48
    s_lshr_b32 s6, s1, 1
    s_lshl_b32 s5, s5, 5
    s_add_u32 s5, s5, s6
    s_add_u32 s5, s5, 188
    s_sub_u32 s6, s5, 224
    s_cselect_b32 s5, s5, s6
    s_mul_i32 s5, s5, 7168
    buffer_load_dword v221, v222, s[40:43], s5 offen
    ds_read_b64_tr_b16 a[8:9], v223 offset:4096
    ds_read_b64_tr_b16 a[10:11], v223 offset:4608
    v_mfma_f32_32x32x16_bf16 v[32:47], v[72:75], a[204:207], v[32:47]
    ds_read_b64_tr_b16 v[96:97], v9 offset:34304
    ds_read_b64_tr_b16 v[98:99], v9 offset:33280
    ds_read_b64_tr_b16 v[68:69], v9 offset:39936
    ds_read_b64_tr_b16 v[70:71], v9 offset:38912
    ds_read_b64_tr_b16 a[12:13], v223 offset:6144
    ds_read_b64_tr_b16 a[14:15], v223 offset:6656
    s_waitcnt lgkmcnt(15)
    v_mfma_f32_32x32x16_bf16 v[48:63], a[204:207], v[76:79], v[48:63]
    ds_read_b64_tr_b16 v[72:73], v9 offset:40448
    ds_read_b64_tr_b16 v[74:75], v9 offset:39424
    ds_read_b64_tr_b16 v[76:77], v9 offset:30720
    ds_read_b64_tr_b16 v[78:79], v9 offset:34816
    ds_read_b64_tr_b16 a[16:17], v223 offset:8192
    ds_read_b64_tr_b16 a[18:19], v223 offset:8704
    v_mfma_f32_16x16x32_bf16 v[64:67], v[80:83], a[244:247], v[64:67]
    ds_read_b64_tr_b16 v[80:81], v9 offset:31744
    ds_read_b64_tr_b16 v[82:83], v9 offset:35840
    ds_read_b64_tr_b16 a[20:21], v223 offset:10240
    ds_read_b64_tr_b16 a[22:23], v223 offset:10752
    v_mfma_f32_16x16x32_bf16 v[64:67], v[84:87], a[248:251], v[64:67]
    ds_read_b64_tr_b16 v[84:85], v9 offset:31232
    ds_read_b64_tr_b16 v[86:87], v9 offset:35328
    ds_read_b64_tr_b16 a[24:25], v223 offset:12288
    ds_read_b64_tr_b16 a[26:27], v223 offset:12800
    s_waitcnt lgkmcnt(15)
    v_mfma_f32_16x16x32_bf16 v[64:67], v[88:91], a[252:255], v[64:67]
    ds_read_b64_tr_b16 v[88:89], v9 offset:32256
    ds_read_b64_tr_b16 a[28:29], v223 offset:28672
    ds_read_b64_tr_b16 a[30:31], v223 offset:29184
    v_mfma_f32_32x32x16_bf16 v[16:31], v[92:95], a[208:211], v[16:31]
    ds_read_b64_tr_b16 v[90:91], v9 offset:36352
    ds_read_b64_tr_b16 a[32:33], v223 offset:30720
    ds_read_b64_tr_b16 a[34:35], v223 offset:31232
    ds_read_b32 v160, v164 offset:1024
    v_mfma_f32_16x16x32_bf16 v[196:199], v[204:207], v[92:95], v[196:199]
    ds_read_b64_tr_b16 v[92:93], v9 offset:36864
    ds_read_b64_tr_b16 v[94:95], v9 offset:40960
    ds_read_b64_tr_b16 a[36:37], v223 offset:32768
    ds_read_b64_tr_b16 a[38:39], v223 offset:33280
    v_mfma_f32_32x32x16_bf16 v[16:31], v[96:99], a[212:215], v[16:31]
    ds_read_b64_tr_b16 a[40:41], v223 offset:34816
    ds_read_b64_tr_b16 a[42:43], v223 offset:35328
    ds_read_b32 v161, v165 offset:1024
    ds_read_b32 v162, v166 offset:1024
    v_mfma_f32_16x16x32_bf16 v[196:199], v[204:207], v[96:99], v[196:199]
    ds_read_b64_tr_b16 v[96:97], v9 offset:37888
    ds_read_b64_tr_b16 v[98:99], v9 offset:41984
    ds_read_b64_tr_b16 a[44:45], v223 offset:36864
    ds_read_b64_tr_b16 a[46:47], v223 offset:37376
    v_mfma_f32_32x32x16_bf16 v[16:31], v[68:71], a[216:219], v[16:31]
    ds_read_b64_tr_b16 a[48:49], v223 offset:38912
    ds_read_b64_tr_b16 a[50:51], v223 offset:39424
    ds_read_b32 v163, v167 offset:1024
    v_and_b32 v108, 0xffff0000, v64
    v_and_b32 v109, 0xffff0000, v65
    v_mfma_f32_16x16x32_bf16 v[196:199], v[204:207], v[68:71], v[196:199]
    ds_read_b64_tr_b16 v[68:69], v9 offset:37376
    ds_read_b64_tr_b16 v[70:71], v9 offset:41472
    ds_read_b64_tr_b16 a[52:53], v223 offset:40960
    ds_read_b64_tr_b16 a[54:55], v223 offset:41472
    s_waitcnt lgkmcnt(15)
    v_mfma_f32_32x32x16_bf16 v[16:31], v[72:75], a[220:223], v[16:31]
    v_and_b32 v110, 0xffff0000, v66
    v_and_b32 v111, 0xffff0000, v67
    v_sub_f32 v104, v64, v108
    v_sub_f32 v105, v65, v109
    v_sub_f32 v106, v66, v110
    v_sub_f32 v107, v67, v111
    v_mfma_f32_16x16x32_bf16 v[196:199], v[204:207], v[72:75], v[196:199]
    ds_read_b64_tr_b16 v[72:73], v9 offset:38400
    ds_read_b64_tr_b16 v[74:75], v9 offset:42496
    v_mfma_f32_32x32x16_bf16 v[32:47], v[76:79], a[208:211], v[32:47]
    v_and_b32 v100, 0xffff0000, v104
    v_and_b32 v101, 0xffff0000, v105
    v_and_b32 v102, 0xffff0000, v106
    v_and_b32 v103, 0xffff0000, v107
    v_sub_f32 v104, v104, v100
    v_sub_f32 v105, v105, v101
    v_sub_f32 v106, v106, v102
    v_mfma_f32_32x32x16_bf16 v[48:63], a[208:211], v[80:83], v[48:63]
    v_sub_f32 v107, v107, v103
    v_lshrrev_b32 v108, 16, v108
    v_lshrrev_b32 v109, 16, v109
    v_lshrrev_b32 v110, 16, v110
    v_lshrrev_b32 v111, 16, v111
    v_or_b32 v100, v100, v108
    v_or_b32 v101, v101, v109
    v_mfma_f32_32x32x16_bf16 v[32:47], v[84:87], a[212:215], v[32:47]
    v_or_b32 v102, v102, v110
    v_or_b32 v103, v103, v111
    v_lshrrev_b32 v104, 16, v104
    v_lshrrev_b32 v105, 16, v105
    v_lshrrev_b32 v106, 16, v106
    v_lshrrev_b32 v107, 16, v107
    v_mfma_f32_32x32x16_bf16 v[48:63], a[212:215], v[88:91], v[48:63]
    ds_write_b128 v244, v[100:103]
    v_mfma_f32_32x32x16_bf16 v[32:47], v[92:95], a[216:219], v[32:47]
    ds_write_b128 v244, v[104:107] offset:128
    v_and_b32 v199, 0xffff0000, v196
    v_mul_f32 v164, v160, v168
    v_sub_f32 v198, v196, v199
    s_waitcnt lgkmcnt(15)
    v_mul_f32 v165, v161, v168
    v_and_b32 v197, 0xffff0000, v198
    v_sub_f32 v198, v198, v197
    v_mul_f32 v166, v162, v168
    v_lshrrev_b32 v199, 16, v199
    v_or_b32 v197, v197, v199
    s_waitcnt lgkmcnt(8)
    v_mul_f32 v167, v163, v168
    v_lshrrev_b32 v198, 16, v198
    v_cndmask_b32 v196, v197, v198, s[90:91]
    ds_write_b32 v170, v196
    s_waitcnt lgkmcnt(0)
    s_barrier
    s_add_u32 m0, s45, 0
    s_mov_b32 s5, 0
    buffer_load_dwordx4 v245, s[16:19], s5 offen offset:0 lds
    v_mfma_f32_32x32x16_bf16 v[48:63], a[216:219], v[96:99], v[48:63]
    ds_read_b32 v76, v170 offset:256
    ds_read_b32 v80, v170 offset:512
    ds_read_b32 v84, v171
    ds_read_b32 v88, v170 offset:0
    v_mfma_f32_32x32x16_bf16 v[32:47], v[68:71], a[220:223], v[32:47]
    s_mov_b32 s5, 6144
    buffer_load_dwordx4 v245, s[16:19], s5 offen offset:1024 lds
    v_mfma_f32_32x32x16_bf16 v[48:63], a[220:223], v[72:75], v[48:63]
    s_waitcnt lgkmcnt(3)
    v_mfma_f32_32x32x16_bf16 v[32:47], v[76:79], v[148:151], v[32:47]
    s_mov_b32 s5, 12288
    buffer_load_dwordx4 v245, s[16:19], s5 offen offset:2048 lds
    s_waitcnt lgkmcnt(0)
    v_mfma_f32_32x32x16_bf16 v[48:63], v[148:151], v[80:83], v[48:63]
    s_nop 7
    v_cvt_pk_bf16_f32 v32, v32, v33
    v_cvt_pk_bf16_f32 v33, v34, v35
    v_cvt_pk_bf16_f32 v34, v36, v37
    v_cvt_pk_bf16_f32 v35, v38, v39
    v_cvt_pk_bf16_f32 v36, v40, v41
    v_cvt_pk_bf16_f32 v37, v42, v43
    v_mfma_f32_16x16x32_bf16 v[64:67], v[84:87], v[152:155], v[64:67]
    s_mov_b32 s5, 18432
    buffer_load_dwordx4 v245, s[16:19], s5 offen offset:3072 lds
    v_mfma_f32_32x32x16_bf16 v[16:31], v[88:91], v[148:151], v[16:31]
    v_cvt_pk_bf16_f32 v38, v44, v45
    v_cvt_pk_bf16_f32 v39, v46, v47
    s_mov_b32 exec_lo, 0xffff0000
    s_mov_b32 exec_hi, 0xffff0000
    ds_write_b128 v13, v[32:35] offset:2048
    ds_write_b128 v13, v[36:39] offset:2560
    s_mov_b64 exec, -1
    s_add_u32 m0, s45, 16384
    s_mov_b32 s5, 114688
    buffer_load_dwordx4 v245, s[16:19], s5 offen offset:0 lds
    v_cvt_pk_bf16_f32 v48, v48, v49
    v_cvt_pk_bf16_f32 v49, v50, v51
    v_cvt_pk_bf16_f32 v50, v52, v53
    v_cvt_pk_bf16_f32 v51, v54, v55
    v_cvt_pk_bf16_f32 v52, v56, v57
    v_cvt_pk_bf16_f32 v53, v58, v59
    v_cvt_pk_bf16_f32 v54, v60, v61
    v_cvt_pk_bf16_f32 v55, v62, v63
    ds_write_b128 v14, v[52:55] offset:3072
    s_mov_b32 s5, 120832
    buffer_load_dwordx4 v245, s[16:19], s5 offen offset:1024 lds
    v_cvt_pk_bf16_f32 v64, v64, v65
    v_cvt_pk_bf16_f32 v65, v66, v67
    ds_write_b64 v15, v[64:65]
    ds_write_b16 v4, v64
    ds_write_b16_d16_hi v4, v64 offset:16
    ds_write_b16 v4, v65 offset:32
    ds_write_b16_d16_hi v4, v65 offset:48
    s_waitcnt lgkmcnt(0)
    s_barrier
    ds_read_b128 v[40:43], v13
    s_mov_b32 s5, 126976
    buffer_load_dwordx4 v245, s[16:19], s5 offen offset:2048 lds
    ds_read_b128 v[44:47], v13 offset:512
    v_cvt_pk_bf16_f32 v16, v16, v17
    v_cvt_pk_bf16_f32 v17, v18, v19
    v_cvt_pk_bf16_f32 v18, v20, v21
    v_cvt_pk_bf16_f32 v19, v22, v23
    ds_read_b128 v[56:59], v14 offset:1024
    ds_read_b128 v[68:71], v169 offset:2432
    v_mfma_f32_32x32x16_bf16 v[132:147], v[32:35], v[16:19], v[132:147]
    s_mov_b32 s5, 133120
    buffer_load_dwordx4 v245, s[16:19], s5 offen offset:3072 lds
    v_cvt_pk_bf16_f32 v20, v24, v25
    v_cvt_pk_bf16_f32 v21, v26, v27
    v_cvt_pk_bf16_f32 v22, v28, v29
    v_cvt_pk_bf16_f32 v23, v30, v31
    v_cndmask_b32 v22, v22, 0, s[90:91]
    v_cndmask_b32 v23, v23, 0, s[90:91]
    ds_read_b128 v[72:75], v169 offset:2176
    ds_read_b128 v[76:79], v169 offset:2688
    v_mfma_f32_32x32x16_bf16 v[132:147], v[36:39], v[20:23], v[132:147]
    s_add_u32 m0, s45, 32768
    s_mov_b32 s5, 229376
    buffer_load_dwordx4 v245, s[16:19], s5 offen offset:0 lds
    v_and_b32 v30, 1, v2
    v_and_b32 v29, 0x1ff, v13
    v_lshl_add_u32 v30, v30, 14, v29
    s_waitcnt lgkmcnt(5)
    v_mfma_f32_32x32x16_bf16 v[116:131], v[40:43], v[16:19], v[116:131]
    s_lshl2_add_u32 s72, s52, s50
    s_mov_b32 s5, 235520
    buffer_load_dwordx4 v245, s[16:19], s5 offen offset:1024 lds
    s_lshl_b32 s72, s72, 15
    s_lshl_b32 s73, s51, 10
    s_add_u32 s72, s72, s73
    s_waitcnt lgkmcnt(4)
    v_mfma_f32_32x32x16_bf16 v[116:131], v[44:47], v[20:23], v[116:131]
    v_max3_f32 v24, v132, v133, v140
    s_mov_b32 s5, 241664
    buffer_load_dwordx4 v245, s[16:19], s5 offen offset:2048 lds
    v_max3_f32 v25, v134, v135, v142
    v_max3_f32 v26, v136, v137, v144
    v_max3_f32 v27, v138, v139, v146
    v_max_f32 v24, v24, v141
    v_max_f32 v25, v25, v143
    v_max_f32 v26, v26, v145
    v_max_f32 v27, v27, v147
    s_nop 1
    v_max3_f32 v24, v24, v124, v125
    v_max3_f32 v25, v25, v126, v127
    v_max3_f32 v26, v26, v128, v129
    v_max3_f32 v27, v27, v130, v131
    v_mul_f32 v24, v24, v164
    s_mov_b32 s5, 247808
    buffer_load_dwordx4 v245, s[16:19], s5 offen offset:3072 lds
    v_mul_f32 v25, v25, v165
    v_mul_f32 v26, v26, v166
    v_mul_f32 v27, v27, v167
    v_max3_f32 v28, v24, v25, v26
    v_max_f32 v28, v28, v27
    v_max_f32 v29, v28, v27
    s_nop 1
    v_permlane32_swap_b32 v28, v29
    v_max_f32 v28, v28, v29
    v_sub_f32 v24, v24, v28
    v_sub_f32 v25, v25, v28
    v_sub_f32 v26, v26, v28
    v_sub_f32 v27, v27, v28
    s_lshl_b32 s5, s50, 11
    s_add_u32 m0, s5, 140800
    s_mul_i32 s5, s50, 14336
    s_sub_u32 s46, 344064, s5
    buffer_load_dwordx4 v245, s[16:19], s46 offen offset:0 lds
    v_exp_f32 v24, v24
    v_exp_f32 v25, v25
    v_exp_f32 v26, v26
    v_exp_f32 v27, v27
    v_add_f32 v28, v24, v25
    v_add_f32 v29, v26, v27
    v_add_f32 v28, v28, v29
    v_mov_b32 v29, v28
    s_add_u32 s46, s46, 6144
    buffer_load_dwordx4 v245, s[16:19], s46 offen offset:1024 lds
    v_mul_f32 v24, v24, v160
    v_mul_f32 v25, v25, v161
    v_permlane32_swap_b32 v28, v29
    v_add_f32 v28, v28, v29
    v_rcp_f32 v28, v28
    v_mul_f32 v26, v26, v162
    v_mul_f32 v27, v27, v163
    v_mul_f32 v24, v24, v28
    v_mul_f32 v25, v25, v28
    v_mul_f32 v26, v26, v28
    v_mul_f32 v27, v27, v28
    v_cvt_pk_bf16_f32 v24, v24, v24
    v_cvt_pk_bf16_f32 v25, v25, v25
    v_cvt_pk_bf16_f32 v26, v26, v26
    v_cvt_pk_bf16_f32 v27, v27, v27
    s_waitcnt lgkmcnt(2)
    v_and_b32 v68, v24, v68
    v_and_b32 v69, v25, v69
    v_and_b32 v70, v26, v70
    v_and_b32 v71, v27, v71
    s_waitcnt lgkmcnt(1)
    v_and_b32 v72, v24, v72
    v_and_b32 v73, v25, v73
    v_mfma_f32_32x32x16_bf16 v[100:115], v[48:51], v[68:71], 0
    v_and_b32 v74, v26, v74
    v_and_b32 v75, v27, v75
    s_waitcnt lgkmcnt(0)
    v_and_b32 v76, v24, v76
    v_and_b32 v77, v25, v77
    v_mfma_f32_32x32x16_bf16 v[100:115], v[52:55], v[72:75], v[100:115]
    v_and_b32 v78, v26, v78
    v_and_b32 v79, v27, v79
    s_nop 1
    v_mfma_f32_32x32x16_bf16 v[100:115], v[56:59], v[76:79], v[100:115]
    s_mov_b32 s4, 0
    s_waitcnt vmcnt(15)
    v_xor_b32 v246, s0, v246
    v_xor_b32 v247, s61, v247
    v_or_b32 v246, v246, v247
    v_cmp_ne_u32 vcc, 0, v246
    s_nop 0
    s_cmp_eq_u32 vcc_lo, 0
    s_cbranch_scc0 Lvfs_80
Lvfd_82:
    s_lshl_b32 s5, s4, 26
    s_lshl_b32 s55, s48, 21
    s_add_u32 s55, s55, s5
    s_mul_i32 s20, s48, 917504
    s_add_u32 s20, s20, s5
    s_add_u32 s20, s20, 16777216
    s_add_u32 s21, s55, 516096
    s_add_u32 s72, s72, s55
    v_cvt_pk_bf16_f32 v100, v100, v101
    v_cvt_pk_bf16_f32 v101, v102, v103
    v_cvt_pk_bf16_f32 v102, v104, v105
    v_cvt_pk_bf16_f32 v103, v106, v107
    v_cvt_pk_bf16_f32 v104, v108, v109
    v_cvt_pk_bf16_f32 v105, v110, v111
    v_cvt_pk_bf16_f32 v106, v112, v113
    v_cvt_pk_bf16_f32 v107, v114, v115
    v_cndmask_b32 v106, v106, 0, s[90:91]
    v_cndmask_b32 v107, v107, 0, s[90:91]
    s_cmp_eq_u32 s4, 0
    s_cbranch_scc0 Lslow_85
    buffer_store_dwordx4 v[100:103], v30, s[36:39], s72 offen
    buffer_store_dwordx4 v[104:107], v30, s[36:39], s72 offen offset:512
Lsdone_86:
    s_cmp_eq_u32 s4, 0
    s_cbranch_scc0 Lss_87
Lssd_89:
    s_lshl2_add_u32 s5, s54, s50
    s_mul_i32 s5, s5, 896
    s_add_u32 s5, s5, 41975808
    v_min_u32 v254, 27, v0
    v_lshl_add_u32 v254, v254, 5, s5
    buffer_load_dword v220, v254, s[36:39], 0 offen sc1
    v_and_b32 v5, 1, v2
    v_lshrrev_b32 v7, 1, v2
    v_lshl_add_u32 v5, v5, 1, v7
    v_lshlrev_b32 v7, 4, v3
    v_lshl_add_u32 v5, v5, 8, v7
    s_and_b32 s75, s60, 15
    s_lshl_b32 s77, s75, 14
    s_add_u32 s77, s77, s55
    s_add_u32 s78, s77, 4096
    s_add_u32 s79, s77, 8192
    s_add_u32 s80, s77, 12288
    v_and_b32 v4, 1, v2
    v_lshrrev_b32 v7, 1, v2
    v_lshl_add_u32 v4, v4, 1, v7
    v_mul_u32_u24 v7, 896, v3
    v_lshl_add_u32 v4, v4, 4, v7
    s_mul_i32 s72, s60, 14336
    s_lshl_b32 s73, s54, 7
    s_add_u32 s76, s72, s73
    buffer_load_dwordx4 v[164:167], v4, s[8:11], s76 offen
    buffer_load_dwordx4 v[168:171], v4, s[8:11], s76 offen offset:64
    s_mul_i32 s72, s75, 14336
    s_lshl_b32 s73, s54, 11
    s_add_u32 s72, s72, s73
    s_add_u32 s72, s72, s55
    s_add_u32 s72, s72, 262144
    s_cmp_eq_u32 s48, 7
    s_cselect_b32 s5, 3, s48
    s_cmp_lt_u32 s54, s5
    s_cselect_b32 s6, 7, 0
    s_sub_u32 s5, s6, s5
    s_lshl_b32 s5, s5, 11
    s_add_u32 s72, s72, s5
    s_lshl_b32 s74, s75, 7
    s_add_u32 s73, s73, s74
    s_add_u32 s73, s73, s55
    s_add_u32 s73, s73, 491520
    v_mov_b32 v80, v2
    v_lshrrev_b32 v81, 2, v3
    v_and_b32 v82, 2, v80
    v_add_u32 v80, v80, v82
    v_lshl_add_u32 v82, v80, 2, v81
    v_lshlrev_b32 v83, 7, v82
    v_bfe_u32 v82, v82, 1, 2
    v_lshl_add_u32 v83, v82, 5, v83
    v_and_b32 v81, 3, v3
    v_lshl_add_u32 v83, v81, 3, v83
    v_add_u32 v8, 91648, v83
    v_xor_b32 v9, 32, v8
    v_xor_b32 v10, 64, v8
    v_xor_b32 v11, 96, v8
    v_cmp_eq_u32 vcc, 3, v2
    s_nop 1
    v_cndmask_b32 v80, v2, 1, vcc
    v_lshrrev_b32 v81, 2, v3
    v_and_b32 v82, 2, v80
    v_add_u32 v80, v80, v82
    v_lshl_add_u32 v82, v80, 2, v81
    v_lshlrev_b32 v83, 7, v82
    v_bfe_u32 v82, v82, 1, 2
    v_lshl_add_u32 v83, v82, 5, v83
    v_and_b32 v81, 3, v3
    v_lshl_add_u32 v83, v81, 3, v83
    v_add_u32 v12, 91648, v83
    v_xor_b32 v13, 32, v12
    v_xor_b32 v14, 64, v12
    v_xor_b32 v15, 96, v12
    s_waitcnt vmcnt(5)
    s_barrier
    ds_read_b64_tr_b16 v[96:97], v8 offset:0
    ds_read_b64_tr_b16 v[98:99], v12 offset:1024
    ds_read_b64_tr_b16 v[100:101], v9 offset:0
    ds_read_b64_tr_b16 v[102:103], v13 offset:1024
    ds_read_b64_tr_b16 v[104:105], v10 offset:0
    ds_read_b64_tr_b16 v[106:107], v14 offset:1024
    ds_read_b64_tr_b16 v[108:109], v11 offset:0
    ds_read_b64_tr_b16 v[110:111], v15 offset:1024
    buffer_load_dwordx4 v[16:19], v1, s[36:39], s77 offen offset:0 sc1
    ds_read_b64_tr_b16 v[112:113], v10 offset:3584
    ds_read_b64_tr_b16 v[114:115], v14 offset:4608
    buffer_load_dwordx4 v[20:23], v1, s[36:39], s77 offen offset:1024 sc1
    ds_read_b64_tr_b16 v[116:117], v11 offset:3584
    ds_read_b64_tr_b16 v[118:119], v15 offset:4608
    buffer_load_dwordx4 v[24:27], v1, s[36:39], s77 offen offset:2048 sc1
    ds_read_b64_tr_b16 v[120:121], v8 offset:3584
    ds_read_b64_tr_b16 v[122:123], v12 offset:4608
    buffer_load_dwordx4 v[28:31], v1, s[36:39], s77 offen offset:3072 sc1
    ds_read_b64_tr_b16 v[124:125], v9 offset:3584
    ds_read_b64_tr_b16 v[126:127], v13 offset:4608
    buffer_load_dwordx4 v[32:35], v1, s[36:39], s78 offen offset:0 sc1
    ds_read_b64_tr_b16 v[128:129], v8 offset:7168
    ds_read_b64_tr_b16 v[130:131], v12 offset:8192
    buffer_load_dwordx4 v[36:39], v1, s[36:39], s78 offen offset:1024 sc1
    ds_read_b64_tr_b16 v[132:133], v9 offset:7168
    ds_read_b64_tr_b16 v[134:135], v13 offset:8192
    buffer_load_dwordx4 v[40:43], v1, s[36:39], s78 offen offset:2048 sc1
    ds_read_b64_tr_b16 v[136:137], v10 offset:7168
    ds_read_b64_tr_b16 v[138:139], v14 offset:8192
    buffer_load_dwordx4 v[44:47], v1, s[36:39], s78 offen offset:3072 sc1
    ds_read_b64_tr_b16 v[140:141], v11 offset:7168
    ds_read_b64_tr_b16 v[142:143], v15 offset:8192
    buffer_load_dwordx4 v[48:51], v1, s[36:39], s79 offen offset:0 sc1
    ds_read_b64_tr_b16 v[144:145], v10 offset:10752
    ds_read_b64_tr_b16 v[146:147], v14 offset:11776
    ds_read_b64_tr_b16 v[148:149], v11 offset:10752
    ds_read_b64_tr_b16 v[150:151], v15 offset:11776
    ds_read_b64_tr_b16 v[152:153], v8 offset:10752
    ds_read_b64_tr_b16 v[154:155], v12 offset:11776
    ds_read_b64_tr_b16 v[156:157], v9 offset:10752
    ds_read_b64_tr_b16 v[158:159], v13 offset:11776
    ds_read_b64_tr_b16 v[160:161], v8 offset:14336
    ds_read_b64_tr_b16 v[162:163], v12 offset:15360
    s_waitcnt vmcnt(10)
    v_permlane16_swap_b32 v164, v166
    v_permlane16_swap_b32 v165, v167
    s_waitcnt vmcnt(9)
    v_permlane16_swap_b32 v168, v170
    v_permlane16_swap_b32 v169, v171
    v_lshlrev_b32 v80, 16, v164
    v_and_b32 v81, 0xffff0000, v164
    v_lshlrev_b32 v82, 16, v165
    v_and_b32 v83, 0xffff0000, v165
    v_lshlrev_b32 v84, 16, v166
    v_and_b32 v85, 0xffff0000, v166
    v_lshlrev_b32 v86, 16, v167
    v_and_b32 v87, 0xffff0000, v167
    v_lshlrev_b32 v88, 16, v168
    v_and_b32 v89, 0xffff0000, v168
    v_lshlrev_b32 v90, 16, v169
    v_and_b32 v91, 0xffff0000, v169
    v_lshlrev_b32 v92, 16, v170
    v_and_b32 v93, 0xffff0000, v170
    v_lshlrev_b32 v94, 16, v171
    v_and_b32 v95, 0xffff0000, v171
    v_mov_b32 v164, 0x3f803f80
    v_mov_b32 v165, 0x3f803f80
    v_mov_b32 v166, 0x3f803f80
    v_mov_b32 v167, 0x3f803f80
    v_lshlrev_b32 v168, 3, v3
    s_waitcnt vmcnt(6)
    v_max3_u32 v7, v16, v20, v24
    v_cmp_eq_u32 vcc, -1, v7
    s_nop 0
    s_cbranch_vccnz Lsc_90
Lscd_92:
    s_waitcnt lgkmcnt(15)
    v_mfma_f32_16x16x32_bf16 v[80:83], v[96:99], v[16:19], v[80:83]
    ds_read_b64_tr_b16 v[96:97], v9 offset:14336
    ds_read_b64_tr_b16 v[98:99], v13 offset:15360
    v_mfma_f32_16x16x32_bf16 v[84:87], v[100:103], v[16:19], v[84:87]
    ds_read_b64_tr_b16 v[100:101], v10 offset:14336
    ds_read_b64_tr_b16 v[102:103], v14 offset:15360
    v_mfma_f32_16x16x32_bf16 v[88:91], v[104:107], v[16:19], v[88:91]
    buffer_load_dwordx4 v[52:55], v1, s[36:39], s79 offen offset:1024 sc1
    ds_read_b64_tr_b16 v[104:105], v11 offset:14336
    ds_read_b64_tr_b16 v[106:107], v15 offset:15360
    v_mfma_f32_16x16x32_bf16 v[92:95], v[108:111], v[16:19], v[92:95]
    ds_read_b64_tr_b16 v[108:109], v10 offset:17920
    ds_read_b64_tr_b16 v[110:111], v14 offset:18944
    v_mfma_f32_16x16x32_bf16 v[80:83], v[112:115], v[20:23], v[80:83]
    buffer_load_dwordx4 v[56:59], v1, s[36:39], s79 offen offset:2048 sc1
    ds_read_b64_tr_b16 v[112:113], v11 offset:17920
    ds_read_b64_tr_b16 v[114:115], v15 offset:18944
    v_mfma_f32_16x16x32_bf16 v[84:87], v[116:119], v[20:23], v[84:87]
    ds_read_b64_tr_b16 v[116:117], v8 offset:17920
    ds_read_b64_tr_b16 v[118:119], v12 offset:18944
    v_mfma_f32_16x16x32_bf16 v[88:91], v[120:123], v[20:23], v[88:91]
    buffer_load_dwordx4 v[60:63], v1, s[36:39], s79 offen offset:3072 sc1
    ds_read_b64_tr_b16 v[120:121], v9 offset:17920
    ds_read_b64_tr_b16 v[122:123], v13 offset:18944
    s_waitcnt lgkmcnt(15)
    v_mfma_f32_16x16x32_bf16 v[92:95], v[124:127], v[20:23], v[92:95]
    ds_read_b64_tr_b16 v[124:125], v8 offset:21504
    ds_read_b64_tr_b16 v[126:127], v12 offset:22528
    v_mfma_f32_16x16x32_bf16 v[80:83], v[128:131], v[24:27], v[80:83]
    buffer_load_dwordx4 v[64:67], v1, s[36:39], s80 offen offset:0 sc1
    ds_read_b64_tr_b16 v[128:129], v9 offset:21504
    ds_read_b64_tr_b16 v[130:131], v13 offset:22528
    v_mfma_f32_16x16x32_bf16 v[84:87], v[132:135], v[24:27], v[84:87]
    s_waitcnt vmcnt(7)
    v_max3_u32 v7, v28, v32, v36
    v_cmp_eq_u32 vcc, -1, v7
    ds_read_b64_tr_b16 v[132:133], v10 offset:21504
    ds_read_b64_tr_b16 v[134:135], v14 offset:22528
    v_mfma_f32_16x16x32_bf16 v[88:91], v[136:139], v[24:27], v[88:91]
    buffer_load_dwordx4 v[68:71], v1, s[36:39], s80 offen offset:1024 sc1
    ds_read_b64_tr_b16 v[136:137], v11 offset:21504
    ds_read_b64_tr_b16 v[138:139], v15 offset:22528
    v_mfma_f32_16x16x32_bf16 v[92:95], v[140:143], v[24:27], v[92:95]
    s_cbranch_vccnz Lsc_102
Lscd_104:
    ds_read_b64_tr_b16 v[140:141], v10 offset:25088
    ds_read_b64_tr_b16 v[142:143], v14 offset:26112
    v_mfma_f32_16x16x32_bf16 v[80:83], v[144:147], v[28:31], v[80:83]
    buffer_load_dwordx4 v[72:75], v1, s[36:39], s80 offen offset:2048 sc1
    ds_read_b64_tr_b16 v[144:145], v11 offset:25088
    ds_read_b64_tr_b16 v[146:147], v15 offset:26112
    v_mfma_f32_16x16x32_bf16 v[84:87], v[148:151], v[28:31], v[84:87]
    ds_read_b64_tr_b16 v[148:149], v8 offset:25088
    ds_read_b64_tr_b16 v[150:151], v12 offset:26112
    v_mfma_f32_16x16x32_bf16 v[88:91], v[152:155], v[28:31], v[88:91]
    buffer_load_dwordx4 v[76:79], v1, s[36:39], s80 offen offset:3072 sc1
    ds_read_b64_tr_b16 v[152:153], v9 offset:25088
    ds_read_b64_tr_b16 v[154:155], v13 offset:26112
    s_waitcnt lgkmcnt(15)
    v_mfma_f32_16x16x32_bf16 v[92:95], v[156:159], v[28:31], v[92:95]
    ds_read_b64_tr_b16 v[156:157], v8 offset:28672
    ds_read_b64_tr_b16 v[158:159], v12 offset:29696
    v_mfma_f32_16x16x32_bf16 v[80:83], v[160:163], v[32:35], v[80:83]
    ds_read_b64_tr_b16 v[160:161], v9 offset:28672
    ds_read_b64_tr_b16 v[162:163], v13 offset:29696
    v_mfma_f32_16x16x32_bf16 v[84:87], v[96:99], v[32:35], v[84:87]
    ds_read_b64_tr_b16 v[96:97], v10 offset:28672
    ds_read_b64_tr_b16 v[98:99], v14 offset:29696
    v_mfma_f32_16x16x32_bf16 v[88:91], v[100:103], v[32:35], v[88:91]
    s_waitcnt lgkmcnt(6)
    s_barrier
    s_add_u32 m0, s47, 0
    s_add_u32 s3, s3, 57344
    buffer_load_dwordx4 v253, s[40:43], s3 offen lds
    v_mfma_f32_16x16x32_bf16 v[92:95], v[104:107], v[32:35], v[92:95]
    ds_read_b64_tr_b16 v[100:101], v11 offset:28672
    ds_read_b64_tr_b16 v[102:103], v15 offset:29696
    ds_read_b64_tr_b16 v[104:105], v10 offset:32256
    ds_read_b64_tr_b16 v[106:107], v14 offset:33280
    v_mfma_f32_16x16x32_bf16 v[80:83], v[108:111], v[36:39], v[80:83]
    s_add_u32 m0, s47, 2048
    s_add_u32 s3, s3, 57344
    buffer_load_dwordx4 v253, s[40:43], s3 offen lds
    ds_read_b64_tr_b16 v[108:109], v11 offset:32256
    ds_read_b64_tr_b16 v[110:111], v15 offset:33280
    v_mfma_f32_16x16x32_bf16 v[84:87], v[112:115], v[36:39], v[84:87]
    s_waitcnt vmcnt(9)
    v_max3_u32 v7, v40, v44, v48
    s_waitcnt vmcnt(7)
    v_max3_u32 v7, v7, v52, v56
    v_cmp_eq_u32 vcc, -1, v7
    v_mfma_f32_16x16x32_bf16 v[88:91], v[116:119], v[36:39], v[88:91]
    s_add_u32 m0, s47, 4096
    s_add_u32 s3, s3, 57344
    s_sub_u32 s6, s3, 1605632
    s_cselect_b32 s3, s3, s6
    buffer_load_dwordx4 v253, s[40:43], s3 offen lds
    v_mfma_f32_16x16x32_bf16 v[92:95], v[120:123], v[36:39], v[92:95]
    s_cbranch_vccnz Lsc_116
Lscd_118:
    ds_read_b64_tr_b16 v[112:113], v8 offset:32256
    ds_read_b64_tr_b16 v[114:115], v12 offset:33280
    ds_read_b64_tr_b16 v[116:117], v9 offset:32256
    v_mfma_f32_16x16x32_bf16 v[80:83], v[124:127], v[40:43], v[80:83]
    s_add_u32 m0, s47, 6144
    s_add_u32 s3, s3, 57344
    buffer_load_dwordx4 v253, s[40:43], s3 offen lds
    ds_read_b64_tr_b16 v[118:119], v13 offset:33280
    ds_read_b64_tr_b16 v[120:121], v8 offset:35840
    v_mfma_f32_16x16x32_bf16 v[84:87], v[128:131], v[40:43], v[84:87]
    ds_read_b64_tr_b16 v[122:123], v12 offset:36864
    ds_read_b64_tr_b16 v[124:125], v9 offset:35840
    ds_read_b64_tr_b16 v[126:127], v13 offset:36864
    ds_read_b64_tr_b16 v[128:129], v10 offset:35840
    v_mfma_f32_16x16x32_bf16 v[88:91], v[132:135], v[40:43], v[88:91]
    s_add_u32 m0, s47, 8192
    s_add_u32 s3, s3, 57344
    buffer_load_dwordx4 v253, s[40:43], s3 offen lds
    ds_read_b64_tr_b16 v[130:131], v14 offset:36864
    ds_read_b64_tr_b16 v[132:133], v11 offset:35840
    v_mfma_f32_16x16x32_bf16 v[92:95], v[136:139], v[40:43], v[92:95]
    ds_read_b64_tr_b16 v[134:135], v15 offset:36864
    ds_read_b64_tr_b16 v[136:137], v10 offset:39424
    ds_read_b64_tr_b16 v[138:139], v14 offset:40448
    v_mfma_f32_16x16x32_bf16 v[80:83], v[140:143], v[44:47], v[80:83]
    s_add_u32 m0, s47, 10240
    s_add_u32 s3, s3, 57344
    buffer_load_dwordx4 v253, s[40:43], s3 offen lds
    ds_read_b64_tr_b16 v[140:141], v11 offset:39424
    ds_read_b64_tr_b16 v[142:143], v15 offset:40448
    v_mfma_f32_16x16x32_bf16 v[84:87], v[144:147], v[44:47], v[84:87]
    ds_read_b64_tr_b16 v[144:145], v8 offset:39424
    ds_read_b64_tr_b16 v[146:147], v12 offset:40448
    v_mfma_f32_16x16x32_bf16 v[88:91], v[148:151], v[44:47], v[88:91]
    s_add_u32 m0, s47, 12288
    s_add_u32 s3, s3, 57344
    s_sub_u32 s6, s3, 1605632
    s_cselect_b32 s3, s3, s6
    buffer_load_dwordx4 v253, s[40:43], s3 offen lds
    s_waitcnt lgkmcnt(15)
    v_mfma_f32_16x16x32_bf16 v[92:95], v[152:155], v[44:47], v[92:95]
    ds_read_b64_tr_b16 v[148:149], v9 offset:39424
    ds_read_b64_tr_b16 v[150:151], v13 offset:40448
    ds_read_b64_tr_b16 v[152:153], v8 offset:43008
    v_mfma_f32_16x16x32_bf16 v[80:83], v[156:159], v[48:51], v[80:83]
    ds_read_b64_tr_b16 v[154:155], v12 offset:44032
    ds_read_b64_tr_b16 v[156:157], v9 offset:43008
    ds_read_b64_tr_b16 v[158:159], v13 offset:44032
    v_mfma_f32_16x16x32_bf16 v[84:87], v[160:163], v[48:51], v[84:87]
    ds_read_b64_tr_b16 v[160:161], v10 offset:43008
    ds_read_b64_tr_b16 v[162:163], v14 offset:44032
    v_mfma_f32_16x16x32_bf16 v[88:91], v[96:99], v[48:51], v[88:91]
    ds_read_b64_tr_b16 v[96:97], v11 offset:43008
    ds_read_b64_tr_b16 v[98:99], v15 offset:44032
    v_mfma_f32_16x16x32_bf16 v[92:95], v[100:103], v[48:51], v[92:95]
    ds_read_b64_tr_b16 v[100:101], v10 offset:46592
    ds_read_b64_tr_b16 v[102:103], v14 offset:47616
    v_mfma_f32_16x16x32_bf16 v[80:83], v[104:107], v[52:55], v[80:83]
    ds_read_b64_tr_b16 v[104:105], v11 offset:46592
    ds_read_b64_tr_b16 v[106:107], v15 offset:47616
    v_mfma_f32_16x16x32_bf16 v[84:87], v[108:111], v[52:55], v[84:87]
    ds_read_b64_tr_b16 v[108:109], v8 offset:46592
    ds_read_b64_tr_b16 v[110:111], v12 offset:47616
    v_mfma_f32_16x16x32_bf16 v[88:91], v[112:115], v[52:55], v[88:91]
    ds_read_b64_tr_b16 v[112:113], v9 offset:46592
    ds_read_b64_tr_b16 v[114:115], v13 offset:47616
    s_waitcnt lgkmcnt(15)
    v_mfma_f32_16x16x32_bf16 v[92:95], v[116:119], v[52:55], v[92:95]
    ds_read_b64_tr_b16 v[116:117], v8 offset:50176
    ds_read_b64_tr_b16 v[118:119], v12 offset:51200
    v_mfma_f32_16x16x32_bf16 v[80:83], v[120:123], v[56:59], v[80:83]
    ds_read_b64_tr_b16 v[120:121], v9 offset:50176
    ds_read_b64_tr_b16 v[122:123], v13 offset:51200
    v_mfma_f32_16x16x32_bf16 v[84:87], v[124:127], v[56:59], v[84:87]
    s_waitcnt vmcnt(9)
    v_max3_u32 v7, v60, v64, v68
    s_waitcnt vmcnt(7)
    v_max3_u32 v7, v7, v72, v76
    v_cmp_eq_u32 vcc, -1, v7
    v_mfma_f32_16x16x32_bf16 v[88:91], v[128:131], v[56:59], v[88:91]
    ds_read_b64_tr_b16 v[124:125], v10 offset:50176
    ds_read_b64_tr_b16 v[126:127], v14 offset:51200
    ds_read_b64_tr_b16 v[128:129], v11 offset:50176
    ds_read_b64_tr_b16 v[130:131], v15 offset:51200
    v_mfma_f32_16x16x32_bf16 v[92:95], v[132:135], v[56:59], v[92:95]
    s_cbranch_vccnz Lsc_129
Lscd_131:
    ds_read_b64_tr_b16 v[132:133], v10 offset:53760
    ds_read_b64_tr_b16 v[134:135], v14 offset:54784
    v_mfma_f32_16x16x32_bf16 v[80:83], v[136:139], v[60:63], v[80:83]
    ds_read_b64_tr_b16 v[136:137], v11 offset:53760
    ds_read_b64_tr_b16 v[138:139], v15 offset:54784
    v_mfma_f32_16x16x32_bf16 v[84:87], v[140:143], v[60:63], v[84:87]
    ds_read_b64_tr_b16 v[140:141], v8 offset:53760
    ds_read_b64_tr_b16 v[142:143], v12 offset:54784
    v_mfma_f32_16x16x32_bf16 v[88:91], v[144:147], v[60:63], v[88:91]
    ds_read_b64_tr_b16 v[144:145], v9 offset:53760
    ds_read_b64_tr_b16 v[146:147], v13 offset:54784
    s_waitcnt lgkmcnt(15)
    v_mfma_f32_16x16x32_bf16 v[92:95], v[148:151], v[60:63], v[92:95]
    v_mfma_f32_16x16x32_bf16 v[80:83], v[152:155], v[64:67], v[80:83]
    s_waitcnt lgkmcnt(0)
    s_barrier
    s_add_u32 m0, s47, 28672
    s_add_u32 s3, s3, 57344
    buffer_load_dwordx4 v253, s[40:43], s3 offen lds
    v_mfma_f32_16x16x32_bf16 v[84:87], v[156:159], v[64:67], v[84:87]
    v_mfma_f32_16x16x32_bf16 v[88:91], v[160:163], v[64:67], v[88:91]
    s_add_u32 m0, s47, 30720
    s_add_u32 s3, s3, 57344
    buffer_load_dwordx4 v253, s[40:43], s3 offen lds
    v_mfma_f32_16x16x32_bf16 v[92:95], v[96:99], v[64:67], v[92:95]
    v_mfma_f32_16x16x32_bf16 v[80:83], v[100:103], v[68:71], v[80:83]
    s_add_u32 m0, s47, 32768
    s_add_u32 s3, s3, 57344
    buffer_load_dwordx4 v253, s[40:43], s3 offen lds
    v_mfma_f32_16x16x32_bf16 v[84:87], v[104:107], v[68:71], v[84:87]
    v_mfma_f32_16x16x32_bf16 v[88:91], v[108:111], v[68:71], v[88:91]
    s_add_u32 m0, s47, 34816
    s_add_u32 s3, s3, 57344
    s_sub_u32 s6, s3, 1605632
    s_cselect_b32 s3, s3, s6
    buffer_load_dwordx4 v253, s[40:43], s3 offen lds
    v_mfma_f32_16x16x32_bf16 v[92:95], v[112:115], v[68:71], v[92:95]
    v_mfma_f32_16x16x32_bf16 v[80:83], v[116:119], v[72:75], v[80:83]
    s_add_u32 m0, s47, 36864
    s_add_u32 s3, s3, 57344
    buffer_load_dwordx4 v253, s[40:43], s3 offen lds
    v_mfma_f32_16x16x32_bf16 v[84:87], v[120:123], v[72:75], v[84:87]
    v_mfma_f32_16x16x32_bf16 v[88:91], v[124:127], v[72:75], v[88:91]
    s_add_u32 m0, s47, 38912
    s_add_u32 s3, s3, 57344
    buffer_load_dwordx4 v253, s[40:43], s3 offen lds
    v_mfma_f32_16x16x32_bf16 v[92:95], v[128:131], v[72:75], v[92:95]
    v_mfma_f32_16x16x32_bf16 v[80:83], v[132:135], v[76:79], v[80:83]
    s_add_u32 m0, s47, 40960
    s_add_u32 s3, s3, 57344
    buffer_load_dwordx4 v253, s[40:43], s3 offen lds
    v_mfma_f32_16x16x32_bf16 v[84:87], v[136:139], v[76:79], v[84:87]
    v_mfma_f32_16x16x32_bf16 v[88:91], v[140:143], v[76:79], v[88:91]
    v_mfma_f32_16x16x32_bf16 v[92:95], v[144:147], v[76:79], v[92:95]
    s_nop 1
    v_cvt_pk_bf16_f32 v16, v80, v81
    v_cvt_pk_bf16_f32 v17, v82, v83
    s_nop 1
    v_cvt_pk_bf16_f32 v18, v84, v85
    v_cvt_pk_bf16_f32 v19, v86, v87
    v_cvt_pk_bf16_f32 v20, v88, v89
    v_cvt_pk_bf16_f32 v21, v90, v91
    v_cvt_pk_bf16_f32 v22, v92, v93
    v_cvt_pk_bf16_f32 v23, v94, v95
    v_permlane16_swap_b32 v16, v18
    v_permlane16_swap_b32 v17, v19
    v_permlane16_swap_b32 v20, v22
    v_permlane16_swap_b32 v21, v23
    s_cmp_eq_u32 s4, 0
    s_cbranch_scc0 Lslow_137
    buffer_store_dwordx4 v[16:19], v5, s[36:39], s72 offen
    buffer_store_dwordx4 v[20:23], v5, s[36:39], s72 offen offset:1024
Lsdone_138:
    v_mfma_f32_16x16x32_bf16 v[28:31], v[16:19], v[16:19], 0
    v_mfma_f32_16x16x32_bf16 v[24:27], v[164:167], v[16:19], 0
    v_mfma_f32_16x16x32_bf16 v[28:31], v[20:23], v[20:23], v[28:31]
    v_mfma_f32_16x16x32_bf16 v[24:27], v[164:167], v[20:23], v[24:27]
    s_nop 7
    v_cndmask_b32 v25, 0, v28, s[62:63]
    v_cndmask_b32 v25, v25, v29, s[64:65]
    v_cndmask_b32 v25, v25, v30, s[66:67]
    v_cndmask_b32 v25, v25, v31, s[68:69]
    s_mov_b64 exec, s[70:71]
    s_cmp_eq_u32 s4, 0
    s_cbranch_scc0 Lslow_139
    buffer_store_dwordx2 v[24:25], v168, s[36:39], s73 offen
Lsdone_140:
    s_mov_b64 exec, -1
    s_cmp_eq_u32 s4, 0
    s_cbranch_scc0 Lss_141
Lssd_143:
    v_cmp_ne_u32 vcc, s0, v220
    s_nop 0
    s_cbranch_vccnz Lmc_144
Lmcd_146:
    s_mul_i32 s5, s50, 57344
    s_mul_i32 s6, s54, 229376
    s_add_u32 s5, s5, s6
    s_and_b32 s6, s50, 1
    s_lshl_b32 s6, s6, 12
    s_add_u32 s5, s5, s6
    s_add_u32 s5, s5, 48234496
    s_lshl_b32 s6, s53, 14
    s_add_u32 s41, s5, s6
    s_add_u32 s42, s41, 8192
    s_cmp_eq_u32 s53, 3
    s_cselect_b32 s42, s5, s42
    s_add_u32 s43, s42, 8192
    s_add_u32 s44, s43, 8192
    s_cmp_eq_u32 s53, 2
    s_cselect_b32 s44, s5, s44
    s_add_u32 s45, s44, 8192
    s_add_u32 s46, s45, 8192
    s_cmp_eq_u32 s53, 1
    s_cselect_b32 s46, s5, s46
    s_add_u32 s47, s46, 8192
    s_xor_b32 s3, s41, 4096
    buffer_load_dwordx4 a[112:115], v1, s[36:39], s3 offen offset:0
    s_xor_b32 s3, s42, 4096
    buffer_load_dwordx4 a[144:147], v1, s[36:39], s3 offen offset:0
    s_xor_b32 s3, s41, 4096
    buffer_load_dwordx4 a[120:123], v1, s[36:39], s3 offen offset:1024
    s_xor_b32 s3, s42, 4096
    buffer_load_dwordx4 a[152:155], v1, s[36:39], s3 offen offset:1024
    s_lshr_b32 s86, s50, 1
    s_mul_i32 s86, s86, 14336
    s_and_b32 s87, s50, 1
    s_lshl_b32 s84, s87, 12
    s_add_u32 s84, s84, s86
    s_mul_i32 s85, s87, 3072
    s_add_u32 s85, s85, s86
    s_add_u32 s85, s85, 8192
    s_add_u32 s86, s55, 170496
    s_cmp_lt_u32 s53, 2
    s_cselect_b32 s31, 28672, 0
    s_add_u32 s86, s86, s31
    s_lshl_b32 s31, s31, 1
    s_lshr_b32 s87, s54, 1
    s_sub_u32 s80, s87, 0
    s_and_b32 s80, s80, 3
    s_mul_i32 s72, s80, 57344
    s_add_u32 s72, s72, s86
    s_sub_u32 s81, s87, 1
    s_and_b32 s81, s81, 3
    s_mul_i32 s73, s81, 57344
    s_add_u32 s73, s73, s86
    s_sub_u32 s82, s87, 2
    s_and_b32 s82, s82, 3
    s_mul_i32 s74, s82, 57344
    s_waitcnt vmcnt(7)
    s_barrier
    s_add_u32 s74, s74, s86
    ds_read_b64_tr_b16 a[56:57], v223 offset:0
    s_sub_u32 s83, s87, 3
    ds_read_b64_tr_b16 a[58:59], v223 offset:512
    s_and_b32 s83, s83, 3
    s_mul_i32 s75, s83, 57344
    ds_read_b64_tr_b16 a[60:61], v223 offset:2048
    s_add_u32 s75, s75, s86
    ds_read_b64_tr_b16 a[62:63], v223 offset:2560
    v_bfe_u32 v133, v0, 2, 3
    v_min_u32 v133, 6, v133
    ds_read_b64_tr_b16 a[64:65], v223 offset:4096
    v_and_b32 v132, 3, v0
    v_lshlrev_b32 v133, 11, v133
    ds_read_b64_tr_b16 a[66:67], v223 offset:4608
    v_lshl_add_u32 v133, v132, 7, v133
    ds_read_b64_tr_b16 a[68:69], v223 offset:6144
    v_lshrrev_b32 v9, 1, v2
    v_lshl_add_u32 v133, v9, 30, v133
    ds_read_b64_tr_b16 a[70:71], v223 offset:6656
    s_lshl_b32 s86, s80, 9
    s_add_u32 s95, s55, 491520
    ds_read_b64_tr_b16 a[72:73], v223 offset:8192
    s_add_u32 s86, s86, s95
    ds_read_b64_tr_b16 a[74:75], v223 offset:8704
    v_add_u32 v133, s86, v133
    s_lshl_b32 s87, s50, 9
    ds_read_b64_tr_b16 a[76:77], v223 offset:10240
    s_add_u32 s95, s95, s87
    v_lshlrev_b32 v131, 3, v0
    ds_read_b64_tr_b16 a[78:79], v223 offset:10752
    v_and_b32 v132, 1, v2
    ds_read_b64_tr_b16 a[80:81], v223 offset:12288
    v_lshlrev_b32 v8, 4, v3
    v_lshl_add_u32 v8, v9, 8, v8
    ds_read_b64_tr_b16 a[82:83], v223 offset:12800
    v_mul_u32_u24 v132, 14336, v132
    v_add_u32 v5, v8, v132
    ds_read_b64_tr_b16 a[84:85], v223 offset:28672
    v_add_u32 v8, 91648, v5
    ds_read_b64_tr_b16 a[86:87], v223 offset:29184
    s_lshl2_add_u32 s87, s49, s50
    s_lshl_b32 s87, s87, 10
    ds_read_b64_tr_b16 a[88:89], v223 offset:30720
    v_add_u32 v10, s87, v1
    ds_read_b64_tr_b16 a[90:91], v223 offset:31232
    s_add_u32 s76, s20, 0
    s_lshl_b32 s80, s80, 10
    ds_read_b64_tr_b16 a[92:93], v223 offset:32768
    s_add_u32 s80, s80, 148992
    s_add_u32 s77, s20, 229376
    ds_read_b64_tr_b16 a[94:95], v223 offset:33280
    s_lshl_b32 s81, s81, 10
    ds_read_b64_tr_b16 a[96:97], v223 offset:34816
    s_add_u32 s81, s81, 148992
    s_add_u32 s78, s20, 458752
    ds_read_b64_tr_b16 a[98:99], v223 offset:35328
    s_lshl_b32 s82, s82, 10
    s_add_u32 s82, s82, 148992
    ds_read_b64_tr_b16 a[100:101], v223 offset:36864
    s_add_u32 s79, s20, 688128
    ds_read_b64_tr_b16 a[102:103], v223 offset:37376
    s_cmp_eq_u32 s4, 0
    s_cselect_b32 s79, s55, s79
    s_lshl_b32 s83, s83, 10
    ds_read_b64_tr_b16 a[104:105], v223 offset:38912
    s_add_u32 s83, s83, 148992
    v_mov_b32 v46, 0
    ds_read_b64_tr_b16 a[106:107], v223 offset:39424
    v_mov_b32 v47, 0
    ds_read_b64_tr_b16 a[108:109], v223 offset:40960
    v_mov_b32 v50, 0
    v_mov_b32 v51, 0
    ds_read_b64_tr_b16 a[110:111], v223 offset:41472
    v_and_b32 v11, 0x1f0, v1
    s_waitcnt lgkmcnt(0)
    s_barrier
    s_nop 0
Lffn0:
    s_mov_b32 s29, 6
Lp3top0:
    buffer_load_dword v130, v133, s[36:39], 0 offen sc1
    v_lshrrev_b32 v32, 2, v3
    v_xor_b32 v32, v32, v2
    v_and_b32 v32, 1, v32
    v_cmp_eq_u32 vcc, 0, v32
    v_mov_b32 v33, 0x3f803f80
    s_nop 0
    v_cndmask_b32 v32, 0, v33, vcc
    v_mov_b32 v33, v32
    v_mov_b32 v34, v32
    v_mov_b32 v35, v32
    s_nop 1
    v_mfma_f32_16x16x32_bf16 v[36:39], v[32:35], a[0:3], 0
    v_min_u32 v9, 27, v0
    v_mfma_f32_16x16x32_bf16 v[36:39], v[32:35], a[4:7], v[36:39]
    v_lshrrev_b32 v4, 2, v9
    v_mfma_f32_16x16x32_bf16 v[36:39], v[32:35], a[8:11], v[36:39]
    s_add_u32 m0, s84, 91648
    s_add_u32 s61, s72, m0
    buffer_load_dwordx4 v1, s[36:39], s61 offen offset:0 sc1 lds
    v_mfma_f32_16x16x32_bf16 v[36:39], v[32:35], a[12:15], v[36:39]
    s_lshl_b32 s86, s53, 1
    v_add_u32 v4, s86, v4
    v_mfma_f32_16x16x32_bf16 v[36:39], v[32:35], a[16:19], v[36:39]
    v_subrev_u32 v6, 7, v4
    v_mfma_f32_16x16x32_bf16 v[36:39], v[32:35], a[20:23], v[36:39]
    v_min_u32 v4, v4, v6
    v_mfma_f32_16x16x32_bf16 v[36:39], v[32:35], a[24:27], v[36:39]
    buffer_load_dwordx4 v1, s[36:39], s61 offen offset:1024 sc1 lds
    v_mfma_f32_16x16x32_bf16 v[36:39], v[32:35], a[28:31], v[36:39]
    v_and_b32 v9, 3, v9
    v_mfma_f32_16x16x32_bf16 v[36:39], v[32:35], a[32:35], v[36:39]
    v_lshlrev_b32 v9, 2, v9
    v_mfma_f32_16x16x32_bf16 v[36:39], v[32:35], a[36:39], v[36:39]
    v_lshl_add_u32 v6, v4, 4, v9
    v_mfma_f32_16x16x32_bf16 v[36:39], v[32:35], a[40:43], v[36:39]
    buffer_load_dwordx4 v1, s[36:39], s61 offen offset:2048 sc1 lds
    v_mfma_f32_16x16x32_bf16 v[36:39], v[32:35], a[44:47], v[36:39]
    s_mul_i32 s86, s50, 112
    s_add_u32 s86, s86, s58
    v_add_u32 v6, s86, v6
    v_mfma_f32_16x16x32_bf16 v[36:39], v[32:35], a[48:51], v[36:39]
    v_lshrrev_b32 v4, 1, v4
    v_mfma_f32_16x16x32_bf16 v[36:39], v[32:35], a[52:55], v[36:39]
    v_subrev_u32 v4, s53, v4
    v_mfma_f32_16x16x32_bf16 v[36:39], v[32:35], a[56:59], v[36:39]
    buffer_load_dwordx4 v1, s[36:39], s61 offen offset:3072 sc1 lds
    v_mfma_f32_16x16x32_bf16 v[36:39], v[32:35], a[60:63], v[36:39]
    v_and_b32 v4, 3, v4
    v_mfma_f32_16x16x32_bf16 v[36:39], v[32:35], a[64:67], v[36:39]
    v_add_u32 v4, 3, v4
    v_mfma_f32_16x16x32_bf16 v[36:39], v[32:35], a[68:71], v[36:39]
    s_mul_i32 s86, s50, 28672
    v_add_u32 v12, s86, v1
    v_mfma_f32_16x16x32_bf16 v[36:39], v[32:35], a[72:75], v[36:39]
    s_add_u32 m0, s85, 91648
    s_add_u32 s61, s72, m0
    buffer_load_dwordx4 v1, s[36:39], s61 offen offset:0 sc1 lds
    v_mfma_f32_16x16x32_bf16 v[36:39], v[32:35], a[76:79], v[36:39]
    v_add_u32 v13, 114688, v12
    v_mfma_f32_16x16x32_bf16 v[36:39], v[32:35], a[80:83], v[36:39]
    v_and_b32 v14, 7, v0
    v_mfma_f32_16x16x32_bf16 v[36:39], v[32:35], a[84:87], v[36:39]
    v_lshlrev_b32 v14, 9, v14
    v_mfma_f32_16x16x32_bf16 v[36:39], v[32:35], a[88:91], v[36:39]
    buffer_load_dwordx4 v1, s[36:39], s61 offen offset:1024 sc1 lds
    v_mfma_f32_16x16x32_bf16 v[36:39], v[32:35], a[92:95], v[36:39]
    s_lshl_b32 s5, s48, 9
    s_add_u32 s5, s5, 64
    v_lshl_add_u32 v15, v3, 2, s5
    v_mfma_f32_16x16x32_bf16 v[36:39], v[32:35], a[96:99], v[36:39]
    v_cmp_lt_u32 vcc, 31, v0
    s_nop 1
    v_cndmask_b32 v14, v14, v15, vcc
    v_mfma_f32_16x16x32_bf16 v[36:39], v[32:35], a[100:103], v[36:39]
    v_add_u32 v14, 41959680, v14
    v_mfma_f32_16x16x32_bf16 v[36:39], v[32:35], a[104:107], v[36:39]
    buffer_load_dwordx4 v1, s[36:39], s61 offen offset:2048 sc1 lds
    v_mfma_f32_16x16x32_bf16 v[36:39], v[32:35], a[108:111], v[36:39]
    s_nop 7
    v_and_b32 v174, 0xffff0000, v36
    v_sub_f32 v173, v36, v174
    v_and_b32 v172, 0xffff0000, v173
    v_sub_f32 v173, v173, v172
    v_lshrrev_b32 v174, 16, v174
    v_or_b32 v172, v172, v174
    v_lshrrev_b32 v173, 16, v173
    v_cmp_lt_u32 vcc, 31, v0
    s_nop 1
    v_cndmask_b32 v172, v172, v173, vcc
    v_mov_b32 v173, 0
    v_mov_b32 v174, 0
    v_mov_b32 v175, 0
    s_waitcnt vmcnt(7)
    v_cmp_eq_u32 vcc, -1, v130
    s_nop 0
    s_cbranch_vccnz Lpb_147
Lpbd_149:
    buffer_load_dwordx2 v[116:117], v131, s[36:39], s95 offen offset:0 sc1
    buffer_load_dwordx2 v[118:119], v131, s[36:39], s95 offen offset:2048 sc1
    s_add_u32 s86, s95, 4096
    buffer_load_dwordx2 v[120:121], v131, s[36:39], s86 offen offset:0 sc1
    s_add_u32 s86, s95, 4096
    buffer_load_dwordx2 v[122:123], v131, s[36:39], s86 offen offset:2048 sc1
    s_add_u32 s86, s95, 8192
    buffer_load_dwordx2 v[124:125], v131, s[36:39], s86 offen offset:0 sc1
    s_add_u32 s86, s95, 8192
    buffer_load_dwordx2 v[126:127], v131, s[36:39], s86 offen offset:2048 sc1
    s_add_u32 s86, s95, 12288
    buffer_load_dwordx2 v[128:129], v131, s[36:39], s86 offen offset:0 sc1
    s_waitcnt vmcnt(10)
    s_barrier
    ds_read_b128 v[68:71], v8 offset:0
    ds_read_b128 v[72:75], v8 offset:512
    ds_read_b128 v[76:79], v8 offset:1024
    ds_read_b128 v[80:83], v8 offset:1536
    ds_read_b128 v[84:87], v8 offset:2048
    ds_read_b128 v[88:91], v8 offset:2560
    s_waitcnt lgkmcnt(5)
    v_mfma_f32_32x32x16_bf16 v[52:67], a[0:3], v[68:71], 0
    ds_read_b128 v[92:95], v8 offset:3072
    ds_read_b128 v[96:99], v8 offset:3584
    ds_read_b128 v[100:103], v8 offset:4096
    ds_read_b128 v[104:107], v8 offset:4608
    s_waitcnt lgkmcnt(8)
    v_mfma_f32_32x32x16_bf16 v[52:67], a[4:7], v[72:75], v[52:67]
    ds_read_b128 v[108:111], v8 offset:5120
    ds_read_b128 v[112:115], v8 offset:5632
    ds_read_b128 v[68:71], v8 offset:6144
    ds_read_b128 v[72:75], v8 offset:6656
    s_waitcnt lgkmcnt(11)
    v_mfma_f32_32x32x16_bf16 v[52:67], a[8:11], v[76:79], v[52:67]
    s_add_u32 m0, s84, 120320
    s_add_u32 s61, s72, m0
    s_sub_u32 s61, s61, s31
    buffer_load_dwordx4 v1, s[36:39], s61 offen offset:0 sc1 lds
    s_waitcnt lgkmcnt(10)
    v_mfma_f32_32x32x16_bf16 v[52:67], a[12:15], v[80:83], v[52:67]
    ds_read_b128 v[76:79], v8 offset:7168
    ds_read_b128 v[80:83], v8 offset:7680
    s_waitcnt lgkmcnt(8)
    v_mfma_f32_32x32x16_bf16 v[52:67], a[16:19], v[84:87], v[52:67]
    buffer_load_dwordx4 v1, s[36:39], s61 offen offset:1024 sc1 lds
    s_waitcnt vmcnt(7)
    v_add_f32 v116, v116, v118
    v_add_f32 v117, v117, v119
    s_waitcnt vmcnt(6)
    v_add_f32 v116, v116, v120
    v_mfma_f32_32x32x16_bf16 v[52:67], a[20:23], v[88:91], v[52:67]
    s_xor_b32 s3, s41, 4096
    buffer_load_dwordx4 a[128:131], v1, s[36:39], s3 offen offset:2048
    v_add_f32 v117, v117, v121
    s_waitcnt vmcnt(6)
    v_add_f32 v116, v116, v122
    v_add_f32 v117, v117, v123
    v_mfma_f32_32x32x16_bf16 v[52:67], a[24:27], v[92:95], v[52:67]
    s_waitcnt vmcnt(5)
    v_add_f32 v116, v116, v124
    v_add_f32 v117, v117, v125
    s_waitcnt vmcnt(4)
    v_add_f32 v116, v116, v126
    v_add_f32 v117, v117, v127
    s_waitcnt vmcnt(3)
    v_add_f32 v116, v116, v128
    v_add_f32 v117, v117, v129
    v_mfma_f32_32x32x16_bf16 v[52:67], a[28:31], v[96:99], v[52:67]
    buffer_load_dwordx4 v1, s[36:39], s61 offen offset:2048 sc1 lds
    v_cmp_u_f32 vcc, v116, v116
    s_nop 0
    s_cbranch_vccnz Lnc_150
Lncd_152:
    v_mul_f32 v116, 0xbb124925, v116
    v_mul_f32 v119, 0x3b124925, v117
    s_waitcnt lgkmcnt(4)
    v_mfma_f32_32x32x16_bf16 v[52:67], a[32:35], v[100:103], v[52:67]
    s_waitcnt lgkmcnt(0)
    s_barrier
    s_xor_b32 s3, s42, 4096
    buffer_load_dwordx4 a[160:163], v1, s[36:39], s3 offen offset:2048
    v_mfma_f32_32x32x16_bf16 v[52:67], a[36:39], v[104:107], v[52:67]
    ds_read_b128 v[84:87], v8 offset:8192
    ds_read_b128 v[88:91], v8 offset:8704
    ds_read_b128 v[92:95], v8 offset:9216
    ds_read_b128 v[96:99], v8 offset:9728
    v_fma_f32 v119, -v116, v116, v119
    v_mfma_f32_32x32x16_bf16 v[52:67], a[40:43], v[108:111], v[52:67]
    buffer_load_dwordx4 v1, s[36:39], s61 offen offset:3072 sc1 lds
    ds_read_b128 v[100:103], v8 offset:10240
    ds_read_b128 v[104:107], v8 offset:10752
    v_max_f32 v119, 0, v119
    v_mfma_f32_32x32x16_bf16 v[52:67], a[44:47], v[112:115], v[52:67]
    ds_read_b128 v[108:111], v8 offset:11264
    ds_read_b128 v[112:115], v8 offset:11776
    v_cvt_pk_bf16_f32 v116, v116, v116
    v_cvt_pk_bf16_f32 v119, v119, v119
    v_lshlrev_b32 v119, 16, v119
    v_add_f32 v119, 0x3727c5ac, v119
    v_mfma_f32_32x32x16_bf16 v[52:67], a[48:51], v[68:71], v[52:67]
    s_add_u32 m0, s85, 120320
    s_add_u32 s61, s72, m0
    s_sub_u32 s61, s61, s31
    buffer_load_dwordx4 v1, s[36:39], s61 offen offset:0 sc1 lds
    v_cvt_pk_bf16_f32 v119, v119, v119
    v_mfma_f32_32x32x16_bf16 v[52:67], a[52:55], v[72:75], v[52:67]
    s_xor_b32 s3, s41, 4096
    buffer_load_dwordx4 a[136:139], v1, s[36:39], s3 offen offset:3072
    ds_read_b128 v[68:71], v8 offset:12288
    ds_read_b128 v[72:75], v8 offset:12800
    v_mfma_f32_32x32x16_bf16 v[52:67], a[56:59], v[76:79], v[52:67]
    ds_read_b128 v[76:79], v8 offset:13312
    v_lshlrev_b32 v119, 16, v119
    v_sqrt_f32 v119, v119
    s_nop 0
    v_cvt_pk_bf16_f32 v119, v119, v119
    v_lshlrev_b32 v119, 16, v119
    v_mfma_f32_32x32x16_bf16 v[52:67], a[60:63], v[80:83], v[52:67]
    buffer_load_dwordx4 v1, s[36:39], s61 offen offset:1024 sc1 lds
    ds_read_b128 v[80:83], v8 offset:13824
    v_rcp_f32 v118, v119
    s_waitcnt lgkmcnt(8)
    v_mfma_f32_32x32x16_bf16 v[52:67], a[64:67], v[84:87], v[52:67]
    s_xor_b32 s3, s43, 4096
    buffer_load_dwordx4 a[176:179], v1, s[36:39], s3 offen offset:0
    v_mul_f32 v117, 0xbfb8aa3b, v118
    v_and_b32 v117, 0xffffff7f, v117
    v_mfma_f32_32x32x16_bf16 v[52:67], a[68:71], v[88:91], v[52:67]
    v_mul_f32 v118, v118, v118
    s_lshr_b32 s87, s31, 6
    s_and_b32 s87, s87, 512
    v_xor_b32 v131, s87, v1
    s_lshl_b32 s87, s50, 10
    s_add_u32 s87, s87, 148992
    v_add_u32 v131, s87, v131
    v_mfma_f32_32x32x16_bf16 v[52:67], a[72:75], v[92:95], v[52:67]
    buffer_load_dwordx4 v1, s[36:39], s61 offen offset:2048 sc1 lds
    ds_write_b128 v131, v[116:119]
    v_mfma_f32_32x32x16_bf16 v[52:67], a[76:79], v[96:99], v[52:67]
    s_lshl_b32 s88, s53, 13
    s_cmp_ge_u32 s53, 3
    s_cselect_b32 s90, 4294938624, 0
    s_cselect_b32 s89, s77, s76
    s_add_u32 s90, s90, s88
    s_add_u32 s89, s89, s90
    s_add_u32 s89, s89, 4096
    s_waitcnt lgkmcnt(5)
    v_mfma_f32_32x32x16_bf16 v[52:67], a[80:83], v[100:103], v[52:67]
    s_add_u32 m0, s84, 91648
    s_add_u32 s61, s73, m0
    buffer_load_dwordx4 v1, s[36:39], s61 offen offset:0 sc1 lds
    s_add_u32 s90, s90, s77
    v_mfma_f32_32x32x16_bf16 v[52:67], a[84:87], v[104:107], v[52:67]
    s_waitcnt vmcnt(6) lgkmcnt(0)
    s_barrier
    v_add_u32 v7, s80, v11
    ds_read_b64 v[44:45], v7 offset:0
    s_xor_b32 s3, s44, 4096
    buffer_load_dwordx4 a[208:211], v1, s[36:39], s3 offen offset:0
    v_mfma_f32_32x32x16_bf16 v[52:67], a[88:91], v[108:111], v[52:67]
    ds_read_b128 v[84:87], v8 offset:28672
    ds_read_b128 v[88:91], v8 offset:29184
    ds_read_b128 v[92:95], v8 offset:29696
    ds_read_b128 v[96:99], v8 offset:30208
    s_add_u32 s90, s90, 8192
    v_mfma_f32_32x32x16_bf16 v[52:67], a[92:95], v[112:115], v[52:67]
    buffer_load_dwordx4 v1, s[36:39], s61 offen offset:1024 sc1 lds
    ds_read_b128 v[100:103], v8 offset:30720
    ds_read_b128 v[104:107], v8 offset:31232
    v_mfma_f32_32x32x16_bf16 v[52:67], a[96:99], v[68:71], v[52:67]
    s_xor_b32 s3, s45, 4096
    buffer_load_dwordx4 a[240:243], v1, s[36:39], s3 offen offset:0
    ds_read_b128 v[108:111], v8 offset:31744
    ds_read_b128 v[112:115], v8 offset:32256
    v_mfma_f32_32x32x16_bf16 v[52:67], a[100:103], v[72:75], v[52:67]
    ds_read_b128 v[68:71], v8 offset:32768
    ds_read_b128 v[72:75], v8 offset:33280
    s_cmp_ge_u32 s53, 2
    s_cselect_b32 s92, 4294938624, 0
    s_cselect_b32 s91, s78, s77
    s_add_u32 s92, s92, s88
    v_mfma_f32_32x32x16_bf16 v[52:67], a[104:107], v[76:79], v[52:67]
    buffer_load_dwordx4 v1, s[36:39], s61 offen offset:2048 sc1 lds
    ds_read_b128 v[76:79], v8 offset:33792
    s_add_u32 s91, s91, s92
    s_add_u32 s91, s91, 12288
    v_mfma_f32_32x32x16_bf16 v[52:67], a[108:111], v[80:83], v[52:67]
    ds_read_b128 v[80:83], v8 offset:34304
    s_add_u32 s92, s92, s78
    s_add_u32 s92, s92, 16384
    s_cmp_ge_u32 s53, 1
    s_cselect_b32 s94, 4294938624, 0
    s_cselect_b32 s93, s79, s78
    s_waitcnt lgkmcnt(12)
    v_mfma_f32_32x32x16_bf16 v[52:67], v[172:175], v[44:47], v[52:67]
    buffer_load_dwordx4 v1, s[36:39], s61 offen offset:3072 sc1 lds
    s_add_u32 s94, s94, s88
    s_add_u32 s93, s93, s94
    s_add_u32 s93, s93, 20480
    s_add_u32 s94, s94, s79
    s_waitcnt lgkmcnt(8)
    v_mfma_f32_32x32x16_bf16 v[16:31], a[0:3], v[84:87], 0
    s_xor_b32 s3, s42, 4096
    buffer_load_dwordx4 a[168:171], v1, s[36:39], s3 offen offset:3072
    ds_read_b128 v[84:87], v8 offset:34816
    v_mfma_f32_32x32x16_bf16 v[16:31], a[4:7], v[88:91], v[16:31]
    ds_read_b128 v[88:91], v8 offset:35328
    s_add_u32 s94, s94, 24576
    s_add_u32 s88, s88, s76
    v_mfma_f32_32x32x16_bf16 v[16:31], a[8:11], v[92:95], v[16:31]
    s_add_u32 m0, s85, 91648
    s_add_u32 s61, s73, m0
    buffer_load_dwordx4 v1, s[36:39], s61 offen offset:0 sc1 lds
    ds_read_b128 v[92:95], v8 offset:35840
    v_mfma_f32_32x32x16_bf16 v[16:31], a[12:15], v[96:99], v[16:31]
    s_xor_b32 s3, s46, 4096
    buffer_load_dwordx4 v[192:195], v1, s[36:39], s3 offen offset:0
    ds_read_b128 v[96:99], v8 offset:36352
    v_mul_f32 v32, v45, v52
    s_waitcnt lgkmcnt(8)
    v_mfma_f32_32x32x16_bf16 v[16:31], a[16:19], v[100:103], v[16:31]
    v_mul_f32 v33, v45, v53
    v_cmp_u_f32 vcc, v52, v52
    s_nop 0
    s_cbranch_vccnz Lnn_153
Lnnd_154:
    v_exp_f32 v32, v32
    v_mfma_f32_32x32x16_bf16 v[16:31], a[20:23], v[104:107], v[16:31]
    buffer_load_dwordx4 v1, s[36:39], s61 offen offset:1024 sc1 lds
    v_mul_f32 v34, v45, v54
    v_mul_f32 v52, v60, v52
    v_exp_f32 v33, v33
    v_mfma_f32_32x32x16_bf16 v[16:31], a[24:27], v[108:111], v[16:31]
    v_mul_f32 v35, v45, v55
    v_mul_f32 v53, v61, v53
    v_exp_f32 v34, v34
    v_mul_f32 v36, v45, v56
    v_mul_f32 v54, v62, v54
    v_mfma_f32_32x32x16_bf16 v[16:31], a[28:31], v[112:115], v[16:31]
    buffer_load_dwordx4 v1, s[36:39], s61 offen offset:2048 sc1 lds
    v_exp_f32 v35, v35
    v_mul_f32 v37, v45, v57
    v_mul_f32 v55, v63, v55
    s_waitcnt lgkmcnt(4)
    v_mfma_f32_32x32x16_bf16 v[16:31], a[32:35], v[68:71], v[16:31]
    s_waitcnt vmcnt(11) lgkmcnt(0)
    s_barrier
    s_xor_b32 s3, s47, 4096
    buffer_load_dwordx4 v[224:227], v1, s[36:39], s3 offen offset:0
    v_mfma_f32_32x32x16_bf16 v[16:31], a[36:39], v[72:75], v[16:31]
    ds_read_b128 v[100:103], v8 offset:36864
    ds_read_b128 v[104:107], v8 offset:37376
    ds_read_b128 v[108:111], v8 offset:37888
    ds_read_b128 v[112:115], v8 offset:38400
    v_mfma_f32_32x32x16_bf16 v[16:31], a[40:43], v[76:79], v[16:31]
    s_add_u32 m0, s84, 120320
    s_add_u32 s61, s73, m0
    s_sub_u32 s61, s61, s31
    buffer_load_dwordx4 v1, s[36:39], s61 offen offset:0 sc1 lds
    v_mfma_f32_32x32x16_bf16 v[16:31], a[44:47], v[80:83], v[16:31]
    buffer_load_dwordx4 a[116:119], v1, s[36:39], s41 offen offset:0
    ds_read_b128 v[68:71], v8 offset:38912
    ds_read_b128 v[72:75], v8 offset:39424
    v_mfma_f32_32x32x16_bf16 v[16:31], a[48:51], v[84:87], v[16:31]
    ds_read_b128 v[76:79], v8 offset:39936
    ds_read_b128 v[80:83], v8 offset:40448
    ds_read_b128 v[84:87], v8 offset:40960
    v_exp_f32 v36, v36
    v_mfma_f32_32x32x16_bf16 v[16:31], a[52:55], v[88:91], v[16:31]
    buffer_load_dwordx4 v1, s[36:39], s61 offen offset:1024 sc1 lds
    ds_read_b128 v[88:91], v8 offset:41472
    v_mul_f32 v38, v45, v58
    v_mul_f32 v56, v64, v56
    v_mfma_f32_32x32x16_bf16 v[16:31], a[56:59], v[92:95], v[16:31]
    ds_read_b128 v[92:95], v8 offset:41984
    v_exp_f32 v37, v37
    v_mul_f32 v39, v45, v59
    v_mul_f32 v57, v65, v57
    v_mfma_f32_32x32x16_bf16 v[16:31], a[60:63], v[96:99], v[16:31]
    buffer_load_dwordx4 v1, s[36:39], s61 offen offset:2048 sc1 lds
    ds_read_b128 v[96:99], v8 offset:42496
    v_exp_f32 v38, v38
    s_waitcnt lgkmcnt(8)
    v_mfma_f32_32x32x16_bf16 v[16:31], a[64:67], v[100:103], v[16:31]
    s_xor_b32 s3, s43, 4096
    buffer_load_dwordx4 a[184:187], v1, s[36:39], s3 offen offset:1024
    v_mul_f32 v58, v66, v58
    v_add_f32 v32, 1.0, v32
    v_mfma_f32_32x32x16_bf16 v[16:31], a[68:71], v[104:107], v[16:31]
    v_exp_f32 v39, v39
    v_mul_f32 v59, v67, v59
    v_add_f32 v33, 1.0, v33
    v_rcp_f32 v32, v32
    v_add_f32 v34, 1.0, v34
    v_mfma_f32_32x32x16_bf16 v[16:31], a[72:75], v[108:111], v[16:31]
    buffer_load_dwordx4 v1, s[36:39], s61 offen offset:3072 sc1 lds
    v_add_f32 v35, 1.0, v35
    v_rcp_f32 v33, v33
    v_mul_f32 v32, v32, v52
    v_mfma_f32_32x32x16_bf16 v[16:31], a[76:79], v[112:115], v[16:31]
    s_xor_b32 s3, s44, 4096
    buffer_load_dwordx4 a[216:219], v1, s[36:39], s3 offen offset:1024
    v_add_f32 v36, 1.0, v36
    v_rcp_f32 v34, v34
    s_waitcnt lgkmcnt(4)
    v_mfma_f32_32x32x16_bf16 v[16:31], a[80:83], v[68:71], v[16:31]
    v_mul_f32 v33, v33, v53
    v_add_f32 v37, 1.0, v37
    v_rcp_f32 v35, v35
    v_mul_f32 v34, v34, v54
    v_add_f32 v38, 1.0, v38
    v_mfma_f32_32x32x16_bf16 v[16:31], a[84:87], v[72:75], v[16:31]
    s_waitcnt vmcnt(13) lgkmcnt(0)
    s_barrier
    v_add_u32 v7, s80, v11
    ds_read_b64 v[48:49], v7 offset:512
    s_add_u32 m0, s85, 120320
    s_add_u32 s61, s73, m0
    s_sub_u32 s61, s61, s31
    buffer_load_dwordx4 v1, s[36:39], s61 offen offset:0 sc1 lds
    v_mfma_f32_32x32x16_bf16 v[16:31], a[88:91], v[76:79], v[16:31]
    ds_read_b128 v[100:103], v8 offset:0
    ds_read_b128 v[104:107], v8 offset:512
    ds_read_b128 v[108:111], v8 offset:1024
    ds_read_b128 v[112:115], v8 offset:1536
    v_mfma_f32_32x32x16_bf16 v[16:31], a[92:95], v[80:83], v[16:31]
    buffer_load_dwordx4 v1, s[36:39], s61 offen offset:1024 sc1 lds
    ds_read_b128 v[68:71], v8 offset:2048
    ds_read_b128 v[72:75], v8 offset:2560
    v_mfma_f32_32x32x16_bf16 v[16:31], a[96:99], v[84:87], v[16:31]
    s_xor_b32 s3, s45, 4096
    buffer_load_dwordx4 a[248:251], v1, s[36:39], s3 offen offset:1024
    ds_read_b128 v[76:79], v8 offset:3072
    ds_read_b128 v[80:83], v8 offset:3584
    v_mfma_f32_32x32x16_bf16 v[16:31], a[100:103], v[88:91], v[16:31]
    ds_read_b128 v[84:87], v8 offset:4096
    ds_read_b128 v[88:91], v8 offset:4608
    v_rcp_f32 v36, v36
    v_mul_f32 v35, v35, v55
    v_add_f32 v39, 1.0, v39
    v_mfma_f32_32x32x16_bf16 v[16:31], a[104:107], v[92:95], v[16:31]
    buffer_load_dwordx4 v1, s[36:39], s61 offen offset:2048 sc1 lds
    ds_read_b128 v[92:95], v8 offset:5120
    v_rcp_f32 v37, v37
    v_mfma_f32_32x32x16_bf16 v[16:31], a[108:111], v[96:99], v[16:31]
    buffer_load_dwordx4 a[148:151], v1, s[36:39], s42 offen offset:0
    ds_read_b128 v[96:99], v8 offset:5632
    v_mul_f32 v36, v36, v56
    v_cvt_pk_bf16_f32 v40, v32, v33
    s_waitcnt lgkmcnt(12)
    v_mfma_f32_32x32x16_bf16 v[16:31], v[172:175], v[48:51], v[16:31]
    v_rcp_f32 v38, v38
    v_mul_f32 v37, v37, v57
    v_cvt_pk_bf16_f32 v41, v34, v35
    v_rcp_f32 v39, v39
    v_mul_f32 v38, v38, v58
    v_cvt_pk_bf16_f32 v42, v36, v37
    v_mul_f32 v39, v39, v59
    s_waitcnt lgkmcnt(8)
    v_mfma_f32_32x32x16_bf16 v[52:67], a[0:3], v[100:103], 0
    ds_read_b128 v[100:103], v8 offset:6144
    v_cvt_pk_bf16_f32 v43, v38, v39
    v_mfma_f32_32x32x16_bf16 v[52:67], a[4:7], v[104:107], v[52:67]
    ds_read_b128 v[104:107], v8 offset:6656
    s_add_u32 s87, s76, 0
    buffer_store_dwordx4 v[40:43], v10, s[36:39], s87 offen sc1
    v_mfma_f32_32x32x16_bf16 v[52:67], a[8:11], v[108:111], v[52:67]
    s_xor_b32 s3, s46, 4096
    buffer_load_dwordx4 v[200:203], v1, s[36:39], s3 offen offset:1024
    ds_read_b128 v[108:111], v8 offset:7168
    v_mul_f32 v32, v49, v16
    v_mfma_f32_32x32x16_bf16 v[52:67], a[12:15], v[112:115], v[52:67]
    ds_read_b128 v[112:115], v8 offset:7680
    v_mul_f32 v33, v49, v17
    v_cmp_u_f32 vcc, v16, v16
    s_nop 0
    s_cbranch_vccnz Lnn_155
Lnnd_156:
    s_waitcnt lgkmcnt(8)
    v_mfma_f32_32x32x16_bf16 v[52:67], a[16:19], v[68:71], v[52:67]
    v_exp_f32 v32, v32
    v_mul_f32 v34, v49, v18
    v_mul_f32 v16, v24, v16
    v_exp_f32 v33, v33
    v_mfma_f32_32x32x16_bf16 v[52:67], a[20:23], v[72:75], v[52:67]
    v_mul_f32 v35, v49, v19
    v_mul_f32 v17, v25, v17
    v_exp_f32 v34, v34
    v_mul_f32 v36, v49, v20
    v_mul_f32 v18, v26, v18
    v_mfma_f32_32x32x16_bf16 v[52:67], a[24:27], v[76:79], v[52:67]
    s_xor_b32 s3, s47, 4096
    buffer_load_dwordx4 v[232:235], v1, s[36:39], s3 offen offset:1024
    v_exp_f32 v35, v35
    v_mul_f32 v37, v49, v21
    v_mfma_f32_32x32x16_bf16 v[52:67], a[28:31], v[80:83], v[52:67]
    v_mul_f32 v19, v27, v19
    v_exp_f32 v36, v36
    v_mul_f32 v38, v49, v22
    v_mul_f32 v20, v28, v20
    v_exp_f32 v37, v37
    s_waitcnt lgkmcnt(4)
    v_mfma_f32_32x32x16_bf16 v[52:67], a[32:35], v[84:87], v[52:67]
    s_waitcnt vmcnt(16) lgkmcnt(0)
    s_barrier
    s_add_u32 m0, s84, 91648
    s_add_u32 s61, s74, m0
    buffer_load_dwordx4 v1, s[36:39], s61 offen offset:0 sc1 lds
    v_mfma_f32_32x32x16_bf16 v[52:67], a[36:39], v[88:91], v[52:67]
    ds_read_b128 v[68:71], v8 offset:8192
    ds_read_b128 v[72:75], v8 offset:8704
    ds_read_b128 v[76:79], v8 offset:9216
    ds_read_b128 v[80:83], v8 offset:9728
    v_mul_f32 v39, v49, v23
    v_mfma_f32_32x32x16_bf16 v[52:67], a[40:43], v[92:95], v[52:67]
    buffer_load_dwordx4 v1, s[36:39], s61 offen offset:1024 sc1 lds
    ds_read_b128 v[84:87], v8 offset:10240
    ds_read_b128 v[88:91], v8 offset:10752
    v_mul_f32 v21, v29, v21
    v_mfma_f32_32x32x16_bf16 v[52:67], a[44:47], v[96:99], v[52:67]
    buffer_load_dwordx4 a[124:127], v1, s[36:39], s41 offen offset:1024
    ds_read_b128 v[92:95], v8 offset:11264
    ds_read_b128 v[96:99], v8 offset:11776
    v_mfma_f32_32x32x16_bf16 v[52:67], a[48:51], v[100:103], v[52:67]
    ds_read_b128 v[100:103], v8 offset:12288
    v_exp_f32 v38, v38
    v_mul_f32 v22, v30, v22
    v_add_f32 v32, 1.0, v32
    v_mfma_f32_32x32x16_bf16 v[52:67], a[52:55], v[104:107], v[52:67]
    buffer_load_dwordx4 v1, s[36:39], s61 offen offset:2048 sc1 lds
    ds_read_b128 v[104:107], v8 offset:12800
    v_exp_f32 v39, v39
    v_mfma_f32_32x32x16_bf16 v[52:67], a[56:59], v[108:111], v[52:67]
    s_xor_b32 s3, s43, 4096
    buffer_load_dwordx4 a[192:195], v1, s[36:39], s3 offen offset:2048
    ds_read_b128 v[108:111], v8 offset:13312
    v_mul_f32 v23, v31, v23
    v_mfma_f32_32x32x16_bf16 v[52:67], a[60:63], v[112:115], v[52:67]
    ds_read_b128 v[112:115], v8 offset:13824
    v_add_f32 v33, 1.0, v33
    v_rcp_f32 v32, v32
    v_add_f32 v34, 1.0, v34
    v_add_f32 v35, 1.0, v35
    s_waitcnt lgkmcnt(8)
    v_mfma_f32_32x32x16_bf16 v[52:67], a[64:67], v[68:71], v[52:67]
    buffer_load_dwordx4 v1, s[36:39], s61 offen offset:3072 sc1 lds
    v_rcp_f32 v33, v33
    v_mul_f32 v32, v32, v16
    v_mfma_f32_32x32x16_bf16 v[52:67], a[68:71], v[72:75], v[52:67]
    v_add_f32 v36, 1.0, v36
    v_rcp_f32 v34, v34
    v_mul_f32 v33, v33, v17
    v_add_f32 v37, 1.0, v37
    v_rcp_f32 v35, v35
    v_mfma_f32_32x32x16_bf16 v[52:67], a[72:75], v[76:79], v[52:67]
    s_xor_b32 s3, s44, 4096
    buffer_load_dwordx4 a[224:227], v1, s[36:39], s3 offen offset:2048
    v_mul_f32 v34, v34, v18
    v_add_f32 v38, 1.0, v38
    v_mfma_f32_32x32x16_bf16 v[52:67], a[76:79], v[80:83], v[52:67]
    v_rcp_f32 v36, v36
    v_mul_f32 v35, v35, v19
    v_add_f32 v39, 1.0, v39
    v_rcp_f32 v37, v37
    v_mul_f32 v36, v36, v20
    s_waitcnt lgkmcnt(4)
    v_mfma_f32_32x32x16_bf16 v[52:67], a[80:83], v[84:87], v[52:67]
    v_cvt_pk_bf16_f32 v40, v32, v33
    v_rcp_f32 v38, v38
    v_mul_f32 v37, v37, v21
    v_cvt_pk_bf16_f32 v41, v34, v35
    v_mfma_f32_32x32x16_bf16 v[52:67], a[84:87], v[88:91], v[52:67]
    s_waitcnt vmcnt(16) lgkmcnt(0)
    s_barrier
    v_add_u32 v7, s81, v11
    ds_read_b64 v[44:45], v7 offset:0
    s_add_u32 m0, s85, 91648
    s_add_u32 s61, s74, m0
    buffer_load_dwordx4 v1, s[36:39], s61 offen offset:0 sc1 lds
    v_mfma_f32_32x32x16_bf16 v[52:67], a[88:91], v[92:95], v[52:67]
    s_xor_b32 s3, s45, 4096
    buffer_load_dwordx4 v[176:179], v1, s[36:39], s3 offen offset:2048
    ds_read_b128 v[68:71], v8 offset:28672
    ds_read_b128 v[72:75], v8 offset:29184
    v_mfma_f32_32x32x16_bf16 v[52:67], a[92:95], v[96:99], v[52:67]
    ds_read_b128 v[76:79], v8 offset:29696
    ds_read_b128 v[80:83], v8 offset:30208
    ds_read_b128 v[84:87], v8 offset:30720
    ds_read_b128 v[88:91], v8 offset:31232
    v_mfma_f32_32x32x16_bf16 v[52:67], a[96:99], v[100:103], v[52:67]
    buffer_load_dwordx4 v1, s[36:39], s61 offen offset:1024 sc1 lds
    ds_read_b128 v[92:95], v8 offset:31744
    ds_read_b128 v[96:99], v8 offset:32256
    v_mfma_f32_32x32x16_bf16 v[52:67], a[100:103], v[104:107], v[52:67]
    ds_read_b128 v[100:103], v8 offset:32768
    ds_read_b128 v[104:107], v8 offset:33280
    v_rcp_f32 v39, v39
    v_mul_f32 v38, v38, v22
    v_cvt_pk_bf16_f32 v42, v36, v37
    v_mfma_f32_32x32x16_bf16 v[52:67], a[104:107], v[108:111], v[52:67]
    buffer_load_dwordx4 v1, s[36:39], s61 offen offset:2048 sc1 lds
    ds_read_b128 v[108:111], v8 offset:33792
    v_mul_f32 v39, v39, v23
    v_cvt_pk_bf16_f32 v43, v38, v39
    v_mfma_f32_32x32x16_bf16 v[52:67], a[108:111], v[112:115], v[52:67]
    buffer_load_dwordx4 a[156:159], v1, s[36:39], s42 offen offset:1024
    ds_read_b128 v[112:115], v8 offset:34304
    s_waitcnt lgkmcnt(12)
    v_mfma_f32_32x32x16_bf16 v[52:67], v[172:175], v[44:47], v[52:67]
    s_add_u32 s87, s76, 114688
    buffer_store_dwordx4 v[40:43], v10, s[36:39], s87 offen sc1
    s_waitcnt lgkmcnt(8)
    v_mfma_f32_32x32x16_bf16 v[16:31], a[0:3], v[68:71], 0
    ds_read_b128 v[68:71], v8 offset:34816
    v_mfma_f32_32x32x16_bf16 v[16:31], a[4:7], v[72:75], v[16:31]
    s_xor_b32 s3, s46, 4096
    buffer_load_dwordx4 v[208:211], v1, s[36:39], s3 offen offset:2048
    ds_read_b128 v[72:75], v8 offset:35328
    v_mfma_f32_32x32x16_bf16 v[16:31], a[8:11], v[76:79], v[16:31]
    ds_read_b128 v[76:79], v8 offset:35840
    s_nop 0
    v_mul_f32 v32, v45, v52
    v_mul_f32 v33, v45, v53
    v_cmp_u_f32 vcc, v52, v52
    s_nop 0
    s_cbranch_vccnz Lnn_157
Lnnd_158:
    v_mfma_f32_32x32x16_bf16 v[16:31], a[12:15], v[80:83], v[16:31]
    ds_read_b128 v[80:83], v8 offset:36352
    v_exp_f32 v32, v32
    v_mul_f32 v34, v45, v54
    v_mul_f32 v52, v60, v52
    s_waitcnt lgkmcnt(8)
    v_mfma_f32_32x32x16_bf16 v[16:31], a[16:19], v[84:87], v[16:31]
    v_exp_f32 v33, v33
    v_mul_f32 v35, v45, v55
    v_mul_f32 v53, v61, v53
    v_exp_f32 v34, v34
    v_mfma_f32_32x32x16_bf16 v[16:31], a[20:23], v[88:91], v[16:31]
    s_xor_b32 s3, s47, 4096
    buffer_load_dwordx4 v[240:243], v1, s[36:39], s3 offen offset:2048
    v_mul_f32 v36, v45, v56
    v_mul_f32 v54, v62, v54
    v_mfma_f32_32x32x16_bf16 v[16:31], a[24:27], v[92:95], v[16:31]
    v_exp_f32 v35, v35
    v_mul_f32 v37, v45, v57
    v_mul_f32 v55, v63, v55
    v_exp_f32 v36, v36
    v_mul_f32 v38, v45, v58
    v_mfma_f32_32x32x16_bf16 v[16:31], a[28:31], v[96:99], v[16:31]
    v_mul_f32 v56, v64, v56
    v_exp_f32 v37, v37
    v_mul_f32 v39, v45, v59
    v_mul_f32 v57, v65, v57
    v_exp_f32 v38, v38
    s_waitcnt lgkmcnt(4)
    v_mfma_f32_32x32x16_bf16 v[16:31], a[32:35], v[100:103], v[16:31]
    s_waitcnt vmcnt(19) lgkmcnt(0)
    s_barrier
    s_add_u32 m0, s84, 120320
    s_add_u32 s61, s74, m0
    s_sub_u32 s61, s61, s31
    buffer_load_dwordx4 v1, s[36:39], s61 offen offset:0 sc1 lds
    v_mfma_f32_32x32x16_bf16 v[16:31], a[36:39], v[104:107], v[16:31]
    buffer_load_dwordx4 a[132:135], v1, s[36:39], s41 offen offset:2048
    ds_read_b128 v[84:87], v8 offset:36864
    ds_read_b128 v[88:91], v8 offset:37376
    v_mul_f32 v58, v66, v58
    v_mfma_f32_32x32x16_bf16 v[16:31], a[40:43], v[108:111], v[16:31]
    ds_read_b128 v[92:95], v8 offset:37888
    ds_read_b128 v[96:99], v8 offset:38400
    ds_read_b128 v[100:103], v8 offset:38912
    ds_read_b128 v[104:107], v8 offset:39424
    v_add_f32 v32, 1.0, v32
    v_mfma_f32_32x32x16_bf16 v[16:31], a[44:47], v[112:115], v[16:31]
    buffer_load_dwordx4 v1, s[36:39], s61 offen offset:1024 sc1 lds
    ds_read_b128 v[108:111], v8 offset:39936
    ds_read_b128 v[112:115], v8 offset:40448
    v_mfma_f32_32x32x16_bf16 v[16:31], a[48:51], v[68:71], v[16:31]
    ds_read_b128 v[68:71], v8 offset:40960
    v_exp_f32 v39, v39
    v_mul_f32 v59, v67, v59
    v_add_f32 v33, 1.0, v33
    v_mfma_f32_32x32x16_bf16 v[16:31], a[52:55], v[72:75], v[16:31]
    buffer_load_dwordx4 v1, s[36:39], s61 offen offset:2048 sc1 lds
    ds_read_b128 v[72:75], v8 offset:41472
    v_rcp_f32 v32, v32
    v_mfma_f32_32x32x16_bf16 v[16:31], a[56:59], v[76:79], v[16:31]
    s_xor_b32 s3, s43, 4096
    buffer_load_dwordx4 a[200:203], v1, s[36:39], s3 offen offset:3072
    ds_read_b128 v[76:79], v8 offset:41984
    v_add_f32 v34, 1.0, v34
    v_mfma_f32_32x32x16_bf16 v[16:31], a[60:63], v[80:83], v[16:31]
    ds_read_b128 v[80:83], v8 offset:42496
    v_add_f32 v35, 1.0, v35
    v_rcp_f32 v33, v33
    v_mul_f32 v32, v32, v52
    v_add_f32 v36, 1.0, v36
    s_waitcnt lgkmcnt(8)
    v_mfma_f32_32x32x16_bf16 v[16:31], a[64:67], v[84:87], v[16:31]
    buffer_load_dwordx4 v1, s[36:39], s61 offen offset:3072 sc1 lds
    v_rcp_f32 v34, v34
    v_mul_f32 v33, v33, v53
    v_mfma_f32_32x32x16_bf16 v[16:31], a[68:71], v[88:91], v[16:31]
    s_xor_b32 s3, s44, 4096
    buffer_load_dwordx4 a[232:235], v1, s[36:39], s3 offen offset:3072
    v_add_f32 v37, 1.0, v37
    v_rcp_f32 v35, v35
    v_mfma_f32_32x32x16_bf16 v[16:31], a[72:75], v[92:95], v[16:31]
    v_mul_f32 v34, v34, v54
    v_add_f32 v38, 1.0, v38
    v_rcp_f32 v36, v36
    v_mul_f32 v35, v35, v55
    v_add_f32 v39, 1.0, v39
    v_mfma_f32_32x32x16_bf16 v[16:31], a[76:79], v[96:99], v[16:31]
    v_rcp_f32 v37, v37
    v_mul_f32 v36, v36, v56
    v_cvt_pk_bf16_f32 v40, v32, v33
    v_rcp_f32 v38, v38
    v_mul_f32 v37, v37, v57
    s_waitcnt lgkmcnt(4)
    v_mfma_f32_32x32x16_bf16 v[16:31], a[80:83], v[100:103], v[16:31]
    v_cvt_pk_bf16_f32 v41, v34, v35
    v_rcp_f32 v39, v39
    v_mul_f32 v38, v38, v58
    v_cvt_pk_bf16_f32 v42, v36, v37
    v_mul_f32 v39, v39, v59
    v_mfma_f32_32x32x16_bf16 v[16:31], a[84:87], v[104:107], v[16:31]
    s_waitcnt vmcnt(16) lgkmcnt(0)
    s_barrier
    v_add_u32 v7, s81, v11
    ds_read_b64 v[48:49], v7 offset:512
    s_add_u32 m0, s85, 120320
    s_add_u32 s61, s74, m0
    s_sub_u32 s61, s61, s31
    buffer_load_dwordx4 v1, s[36:39], s61 offen offset:0 sc1 lds
    v_mfma_f32_32x32x16_bf16 v[16:31], a[88:91], v[108:111], v[16:31]
    s_xor_b32 s3, s45, 4096
    buffer_load_dwordx4 v[184:187], v1, s[36:39], s3 offen offset:3072
    ds_read_b128 v[84:87], v8 offset:0
    ds_read_b128 v[88:91], v8 offset:512
    v_mfma_f32_32x32x16_bf16 v[16:31], a[92:95], v[112:115], v[16:31]
    ds_read_b128 v[92:95], v8 offset:1024
    ds_read_b128 v[96:99], v8 offset:1536
    ds_read_b128 v[100:103], v8 offset:2048
    ds_read_b128 v[104:107], v8 offset:2560
    v_cvt_pk_bf16_f32 v43, v38, v39
    v_mfma_f32_32x32x16_bf16 v[16:31], a[96:99], v[68:71], v[16:31]
    s_waitcnt vmcnt(11)
    v_mov_b32 v7, 3
    s_cmp_eq_u32 s4, 0
    s_cbranch_scc0 Lslow_159
    buffer_store_dword v7, off, s[36:39], s56
Lsdone_160:
    ds_read_b128 v[108:111], v8 offset:3072
    v_mfma_f32_32x32x16_bf16 v[16:31], a[100:103], v[72:75], v[16:31]
    buffer_load_dwordx4 a[164:167], v1, s[36:39], s42 offen offset:2048
    ds_read_b128 v[112:115], v8 offset:3584
    ds_read_b128 v[68:71], v8 offset:4096
    v_mfma_f32_32x32x16_bf16 v[16:31], a[104:107], v[76:79], v[16:31]
    ds_read_b128 v[72:75], v8 offset:4608
    ds_read_b128 v[76:79], v8 offset:5120
    s_add_u32 s87, s77, 0
    buffer_store_dwordx4 v[40:43], v10, s[36:39], s87 offen sc1
    v_mfma_f32_32x32x16_bf16 v[16:31], a[108:111], v[80:83], v[16:31]
    ds_read_b128 v[80:83], v8 offset:5632
    s_waitcnt lgkmcnt(12)
    v_mfma_f32_32x32x16_bf16 v[16:31], v[172:175], v[48:51], v[16:31]
    buffer_load_dwordx4 v1, s[36:39], s61 offen offset:1024 sc1 lds
    s_waitcnt lgkmcnt(8)
    v_mfma_f32_32x32x16_bf16 v[52:67], a[0:3], v[84:87], 0
    s_xor_b32 s3, s46, 4096
    buffer_load_dwordx4 v[216:219], v1, s[36:39], s3 offen offset:3072
    ds_read_b128 v[84:87], v8 offset:6144
    v_mfma_f32_32x32x16_bf16 v[52:67], a[4:7], v[88:91], v[52:67]
    ds_read_b128 v[88:91], v8 offset:6656
    v_mfma_f32_32x32x16_bf16 v[52:67], a[8:11], v[92:95], v[52:67]
    buffer_load_dwordx4 v1, s[36:39], s61 offen offset:2048 sc1 lds
    ds_read_b128 v[92:95], v8 offset:7168
    s_nop 0
    v_mul_f32 v32, v49, v16
    v_mul_f32 v33, v49, v17
    v_mfma_f32_32x32x16_bf16 v[52:67], a[12:15], v[96:99], v[52:67]
    ds_read_b128 v[96:99], v8 offset:7680
    v_cmp_u_f32 vcc, v16, v16
    s_nop 0
    s_cbranch_vccnz Lnn_161
Lnnd_162:
    v_exp_f32 v32, v32
    s_waitcnt lgkmcnt(8)
    v_mfma_f32_32x32x16_bf16 v[52:67], a[16:19], v[100:103], v[52:67]
    s_xor_b32 s3, s47, 4096
    buffer_load_dwordx4 v[248:251], v1, s[36:39], s3 offen offset:3072
    v_mul_f32 v34, v49, v18
    v_mul_f32 v16, v24, v16
    v_mfma_f32_32x32x16_bf16 v[52:67], a[20:23], v[104:107], v[52:67]
    v_exp_f32 v33, v33
    v_mul_f32 v35, v49, v19
    v_mul_f32 v17, v25, v17
    v_exp_f32 v34, v34
    v_mul_f32 v36, v49, v20
    v_mfma_f32_32x32x16_bf16 v[52:67], a[24:27], v[108:111], v[52:67]
    v_mul_f32 v18, v26, v18
    v_exp_f32 v35, v35
    v_mul_f32 v37, v49, v21
    v_mul_f32 v19, v27, v19
    v_exp_f32 v36, v36
    v_mfma_f32_32x32x16_bf16 v[52:67], a[28:31], v[112:115], v[52:67]
    v_mul_f32 v38, v49, v22
    v_mul_f32 v20, v28, v20
    v_exp_f32 v37, v37
    v_mul_f32 v39, v49, v23
    v_mul_f32 v21, v29, v21
    s_waitcnt lgkmcnt(4)
    v_mfma_f32_32x32x16_bf16 v[52:67], a[32:35], v[68:71], v[52:67]
    s_waitcnt lgkmcnt(0)
    s_barrier
    s_add_u32 m0, s84, 91648
    s_add_u32 s61, s75, m0
    buffer_load_dwordx4 v1, s[36:39], s61 offen offset:0 sc1 lds
    v_mfma_f32_32x32x16_bf16 v[52:67], a[36:39], v[72:75], v[52:67]
    buffer_load_dwordx4 a[140:143], v1, s[36:39], s41 offen offset:3072
    ds_read_b128 v[100:103], v8 offset:8192
    ds_read_b128 v[104:107], v8 offset:8704
    v_mfma_f32_32x32x16_bf16 v[52:67], a[40:43], v[76:79], v[52:67]
    ds_read_b128 v[108:111], v8 offset:9216
    ds_read_b128 v[112:115], v8 offset:9728
    ds_read_b128 v[68:71], v8 offset:10240
    ds_read_b128 v[72:75], v8 offset:10752
    v_mfma_f32_32x32x16_bf16 v[52:67], a[44:47], v[80:83], v[52:67]
    buffer_load_dwordx4 v1, s[36:39], s61 offen offset:1024 sc1 lds
    ds_read_b128 v[76:79], v8 offset:11264
    ds_read_b128 v[80:83], v8 offset:11776
    v_mfma_f32_32x32x16_bf16 v[52:67], a[48:51], v[84:87], v[52:67]
    buffer_load_dwordx4 a[180:183], v1, s[36:39], s43 offen offset:0
    ds_read_b128 v[84:87], v8 offset:12288
    v_exp_f32 v38, v38
    v_mfma_f32_32x32x16_bf16 v[52:67], a[52:55], v[88:91], v[52:67]
    ds_read_b128 v[88:91], v8 offset:12800
    v_mul_f32 v22, v30, v22
    v_add_f32 v32, 1.0, v32
    v_exp_f32 v39, v39
    v_mul_f32 v23, v31, v23
    v_mfma_f32_32x32x16_bf16 v[52:67], a[56:59], v[92:95], v[52:67]
    buffer_load_dwordx4 v1, s[36:39], s61 offen offset:2048 sc1 lds
    ds_read_b128 v[92:95], v8 offset:13312
    v_add_f32 v33, 1.0, v33
    v_mfma_f32_32x32x16_bf16 v[52:67], a[60:63], v[96:99], v[52:67]
    ds_read_b128 v[96:99], v8 offset:13824
    v_rcp_f32 v32, v32
    v_add_f32 v34, 1.0, v34
    v_add_f32 v35, 1.0, v35
    s_waitcnt lgkmcnt(8)
    v_mfma_f32_32x32x16_bf16 v[52:67], a[64:67], v[100:103], v[52:67]
    buffer_load_dwordx4 v1, s[36:39], s61 offen offset:3072 sc1 lds
    v_rcp_f32 v33, v33
    v_mul_f32 v32, v32, v16
    v_mfma_f32_32x32x16_bf16 v[52:67], a[68:71], v[104:107], v[52:67]
    buffer_load_dwordx4 a[212:215], v1, s[36:39], s44 offen offset:0
    v_add_f32 v36, 1.0, v36
    v_rcp_f32 v34, v34
    v_mul_f32 v33, v33, v17
    v_mfma_f32_32x32x16_bf16 v[52:67], a[72:75], v[108:111], v[52:67]
    v_add_f32 v37, 1.0, v37
    v_rcp_f32 v35, v35
    v_mul_f32 v34, v34, v18
    v_add_f32 v38, 1.0, v38
    v_rcp_f32 v36, v36
    v_mfma_f32_32x32x16_bf16 v[52:67], a[76:79], v[112:115], v[52:67]
    v_mul_f32 v35, v35, v19
    v_add_f32 v39, 1.0, v39
    v_rcp_f32 v37, v37
    v_mul_f32 v36, v36, v20
    v_cvt_pk_bf16_f32 v40, v32, v33
    s_waitcnt lgkmcnt(4)
    v_mfma_f32_32x32x16_bf16 v[52:67], a[80:83], v[68:71], v[52:67]
    buffer_load_dwordx4 a[244:247], v1, s[36:39], s45 offen offset:0
    v_rcp_f32 v38, v38
    v_mul_f32 v37, v37, v21
    v_mfma_f32_32x32x16_bf16 v[52:67], a[84:87], v[72:75], v[52:67]
    s_waitcnt vmcnt(18) lgkmcnt(0)
    s_barrier
    v_add_u32 v7, s82, v11
    ds_read_b64 v[44:45], v7 offset:0
    ds_read_b128 v[100:103], v8 offset:28672
    ds_read_b128 v[104:107], v8 offset:29184
    v_mfma_f32_32x32x16_bf16 v[52:67], a[88:91], v[76:79], v[52:67]
    s_add_u32 m0, s85, 91648
    s_add_u32 s61, s75, m0
    buffer_load_dwordx4 v1, s[36:39], s61 offen offset:0 sc1 lds
    ds_read_b128 v[108:111], v8 offset:29696
    v_mfma_f32_32x32x16_bf16 v[52:67], a[92:95], v[80:83], v[52:67]
    ds_read_b128 v[112:115], v8 offset:30208
    ds_read_b128 v[68:71], v8 offset:30720
    ds_read_b128 v[72:75], v8 offset:31232
    ds_read_b128 v[76:79], v8 offset:31744
    v_cvt_pk_bf16_f32 v41, v34, v35
    v_mfma_f32_32x32x16_bf16 v[52:67], a[96:99], v[84:87], v[52:67]
    buffer_load_dwordx4 v1, s[36:39], s61 offen offset:1024 sc1 lds
    ds_read_b128 v[80:83], v8 offset:32256
    ds_read_b128 v[84:87], v8 offset:32768
    v_mfma_f32_32x32x16_bf16 v[52:67], a[100:103], v[88:91], v[52:67]
    buffer_load_dwordx4 a[172:175], v1, s[36:39], s42 offen offset:3072
    ds_read_b128 v[88:91], v8 offset:33280
    v_rcp_f32 v39, v39
    v_mfma_f32_32x32x16_bf16 v[52:67], a[104:107], v[92:95], v[52:67]
    ds_read_b128 v[92:95], v8 offset:33792
    v_mul_f32 v38, v38, v22
    v_cvt_pk_bf16_f32 v42, v36, v37
    v_mul_f32 v39, v39, v23
    v_cvt_pk_bf16_f32 v43, v38, v39
    v_mfma_f32_32x32x16_bf16 v[52:67], a[108:111], v[96:99], v[52:67]
    buffer_load_dwordx4 v1, s[36:39], s61 offen offset:2048 sc1 lds
    ds_read_b128 v[96:99], v8 offset:34304
    s_waitcnt lgkmcnt(12)
    v_mfma_f32_32x32x16_bf16 v[52:67], v[172:175], v[44:47], v[52:67]
    buffer_load_dwordx4 v[196:199], v1, s[36:39], s46 offen offset:0
    s_add_u32 s87, s77, 114688
    buffer_store_dwordx4 v[40:43], v10, s[36:39], s87 offen sc1
    s_waitcnt lgkmcnt(8)
    v_mfma_f32_32x32x16_bf16 v[16:31], a[0:3], v[100:103], 0
    ds_read_b128 v[100:103], v8 offset:34816
    v_mfma_f32_32x32x16_bf16 v[16:31], a[4:7], v[104:107], v[16:31]
    ds_read_b128 v[104:107], v8 offset:35328
    v_mfma_f32_32x32x16_bf16 v[16:31], a[8:11], v[108:111], v[16:31]
    ds_read_b128 v[108:111], v8 offset:35840
    s_nop 1
    v_mul_f32 v32, v45, v52
    v_mul_f32 v33, v45, v53
    v_cmp_u_f32 vcc, v52, v52
    s_nop 0
    s_cbranch_vccnz Lnn_163
Lnnd_164:
    v_mfma_f32_32x32x16_bf16 v[16:31], a[12:15], v[112:115], v[16:31]
    buffer_load_dwordx4 v[228:231], v1, s[36:39], s47 offen offset:0
    ds_read_b128 v[112:115], v8 offset:36352
    v_exp_f32 v32, v32
    s_waitcnt lgkmcnt(8)
    v_mfma_f32_32x32x16_bf16 v[16:31], a[16:19], v[68:71], v[16:31]
    v_mul_f32 v34, v45, v54
    v_mul_f32 v52, v60, v52
    v_exp_f32 v33, v33
    v_mul_f32 v35, v45, v55
    v_mul_f32 v53, v61, v53
    v_mfma_f32_32x32x16_bf16 v[16:31], a[20:23], v[72:75], v[16:31]
    v_exp_f32 v34, v34
    v_mul_f32 v36, v45, v56
    v_mul_f32 v54, v62, v54
    v_exp_f32 v35, v35
    v_mul_f32 v37, v45, v57
    v_mfma_f32_32x32x16_bf16 v[16:31], a[24:27], v[76:79], v[16:31]
    v_mul_f32 v55, v63, v55
    v_exp_f32 v36, v36
    v_mul_f32 v38, v45, v58
    v_mul_f32 v56, v64, v56
    v_exp_f32 v37, v37
    v_mfma_f32_32x32x16_bf16 v[16:31], a[28:31], v[80:83], v[16:31]
    buffer_load_dwordx4 a[188:191], v1, s[36:39], s43 offen offset:1024
    v_mul_f32 v39, v45, v59
    v_mul_f32 v57, v65, v57
    v_exp_f32 v38, v38
    s_waitcnt lgkmcnt(4)
    v_mfma_f32_32x32x16_bf16 v[16:31], a[32:35], v[84:87], v[16:31]
    s_waitcnt vmcnt(17) lgkmcnt(0)
    s_barrier
    ds_read_b128 v[68:71], v8 offset:36864
    ds_read_b128 v[72:75], v8 offset:37376
    v_mul_f32 v58, v66, v58
    v_mfma_f32_32x32x16_bf16 v[16:31], a[36:39], v[88:91], v[16:31]
    s_add_u32 m0, s84, 120320
    s_add_u32 s61, s75, m0
    s_sub_u32 s61, s61, s31
    buffer_load_dwordx4 v1, s[36:39], s61 offen offset:0 sc1 lds
    v_add_f32 v32, 1.0, v32
    v_mfma_f32_32x32x16_bf16 v[16:31], a[40:43], v[92:95], v[16:31]
    ds_read_b128 v[76:79], v8 offset:37888
    ds_read_b128 v[80:83], v8 offset:38400
    ds_read_b128 v[84:87], v8 offset:38912
    ds_read_b128 v[88:91], v8 offset:39424
    v_mfma_f32_32x32x16_bf16 v[16:31], a[44:47], v[96:99], v[16:31]
    buffer_load_dwordx4 v1, s[36:39], s61 offen offset:1024 sc1 lds
    ds_read_b128 v[92:95], v8 offset:39936
    ds_read_b128 v[96:99], v8 offset:40448
    v_mfma_f32_32x32x16_bf16 v[16:31], a[48:51], v[100:103], v[16:31]
    buffer_load_dwordx4 a[220:223], v1, s[36:39], s44 offen offset:1024
    ds_read_b128 v[100:103], v8 offset:40960
    v_exp_f32 v39, v39
    v_mfma_f32_32x32x16_bf16 v[16:31], a[52:55], v[104:107], v[16:31]
    ds_read_b128 v[104:107], v8 offset:41472
    v_mul_f32 v59, v67, v59
    v_add_f32 v33, 1.0, v33
    v_rcp_f32 v32, v32
    v_add_f32 v34, 1.0, v34
    v_mfma_f32_32x32x16_bf16 v[16:31], a[56:59], v[108:111], v[16:31]
    buffer_load_dwordx4 v1, s[36:39], s61 offen offset:2048 sc1 lds
    ds_read_b128 v[108:111], v8 offset:41984
    v_add_f32 v35, 1.0, v35
    v_mfma_f32_32x32x16_bf16 v[16:31], a[60:63], v[112:115], v[16:31]
    buffer_load_dwordx4 a[252:255], v1, s[36:39], s45 offen offset:1024
    ds_read_b128 v[112:115], v8 offset:42496
    v_rcp_f32 v33, v33
    s_waitcnt lgkmcnt(8)
    v_mfma_f32_32x32x16_bf16 v[16:31], a[64:67], v[68:71], v[16:31]
    v_mul_f32 v32, v32, v52
    v_add_f32 v36, 1.0, v36
    v_rcp_f32 v34, v34
    v_mul_f32 v33, v33, v53
    v_add_f32 v37, 1.0, v37
    v_mfma_f32_32x32x16_bf16 v[16:31], a[68:71], v[72:75], v[16:31]
    buffer_load_dwordx4 v1, s[36:39], s61 offen offset:3072 sc1 lds
    v_rcp_f32 v35, v35
    v_mul_f32 v34, v34, v54
    v_add_f32 v38, 1.0, v38
    v_mfma_f32_32x32x16_bf16 v[16:31], a[72:75], v[76:79], v[16:31]
    v_rcp_f32 v36, v36
    v_mul_f32 v35, v35, v55
    v_add_f32 v39, 1.0, v39
    v_rcp_f32 v37, v37
    v_mul_f32 v36, v36, v56
    v_mfma_f32_32x32x16_bf16 v[16:31], a[76:79], v[80:83], v[16:31]
    buffer_load_dwordx4 v[204:207], v1, s[36:39], s46 offen offset:1024
    v_cvt_pk_bf16_f32 v40, v32, v33
    v_rcp_f32 v38, v38
    v_mul_f32 v37, v37, v57
    s_waitcnt lgkmcnt(4)
    v_mfma_f32_32x32x16_bf16 v[16:31], a[80:83], v[84:87], v[16:31]
    v_cvt_pk_bf16_f32 v41, v34, v35
    v_rcp_f32 v39, v39
    v_mul_f32 v38, v38, v58
    v_cvt_pk_bf16_f32 v42, v36, v37
    v_mul_f32 v39, v39, v59
    v_mfma_f32_32x32x16_bf16 v[16:31], a[84:87], v[88:91], v[16:31]
    s_waitcnt vmcnt(17) lgkmcnt(0)
    s_barrier
    v_add_u32 v7, s82, v11
    ds_read_b64 v[48:49], v7 offset:512
    s_add_u32 m0, s85, 120320
    s_add_u32 s61, s75, m0
    s_sub_u32 s61, s61, s31
    buffer_load_dwordx4 v1, s[36:39], s61 offen offset:0 sc1 lds
    v_mfma_f32_32x32x16_bf16 v[16:31], a[88:91], v[92:95], v[16:31]
    ds_read_b128 v[68:71], v8 offset:0
    ds_read_b128 v[72:75], v8 offset:512
    ds_read_b128 v[76:79], v8 offset:1024
    ds_read_b128 v[80:83], v8 offset:1536
    v_cvt_pk_bf16_f32 v43, v38, v39
    v_mfma_f32_32x32x16_bf16 v[16:31], a[92:95], v[96:99], v[16:31]
    buffer_load_dwordx4 v1, s[36:39], s61 offen offset:1024 sc1 lds
    ds_read_b128 v[84:87], v8 offset:2048
    ds_read_b128 v[88:91], v8 offset:2560
    v_mfma_f32_32x32x16_bf16 v[16:31], a[96:99], v[100:103], v[16:31]
    s_waitcnt vmcnt(11)
    v_mov_b32 v7, 4
    s_cmp_eq_u32 s4, 0
    s_cbranch_scc0 Lslow_165
    buffer_store_dword v7, off, s[36:39], s56
Lsdone_166:
    ds_read_b128 v[92:95], v8 offset:3072
    v_mfma_f32_32x32x16_bf16 v[16:31], a[100:103], v[104:107], v[16:31]
    buffer_load_dwordx4 v[236:239], v1, s[36:39], s47 offen offset:1024
    ds_read_b128 v[96:99], v8 offset:3584
    ds_read_b128 v[100:103], v8 offset:4096
    v_mfma_f32_32x32x16_bf16 v[16:31], a[104:107], v[108:111], v[16:31]
    ds_read_b128 v[104:107], v8 offset:4608
    ds_read_b128 v[108:111], v8 offset:5120
    s_add_u32 s87, s78, 0
    buffer_store_dwordx4 v[40:43], v10, s[36:39], s87 offen sc1
    v_mfma_f32_32x32x16_bf16 v[16:31], a[108:111], v[112:115], v[16:31]
    buffer_load_dwordx4 a[196:199], v1, s[36:39], s43 offen offset:2048
    ds_read_b128 v[112:115], v8 offset:5632
    s_waitcnt lgkmcnt(12)
    v_mfma_f32_32x32x16_bf16 v[16:31], v[172:175], v[48:51], v[16:31]
    s_waitcnt lgkmcnt(8)
    v_mfma_f32_32x32x16_bf16 v[52:67], a[0:3], v[68:71], 0
    buffer_load_dwordx4 v1, s[36:39], s61 offen offset:2048 sc1 lds
    ds_read_b128 v[68:71], v8 offset:6144
    v_mfma_f32_32x32x16_bf16 v[52:67], a[4:7], v[72:75], v[52:67]
    ds_read_b128 v[72:75], v8 offset:6656
    v_mfma_f32_32x32x16_bf16 v[52:67], a[8:11], v[76:79], v[52:67]
    buffer_load_dwordx4 a[228:231], v1, s[36:39], s44 offen offset:2048
    ds_read_b128 v[76:79], v8 offset:7168
    s_nop 2
    v_mul_f32 v32, v49, v16
    v_mul_f32 v33, v49, v17
    v_mfma_f32_32x32x16_bf16 v[52:67], a[12:15], v[80:83], v[52:67]
    ds_read_b128 v[80:83], v8 offset:7680
    v_cmp_u_f32 vcc, v16, v16
    s_nop 0
    s_cbranch_vccnz Lnn_167
Lnnd_168:
    v_exp_f32 v32, v32
    s_waitcnt lgkmcnt(8)
    v_mfma_f32_32x32x16_bf16 v[52:67], a[16:19], v[84:87], v[52:67]
    v_mul_f32 v34, v49, v18
    v_mul_f32 v16, v24, v16
    v_exp_f32 v33, v33
    v_mul_f32 v35, v49, v19
    v_mul_f32 v17, v25, v17
    v_mfma_f32_32x32x16_bf16 v[52:67], a[20:23], v[88:91], v[52:67]
    buffer_load_dword v9, v6, s[36:39], 0 offen sc1
    v_exp_f32 v34, v34
    v_mul_f32 v36, v49, v20
    v_mul_f32 v18, v26, v18
    v_exp_f32 v35, v35
    v_mfma_f32_32x32x16_bf16 v[52:67], a[24:27], v[92:95], v[52:67]
    buffer_load_dwordx4 v[180:183], v1, s[36:39], s45 offen offset:2048
    v_mul_f32 v37, v49, v21
    v_mul_f32 v19, v27, v19
    v_exp_f32 v36, v36
    v_mfma_f32_32x32x16_bf16 v[52:67], a[28:31], v[96:99], v[52:67]
    v_mul_f32 v38, v49, v22
    v_mul_f32 v20, v28, v20
    v_exp_f32 v37, v37
    v_mul_f32 v39, v49, v23
    v_mul_f32 v21, v29, v21
    s_waitcnt lgkmcnt(4)
    v_mfma_f32_32x32x16_bf16 v[52:67], a[32:35], v[100:103], v[52:67]
    s_waitcnt lgkmcnt(0)
    s_barrier
    ds_read_b128 v[84:87], v8 offset:8192
    ds_read_b128 v[88:91], v8 offset:8704
    v_mfma_f32_32x32x16_bf16 v[52:67], a[36:39], v[104:107], v[52:67]
    ds_read_b128 v[92:95], v8 offset:9216
    ds_read_b128 v[96:99], v8 offset:9728
    ds_read_b128 v[100:103], v8 offset:10240
    ds_read_b128 v[104:107], v8 offset:10752
    v_mfma_f32_32x32x16_bf16 v[52:67], a[40:43], v[108:111], v[52:67]
    buffer_load_dwordx4 v[212:215], v1, s[36:39], s46 offen offset:2048
    ds_read_b128 v[108:111], v8 offset:11264
    v_exp_f32 v38, v38
    v_mfma_f32_32x32x16_bf16 v[52:67], a[44:47], v[112:115], v[52:67]
    ds_read_b128 v[112:115], v8 offset:11776
    v_mul_f32 v22, v30, v22
    v_add_f32 v32, 1.0, v32
    v_exp_f32 v39, v39
    v_mul_f32 v23, v31, v23
    v_mfma_f32_32x32x16_bf16 v[52:67], a[48:51], v[68:71], v[52:67]
    ds_read_b128 v[68:71], v8 offset:12288
    v_add_f32 v33, 1.0, v33
    v_rcp_f32 v32, v32
    v_add_f32 v34, 1.0, v34
    v_add_f32 v35, 1.0, v35
    v_mfma_f32_32x32x16_bf16 v[52:67], a[52:55], v[72:75], v[52:67]
    ds_read_b128 v[72:75], v8 offset:12800
    v_rcp_f32 v33, v33
    v_mul_f32 v32, v32, v16
    v_add_f32 v36, 1.0, v36
    v_mfma_f32_32x32x16_bf16 v[52:67], a[56:59], v[76:79], v[52:67]
    buffer_load_dwordx4 v[244:247], v1, s[36:39], s47 offen offset:2048
    ds_read_b128 v[76:79], v8 offset:13312
    v_rcp_f32 v34, v34
    v_mfma_f32_32x32x16_bf16 v[52:67], a[60:63], v[80:83], v[52:67]
    ds_read_b128 v[80:83], v8 offset:13824
    v_mul_f32 v33, v33, v17
    v_add_f32 v37, 1.0, v37
    v_rcp_f32 v35, v35
    v_mul_f32 v34, v34, v18
    s_waitcnt lgkmcnt(8)
    v_mfma_f32_32x32x16_bf16 v[52:67], a[64:67], v[84:87], v[52:67]
    v_add_f32 v38, 1.0, v38
    v_rcp_f32 v36, v36
    v_mul_f32 v35, v35, v19
    v_add_f32 v39, 1.0, v39
    v_mfma_f32_32x32x16_bf16 v[52:67], a[68:71], v[88:91], v[52:67]
    v_rcp_f32 v37, v37
    v_mul_f32 v36, v36, v20
    v_cvt_pk_bf16_f32 v40, v32, v33
    v_rcp_f32 v38, v38
    v_mul_f32 v37, v37, v21
    v_mfma_f32_32x32x16_bf16 v[52:67], a[72:75], v[92:95], v[52:67]
    buffer_load_dwordx4 a[204:207], v1, s[36:39], s43 offen offset:3072
    v_cvt_pk_bf16_f32 v41, v34, v35
    v_rcp_f32 v39, v39
    v_mul_f32 v38, v38, v22
    v_mfma_f32_32x32x16_bf16 v[52:67], a[76:79], v[96:99], v[52:67]
    v_cvt_pk_bf16_f32 v42, v36, v37
    v_mul_f32 v39, v39, v23
    v_cvt_pk_bf16_f32 v43, v38, v39
    s_add_u32 s87, s78, 114688
    buffer_store_dwordx4 v[40:43], v10, s[36:39], s87 offen sc1
    s_waitcnt lgkmcnt(4)
    v_mfma_f32_32x32x16_bf16 v[52:67], a[80:83], v[100:103], v[52:67]
    v_mfma_f32_32x32x16_bf16 v[52:67], a[84:87], v[104:107], v[52:67]
    buffer_load_dword v15, v14, s[36:39], 0 offen sc1
    s_waitcnt vmcnt(16) lgkmcnt(0)
    s_barrier
    v_add_u32 v7, s83, v11
    ds_read_b64 v[44:45], v7 offset:0
    ds_read_b128 v[84:87], v8 offset:28672
    v_mfma_f32_32x32x16_bf16 v[52:67], a[88:91], v[108:111], v[52:67]
    buffer_load_dwordx4 a[236:239], v1, s[36:39], s44 offen offset:3072
    ds_read_b128 v[88:91], v8 offset:29184
    ds_read_b128 v[92:95], v8 offset:29696
    v_mfma_f32_32x32x16_bf16 v[52:67], a[92:95], v[112:115], v[52:67]
    s_waitcnt vmcnt(7)
    v_cmp_gt_u32 vcc, v4, v9
    s_nop 0
    s_and_b32 s6, vcc_lo, 0xff
    s_cbranch_scc1 Lps_169
Lpd_170:
    ds_read_b128 v[96:99], v8 offset:30208
    v_mfma_f32_32x32x16_bf16 v[52:67], a[96:99], v[68:71], v[52:67]
    ds_read_b128 v[100:103], v8 offset:30720
    ds_read_b128 v[104:107], v8 offset:31232
    ds_read_b128 v[108:111], v8 offset:31744
    ds_read_b128 v[112:115], v8 offset:32256
    v_mfma_f32_32x32x16_bf16 v[52:67], a[100:103], v[72:75], v[52:67]
    ds_read_b128 v[68:71], v8 offset:32768
    ds_read_b128 v[72:75], v8 offset:33280
    buffer_load_dwordx4 v[116:119], v12, s[36:39], s88 offen offset:0 sc1
    v_mfma_f32_32x32x16_bf16 v[52:67], a[104:107], v[76:79], v[52:67]
    buffer_load_dwordx4 v[188:191], v1, s[36:39], s45 offen offset:3072
    ds_read_b128 v[76:79], v8 offset:33792
    v_mfma_f32_32x32x16_bf16 v[52:67], a[108:111], v[80:83], v[52:67]
    ds_read_b128 v[80:83], v8 offset:34304
    s_waitcnt lgkmcnt(12)
    v_mfma_f32_32x32x16_bf16 v[52:67], v[172:175], v[44:47], v[52:67]
    buffer_load_dwordx4 v[120:123], v13, s[36:39], s88 offen offset:0 sc1
    s_waitcnt lgkmcnt(8)
    v_mfma_f32_32x32x16_bf16 v[16:31], a[0:3], v[84:87], 0
    ds_read_b128 v[84:87], v8 offset:34816
    v_mfma_f32_32x32x16_bf16 v[16:31], a[4:7], v[88:91], v[16:31]
    buffer_load_dwordx4 v[220:223], v1, s[36:39], s46 offen offset:3072
    ds_read_b128 v[88:91], v8 offset:35328
    v_mfma_f32_32x32x16_bf16 v[16:31], a[8:11], v[92:95], v[16:31]
    v_add_u32 v7, s83, v11
    ds_read_b64 v[48:49], v7 offset:512
    ds_read_b128 v[92:95], v8 offset:35840
    s_nop 0
    v_mul_f32 v32, v45, v52
    v_mul_f32 v33, v45, v53
    v_mfma_f32_32x32x16_bf16 v[16:31], a[12:15], v[96:99], v[16:31]
    ds_read_b128 v[96:99], v8 offset:36352
    buffer_load_dwordx4 v[124:127], v12, s[36:39], s88 offen offset:1024 sc1
    s_waitcnt lgkmcnt(9)
    v_mfma_f32_32x32x16_bf16 v[16:31], a[16:19], v[100:103], v[16:31]
    v_cmp_u_f32 vcc, v52, v52
    s_nop 0
    s_cbranch_vccnz Lnn_172
Lnnd_173:
    v_exp_f32 v32, v32
    v_mul_f32 v34, v45, v54
    v_mfma_f32_32x32x16_bf16 v[16:31], a[20:23], v[104:107], v[16:31]
    buffer_load_dwordx4 v[252:255], v1, s[36:39], s47 offen offset:3072
    v_mul_f32 v52, v60, v52
    v_exp_f32 v33, v33
    v_mul_f32 v35, v45, v55
    v_mfma_f32_32x32x16_bf16 v[16:31], a[24:27], v[108:111], v[16:31]
    v_mul_f32 v53, v61, v53
    v_exp_f32 v34, v34
    v_mul_f32 v36, v45, v56
    v_mul_f32 v54, v62, v54
    v_exp_f32 v35, v35
    v_mfma_f32_32x32x16_bf16 v[16:31], a[28:31], v[112:115], v[16:31]
    buffer_load_dwordx4 v[128:131], v13, s[36:39], s88 offen offset:1024 sc1
    v_mul_f32 v37, v45, v57
    v_mul_f32 v55, v63, v55
    v_exp_f32 v36, v36
    s_waitcnt lgkmcnt(5)
    v_mfma_f32_32x32x16_bf16 v[16:31], a[32:35], v[68:71], v[16:31]
    s_waitcnt lgkmcnt(0)
    s_barrier
    ds_read_b128 v[100:103], v8 offset:36864
    ds_read_b128 v[104:107], v8 offset:37376
    v_mul_f32 v38, v45, v58
    v_mfma_f32_32x32x16_bf16 v[16:31], a[36:39], v[72:75], v[16:31]
    ds_read_b128 v[108:111], v8 offset:37888
    ds_read_b128 v[112:115], v8 offset:38400
    ds_read_b128 v[68:71], v8 offset:38912
    ds_read_b128 v[72:75], v8 offset:39424
    v_mul_f32 v56, v64, v56
    v_mfma_f32_32x32x16_bf16 v[16:31], a[40:43], v[76:79], v[16:31]
    ds_read_b128 v[76:79], v8 offset:39936
    buffer_load_dwordx4 v[132:135], v12, s[36:39], s88 offen offset:2048 sc1
    v_exp_f32 v37, v37
    v_mfma_f32_32x32x16_bf16 v[16:31], a[44:47], v[80:83], v[16:31]
    ds_read_b128 v[80:83], v8 offset:40448
    v_mul_f32 v39, v45, v59
    v_mul_f32 v57, v65, v57
    v_exp_f32 v38, v38
    v_mul_f32 v58, v66, v58
    v_mfma_f32_32x32x16_bf16 v[16:31], a[48:51], v[84:87], v[16:31]
    ds_read_b128 v[84:87], v8 offset:40960
    buffer_load_dwordx4 v[136:139], v13, s[36:39], s88 offen offset:2048 sc1
    v_add_f32 v32, 1.0, v32
    v_mfma_f32_32x32x16_bf16 v[16:31], a[52:55], v[88:91], v[16:31]
    s_waitcnt vmcnt(10)
    v_cmp_ne_u32 vcc, s0, v15
    s_nop 0
    s_cbranch_vccnz Lmc_174
Lmcd_176:
    ds_read_b128 v[88:91], v8 offset:41472
    v_mfma_f32_32x32x16_bf16 v[16:31], a[56:59], v[92:95], v[16:31]
    v_mov_b32 v7, 5
    s_cmp_eq_u32 s4, 0
    s_cbranch_scc0 Lslow_177
    buffer_store_dword v7, off, s[36:39], s56
Lsdone_178:
    ds_read_b128 v[92:95], v8 offset:41984
    v_mfma_f32_32x32x16_bf16 v[16:31], a[60:63], v[96:99], v[16:31]
    ds_read_b128 v[96:99], v8 offset:42496
    v_exp_f32 v39, v39
    v_mul_f32 v59, v67, v59
    v_add_f32 v33, 1.0, v33
    s_waitcnt lgkmcnt(8)
    v_mfma_f32_32x32x16_bf16 v[16:31], a[64:67], v[100:103], v[16:31]
    buffer_load_dwordx4 v[140:143], v12, s[36:39], s88 offen offset:3072 sc1
    v_rcp_f32 v32, v32
    v_add_f32 v34, 1.0, v34
    v_mfma_f32_32x32x16_bf16 v[16:31], a[68:71], v[104:107], v[16:31]
    v_add_f32 v35, 1.0, v35
    v_rcp_f32 v33, v33
    v_mul_f32 v32, v32, v52
    v_add_f32 v36, 1.0, v36
    v_rcp_f32 v34, v34
    v_mfma_f32_32x32x16_bf16 v[16:31], a[72:75], v[108:111], v[16:31]
    buffer_load_dwordx4 v[144:147], v13, s[36:39], s88 offen offset:3072 sc1
    v_mul_f32 v33, v33, v53
    v_add_f32 v37, 1.0, v37
    v_rcp_f32 v35, v35
    v_mfma_f32_32x32x16_bf16 v[16:31], a[76:79], v[112:115], v[16:31]
    v_mul_f32 v34, v34, v54
    v_add_f32 v38, 1.0, v38
    v_rcp_f32 v36, v36
    v_mul_f32 v35, v35, v55
    v_add_f32 v39, 1.0, v39
    s_waitcnt lgkmcnt(4)
    v_mfma_f32_32x32x16_bf16 v[16:31], a[80:83], v[68:71], v[16:31]
    buffer_load_dwordx4 v[148:151], v12, s[36:39], s89 offen offset:0 sc1
    v_rcp_f32 v37, v37
    v_mul_f32 v36, v36, v56
    v_mfma_f32_32x32x16_bf16 v[16:31], a[84:87], v[72:75], v[16:31]
    v_cvt_pk_bf16_f32 v40, v32, v33
    v_rcp_f32 v38, v38
    v_mul_f32 v37, v37, v57
    v_cvt_pk_bf16_f32 v41, v34, v35
    v_rcp_f32 v39, v39
    v_mfma_f32_32x32x16_bf16 v[16:31], a[88:91], v[76:79], v[16:31]
    buffer_load_dwordx4 v[152:155], v13, s[36:39], s89 offen offset:0 sc1
    v_mul_f32 v38, v38, v58
    v_cvt_pk_bf16_f32 v42, v36, v37
    v_mul_f32 v39, v39, v59
    v_cvt_pk_bf16_f32 v43, v38, v39
    v_mfma_f32_32x32x16_bf16 v[16:31], a[92:95], v[80:83], v[16:31]
    buffer_load_dword v9, v6, s[36:39], 0 offen sc1
    s_add_u32 s87, s79, 0
    s_cmp_eq_u32 s4, 0
    s_cbranch_scc0 Lslow_179
    buffer_store_dwordx4 v[40:43], v10, s[36:39], s87 offen
Lsdone_180:
    s_waitcnt lgkmcnt(0)
    v_mfma_f32_32x32x16_bf16 v[16:31], a[96:99], v[84:87], v[16:31]
    buffer_load_dwordx4 v[156:159], v12, s[36:39], s89 offen offset:1024 sc1
    v_mfma_f32_32x32x16_bf16 v[16:31], a[100:103], v[88:91], v[16:31]
    v_mfma_f32_32x32x16_bf16 v[16:31], a[104:107], v[92:95], v[16:31]
    buffer_load_dwordx4 v[160:163], v13, s[36:39], s89 offen offset:1024 sc1
    v_mfma_f32_32x32x16_bf16 v[16:31], a[108:111], v[96:99], v[16:31]
    v_mfma_f32_32x32x16_bf16 v[16:31], v[172:175], v[48:51], v[16:31]
    buffer_load_dwordx4 v[164:167], v12, s[36:39], s89 offen offset:2048 sc1
    s_waitcnt vmcnt(16)
    v_mfma_f32_32x32x16_bf16 v[52:67], a[112:115], v[116:119], 0
    v_mfma_f32_32x32x16_bf16 v[68:83], a[116:119], v[116:119], 0
    buffer_load_dwordx4 v[168:171], v13, s[36:39], s89 offen offset:2048 sc1
    s_nop 6
    v_mul_f32 v32, v49, v16
    v_mul_f32 v33, v49, v17
    v_mfma_f32_32x32x16_bf16 v[84:99], a[112:115], v[120:123], 0
    v_cmp_u_f32 vcc, v16, v16
    s_nop 0
    s_cbranch_vccnz Lnn_181
Lnnd_182:
    v_exp_f32 v32, v32
    v_mul_f32 v34, v49, v18
    v_mul_f32 v16, v24, v16
    v_mfma_f32_32x32x16_bf16 v[100:115], a[116:119], v[120:123], 0
    buffer_load_dwordx4 v[116:119], v12, s[36:39], s89 offen offset:3072 sc1
    v_exp_f32 v33, v33
    v_mul_f32 v35, v49, v19
    v_mul_f32 v17, v25, v17
    s_waitcnt vmcnt(14)
    v_mfma_f32_32x32x16_bf16 v[52:67], a[120:123], v[124:127], v[52:67]
    v_exp_f32 v34, v34
    v_mul_f32 v36, v49, v20
    v_mul_f32 v18, v26, v18
    v_exp_f32 v35, v35
    v_mfma_f32_32x32x16_bf16 v[68:83], a[124:127], v[124:127], v[68:83]
    buffer_load_dwordx4 v[120:123], v13, s[36:39], s89 offen offset:3072 sc1
    v_mul_f32 v37, v49, v21
    v_mul_f32 v19, v27, v19
    v_exp_f32 v36, v36
    v_mfma_f32_32x32x16_bf16 v[84:99], a[120:123], v[128:131], v[84:99]
    v_mul_f32 v38, v49, v22
    v_mul_f32 v20, v28, v20
    v_exp_f32 v37, v37
    v_mul_f32 v39, v49, v23
    v_mul_f32 v21, v29, v21
    v_mfma_f32_32x32x16_bf16 v[100:115], a[124:127], v[128:131], v[100:115]
    v_exp_f32 v38, v38
    v_mul_f32 v22, v30, v22
    v_add_f32 v32, 1.0, v32
    v_exp_f32 v39, v39
    v_mul_f32 v23, v31, v23
    s_waitcnt vmcnt(13)
    v_mfma_f32_32x32x16_bf16 v[52:67], a[128:131], v[132:135], v[52:67]
    v_add_f32 v33, 1.0, v33
    v_rcp_f32 v32, v32
    v_add_f32 v34, 1.0, v34
    v_add_f32 v35, 1.0, v35
    v_mfma_f32_32x32x16_bf16 v[68:83], a[132:135], v[132:135], v[68:83]
    v_rcp_f32 v33, v33
    v_mul_f32 v32, v32, v16
    v_add_f32 v36, 1.0, v36
    v_rcp_f32 v34, v34
    v_mul_f32 v33, v33, v17
    v_mfma_f32_32x32x16_bf16 v[84:99], a[128:131], v[136:139], v[84:99]
    s_waitcnt vmcnt(6)
    v_mov_b32 v7, 6
    s_cmp_eq_u32 s4, 0
    s_cbranch_scc0 Lslow_183
    buffer_store_dword v7, off, s[36:39], s56
Lsdone_184:
    v_add_f32 v37, 1.0, v37
    v_mfma_f32_32x32x16_bf16 v[100:115], a[132:135], v[136:139], v[100:115]
    v_rcp_f32 v35, v35
    v_mul_f32 v34, v34, v18
    v_add_f32 v38, 1.0, v38
    v_rcp_f32 v36, v36
    v_mul_f32 v35, v35, v19
    v_mfma_f32_32x32x16_bf16 v[52:67], a[136:139], v[140:143], v[52:67]
    v_cmp_gt_u32 vcc, v4, v9
    s_nop 0
    s_and_b32 s6, vcc_lo, 0xfff00
    s_cbranch_scc1 Lps_185
Lpd_186:
    buffer_load_dwordx4 v[124:127], v12, s[36:39], s90 offen offset:0 sc1
    v_mfma_f32_32x32x16_bf16 v[68:83], a[140:143], v[140:143], v[68:83]
    buffer_load_dwordx4 v[128:131], v12, s[36:39], s90 offen offset:1024 sc1
    v_add_f32 v39, 1.0, v39
    v_rcp_f32 v37, v37
    v_mul_f32 v36, v36, v20
    v_mfma_f32_32x32x16_bf16 v[84:99], a[136:139], v[144:147], v[84:99]
    v_cvt_pk_bf16_f32 v40, v32, v33
    v_rcp_f32 v38, v38
    v_mul_f32 v37, v37, v21
    v_cvt_pk_bf16_f32 v41, v34, v35
    v_rcp_f32 v39, v39
    v_mul_f32 v38, v38, v22
    v_cvt_pk_bf16_f32 v42, v36, v37
    v_mul_f32 v39, v39, v23
    v_cvt_pk_bf16_f32 v43, v38, v39
    s_add_u32 s87, s79, 114688
    s_cmp_eq_u32 s4, 0
    s_cbranch_scc0 Lslow_188
    buffer_store_dwordx4 v[40:43], v10, s[36:39], s87 offen
Lsdone_189:
    v_mfma_f32_32x32x16_bf16 v[100:115], a[140:143], v[144:147], v[100:115]
    buffer_load_dwordx4 v[132:135], v12, s[36:39], s90 offen offset:2048 sc1
    v_mfma_f32_32x32x16_bf16 v[52:67], a[144:147], v[148:151], v[52:67]
    buffer_load_dwordx4 v[136:139], v12, s[36:39], s90 offen offset:3072 sc1
    v_mfma_f32_32x32x16_bf16 v[68:83], a[148:151], v[148:151], v[68:83]
    buffer_load_dwordx4 v[140:143], v12, s[36:39], s91 offen offset:0 sc1
    v_mfma_f32_32x32x16_bf16 v[84:99], a[144:147], v[152:155], v[84:99]
    buffer_load_dwordx4 v[144:147], v12, s[36:39], s91 offen offset:1024 sc1
    v_mfma_f32_32x32x16_bf16 v[100:115], a[148:151], v[152:155], v[100:115]
    buffer_load_dwordx4 v[148:151], v12, s[36:39], s91 offen offset:2048 sc1
    s_waitcnt vmcnt(13)
    v_mfma_f32_32x32x16_bf16 v[52:67], a[152:155], v[156:159], v[52:67]
    v_mfma_f32_32x32x16_bf16 v[68:83], a[156:159], v[156:159], v[68:83]
    buffer_load_dwordx4 v[152:155], v12, s[36:39], s91 offen offset:3072 sc1
    v_mfma_f32_32x32x16_bf16 v[84:99], a[152:155], v[160:163], v[84:99]
    v_mfma_f32_32x32x16_bf16 v[100:115], a[156:159], v[160:163], v[100:115]
    buffer_load_dwordx4 v[156:159], v12, s[36:39], s92 offen offset:0 sc1
    s_waitcnt vmcnt(13)
    v_mfma_f32_32x32x16_bf16 v[52:67], a[160:163], v[164:167], v[52:67]
    v_mfma_f32_32x32x16_bf16 v[68:83], a[164:167], v[164:167], v[68:83]
    buffer_load_dwordx4 v[160:163], v12, s[36:39], s92 offen offset:1024 sc1
    v_mfma_f32_32x32x16_bf16 v[84:99], a[160:163], v[168:171], v[84:99]
    s_waitcnt vmcnt(8)
    v_mov_b32 v7, 7
    s_cmp_eq_u32 s4, 0
    s_cbranch_scc0 Lslow_190
    buffer_store_dword v7, off, s[36:39], s56
Lsdone_191:
    s_barrier
    v_mfma_f32_32x32x16_bf16 v[100:115], a[164:167], v[168:171], v[100:115]
    buffer_load_dwordx4 v[164:167], v12, s[36:39], s92 offen offset:2048 sc1
    s_and_b32 s74, s60, 14
    s_and_b32 s75, s50, 1
    s_lshl1_add_u32 s77, s54, s75
    s_mul_i32 s72, s74, 14336
    v_mfma_f32_32x32x16_bf16 v[52:67], a[168:171], v[116:119], v[52:67]
    buffer_load_dword v9, v6, s[36:39], 0 offen sc1
    s_lshl_b32 s73, s77, 10
    s_add_u32 s72, s72, s73
    s_add_u32 s95, s72, s55
    s_add_u32 s95, s95, 262144
    v_mfma_f32_32x32x16_bf16 v[68:83], a[172:175], v[116:119], v[68:83]
    buffer_load_dwordx4 v[168:171], v12, s[36:39], s92 offen offset:3072 sc1
    v_mfma_f32_32x32x16_bf16 v[84:99], a[168:171], v[120:123], v[84:99]
    s_cmp_eq_u32 s48, 7
    s_cselect_b32 s5, 3, s48
    s_cmp_lt_u32 s54, s5
    s_cselect_b32 s6, 7, 0
    s_sub_u32 s5, s6, s5
    s_lshl_b32 s5, s5, 11
    s_add_u32 s95, s95, s5
    v_mfma_f32_32x32x16_bf16 v[100:115], a[172:175], v[120:123], v[100:115]
    buffer_load_dwordx4 v[116:119], v13, s[36:39], s90 offen offset:0 sc1
    buffer_load_dwordx4 v[16:19], v5, s[36:39], s95 offen sc1
    v_mfma_f32_32x32x16_bf16 v[52:67], a[176:179], v[124:127], v[52:67]
    buffer_load_dwordx4 v[20:23], v5, s[36:39], s95 offen offset:512 sc1
    s_lshl_b32 s74, s74, 8
    s_lshr_b32 s95, s31, 6
    s_and_b32 s95, s95, 512
    s_xor_b32 s95, s95, s74
    v_mfma_f32_32x32x16_bf16 v[68:83], a[180:183], v[124:127], v[68:83]
    buffer_load_dwordx4 v[120:123], v13, s[36:39], s90 offen offset:1024 sc1
    s_add_u32 s95, s95, 149000
    v_add_u32 v27, s95, v11
    ds_read_b32 v24, v27
    v_mfma_f32_32x32x16_bf16 v[52:67], a[184:187], v[128:131], v[52:67]
    s_xor_b32 s95, s50, 3
    s_mul_i32 s95, s95, 12288
    s_add_u32 s95, s95, 91648
    v_add_u32 v27, s95, v1
    s_xor_b32 s95, s50, 2
    s_mul_i32 s95, s95, 12288
    s_add_u32 s95, s95, 95744
    v_mfma_f32_32x32x16_bf16 v[68:83], a[188:191], v[128:131], v[68:83]
    buffer_load_dwordx4 v[124:127], v13, s[36:39], s90 offen offset:2048 sc1
    v_add_u32 v28, s95, v1
    s_xor_b32 s95, s50, 1
    s_mul_i32 s95, s95, 12288
    s_add_u32 s95, s95, 99840
    s_waitcnt vmcnt(16)
    v_mfma_f32_32x32x16_bf16 v[52:67], a[192:195], v[132:135], v[52:67]
    v_add_u32 v29, s95, v1
    s_xor_b32 s95, s50, 0
    s_mul_i32 s95, s95, 12288
    s_add_u32 s95, s95, 91648
    v_add_u32 v30, s95, v1
    s_add_u32 s72, s72, s21
    v_mfma_f32_32x32x16_bf16 v[68:83], a[196:199], v[132:135], v[68:83]
    buffer_load_dwordx4 v[128:131], v13, s[36:39], s90 offen offset:3072 sc1
    v_lshrrev_b32 v26, 1, v2
    v_lshl_add_u32 v26, v26, 3, v11
    v_lshrrev_b32 v26, 1, v26
    s_mov_b32 s79, 0x3f803f80
    s_waitcnt vmcnt(16)
    v_mfma_f32_32x32x16_bf16 v[52:67], a[200:203], v[136:139], v[52:67]
    s_mul_i32 s77, s48, 28672
    s_add_u32 s77, s77, s73
    s_add_u32 s77, s77, 42467328
    s_lshl_b32 s78, s48, 8
    s_add_u32 s78, s78, 42729472
    v_mfma_f32_32x32x16_bf16 v[68:83], a[204:207], v[136:139], v[68:83]
    buffer_load_dwordx4 v[132:135], v13, s[36:39], s91 offen offset:0 sc1
    s_cmp_eq_u32 s59, 2146435072
    s_cselect_b32 s77, 2146435072, s77
    s_cselect_b32 s78, 2146435072, s78
    s_lshr_b32 s73, s74, 1
    s_waitcnt vmcnt(15)
    v_mfma_f32_32x32x16_bf16 v[52:67], a[208:211], v[140:143], v[52:67]
    s_add_u32 s73, s73, s21
    s_add_u32 s73, s73, 229376
    s_lshl_b32 s74, s54, 11
    s_add_u32 s73, s73, s74
    s_add_u32 s78, s78, s74
    v_mfma_f32_32x32x16_bf16 v[68:83], a[212:215], v[140:143], v[68:83]
    buffer_load_dwordx4 v[136:139], v13, s[36:39], s91 offen offset:1024 sc1
    s_cmp_eq_u32 s75, 0
    s_cselect_b32 s73, s73, 2146435072
    s_cselect_b32 s78, 2146435072, s78
    s_lshl_b32 s74, s50, 8
    v_mfma_f32_32x32x16_bf16 v[52:67], a[216:219], v[144:147], v[52:67]
    s_add_u32 s74, s74, 153088
    v_lshl_add_u32 v49, v0, 2, s74
    v_xor_b32 v50, 256, v49
    v_mfma_f32_32x32x16_bf16 v[68:83], a[220:223], v[144:147], v[68:83]
    buffer_load_dwordx4 v[140:143], v13, s[36:39], s91 offen offset:2048 sc1
    s_waitcnt vmcnt(15)
    v_mfma_f32_32x32x16_bf16 v[52:67], a[224:227], v[148:151], v[52:67]
    s_waitcnt vmcnt(10)
    v_cmp_gt_u32 vcc, v4, v9
    s_nop 0
    s_and_b32 s6, vcc_lo, 0xff00000
    s_cbranch_scc1 Lps_192
Lpd_193:
    v_mfma_f32_32x32x16_bf16 v[68:83], a[228:231], v[148:151], v[68:83]
    buffer_load_dwordx4 v[144:147], v13, s[36:39], s91 offen offset:3072 sc1
    v_mfma_f32_32x32x16_bf16 v[52:67], a[232:235], v[152:155], v[52:67]
    v_mfma_f32_32x32x16_bf16 v[68:83], a[236:239], v[152:155], v[68:83]
    buffer_load_dwordx4 v[148:151], v13, s[36:39], s92 offen offset:0 sc1
    v_mfma_f32_32x32x16_bf16 v[52:67], a[240:243], v[156:159], v[52:67]
    v_mfma_f32_32x32x16_bf16 v[68:83], a[244:247], v[156:159], v[68:83]
    buffer_load_dwordx4 v[152:155], v12, s[36:39], s93 offen offset:0 sc1
    v_mfma_f32_32x32x16_bf16 v[52:67], a[248:251], v[160:163], v[52:67]
    v_mfma_f32_32x32x16_bf16 v[68:83], a[252:255], v[160:163], v[68:83]
    buffer_load_dwordx4 v[156:159], v12, s[36:39], s93 offen offset:1024 sc1
    s_waitcnt vmcnt(11)
    v_lshlrev_b32 v32, 16, v16
    v_and_b32 v33, 0xffff0000, v16
    v_lshlrev_b32 v34, 16, v17
    v_and_b32 v35, 0xffff0000, v17
    v_mfma_f32_32x32x16_bf16 v[52:67], v[176:179], v[164:167], v[52:67]
    buffer_load_dword v9, v6, s[36:39], 0 offen sc1
    v_lshlrev_b32 v36, 16, v18
    v_and_b32 v37, 0xffff0000, v18
    v_lshlrev_b32 v38, 16, v19
    v_and_b32 v39, 0xffff0000, v19
    s_waitcnt vmcnt(11)
    v_lshlrev_b32 v40, 16, v20
    v_and_b32 v41, 0xffff0000, v20
    v_mfma_f32_32x32x16_bf16 v[68:83], v[180:183], v[164:167], v[68:83]
    buffer_load_dwordx4 v[160:163], v12, s[36:39], s93 offen offset:2048 sc1
    v_lshlrev_b32 v42, 16, v21
    v_and_b32 v43, 0xffff0000, v21
    v_lshlrev_b32 v44, 16, v22
    v_and_b32 v45, 0xffff0000, v22
    v_mfma_f32_32x32x16_bf16 v[52:67], v[184:187], v[168:171], v[52:67]
    v_lshlrev_b32 v46, 16, v23
    v_and_b32 v47, 0xffff0000, v23
    s_lshl2_add_u32 s80, s52, s50
    s_mul_i32 s80, s80, 28672
    s_add_u32 s80, s80, s21
    s_lshl4_add_u32 s8, s22, s80
    s_lshl4_add_u32 s9, s23, s80
    v_mfma_f32_32x32x16_bf16 v[68:83], v[188:191], v[168:171], v[68:83]
    buffer_load_dwordx4 v[164:167], v12, s[36:39], s93 offen offset:3072 sc1
    s_lshl4_add_u32 s10, s24, s80
    s_lshl4_add_u32 s11, s25, s80
    s_lshl4_add_u32 s12, s26, s80
    s_lshl4_add_u32 s13, s27, s80
    s_waitcnt vmcnt(12)
    v_mfma_f32_32x32x16_bf16 v[84:99], a[176:179], v[116:119], v[84:99]
    s_lshl4_add_u32 s14, s28, s80
    s_lshl_b32 s80, s52, 10
    s_add_u32 s80, s80, s21
    s_add_u32 s80, s80, 229248
    s_lshl_b32 s82, s48, 8
    s_add_u32 s82, s82, 42729344
    v_mfma_f32_32x32x16_bf16 v[100:115], a[180:183], v[116:119], v[100:115]
    buffer_load_dwordx4 v[168:171], v12, s[36:39], s94 offen offset:0 sc1
    s_add_u32 s81, s80, 128
    s_cmp_eq_u32 s48, 0
    s_cselect_b32 s82, s81, s82
    s_lshl_b32 s81, s50, 9
    v_mfma_f32_32x32x16_bf16 v[84:99], a[184:187], v[120:123], v[84:99]
    s_add_u32 s80, s80, s81
    s_add_u32 s81, s50, s52
    s_cmp_eq_u32 s81, 0
    s_cselect_b32 s82, s82, s80
    v_lshl_add_u32 v15, v0, 3, s82
    v_lshl_add_u32 v14, v0, 3, s80
    v_mfma_f32_32x32x16_bf16 v[100:115], a[188:191], v[120:123], v[100:115]
    buffer_load_dwordx4 v[116:119], v12, s[36:39], s94 offen offset:1024 sc1
    v_cmp_gt_u32 vcc, 16, v0
    s_lshl_b32 s80, s50, 6
    s_nop 0
    v_cndmask_b32 v14, v14, v15, vcc
    v_add_u32 v15, s80, v0
    s_waitcnt vmcnt(12)
    v_mfma_f32_32x32x16_bf16 v[84:99], a[192:195], v[124:127], v[84:99]
    buffer_load_dwordx4 v[120:123], v12, s[36:39], s94 offen offset:2048 sc1
    v_cmp_gt_u32 vcc, 144, v15
    v_mov_b32 v48, 2146435072
    s_nop 0
    v_cndmask_b32 v14, v48, v14, vcc
    v_mfma_f32_32x32x16_bf16 v[100:115], a[196:199], v[124:127], v[100:115]
    v_lshlrev_b32 v15, 2, v15
    v_add_u32 v15, 159232, v15
    s_add_u32 s46, s50, s57
    s_cmp_eq_u32 s46, 0
    s_cselect_b32 s46, 256, 0
    s_mov_b32 s47, 159232
    s_lshl_b32 s80, s54, 7
    v_mfma_f32_32x32x16_bf16 v[84:99], a[200:203], v[128:131], v[84:99]
    buffer_load_dwordx4 v[124:127], v12, s[36:39], s94 offen offset:3072 sc1
    s_mul_i32 s81, s50, 7168
    s_add_u32 s80, s80, s81
    s_cmp_lt_u32 s49, 28
    s_cselect_b32 s15, s80, 2146435072
    v_mfma_f32_32x32x16_bf16 v[100:115], a[204:207], v[128:131], v[100:115]
    buffer_load_dwordx4 v[128:131], v13, s[36:39], s92 offen offset:1024 sc1
    s_waitcnt vmcnt(13)
    v_mfma_f32_32x32x16_bf16 v[84:99], a[208:211], v[132:135], v[84:99]
    v_mfma_f32_32x32x16_bf16 v[100:115], a[212:215], v[132:135], v[100:115]
    buffer_load_dwordx4 v[132:135], v13, s[36:39], s92 offen offset:2048 sc1
    v_mfma_f32_32x32x16_bf16 v[84:99], a[216:219], v[136:139], v[84:99]
    v_mfma_f32_32x32x16_bf16 v[100:115], a[220:223], v[136:139], v[100:115]
    buffer_load_dwordx4 v[136:139], v13, s[36:39], s92 offen offset:3072 sc1
    s_waitcnt vmcnt(13)
    v_mfma_f32_32x32x16_bf16 v[84:99], a[224:227], v[140:143], v[84:99]
    s_waitcnt vmcnt(9)
    v_cmp_gt_u32 vcc, 7, v9
    s_nop 0
    s_and_b32 s6, vcc_lo, 0xff00000
    s_cbranch_scc1 Lps_195
Lpd_196:
    v_mfma_f32_32x32x16_bf16 v[100:115], a[228:231], v[140:143], v[100:115]
    buffer_load_dwordx4 v[140:143], v13, s[36:39], s93 offen offset:0 sc1
    v_mfma_f32_32x32x16_bf16 v[84:99], a[232:235], v[144:147], v[84:99]
    s_mul_i32 s80, s52, 100352
    s_add_u32 s80, s80, s21
    s_mul_i32 s44, s48, 28672
    s_add_u32 s44, s44, 42452992
    s_cmp_eq_u32 s48, 0
    s_cselect_b32 s81, 1, s52
    v_mfma_f32_32x32x16_bf16 v[100:115], a[236:239], v[144:147], v[100:115]
    buffer_load_dwordx4 v[144:147], v13, s[36:39], s93 offen offset:1024 sc1
    s_cmp_eq_u32 s81, 0
    s_cselect_b32 s44, s44, s80
    v_mov_b32 v6, v14
    s_and_b32 s81, s50, 1
    v_mfma_f32_32x32x16_bf16 v[84:99], a[240:243], v[148:151], v[84:99]
    s_lshl_b32 s81, s81, 10
    s_add_u32 s44, s44, s81
    s_cmp_lt_u32 s50, 2
    s_cselect_b32 s80, s22, s23
    s_lshl4_add_u32 s40, s80, s44
    s_cmp_lt_u32 s50, 2
    s_cselect_b32 s80, s24, s25
    v_mfma_f32_32x32x16_bf16 v[100:115], a[244:247], v[148:151], v[100:115]
    buffer_load_dwordx4 v[148:151], v13, s[36:39], s93 offen offset:2048 sc1
    s_lshl4_add_u32 s41, s80, s44
    s_cmp_lt_u32 s50, 2
    s_cselect_b32 s80, s26, s27
    s_lshl4_add_u32 s42, s80, s44
    v_mfma_f32_32x32x16_bf16 v[52:67], v[192:195], v[152:155], v[52:67]
    s_cmp_lt_u32 s50, 2
    s_cselect_b32 s80, s28, s28
    s_lshl4_add_u32 s43, s80, s44
    s_add_u32 s44, s81, 144896
    s_lshl_b32 s45, s50, 10
    s_add_u32 s45, s45, 132608
    s_sub_u32 s30, s45, 40960
    v_mfma_f32_32x32x16_bf16 v[68:83], v[196:199], v[152:155], v[68:83]
    buffer_load_dwordx4 v[152:155], v13, s[36:39], s93 offen offset:3072 sc1
    s_waitcnt vmcnt(12)
    v_mfma_f32_32x32x16_bf16 v[52:67], v[200:203], v[156:159], v[52:67]
    s_add_u32 s55, s21, 245760
    s_add_u32 s20, s20, 8388608
    s_sub_u32 s5, s21, 409600
    s_cmp_eq_u32 s4, 0
    s_cselect_b32 s20, s5, s20
    s_and_b32 s80, s50, 1
    v_mfma_f32_32x32x16_bf16 v[68:83], v[204:207], v[156:159], v[68:83]
    buffer_load_dwordx4 v[156:159], v13, s[36:39], s94 offen offset:0 sc1
    s_lshr_b32 s81, s50, 1
    v_lshrrev_b32 v48, 2, v3
    v_lshlrev_b32 v9, 6, v48
    v_and_b32 v48, 3, v3
    v_mfma_f32_32x32x16_bf16 v[52:67], v[208:211], v[160:163], v[52:67]
    v_lshl_add_u32 v9, v48, 3, v9
    v_lshrrev_b32 v48, 1, v2
    v_lshl_add_u32 v8, v48, 8, v9
    v_xor_b32 v48, v48, v2
    v_and_b32 v48, 1, v48
    v_lshl_add_u32 v8, v48, 5, v8
    v_lshl_add_u32 v10, v2, 8, v9
    v_mfma_f32_32x32x16_bf16 v[68:83], v[212:215], v[160:163], v[68:83]
    buffer_load_dwordx4 v[160:163], v13, s[36:39], s94 offen offset:1024 sc1
    v_xor_b32 v48, s80, v2
    v_and_b32 v48, 1, v48
    v_lshl_add_u32 v10, v48, 5, v10
    v_add_u32 v9, 43008, v8
    s_waitcnt vmcnt(12)
    v_mfma_f32_32x32x16_bf16 v[52:67], v[216:219], v[164:167], v[52:67]
    s_lshl_b32 s82, s81, 10
    v_add_u32 v10, s82, v10
    v_add_u32 v11, 43008, v10
    v_and_b32 v48, 4, v3
    v_lshlrev_b32 v4, 7, v48
    v_lshl_add_u32 v4, v2, 6, v4
    v_mfma_f32_32x32x16_bf16 v[68:83], v[220:223], v[164:167], v[68:83]
    buffer_load_dwordx4 v[164:167], v13, s[36:39], s94 offen offset:2048 sc1
    v_and_b32 v48, 8, v3
    v_add_u32 v4, v4, v48
    v_and_b32 v48, 3, v3
    v_lshl_add_u32 v4, v48, 1, v4
    v_mfma_f32_32x32x16_bf16 v[52:67], v[224:227], v[168:171], v[52:67]
    s_mul_i32 s83, s81, 12288
    s_lshl_b32 s82, s80, 8
    s_sub_u32 s82, s82, s83
    s_add_u32 s82, s82, 162304
    v_add_u32 v4, s82, v4
    s_lshl_b32 s82, s80, 9
    s_add_u32 s83, s82, s83
    v_mfma_f32_32x32x16_bf16 v[68:83], v[228:231], v[168:171], v[68:83]
    buffer_load_dwordx4 v[168:171], v13, s[36:39], s94 offen offset:3072 sc1
    s_add_u32 s83, s83, 148992
    s_lshl_b32 s82, s50, 11
    s_add_u32 s82, s82, 148992
    s_waitcnt vmcnt(12)
    v_mfma_f32_32x32x16_bf16 v[52:67], v[232:235], v[116:119], v[52:67]
    v_mfma_f32_32x32x16_bf16 v[68:83], v[236:239], v[116:119], v[68:83]
    v_mfma_f32_32x32x16_bf16 v[52:67], v[240:243], v[120:123], v[52:67]
    v_mfma_f32_32x32x16_bf16 v[68:83], v[244:247], v[120:123], v[68:83]
    s_waitcnt vmcnt(9)
    v_mfma_f32_32x32x16_bf16 v[52:67], v[248:251], v[124:127], v[52:67]
    v_mfma_f32_32x32x16_bf16 v[68:83], v[252:255], v[124:127], v[68:83]
    v_mfma_f32_32x32x16_bf16 v[84:99], a[248:251], v[128:131], v[84:99]
    v_mfma_f32_32x32x16_bf16 v[84:99], v[176:179], v[132:135], v[84:99]
    s_nop 8
    ds_write_b128 v27, v[52:55] offset:0
    s_waitcnt vmcnt(7)
    v_mfma_f32_32x32x16_bf16 v[84:99], v[184:187], v[136:139], v[84:99]
    ds_write_b128 v27, v[56:59] offset:1024
    v_mfma_f32_32x32x16_bf16 v[84:99], v[192:195], v[140:143], v[84:99]
    ds_write_b128 v27, v[60:63] offset:2048
    s_waitcnt vmcnt(6)
    v_mfma_f32_32x32x16_bf16 v[84:99], v[200:203], v[144:147], v[84:99]
    ds_write_b128 v27, v[64:67] offset:3072
    s_waitcnt vmcnt(5)
    v_mfma_f32_32x32x16_bf16 v[84:99], v[208:211], v[148:151], v[84:99]
    s_waitcnt vmcnt(4)
    v_mfma_f32_32x32x16_bf16 v[84:99], v[216:219], v[152:155], v[84:99]
    ds_write_b128 v28, v[68:71] offset:0
    s_waitcnt vmcnt(3)
    v_mfma_f32_32x32x16_bf16 v[84:99], v[224:227], v[156:159], v[84:99]
    ds_write_b128 v28, v[72:75] offset:1024
    s_waitcnt vmcnt(2)
    v_mfma_f32_32x32x16_bf16 v[84:99], v[232:235], v[160:163], v[84:99]
    ds_write_b128 v28, v[76:79] offset:2048
    s_waitcnt vmcnt(1)
    v_mfma_f32_32x32x16_bf16 v[84:99], v[240:243], v[164:167], v[84:99]
    ds_write_b128 v28, v[80:83] offset:3072
    s_waitcnt vmcnt(0)
    v_mfma_f32_32x32x16_bf16 v[84:99], v[248:251], v[168:171], v[84:99]
    v_mfma_f32_32x32x16_bf16 v[100:115], a[252:255], v[128:131], v[100:115]
    v_mfma_f32_32x32x16_bf16 v[100:115], v[180:183], v[132:135], v[100:115]
    s_waitcnt lgkmcnt(0)
    s_barrier
    s_nop 7
    ds_write_b128 v29, v[84:87] offset:0
    ds_read_b128 v[52:55], v30 offset:0
    ds_read_b128 v[56:59], v30 offset:1024
    v_mfma_f32_32x32x16_bf16 v[100:115], v[188:191], v[136:139], v[100:115]
    ds_write_b128 v29, v[88:91] offset:1024
    ds_read_b128 v[60:63], v30 offset:2048
    ds_read_b128 v[64:67], v30 offset:3072
    ds_read_b128 v[68:71], v30 offset:4096
    ds_read_b128 v[72:75], v30 offset:5120
    v_mfma_f32_32x32x16_bf16 v[100:115], v[196:199], v[140:143], v[100:115]
    ds_write_b128 v29, v[92:95] offset:2048
    ds_read_b128 v[76:79], v30 offset:6144
    ds_read_b128 v[80:83], v30 offset:7168
    v_mfma_f32_32x32x16_bf16 v[100:115], v[204:207], v[144:147], v[100:115]
    ds_write_b128 v29, v[96:99] offset:3072
    v_mfma_f32_32x32x16_bf16 v[100:115], v[212:215], v[148:151], v[100:115]
    s_waitcnt lgkmcnt(10)
    v_fmac_f32 v32, v52, v24
    v_fmac_f32 v33, v53, v24
    v_fmac_f32 v34, v54, v24
    v_fmac_f32 v35, v55, v24
    s_waitcnt lgkmcnt(9)
    v_fmac_f32 v36, v56, v24
    v_fmac_f32 v37, v57, v24
    v_fmac_f32 v38, v58, v24
    v_mfma_f32_32x32x16_bf16 v[100:115], v[220:223], v[152:155], v[100:115]
    s_waitcnt lgkmcnt(0)
    s_barrier
    ds_read_b128 v[84:87], v30 offset:8192
    ds_read_b128 v[88:91], v30 offset:9216
    ds_read_b128 v[92:95], v30 offset:10240
    ds_read_b128 v[96:99], v30 offset:11264
    v_fmac_f32 v39, v59, v24
    v_mfma_f32_32x32x16_bf16 v[100:115], v[228:231], v[156:159], v[100:115]
    v_fmac_f32 v40, v60, v24
    v_fmac_f32 v41, v61, v24
    v_fmac_f32 v42, v62, v24
    v_fmac_f32 v43, v63, v24
    v_fmac_f32 v44, v64, v24
    v_fmac_f32 v45, v65, v24
    v_fmac_f32 v46, v66, v24
    v_mfma_f32_32x32x16_bf16 v[100:115], v[236:239], v[160:163], v[100:115]
    v_fmac_f32 v47, v67, v24
    v_fmac_f32 v32, v68, v24
    v_fmac_f32 v33, v69, v24
    v_fmac_f32 v34, v70, v24
    v_fmac_f32 v35, v71, v24
    v_fmac_f32 v36, v72, v24
    v_fmac_f32 v37, v73, v24
    v_mfma_f32_32x32x16_bf16 v[100:115], v[244:247], v[164:167], v[100:115]
    v_fmac_f32 v38, v74, v24
    v_fmac_f32 v39, v75, v24
    v_fmac_f32 v40, v76, v24
    v_fmac_f32 v41, v77, v24
    v_fmac_f32 v42, v78, v24
    v_fmac_f32 v43, v79, v24
    v_fmac_f32 v44, v80, v24
    v_mfma_f32_32x32x16_bf16 v[100:115], v[252:255], v[168:171], v[100:115]
    v_fmac_f32 v45, v81, v24
    v_fmac_f32 v46, v82, v24
    v_fmac_f32 v47, v83, v24
    s_waitcnt lgkmcnt(3)
    v_fmac_f32 v32, v84, v24
    v_fmac_f32 v33, v85, v24
    v_fmac_f32 v34, v86, v24
    v_fmac_f32 v35, v87, v24
    s_waitcnt lgkmcnt(2)
    v_fmac_f32 v36, v88, v24
    v_fmac_f32 v37, v89, v24
    v_fmac_f32 v38, v90, v24
    v_fmac_f32 v39, v91, v24
    s_waitcnt lgkmcnt(1)
    v_fmac_f32 v40, v92, v24
    v_fmac_f32 v41, v93, v24
    v_fmac_f32 v42, v94, v24
    v_fmac_f32 v43, v95, v24
    s_waitcnt lgkmcnt(0)
    v_fmac_f32 v44, v96, v24
    v_fmac_f32 v45, v97, v24
    v_fmac_f32 v46, v98, v24
    v_fmac_f32 v47, v99, v24
    v_pk_fma_f32 v[100:101], v[100:101], v[24:25], v[32:33] op_sel_hi:[1,0,1]
    v_pk_fma_f32 v[102:103], v[102:103], v[24:25], v[34:35] op_sel_hi:[1,0,1]
    v_pk_fma_f32 v[104:105], v[104:105], v[24:25], v[36:37] op_sel_hi:[1,0,1]
    v_pk_fma_f32 v[106:107], v[106:107], v[24:25], v[38:39] op_sel_hi:[1,0,1]
    v_pk_fma_f32 v[108:109], v[108:109], v[24:25], v[40:41] op_sel_hi:[1,0,1]
    v_pk_fma_f32 v[110:111], v[110:111], v[24:25], v[42:43] op_sel_hi:[1,0,1]
    v_pk_fma_f32 v[112:113], v[112:113], v[24:25], v[44:45] op_sel_hi:[1,0,1]
    v_pk_fma_f32 v[114:115], v[114:115], v[24:25], v[46:47] op_sel_hi:[1,0,1]
    v_cvt_pk_bf16_f32 v140, v100, v101
    v_cvt_pk_bf16_f32 v141, v102, v103
    v_cvt_pk_bf16_f32 v142, v104, v105
    v_cvt_pk_bf16_f32 v143, v106, v107
    v_cvt_pk_bf16_f32 v144, v108, v109
    v_cvt_pk_bf16_f32 v145, v110, v111
    v_cvt_pk_bf16_f32 v146, v112, v113
    v_cvt_pk_bf16_f32 v147, v114, v115
    s_cmp_eq_u32 s4, 0
    s_cbranch_scc0 Lslow_198
    buffer_store_dwordx4 v[140:143], v5, s[36:39], s72 offen
    buffer_store_dwordx4 v[144:147], v5, s[36:39], s72 offen offset:512
Lsdone_199:
    v_dot2_f32_bf16 v60, v140, s79, 0
    v_dot2_f32_bf16 v62, v140, v140, 0
    v_dot2_f32_bf16 v61, v141, s79, 0
    v_dot2_f32_bf16 v63, v141, v141, 0
    v_dot2_f32_bf16 v60, v142, s79, v60
    v_dot2_f32_bf16 v62, v142, v142, v62
    v_dot2_f32_bf16 v61, v143, s79, v61
    v_dot2_f32_bf16 v63, v143, v143, v63
    v_dot2_f32_bf16 v60, v144, s79, v60
    v_dot2_f32_bf16 v62, v144, v144, v62
    v_dot2_f32_bf16 v61, v145, s79, v61
    v_dot2_f32_bf16 v63, v145, v145, v63
    v_dot2_f32_bf16 v60, v146, s79, v60
    v_dot2_f32_bf16 v62, v146, v146, v62
    v_dot2_f32_bf16 v61, v147, s79, v61
    v_dot2_f32_bf16 v63, v147, v147, v63
    s_nop 1
    v_add_f32 v60, v60, v61
    v_add_f32 v62, v62, v63
    s_nop 1
    v_permlane32_swap_b32 v60, v62
    v_add_f32 v60, v60, v62
    ds_write_b32 v49, v60
    s_waitcnt lgkmcnt(0)
    s_barrier
    ds_read_b32 v61, v50
    s_waitcnt lgkmcnt(0)
    v_add_f32 v139, v60, v61
    s_cmp_eq_u32 s4, 0
    s_cbranch_scc0 Lslow_200
    buffer_store_dword v139, v26, s[36:39], s73 offen
Lsdone_201:
Lp1pre:
    s_cmp_eq_u32 s4, 0
    s_cbranch_scc0 Lss_202
Lssd_204:
    buffer_load_dwordx4 v[100:103], v5, s[36:39], s8 offen offset:0 sc1
    buffer_load_dwordx4 v[104:107], v5, s[36:39], s8 offen offset:512 sc1
    buffer_load_dwordx4 v[108:111], v5, s[36:39], s8 offen offset:1024 sc1
    buffer_load_dwordx4 v[112:115], v5, s[36:39], s8 offen offset:1536 sc1
    ds_read_b64_tr_b16 v[68:69], v8 offset:3072
    ds_read_b64_tr_b16 v[70:71], v8 offset:2048
    ds_read_b64_tr_b16 v[72:73], v8 offset:0
    ds_read_b64_tr_b16 v[74:75], v8 offset:4096
    ds_read_b64_tr_b16 v[76:77], v8 offset:1024
    ds_read_b64_tr_b16 v[78:79], v8 offset:5120
    ds_read_b64_tr_b16 v[80:81], v8 offset:3584
    ds_read_b64_tr_b16 v[82:83], v8 offset:2560
    ds_read_b64_tr_b16 v[84:85], v8 offset:512
    ds_read_b64_tr_b16 v[86:87], v8 offset:4608
    ds_read_b64_tr_b16 v[88:89], v8 offset:1536
    ds_read_b64_tr_b16 v[90:91], v8 offset:5632
    ds_read_b64_tr_b16 v[92:93], v8 offset:9216
    ds_read_b64_tr_b16 v[94:95], v8 offset:8192
    ds_read_b64_tr_b16 v[96:97], v8 offset:6144
    ds_read_b64_tr_b16 v[98:99], v8 offset:10240
    s_lshl_b32 s72, s50, 7
    s_add_u32 s72, s72, 159296
    v_and_b32 v171, 31, v0
    v_lshl_add_u32 v168, v171, 2, s72
    v_lshrrev_b32 v170, 3, v0
    v_and_b32 v170, 4, v170
    v_sub_u32 v171, v171, v170
    v_lshlrev_b32 v169, 4, v171
    v_add_u32 v169, 87680, v169
    v_lshlrev_b32 v171, 2, v171
    v_subrev_u32 v170, 8, v171
    v_and_b32 v171, 56, v171
    v_and_b32 v170, 56, v170
    v_xor_b32 v162, 32, v171
    v_xor_b32 v163, 32, v170
    v_sub_u32 v164, v168, v171
    v_sub_u32 v165, v168, v170
    v_sub_u32 v166, v168, v162
    v_sub_u32 v167, v168, v163
    buffer_load_dwordx4 v[116:119], v5, s[36:39], s9 offen offset:0 sc1
    buffer_load_dwordx4 v[120:123], v5, s[36:39], s9 offen offset:512 sc1
    buffer_load_dwordx4 v[124:127], v5, s[36:39], s9 offen offset:1024 sc1
    buffer_load_dwordx4 v[128:131], v5, s[36:39], s9 offen offset:1536 sc1
    buffer_store_dword v139, v26, s[36:39], s78 offen sc1
    s_mov_b32 exec_lo, 0xffff0000
    s_mov_b32 exec_hi, 0xffff0000
    buffer_store_dwordx4 v[140:143], v5, s[36:39], s77 offen sc1
    buffer_store_dwordx4 v[144:147], v5, s[36:39], s77 offen offset:512 sc1
    s_mov_b64 exec, -1
    v_lshlrev_b32 v170, 2, v0
    v_add_u32 v170, 86016, v170
    s_lshr_b32 s72, s50, 1
    s_lshl_b32 s72, s72, 2
    s_and_b32 s73, s50, 1
    s_add_u32 s72, s72, s73
    s_lshl_b32 s72, s72, 6
    s_add_u32 s72, s72, 86272
    v_and_b32 v171, 1, v2
    v_lshl_add_u32 v171, v171, 5, v3
    v_lshl_add_u32 v171, v171, 2, s72
    s_waitcnt vmcnt(9)
    v_max_u32 v7, v100, v104
    v_cmp_eq_u32 vcc, -1, v7
    s_nop 0
    s_cbranch_vccnz Lsc_205
Lscd_207:
    s_waitcnt lgkmcnt(12)
    v_mfma_f32_32x32x16_bf16 v[16:31], v[68:71], v[100:103], 0
    ds_read_b64_tr_b16 v[68:69], v8 offset:7168
    ds_read_b64_tr_b16 v[70:71], v8 offset:11264
    s_mov_b32 s90, 0
    s_mov_b32 s91, -1
    v_mov_b32 v156, v15
    v_lshl_add_u32 v158, v3, 2, s47
    v_mfma_f32_32x32x16_bf16 v[32:47], v[72:75], v[100:103], 0
    ds_read_b64_tr_b16 v[72:73], v8 offset:9728
    ds_read_b64_tr_b16 v[74:75], v8 offset:8704
    buffer_load_dwordx4 v[132:135], v5, s[36:39], s10 offen offset:0 sc1
    v_add_u32 v159, s46, v169
    v_add_u32 v14, s82, v1
    s_waitcnt lgkmcnt(12)
    v_mfma_f32_32x32x16_bf16 v[48:63], v[100:103], v[76:79], 0
    ds_read_b64_tr_b16 v[76:77], v8 offset:6656
    ds_read_b64_tr_b16 v[78:79], v8 offset:10752
    buffer_load_dwordx4 v[136:139], v5, s[36:39], s10 offen offset:512 sc1
    v_lshrrev_b32 v12, 1, v2
    v_mfma_f32_32x32x16_bf16 v[16:31], v[80:83], v[104:107], v[16:31]
    ds_read_b64_tr_b16 v[80:81], v8 offset:7680
    ds_read_b64_tr_b16 v[82:83], v8 offset:11776
    buffer_load_dwordx4 v[140:143], v5, s[36:39], s10 offen offset:1024 sc1
    v_lshlrev_b32 v15, 4, v3
    v_lshl_add_u32 v13, v12, 8, v15
    s_waitcnt lgkmcnt(12)
    v_mfma_f32_32x32x16_bf16 v[32:47], v[84:87], v[104:107], v[32:47]
    s_waitcnt vmcnt(10)
    v_max_u32 v7, v108, v112
    v_cmp_eq_u32 vcc, -1, v7
    ds_read_b64_tr_b16 v[84:85], v8 offset:15360
    ds_read_b64_tr_b16 v[86:87], v8 offset:14336
    buffer_load_dwordx4 v[144:147], v5, s[36:39], s10 offen offset:1536 sc1
    v_mfma_f32_32x32x16_bf16 v[48:63], v[104:107], v[88:91], v[48:63]
    s_cbranch_vccnz Lsc_216
Lscd_218:
    ds_read_b64_tr_b16 v[88:89], v8 offset:12288
    ds_read_b64_tr_b16 v[90:91], v8 offset:16384
    v_add_u32 v13, s82, v13
    v_lshl_add_u32 v15, v12, 3, v15
    v_and_b32 v12, 1, v2
    v_lshl_add_u32 v15, v12, 8, v15
    s_waitcnt lgkmcnt(12)
    v_mfma_f32_32x32x16_bf16 v[16:31], v[92:95], v[108:111], v[16:31]
    ds_read_b64_tr_b16 v[92:93], v8 offset:13312
    ds_read_b64_tr_b16 v[94:95], v8 offset:17408
    buffer_load_dwordx4 v[100:103], v5, s[36:39], s11 offen offset:0 sc1
    v_add_u32 v15, s83, v15
    v_mfma_f32_32x32x16_bf16 v[32:47], v[96:99], v[108:111], v[32:47]
    ds_read_b64_tr_b16 v[96:97], v8 offset:15872
    ds_read_b64_tr_b16 v[98:99], v8 offset:14848
    buffer_load_dwordx4 v[104:107], v5, s[36:39], s11 offen offset:512 sc1
    v_add_u32 v12, 132608, v1
    v_lshrrev_b32 v157, 3, v0
    s_waitcnt lgkmcnt(12)
    v_mfma_f32_32x32x16_bf16 v[48:63], v[108:111], v[68:71], v[48:63]
    ds_read_b64_tr_b16 v[68:69], v8 offset:12800
    ds_read_b64_tr_b16 v[70:71], v8 offset:16896
    buffer_load_dwordx4 v[108:111], v5, s[36:39], s11 offen offset:1024 sc1
    v_and_b32 v162, 6, v157
    v_mfma_f32_32x32x16_bf16 v[16:31], v[72:75], v[112:115], v[16:31]
    ds_read_b64_tr_b16 v[72:73], v8 offset:13824
    ds_read_b64_tr_b16 v[74:75], v8 offset:17920
    v_and_b32 v163, 7, v0
    v_xor_b32 v162, v162, v163
    v_mul_u32_u24 v157, 896, v157
    v_lshl_add_u32 v157, v162, 4, v157
    v_add_u32 v157, s15, v157
    s_waitcnt lgkmcnt(12)
    v_mfma_f32_32x32x16_bf16 v[32:47], v[76:79], v[112:115], v[32:47]
    s_waitcnt vmcnt(11)
    v_max3_u32 v7, v116, v120, v124
    s_waitcnt vmcnt(10)
    v_max_u32 v7, v7, v128
    v_cmp_eq_u32 vcc, -1, v7
    ds_read_b64_tr_b16 v[76:77], v8 offset:21504
    v_mfma_f32_32x32x16_bf16 v[48:63], v[112:115], v[80:83], v[48:63]
    s_cbranch_vccnz Lsc_229
Lscd_231:
    ds_read_b64_tr_b16 v[78:79], v8 offset:20480
    ds_read_b64_tr_b16 v[80:81], v8 offset:18432
    ds_read_b64_tr_b16 v[82:83], v8 offset:22528
    buffer_load_dwordx4 v[112:115], v5, s[36:39], s11 offen offset:1536 sc1
    s_waitcnt lgkmcnt(12)
    v_mfma_f32_32x32x16_bf16 v[16:31], v[84:87], v[116:119], v[16:31]
    ds_read_b64_tr_b16 v[84:85], v8 offset:19456
    ds_read_b64_tr_b16 v[86:87], v8 offset:23552
    v_mfma_f32_32x32x16_bf16 v[32:47], v[88:91], v[116:119], v[32:47]
    ds_read_b64_tr_b16 v[88:89], v8 offset:22016
    ds_read_b64_tr_b16 v[90:91], v8 offset:20992
    s_waitcnt lgkmcnt(12)
    v_mfma_f32_32x32x16_bf16 v[48:63], v[116:119], v[92:95], v[48:63]
    ds_read_b64_tr_b16 v[92:93], v8 offset:18944
    ds_read_b64_tr_b16 v[94:95], v8 offset:23040
    v_mfma_f32_32x32x16_bf16 v[16:31], v[96:99], v[120:123], v[16:31]
    ds_read_b64_tr_b16 v[96:97], v8 offset:19968
    ds_read_b64_tr_b16 v[98:99], v8 offset:24064
    buffer_load_dwordx2 v[148:149], v6, s[36:39], 0 offen offset:0 sc1
    s_waitcnt lgkmcnt(12)
    v_mfma_f32_32x32x16_bf16 v[32:47], v[68:71], v[120:123], v[32:47]
    ds_read_b64_tr_b16 v[68:69], v8 offset:27648
    ds_read_b64_tr_b16 v[70:71], v8 offset:26624
    buffer_load_dwordx2 v[150:151], v6, s[36:39], 0 offen offset:2048 sc1
    v_mfma_f32_32x32x16_bf16 v[48:63], v[120:123], v[72:75], v[48:63]
    ds_read_b64_tr_b16 v[72:73], v8 offset:24576
    ds_read_b64_tr_b16 v[74:75], v8 offset:28672
    buffer_load_dwordx4 v[116:119], v5, s[36:39], s12 offen offset:0 sc1
    s_waitcnt lgkmcnt(12)
    v_mfma_f32_32x32x16_bf16 v[16:31], v[76:79], v[124:127], v[16:31]
    ds_read_b64_tr_b16 v[76:77], v8 offset:25600
    ds_read_b64_tr_b16 v[78:79], v8 offset:29696
    s_mov_b32 s5, 4096
    buffer_load_dwordx2 v[152:153], v6, s[36:39], s5 offen offset:0 sc1
    v_mfma_f32_32x32x16_bf16 v[32:47], v[80:83], v[124:127], v[32:47]
    ds_read_b64_tr_b16 v[80:81], v8 offset:28160
    ds_read_b64_tr_b16 v[82:83], v8 offset:27136
    s_mov_b32 s5, 4096
    buffer_load_dwordx2 v[154:155], v6, s[36:39], s5 offen offset:2048 sc1
    s_waitcnt lgkmcnt(12)
    v_mfma_f32_32x32x16_bf16 v[48:63], v[124:127], v[84:87], v[48:63]
    ds_read_b64_tr_b16 v[84:85], v8 offset:25088
    ds_read_b64_tr_b16 v[86:87], v8 offset:29184
    buffer_load_dwordx4 v[120:123], v5, s[36:39], s12 offen offset:512 sc1
    v_mfma_f32_32x32x16_bf16 v[16:31], v[88:91], v[128:131], v[16:31]
    ds_read_b64_tr_b16 v[88:89], v8 offset:26112
    ds_read_b64_tr_b16 v[90:91], v8 offset:30208
    s_mov_b32 s5, 8192
    buffer_load_dwordx2 v[160:161], v6, s[36:39], s5 offen offset:0 sc1
    s_waitcnt lgkmcnt(12)
    v_mfma_f32_32x32x16_bf16 v[32:47], v[92:95], v[128:131], v[32:47]
    s_waitcnt vmcnt(12)
    v_max3_u32 v7, v132, v136, v140
    s_waitcnt vmcnt(11)
    v_max_u32 v7, v7, v144
    v_cmp_eq_u32 vcc, -1, v7
    ds_read_b64_tr_b16 v[92:93], v8 offset:33792
    s_mov_b32 s5, 8192
    buffer_load_dwordx2 v[64:65], v6, s[36:39], s5 offen offset:2048 sc1
    v_mfma_f32_32x32x16_bf16 v[48:63], v[128:131], v[96:99], v[48:63]
    s_cbranch_vccnz Lsc_243
Lscd_245:
    ds_read_b64_tr_b16 v[94:95], v8 offset:32768
    ds_read_b64_tr_b16 v[96:97], v8 offset:30720
    ds_read_b64_tr_b16 v[98:99], v8 offset:34816
    s_mov_b32 s5, 12288
    buffer_load_dwordx2 v[66:67], v6, s[36:39], s5 offen offset:0 sc1
    s_waitcnt lgkmcnt(12)
    v_mfma_f32_32x32x16_bf16 v[16:31], v[68:71], v[132:135], v[16:31]
    ds_read_b64_tr_b16 v[68:69], v8 offset:31744
    ds_read_b64_tr_b16 v[70:71], v8 offset:35840
    buffer_load_dwordx4 v[124:127], v5, s[36:39], s12 offen offset:1024 sc1
    v_mfma_f32_32x32x16_bf16 v[32:47], v[72:75], v[132:135], v[32:47]
    ds_read_b64_tr_b16 v[72:73], v8 offset:34304
    ds_read_b64_tr_b16 v[74:75], v8 offset:33280
    buffer_load_dwordx4 v[128:131], v5, s[36:39], s12 offen offset:1536 sc1
    s_waitcnt lgkmcnt(12)
    v_mfma_f32_32x32x16_bf16 v[48:63], v[132:135], v[76:79], v[48:63]
    ds_read_b64_tr_b16 v[76:77], v8 offset:31232
    ds_read_b64_tr_b16 v[78:79], v8 offset:35328
    v_mfma_f32_32x32x16_bf16 v[16:31], v[80:83], v[136:139], v[16:31]
    ds_read_b64_tr_b16 v[80:81], v8 offset:32256
    ds_read_b64_tr_b16 v[82:83], v8 offset:36352
    s_add_u32 m0, s45, 0
    s_nop 0
    buffer_load_dwordx4 v1, s[36:39], s40 offen sc1 lds
    s_waitcnt lgkmcnt(12)
    v_mfma_f32_32x32x16_bf16 v[32:47], v[84:87], v[136:139], v[32:47]
    ds_read_b64_tr_b16 v[84:85], v8 offset:39936
    ds_read_b64_tr_b16 v[86:87], v8 offset:38912
    s_add_u32 m0, s45, 4096
    s_nop 0
    buffer_load_dwordx4 v1, s[36:39], s41 offen sc1 lds
    v_mfma_f32_32x32x16_bf16 v[48:63], v[136:139], v[88:91], v[48:63]
    ds_read_b64_tr_b16 v[88:89], v8 offset:36864
    ds_read_b64_tr_b16 v[90:91], v8 offset:40960
    s_add_u32 m0, s45, 8192
    s_nop 0
    buffer_load_dwordx4 v1, s[36:39], s42 offen sc1 lds
    s_waitcnt lgkmcnt(12)
    v_mfma_f32_32x32x16_bf16 v[16:31], v[92:95], v[140:143], v[16:31]
    ds_read_b64_tr_b16 v[92:93], v8 offset:37888
    ds_read_b64_tr_b16 v[94:95], v8 offset:41984
    s_mov_b32 m0, s44
    s_nop 0
    buffer_load_dwordx4 v1, s[36:39], s43 offen sc1 lds
    v_mfma_f32_32x32x16_bf16 v[32:47], v[96:99], v[140:143], v[32:47]
    ds_read_b64_tr_b16 v[96:97], v8 offset:40448
    ds_read_b64_tr_b16 v[98:99], v8 offset:39424
    s_waitcnt lgkmcnt(12)
    v_mfma_f32_32x32x16_bf16 v[48:63], v[140:143], v[68:71], v[48:63]
    ds_read_b64_tr_b16 v[68:69], v8 offset:37376
    ds_read_b64_tr_b16 v[70:71], v8 offset:41472
    buffer_load_dwordx4 v[132:135], v5, s[36:39], s13 offen offset:0 sc1
    v_mfma_f32_32x32x16_bf16 v[16:31], v[72:75], v[144:147], v[16:31]
    ds_read_b64_tr_b16 v[72:73], v8 offset:38400
    ds_read_b64_tr_b16 v[74:75], v8 offset:42496
    buffer_load_dwordx4 v[136:139], v5, s[36:39], s13 offen offset:512 sc1
    s_waitcnt vmcnt(15)
    v_add_f32 v148, v148, v150
    v_add_f32 v149, v149, v151
    s_waitcnt lgkmcnt(12)
    v_mfma_f32_32x32x16_bf16 v[32:47], v[76:79], v[144:147], v[32:47]
    v_max3_u32 v7, v100, v104, v108
    v_max_u32 v7, v7, v112
    v_cmp_eq_u32 vcc, -1, v7
    ds_read_b64_tr_b16 v[76:77], v9 offset:3072
    ds_read_b64_tr_b16 v[78:79], v9 offset:2048
    buffer_load_dwordx4 v[140:143], v5, s[36:39], s13 offen offset:1024 sc1
    v_mfma_f32_32x32x16_bf16 v[48:63], v[144:147], v[80:83], v[48:63]
    s_cbranch_vccnz Lsc_256
Lscd_258:
    ds_read_b64_tr_b16 v[80:81], v9 offset:0
    ds_read_b64_tr_b16 v[82:83], v9 offset:4096
    buffer_load_dwordx4 v[144:147], v5, s[36:39], s13 offen offset:1536 sc1
    s_waitcnt vmcnt(15)
    v_add_f32 v148, v148, v152
    s_waitcnt lgkmcnt(12)
    v_mfma_f32_32x32x16_bf16 v[16:31], v[84:87], v[100:103], v[16:31]
    ds_read_b64_tr_b16 v[84:85], v9 offset:1024
    ds_read_b64_tr_b16 v[86:87], v9 offset:5120
    v_add_f32 v149, v149, v153
    s_waitcnt vmcnt(14)
    v_add_f32 v148, v148, v154
    v_add_f32 v149, v149, v155
    s_waitcnt vmcnt(12)
    v_add_f32 v148, v148, v160
    v_mfma_f32_32x32x16_bf16 v[32:47], v[88:91], v[100:103], v[32:47]
    ds_read_b64_tr_b16 v[88:89], v9 offset:3584
    ds_read_b64_tr_b16 v[90:91], v9 offset:2560
    v_add_f32 v149, v149, v161
    s_waitcnt vmcnt(11)
    v_add_f32 v148, v148, v64
    v_add_f32 v149, v149, v65
    s_waitcnt vmcnt(10)
    v_add_f32 v148, v148, v66
    v_add_f32 v149, v149, v67
    s_waitcnt lgkmcnt(12)
    v_mfma_f32_32x32x16_bf16 v[48:63], v[100:103], v[92:95], v[48:63]
    ds_read_b64_tr_b16 v[92:93], v9 offset:512
    ds_read_b64_tr_b16 v[94:95], v9 offset:4608
    buffer_load_dwordx4 v[100:103], v5, s[36:39], s14 offen offset:0 sc1
    v_mfma_f32_32x32x16_bf16 v[16:31], v[96:99], v[104:107], v[16:31]
    ds_read_b64_tr_b16 v[96:97], v9 offset:1536
    ds_read_b64_tr_b16 v[98:99], v9 offset:5632
    v_cmp_u_f32 vcc, v148, v148
    s_nop 0
    s_cbranch_vccnz Lnc_270
Lncd_272:
    v_mul_f32 v148, 0xbb124925, v148
    v_mul_f32 v160, 0x3b124925, v149
    s_waitcnt lgkmcnt(12)
    v_mfma_f32_32x32x16_bf16 v[32:47], v[68:71], v[104:107], v[32:47]
    ds_read_b64_tr_b16 v[68:69], v9 offset:9216
    ds_read_b64_tr_b16 v[70:71], v9 offset:8192
    v_fma_f32 v160, -v148, v148, v160
    v_max_f32 v160, 0, v160
    v_mov_b32 v150, 0
    v_cvt_pk_bf16_f32 v148, v148, v148
    v_mfma_f32_32x32x16_bf16 v[48:63], v[104:107], v[72:75], v[48:63]
    ds_read_b64_tr_b16 v[72:73], v9 offset:6144
    ds_read_b64_tr_b16 v[74:75], v9 offset:10240
    buffer_load_dwordx4 v[104:107], v5, s[36:39], s14 offen offset:512 sc1
    v_cvt_pk_bf16_f32 v160, v160, v160
    v_mov_b32 v151, 0
    s_waitcnt lgkmcnt(12)
    v_mfma_f32_32x32x16_bf16 v[16:31], v[76:79], v[108:111], v[16:31]
    ds_read_b64_tr_b16 v[76:77], v9 offset:7168
    ds_read_b64_tr_b16 v[78:79], v9 offset:11264
    v_lshlrev_b32 v160, 16, v160
    v_add_f32 v160, 0x3727c5ac, v160
    v_mov_b32 v153, 0
    v_cvt_pk_bf16_f32 v160, v160, v160
    v_mfma_f32_32x32x16_bf16 v[32:47], v[80:83], v[108:111], v[32:47]
    ds_read_b64_tr_b16 v[80:81], v9 offset:9728
    ds_read_b64_tr_b16 v[82:83], v9 offset:8704
    s_add_u32 m0, s30, 0
    s_mov_b32 s5, 0
    buffer_load_dwordx4 v157, s[16:19], s5 offen lds
    s_waitcnt lgkmcnt(12)
    v_mfma_f32_32x32x16_bf16 v[48:63], v[108:111], v[84:87], v[48:63]
    ds_read_b64_tr_b16 v[84:85], v9 offset:6656
    ds_read_b64_tr_b16 v[86:87], v9 offset:10752
    v_lshlrev_b32 v160, 16, v160
    v_mov_b32 v154, 0
    v_sqrt_f32 v160, v160
    v_mfma_f32_32x32x16_bf16 v[16:31], v[88:91], v[112:115], v[16:31]
    s_waitcnt vmcnt(7)
    v_add_u32 v7, s45, v1
    ds_read_b32 v64, v7 offset:0
    ds_read_b32 v65, v7 offset:4096
    ds_read_b32 v66, v7 offset:8192
    v_add_u32 v7, s44, v1
    ds_read_b32 v67, v7
    s_add_u32 m0, s30, 4096
    s_mov_b32 s5, 28672
    buffer_load_dwordx4 v157, s[16:19], s5 offen lds
    s_waitcnt lgkmcnt(14)
    v_mfma_f32_32x32x16_bf16 v[32:47], v[92:95], v[112:115], v[32:47]
    v_max3_u32 v7, v116, v120, v124
    v_max_u32 v7, v7, v128
    v_cmp_eq_u32 vcc, -1, v7
    ds_read_b64_tr_b16 v[88:89], v9 offset:7680
    ds_read_b64_tr_b16 v[90:91], v9 offset:11776
    v_cvt_pk_bf16_f32 v160, v160, v160
    v_mfma_f32_32x32x16_bf16 v[48:63], v[112:115], v[96:99], v[48:63]
    s_cbranch_vccnz Lsc_273
Lscd_275:
    ds_read_b64_tr_b16 v[92:93], v9 offset:15360
    ds_read_b64_tr_b16 v[94:95], v9 offset:14336
    ds_read_b64_tr_b16 v[96:97], v9 offset:12288
    ds_read_b64_tr_b16 v[98:99], v9 offset:16384
    v_mov_b32 v155, 0
    s_waitcnt lgkmcnt(15)
    v_mfma_f32_32x32x16_bf16 v[16:31], v[68:71], v[116:119], v[16:31]
    ds_read_b64_tr_b16 v[68:69], v9 offset:13312
    ds_read_b64_tr_b16 v[70:71], v9 offset:17408
    buffer_load_dwordx4 v[108:111], v5, s[36:39], s14 offen offset:1024 sc1
    v_lshlrev_b32 v160, 16, v160
    v_mfma_f32_32x32x16_bf16 v[32:47], v[72:75], v[116:119], v[32:47]
    s_waitcnt lgkmcnt(9)
    v_max3_u32 v64, v64, v65, v66
    s_waitcnt lgkmcnt(8)
    v_max_u32 v64, v64, v67
    v_cmp_eq_u32 vcc, -1, v64
    s_nop 0
    s_cbranch_vccnz Lhc_286
Lhcd_288:
    v_mfma_f32_32x32x16_bf16 v[48:63], v[116:119], v[76:79], v[48:63]
    ds_read_b64_tr_b16 v[72:73], v9 offset:15872
    ds_read_b64_tr_b16 v[74:75], v9 offset:14848
    ds_read_b64_tr_b16 v[76:77], v9 offset:12800
    ds_read_b64_tr_b16 v[78:79], v9 offset:16896
    buffer_load_dwordx4 v[112:115], v5, s[36:39], s14 offen offset:1536 sc1
    v_mfma_f32_32x32x16_bf16 v[16:31], v[80:83], v[120:123], v[16:31]
    ds_read_b64_tr_b16 v[80:81], v9 offset:13824
    ds_read_b64_tr_b16 v[82:83], v9 offset:17920
    v_rcp_f32 v161, v160
    ds_write_b32 v156, v148
    v_mov_b32 v149, 0
    s_waitcnt lgkmcnt(13)
    v_mfma_f32_32x32x16_bf16 v[32:47], v[84:87], v[120:123], v[32:47]
    ds_read_b64_tr_b16 v[84:85], v9 offset:21504
    ds_read_b64_tr_b16 v[86:87], v9 offset:20480
    s_add_u32 m0, s30, 8192
    s_mov_b32 s5, 57344
    buffer_load_dwordx4 v157, s[16:19], s5 offen lds
    v_mfma_f32_32x32x16_bf16 v[48:63], v[120:123], v[88:91], v[48:63]
    ds_read_b64_tr_b16 v[88:89], v9 offset:18432
    ds_read_b64_tr_b16 v[90:91], v9 offset:22528
    ds_write_b32 v156, v161 offset:1024
    s_waitcnt lgkmcnt(14)
    v_mfma_f32_32x32x16_bf16 v[16:31], v[92:95], v[124:127], v[16:31]
    ds_read_b64_tr_b16 v[92:93], v9 offset:19456
    ds_read_b64_tr_b16 v[94:95], v9 offset:23552
    s_add_u32 m0, s30, 12288
    s_mov_b32 s5, 86016
    buffer_load_dwordx4 v157, s[16:19], s5 offen lds
    v_mfma_f32_32x32x16_bf16 v[32:47], v[96:99], v[124:127], v[32:47]
    ds_read_b64_tr_b16 v[96:97], v9 offset:22016
    ds_read_b64_tr_b16 v[98:99], v9 offset:20992
    s_waitcnt lgkmcnt(14)
    v_mfma_f32_32x32x16_bf16 v[48:63], v[124:127], v[68:71], v[48:63]
    ds_read_b64_tr_b16 v[68:69], v9 offset:18944
    ds_read_b64_tr_b16 v[70:71], v9 offset:23040
    s_add_u32 m0, s30, 16384
    s_mov_b32 s5, 114688
    buffer_load_dwordx4 v157, s[16:19], s5 offen lds
    v_mfma_f32_32x32x16_bf16 v[16:31], v[72:75], v[128:131], v[16:31]
    ds_read_b64_tr_b16 v[72:73], v9 offset:19968
    ds_read_b64_tr_b16 v[74:75], v9 offset:24064
    s_waitcnt lgkmcnt(14)
    v_mfma_f32_32x32x16_bf16 v[32:47], v[76:79], v[128:131], v[32:47]
    s_waitcnt vmcnt(10)
    v_max3_u32 v7, v132, v136, v140
    s_waitcnt vmcnt(9)
    v_max_u32 v7, v7, v144
    v_cmp_eq_u32 vcc, -1, v7
    ds_read_b64_tr_b16 v[76:77], v10 offset:0
    s_add_u32 m0, s30, 20480
    s_mov_b32 s5, 143360
    buffer_load_dwordx4 v157, s[16:19], s5 offen lds
    v_mfma_f32_32x32x16_bf16 v[48:63], v[128:131], v[80:83], v[48:63]
    s_cbranch_vccnz Lsc_289
Lscd_291:
    ds_read_b64_tr_b16 v[78:79], v10 offset:4096
    s_waitcnt lgkmcnt(10)
    s_barrier
    ds_read_b32 v148, v168
    ds_read_b32 v152, v158
    v_mfma_f32_32x32x16_bf16 v[16:31], v[84:87], v[132:135], v[16:31]
    ds_read_b128 v[80:83], v12 offset:0
    ds_read_b64_tr_b16 v[84:85], v10 offset:6144
    ds_read_b64_tr_b16 v[86:87], v10 offset:10240
    s_add_u32 m0, s30, 24576
    s_mov_b32 s5, 172032
    buffer_load_dwordx4 v157, s[16:19], s5 offen lds
    v_mfma_f32_32x32x16_bf16 v[32:47], v[88:91], v[132:135], v[32:47]
    ds_read_b128 v[88:91], v12 offset:1024
    ds_read_b32 v168, v168 offset:1024
    ds_read_b32 v160, v164 offset:1024
    ds_read_b32 v161, v165 offset:1024
    ds_read_b32 v162, v166 offset:1024
    s_waitcnt lgkmcnt(15)
    v_mfma_f32_32x32x16_bf16 v[48:63], v[132:135], v[92:95], v[48:63]
    ds_read_b64_tr_b16 v[92:93], v9 offset:27648
    ds_read_b64_tr_b16 v[94:95], v9 offset:26624
    ds_read_b32 v163, v167 offset:1024
    v_mfma_f32_32x32x16_bf16 v[16:31], v[96:99], v[136:139], v[16:31]
    ds_read_b64_tr_b16 v[96:97], v9 offset:24576
    ds_read_b64_tr_b16 v[98:99], v9 offset:28672
    s_add_u32 m0, s30, 28672
    s_mov_b32 s5, 200704
    buffer_load_dwordx4 v157, s[16:19], s5 offen lds
    s_waitcnt lgkmcnt(15)
    v_mfma_f32_32x32x16_bf16 v[32:47], v[68:71], v[136:139], v[32:47]
    ds_read_b64_tr_b16 v[68:69], v9 offset:25600
    ds_read_b64_tr_b16 v[70:71], v9 offset:29696
    v_mfma_f32_32x32x16_bf16 v[48:63], v[136:139], v[72:75], v[48:63]
    ds_read_b64_tr_b16 v[72:73], v10 offset:12288
    ds_read_b64_tr_b16 v[74:75], v10 offset:16384
    s_waitcnt lgkmcnt(7)
    v_mfma_f32_16x16x32_bf16 v[64:67], v[76:79], v[80:83], 0
    ds_read_b128 v[76:79], v12 offset:2048
    ds_read_b64_tr_b16 v[80:81], v10 offset:18432
    v_mfma_f32_16x16x32_bf16 v[64:67], v[84:87], v[88:91], v[64:67]
    ds_read_b64_tr_b16 v[82:83], v10 offset:22528
    ds_read_b128 v[84:87], v12 offset:3072
    v_mfma_f32_32x32x16_bf16 v[16:31], v[92:95], v[140:143], v[16:31]
    ds_read_b64_tr_b16 v[88:89], v9 offset:28160
    ds_read_b64_tr_b16 v[90:91], v9 offset:27136
    ds_read_b64_tr_b16 v[92:93], v9 offset:25088
    ds_read_b64_tr_b16 v[94:95], v9 offset:29184
    s_add_u32 m0, s30, 32768
    s_mov_b32 s5, 229376
    buffer_load_dwordx4 v157, s[16:19], s5 offen lds
    s_waitcnt lgkmcnt(10)
    v_mfma_f32_32x32x16_bf16 v[32:47], v[96:99], v[140:143], v[32:47]
    ds_read_b64_tr_b16 v[96:97], v9 offset:26112
    ds_read_b64_tr_b16 v[98:99], v9 offset:30208
    v_mfma_f32_32x32x16_bf16 v[48:63], v[140:143], v[68:71], v[48:63]
    ds_read_b64_tr_b16 v[68:69], v10 offset:24576
    ds_read_b64_tr_b16 v[70:71], v10 offset:28672
    s_waitcnt lgkmcnt(8)
    v_mfma_f32_16x16x32_bf16 v[64:67], v[72:75], v[76:79], v[64:67]
    ds_read_b128 v[72:75], v12 offset:4096
    ds_read_b64_tr_b16 v[76:77], v10 offset:30720
    v_mfma_f32_16x16x32_bf16 v[64:67], v[80:83], v[84:87], v[64:67]
    ds_read_b64_tr_b16 v[78:79], v10 offset:34816
    ds_read_b128 v[80:83], v12 offset:5120
    s_waitcnt lgkmcnt(8)
    v_mfma_f32_32x32x16_bf16 v[16:31], v[88:91], v[144:147], v[16:31]
    ds_read_b64_tr_b16 v[84:85], v9 offset:30720
    ds_read_b64_tr_b16 v[86:87], v9 offset:34816
    ds_read_b64_tr_b16 v[88:89], v9 offset:31744
    ds_read_b64_tr_b16 v[90:91], v9 offset:35840
    s_add_u32 m0, s30, 36864
    s_mov_b32 s5, 258048
    buffer_load_dwordx4 v157, s[16:19], s5 offen lds
    v_mfma_f32_32x32x16_bf16 v[32:47], v[92:95], v[144:147], v[32:47]
    ds_read_b64_tr_b16 v[92:93], v10 offset:36864
    ds_read_b64_tr_b16 v[94:95], v10 offset:40960
    v_mul_f32 v168, 0x3e8b97f6, v168
    v_mul_f32 v164, v160, v168
    v_mul_f32 v165, v161, v168
    v_mul_f32 v166, v162, v168
    v_mul_f32 v167, v163, v168
    s_waitcnt lgkmcnt(10)
    v_mfma_f32_32x32x16_bf16 v[48:63], v[144:147], v[96:99], v[48:63]
    ds_read_b128 v[96:99], v12 offset:6144
    v_cndmask_b32 v152, v152, 0, s[90:91]
    ds_read_b128 v[124:127], v159 offset:640
    ds_read_b128 v[128:131], v159 offset:512
    ds_read_b128 v[132:135], v169 offset:384
    s_waitcnt vmcnt(13) lgkmcnt(10)
    v_mfma_f32_16x16x32_bf16 v[64:67], v[68:71], v[72:75], v[64:67]
    s_waitcnt vmcnt(9)
    v_max3_u32 v7, v100, v104, v108
    s_waitcnt vmcnt(8)
    v_max_u32 v7, v7, v112
    v_cmp_eq_u32 vcc, -1, v7
    ds_read_b64_tr_b16 v[68:69], v11 offset:0
    ds_read_b64_tr_b16 v[70:71], v11 offset:4096
    v_mfma_f32_16x16x32_bf16 v[64:67], v[76:79], v[80:83], v[64:67]
    s_cbranch_vccnz Lsc_300
Lscd_302:
    ds_read_b128 v[72:75], v12 offset:7168
    ds_read_b64_tr_b16 v[76:77], v9 offset:31232
    s_waitcnt lgkmcnt(10)
    v_mfma_f32_32x32x16_bf16 v[32:47], v[84:87], v[100:103], v[32:47]
    ds_read_b64_tr_b16 v[78:79], v9 offset:35328
    ds_read_b64_tr_b16 v[80:81], v9 offset:32256
    ds_read_b64_tr_b16 v[82:83], v9 offset:36352
    ds_read_b64_tr_b16 v[84:85], v11 offset:6144
    v_mfma_f32_32x32x16_bf16 v[48:63], v[100:103], v[88:91], v[48:63]
    ds_read_b64_tr_b16 v[86:87], v11 offset:10240
    ds_read_b128 v[88:91], v12 offset:8192
    ds_read_b128 v[136:139], v169 offset:256
    ds_read_b128 v[140:143], v169 offset:128
    ds_read_b128 v[144:147], v169 offset:0
    s_waitcnt lgkmcnt(15)
    v_mfma_f32_16x16x32_bf16 v[64:67], v[92:95], v[96:99], v[64:67]
    ds_read_b64_tr_b16 v[92:93], v11 offset:12288
    ds_read_b64_tr_b16 v[94:95], v11 offset:16384
    s_waitcnt lgkmcnt(12)
    v_mfma_f32_16x16x32_bf16 v[64:67], v[68:71], v[72:75], v[64:67]
    ds_read_b128 v[96:99], v12 offset:9216
    ds_read_b64_tr_b16 v[68:69], v9 offset:36864
    s_waitcnt lgkmcnt(12)
    v_mfma_f32_32x32x16_bf16 v[32:47], v[76:79], v[104:107], v[32:47]
    ds_read_b64_tr_b16 v[70:71], v9 offset:40960
    ds_read_b64_tr_b16 v[72:73], v9 offset:37888
    ds_read_b64_tr_b16 v[74:75], v9 offset:41984
    ds_read_b64_tr_b16 v[76:77], v11 offset:18432
    s_waitcnt lgkmcnt(14)
    v_mfma_f32_32x32x16_bf16 v[48:63], v[104:107], v[80:83], v[48:63]
    ds_read_b64_tr_b16 v[78:79], v11 offset:22528
    ds_read_b128 v[80:83], v12 offset:10240
    s_waitcnt lgkmcnt(13)
    v_mfma_f32_16x16x32_bf16 v[64:67], v[84:87], v[88:91], v[64:67]
    ds_read_b64_tr_b16 v[84:85], v11 offset:24576
    ds_read_b64_tr_b16 v[86:87], v11 offset:28672
    s_waitcnt lgkmcnt(9)
    v_mfma_f32_16x16x32_bf16 v[64:67], v[92:95], v[96:99], v[64:67]
    ds_read_b128 v[88:91], v12 offset:11264
    ds_read_b64_tr_b16 v[92:93], v9 offset:37376
    s_waitcnt lgkmcnt(9)
    v_mfma_f32_32x32x16_bf16 v[32:47], v[68:71], v[108:111], v[32:47]
    ds_read_b64_tr_b16 v[94:95], v9 offset:41472
    ds_read_b64_tr_b16 v[96:97], v9 offset:38400
    ds_read_b64_tr_b16 v[98:99], v9 offset:42496
    ds_read_b64_tr_b16 v[68:69], v11 offset:30720
    s_waitcnt lgkmcnt(11)
    v_mfma_f32_32x32x16_bf16 v[48:63], v[108:111], v[72:75], v[48:63]
    ds_read_b64_tr_b16 v[70:71], v11 offset:34816
    ds_read_b128 v[72:75], v12 offset:12288
    s_waitcnt lgkmcnt(10)
    v_mfma_f32_16x16x32_bf16 v[64:67], v[76:79], v[80:83], v[64:67]
    ds_read_b64_tr_b16 v[76:77], v11 offset:36864
    ds_read_b64_tr_b16 v[78:79], v11 offset:40960
    s_waitcnt lgkmcnt(9)
    v_mfma_f32_16x16x32_bf16 v[64:67], v[84:87], v[88:91], v[64:67]
    ds_read_b128 v[80:83], v12 offset:13312
    ds_read_b32 v84, v171
    s_waitcnt lgkmcnt(9)
    v_mfma_f32_32x32x16_bf16 v[32:47], v[92:95], v[112:115], v[32:47]
    ds_read_b32 v88, v170 offset:256
    ds_read_b32 v92, v170 offset:512
    s_waitcnt lgkmcnt(9)
    v_mfma_f32_32x32x16_bf16 v[48:63], v[112:115], v[96:99], v[48:63]
    ds_read_b64_tr_b16 v[96:97], v9 offset:33792
    ds_read_b64_tr_b16 v[98:99], v9 offset:32768
    s_waitcnt lgkmcnt(8)
    v_mfma_f32_16x16x32_bf16 v[64:67], v[68:71], v[72:75], v[64:67]
    ds_read_b64_tr_b16 v[68:69], v9 offset:34304
    ds_read_b64_tr_b16 v[70:71], v9 offset:33280
    s_waitcnt lgkmcnt(7)
    v_mfma_f32_16x16x32_bf16 v[64:67], v[76:79], v[80:83], v[64:67]
    ds_read_b64_tr_b16 v[72:73], v9 offset:39936
    ds_read_b64_tr_b16 v[74:75], v9 offset:38912
    s_waitcnt lgkmcnt(8)
    v_mfma_f32_16x16x32_bf16 v[64:67], v[84:87], v[152:155], v[64:67]
    ds_read_b64_tr_b16 v[76:77], v9 offset:40448
    ds_read_b64_tr_b16 v[78:79], v9 offset:39424
    s_waitcnt lgkmcnt(8)
    v_mfma_f32_32x32x16_bf16 v[32:47], v[88:91], v[148:151], v[32:47]
    ds_read_b32 v80, v170 offset:0
    v_mfma_f32_32x32x16_bf16 v[48:63], v[148:151], v[92:95], v[48:63]
    s_nop 1
    v_cvt_pk_bf16_f32 v64, v64, v65
    v_cvt_pk_bf16_f32 v65, v66, v67
    ds_write_b64 v15, v[64:65]
    ds_write_b16 v4, v64
    ds_write_b16_d16_hi v4, v64 offset:16
    ds_write_b16 v4, v65 offset:32
    s_waitcnt lgkmcnt(9)
    v_mfma_f32_32x32x16_bf16 v[16:31], v[96:99], v[100:103], v[16:31]
    ds_write_b16_d16_hi v4, v65 offset:48
    v_cvt_pk_bf16_f32 v32, v32, v33
    v_cvt_pk_bf16_f32 v33, v34, v35
    v_cvt_pk_bf16_f32 v34, v36, v37
    v_cvt_pk_bf16_f32 v35, v38, v39
    v_cvt_pk_bf16_f32 v36, v40, v41
    v_mfma_f32_32x32x16_bf16 v[16:31], v[68:71], v[104:107], v[16:31]
    v_cvt_pk_bf16_f32 v37, v42, v43
    v_cvt_pk_bf16_f32 v38, v44, v45
    v_cvt_pk_bf16_f32 v39, v46, v47
    s_waitcnt lgkmcnt(6)
    v_mfma_f32_32x32x16_bf16 v[16:31], v[72:75], v[108:111], v[16:31]
    s_mov_b32 exec_lo, 0xffff0000
    s_mov_b32 exec_hi, 0xffff0000
    ds_write_b128 v13, v[32:35] offset:2048
    ds_write_b128 v13, v[36:39] offset:2560
    s_mov_b64 exec, -1
    v_mfma_f32_32x32x16_bf16 v[16:31], v[76:79], v[112:115], v[16:31]
    v_cvt_pk_bf16_f32 v48, v48, v49
    v_cvt_pk_bf16_f32 v49, v50, v51
    v_cvt_pk_bf16_f32 v50, v52, v53
    v_cvt_pk_bf16_f32 v51, v54, v55
    v_cvt_pk_bf16_f32 v52, v56, v57
    v_cvt_pk_bf16_f32 v53, v58, v59
    v_cvt_pk_bf16_f32 v54, v60, v61
    v_cvt_pk_bf16_f32 v55, v62, v63
    s_waitcnt lgkmcnt(7)
    v_mfma_f32_32x32x16_bf16 v[16:31], v[80:83], v[148:151], v[16:31]
    ds_write_b128 v14, v[52:55] offset:3072
    s_waitcnt vmcnt(5) lgkmcnt(0)
    s_barrier
    ds_read_b128 v[40:43], v13
    s_add_u32 m0, s30, 40960
    s_mov_b32 s5, 286720
    buffer_load_dwordx4 v157, s[16:19], s5 offen lds
    ds_read_b128 v[44:47], v13 offset:512
    s_nop 3
    v_cvt_pk_bf16_f32 v16, v16, v17
    v_cvt_pk_bf16_f32 v17, v18, v19
    v_cvt_pk_bf16_f32 v18, v20, v21
    v_cvt_pk_bf16_f32 v19, v22, v23
    ds_read_b128 v[56:59], v14 offset:1024
    ds_read_b128 v[68:71], v169 offset:2432
    v_mfma_f32_32x32x16_bf16 v[132:147], v[32:35], v[16:19], v[132:147]
    s_add_u32 m0, s30, 45056
    s_mov_b32 s5, 315392
    buffer_load_dwordx4 v157, s[16:19], s5 offen lds
    v_cvt_pk_bf16_f32 v20, v24, v25
    v_cvt_pk_bf16_f32 v21, v26, v27
    v_cvt_pk_bf16_f32 v22, v28, v29
    v_cvt_pk_bf16_f32 v23, v30, v31
    v_cndmask_b32 v22, v22, 0, s[90:91]
    v_cndmask_b32 v23, v23, 0, s[90:91]
    ds_read_b128 v[72:75], v169 offset:2176
    ds_read_b128 v[76:79], v169 offset:2688
    v_mfma_f32_32x32x16_bf16 v[132:147], v[36:39], v[20:23], v[132:147]
    s_add_u32 m0, s30, 49152
    s_mov_b32 s5, 344064
    buffer_load_dwordx4 v157, s[16:19], s5 offen lds
    v_and_b32 v30, 1, v2
    v_and_b32 v29, 0x1ff, v13
    v_lshl_add_u32 v30, v30, 14, v29
    s_waitcnt lgkmcnt(5)
    v_mfma_f32_32x32x16_bf16 v[116:131], v[40:43], v[16:19], v[116:131]
    s_lshl2_add_u32 s72, s52, s50
    s_lshl_b32 s72, s72, 15
    s_lshl_b32 s73, s51, 10
    s_add_u32 s72, s72, s73
    s_waitcnt lgkmcnt(4)
    v_mfma_f32_32x32x16_bf16 v[116:131], v[44:47], v[20:23], v[116:131]
    s_add_u32 m0, s30, 53248
    s_mov_b32 s5, 372736
    buffer_load_dwordx4 v157, s[16:19], s5 offen lds
    v_max3_f32 v24, v132, v133, v140
    v_max3_f32 v25, v134, v135, v142
    v_max3_f32 v26, v136, v137, v144
    v_max3_f32 v27, v138, v139, v146
    v_max_f32 v24, v24, v141
    v_max_f32 v25, v25, v143
    v_max_f32 v26, v26, v145
    v_max_f32 v27, v27, v147
    s_nop 0
    v_max3_f32 v24, v24, v124, v125
    v_max3_f32 v25, v25, v126, v127
    v_max3_f32 v26, v26, v128, v129
    v_max3_f32 v27, v27, v130, v131
    v_mul_f32 v24, v24, v164
    v_mul_f32 v25, v25, v165
    v_mul_f32 v26, v26, v166
    v_mul_f32 v27, v27, v167
    v_max3_f32 v28, v24, v25, v26
    v_max_f32 v28, v28, v27
    v_max_f32 v29, v28, v27
    s_nop 1
    v_permlane32_swap_b32 v28, v29
    v_max_f32 v28, v28, v29
    v_sub_f32 v24, v24, v28
    v_sub_f32 v25, v25, v28
    v_sub_f32 v26, v26, v28
    v_sub_f32 v27, v27, v28
    v_exp_f32 v24, v24
    v_exp_f32 v25, v25
    v_exp_f32 v26, v26
    v_exp_f32 v27, v27
    v_add_f32 v28, v24, v25
    v_add_f32 v29, v26, v27
    v_add_f32 v28, v28, v29
    v_mov_b32 v29, v28
    v_mul_f32 v24, v24, v160
    v_mul_f32 v25, v25, v161
    v_permlane32_swap_b32 v28, v29
    v_add_f32 v28, v28, v29
    v_rcp_f32 v28, v28
    v_mul_f32 v26, v26, v162
    v_mul_f32 v27, v27, v163
    v_mul_f32 v24, v24, v28
    v_mul_f32 v25, v25, v28
    v_mul_f32 v26, v26, v28
    v_mul_f32 v27, v27, v28
    v_cvt_pk_bf16_f32 v24, v24, v24
    v_cvt_pk_bf16_f32 v25, v25, v25
    v_cvt_pk_bf16_f32 v26, v26, v26
    v_cvt_pk_bf16_f32 v27, v27, v27
    s_waitcnt lgkmcnt(2)
    v_and_b32 v68, v24, v68
    v_and_b32 v69, v25, v69
    v_and_b32 v70, v26, v70
    v_and_b32 v71, v27, v71
    s_waitcnt lgkmcnt(1)
    v_and_b32 v72, v24, v72
    v_and_b32 v73, v25, v73
    v_mfma_f32_32x32x16_bf16 v[100:115], v[48:51], v[68:71], 0
    v_and_b32 v74, v26, v74
    v_and_b32 v75, v27, v75
    s_waitcnt lgkmcnt(0)
    v_and_b32 v76, v24, v76
    v_and_b32 v77, v25, v77
    v_mfma_f32_32x32x16_bf16 v[100:115], v[52:55], v[72:75], v[100:115]
    v_and_b32 v78, v26, v78
    v_and_b32 v79, v27, v79
    s_nop 1
    v_mfma_f32_32x32x16_bf16 v[100:115], v[56:59], v[76:79], v[100:115]
    s_add_u32 s72, s72, s55
    s_nop 10
    v_cvt_pk_bf16_f32 v100, v100, v101
    v_cvt_pk_bf16_f32 v101, v102, v103
    v_cvt_pk_bf16_f32 v102, v104, v105
    v_cvt_pk_bf16_f32 v103, v106, v107
    v_cvt_pk_bf16_f32 v104, v108, v109
    v_cvt_pk_bf16_f32 v105, v110, v111
    v_cvt_pk_bf16_f32 v106, v112, v113
    v_cvt_pk_bf16_f32 v107, v114, v115
    v_cndmask_b32 v106, v106, 0, s[90:91]
    v_cndmask_b32 v107, v107, 0, s[90:91]
    s_cmp_eq_u32 s4, 0
    s_cbranch_scc0 Lslow_307
    buffer_store_dwordx4 v[100:103], v30, s[36:39], s72 offen
    buffer_store_dwordx4 v[104:107], v30, s[36:39], s72 offen offset:512
Lsdone_308:
    s_cmp_ge_u32 s49, 28
    s_cbranch_scc1 Lidle1
    s_cmp_eq_u32 s4, 0
    s_cbranch_scc0 Lss_311
Lssd_313:
    v_and_b32 v5, 1, v2
    v_lshrrev_b32 v7, 1, v2
    v_lshl_add_u32 v5, v5, 1, v7
    v_lshlrev_b32 v7, 4, v3
    v_lshl_add_u32 v5, v5, 8, v7
    s_and_b32 s75, s60, 15
    s_lshl_b32 s77, s75, 14
    s_add_u32 s77, s77, s55
    s_add_u32 s78, s77, 4096
    s_add_u32 s79, s77, 8192
    s_add_u32 s80, s77, 12288
    s_mul_i32 s72, s75, 14336
    s_lshl_b32 s73, s54, 11
    s_add_u32 s72, s72, s73
    s_add_u32 s76, s72, s21
    buffer_load_dwordx4 v[164:167], v5, s[36:39], s76 offen sc1
    buffer_load_dwordx4 v[168:171], v5, s[36:39], s76 offen offset:1024 sc1
    s_add_u32 s72, s72, s55
    s_add_u32 s72, s72, 262144
    s_cmp_eq_u32 s48, 7
    s_cselect_b32 s5, 3, s48
    s_cmp_lt_u32 s54, s5
    s_cselect_b32 s6, 7, 0
    s_sub_u32 s5, s6, s5
    s_lshl_b32 s5, s5, 11
    s_add_u32 s72, s72, s5
    s_lshl_b32 s74, s75, 7
    s_add_u32 s73, s73, s74
    s_add_u32 s73, s73, s55
    s_add_u32 s73, s73, 491520
    v_mov_b32 v80, v2
    v_lshrrev_b32 v81, 2, v3
    v_and_b32 v82, 2, v80
    v_add_u32 v80, v80, v82
    v_lshl_add_u32 v82, v80, 2, v81
    v_lshlrev_b32 v83, 7, v82
    v_bfe_u32 v82, v82, 1, 2
    v_lshl_add_u32 v83, v82, 5, v83
    v_and_b32 v81, 3, v3
    v_lshl_add_u32 v83, v81, 3, v83
    v_add_u32 v8, 91648, v83
    v_xor_b32 v9, 32, v8
    v_xor_b32 v10, 64, v8
    v_xor_b32 v11, 96, v8
    v_cmp_eq_u32 vcc, 3, v2
    s_nop 1
    v_cndmask_b32 v80, v2, 1, vcc
    v_lshrrev_b32 v81, 2, v3
    v_and_b32 v82, 2, v80
    v_add_u32 v80, v80, v82
    v_lshl_add_u32 v82, v80, 2, v81
    v_lshlrev_b32 v83, 7, v82
    v_bfe_u32 v82, v82, 1, 2
    v_lshl_add_u32 v83, v82, 5, v83
    v_and_b32 v81, 3, v3
    v_lshl_add_u32 v83, v81, 3, v83
    v_add_u32 v12, 91648, v83
    v_xor_b32 v13, 32, v12
    v_xor_b32 v14, 64, v12
    v_xor_b32 v15, 96, v12
    ds_read_b64_tr_b16 v[96:97], v8 offset:0
    ds_read_b64_tr_b16 v[98:99], v12 offset:1024
    ds_read_b64_tr_b16 v[100:101], v9 offset:0
    ds_read_b64_tr_b16 v[102:103], v13 offset:1024
    ds_read_b64_tr_b16 v[104:105], v10 offset:0
    ds_read_b64_tr_b16 v[106:107], v14 offset:1024
    ds_read_b64_tr_b16 v[108:109], v11 offset:0
    ds_read_b64_tr_b16 v[110:111], v15 offset:1024
    ds_read_b64_tr_b16 v[112:113], v10 offset:3584
    ds_read_b64_tr_b16 v[114:115], v14 offset:4608
    ds_read_b64_tr_b16 v[116:117], v11 offset:3584
    ds_read_b64_tr_b16 v[118:119], v15 offset:4608
    ds_read_b64_tr_b16 v[120:121], v8 offset:3584
    ds_read_b64_tr_b16 v[122:123], v12 offset:4608
    ds_read_b64_tr_b16 v[124:125], v9 offset:3584
    ds_read_b64_tr_b16 v[126:127], v13 offset:4608
    ds_read_b64_tr_b16 v[128:129], v8 offset:7168
    ds_read_b64_tr_b16 v[130:131], v12 offset:8192
    ds_read_b64_tr_b16 v[132:133], v9 offset:7168
    ds_read_b64_tr_b16 v[134:135], v13 offset:8192
    ds_read_b64_tr_b16 v[136:137], v10 offset:7168
    ds_read_b64_tr_b16 v[138:139], v14 offset:8192
    ds_read_b64_tr_b16 v[140:141], v11 offset:7168
    ds_read_b64_tr_b16 v[142:143], v15 offset:8192
    ds_read_b64_tr_b16 v[144:145], v10 offset:10752
    ds_read_b64_tr_b16 v[146:147], v14 offset:11776
    ds_read_b64_tr_b16 v[148:149], v11 offset:10752
    ds_read_b64_tr_b16 v[150:151], v15 offset:11776
    ds_read_b64_tr_b16 v[152:153], v8 offset:10752
    ds_read_b64_tr_b16 v[154:155], v12 offset:11776
    ds_read_b64_tr_b16 v[156:157], v9 offset:10752
    ds_read_b64_tr_b16 v[158:159], v13 offset:11776
    ds_read_b64_tr_b16 v[160:161], v8 offset:14336
    ds_read_b64_tr_b16 v[162:163], v12 offset:15360
    buffer_load_dwordx4 v[16:19], v1, s[36:39], s77 offen offset:0 sc1
    buffer_load_dwordx4 v[20:23], v1, s[36:39], s77 offen offset:1024 sc1
    buffer_load_dwordx4 v[24:27], v1, s[36:39], s77 offen offset:2048 sc1
    buffer_load_dwordx4 v[28:31], v1, s[36:39], s77 offen offset:3072 sc1
    buffer_load_dwordx4 v[32:35], v1, s[36:39], s78 offen offset:0 sc1
    buffer_load_dwordx4 v[36:39], v1, s[36:39], s78 offen offset:1024 sc1
    buffer_load_dwordx4 v[40:43], v1, s[36:39], s78 offen offset:2048 sc1
    buffer_load_dwordx4 v[44:47], v1, s[36:39], s78 offen offset:3072 sc1
    buffer_load_dwordx4 v[48:51], v1, s[36:39], s79 offen offset:0 sc1
    s_waitcnt vmcnt(13)
    s_barrier
    s_waitcnt vmcnt(10)
    v_permlane16_swap_b32 v164, v166
    v_permlane16_swap_b32 v165, v167
    s_waitcnt vmcnt(9)
    v_permlane16_swap_b32 v168, v170
    v_permlane16_swap_b32 v169, v171
    v_lshlrev_b32 v80, 16, v164
    v_and_b32 v81, 0xffff0000, v164
    v_lshlrev_b32 v82, 16, v165
    v_and_b32 v83, 0xffff0000, v165
    v_lshlrev_b32 v84, 16, v166
    v_and_b32 v85, 0xffff0000, v166
    v_lshlrev_b32 v86, 16, v167
    v_and_b32 v87, 0xffff0000, v167
    v_lshlrev_b32 v88, 16, v168
    v_and_b32 v89, 0xffff0000, v168
    v_lshlrev_b32 v90, 16, v169
    v_and_b32 v91, 0xffff0000, v169
    v_lshlrev_b32 v92, 16, v170
    v_and_b32 v93, 0xffff0000, v170
    v_lshlrev_b32 v94, 16, v171
    v_and_b32 v95, 0xffff0000, v171
    v_mov_b32 v164, 0x3f803f80
    v_mov_b32 v165, 0x3f803f80
    v_mov_b32 v166, 0x3f803f80
    v_mov_b32 v167, 0x3f803f80
    v_lshlrev_b32 v168, 3, v3
    s_waitcnt vmcnt(6)
    v_max3_u32 v7, v16, v20, v24
    v_cmp_eq_u32 vcc, -1, v7
    s_nop 0
    s_cbranch_vccnz Lsc_314
Lscd_316:
    s_waitcnt lgkmcnt(15)
    v_mfma_f32_16x16x32_bf16 v[80:83], v[96:99], v[16:19], v[80:83]
    ds_read_b64_tr_b16 v[96:97], v9 offset:14336
    ds_read_b64_tr_b16 v[98:99], v13 offset:15360
    v_mfma_f32_16x16x32_bf16 v[84:87], v[100:103], v[16:19], v[84:87]
    ds_read_b64_tr_b16 v[100:101], v10 offset:14336
    ds_read_b64_tr_b16 v[102:103], v14 offset:15360
    v_mfma_f32_16x16x32_bf16 v[88:91], v[104:107], v[16:19], v[88:91]
    buffer_load_dwordx4 v[52:55], v1, s[36:39], s79 offen offset:1024 sc1
    ds_read_b64_tr_b16 v[104:105], v11 offset:14336
    v_mfma_f32_16x16x32_bf16 v[92:95], v[108:111], v[16:19], v[92:95]
    ds_read_b64_tr_b16 v[106:107], v15 offset:15360
    ds_read_b64_tr_b16 v[108:109], v10 offset:17920
    ds_read_b64_tr_b16 v[110:111], v14 offset:18944
    v_mfma_f32_16x16x32_bf16 v[80:83], v[112:115], v[20:23], v[80:83]
    buffer_load_dwordx4 v[56:59], v1, s[36:39], s79 offen offset:2048 sc1
    ds_read_b64_tr_b16 v[112:113], v11 offset:17920
    v_mfma_f32_16x16x32_bf16 v[84:87], v[116:119], v[20:23], v[84:87]
    ds_read_b64_tr_b16 v[114:115], v15 offset:18944
    ds_read_b64_tr_b16 v[116:117], v8 offset:17920
    ds_read_b64_tr_b16 v[118:119], v12 offset:18944
    v_mfma_f32_16x16x32_bf16 v[88:91], v[120:123], v[20:23], v[88:91]
    buffer_load_dwordx4 v[60:63], v1, s[36:39], s79 offen offset:3072 sc1
    ds_read_b64_tr_b16 v[120:121], v9 offset:17920
    v_mfma_f32_16x16x32_bf16 v[92:95], v[124:127], v[20:23], v[92:95]
    ds_read_b64_tr_b16 v[122:123], v13 offset:18944
    ds_read_b64_tr_b16 v[124:125], v8 offset:21504
    ds_read_b64_tr_b16 v[126:127], v12 offset:22528
    s_waitcnt lgkmcnt(15)
    v_mfma_f32_16x16x32_bf16 v[80:83], v[128:131], v[24:27], v[80:83]
    buffer_load_dwordx4 v[64:67], v1, s[36:39], s80 offen offset:0 sc1
    v_mfma_f32_16x16x32_bf16 v[84:87], v[132:135], v[24:27], v[84:87]
    s_waitcnt vmcnt(7)
    v_max3_u32 v7, v28, v32, v36
    v_cmp_eq_u32 vcc, -1, v7
    ds_read_b64_tr_b16 v[128:129], v9 offset:21504
    v_mfma_f32_16x16x32_bf16 v[88:91], v[136:139], v[24:27], v[88:91]
    buffer_load_dwordx4 v[68:71], v1, s[36:39], s80 offen offset:1024 sc1
    ds_read_b64_tr_b16 v[130:131], v13 offset:22528
    v_mfma_f32_16x16x32_bf16 v[92:95], v[140:143], v[24:27], v[92:95]
    s_cbranch_vccnz Lsc_326
Lscd_328:
    ds_read_b64_tr_b16 v[132:133], v10 offset:21504
    ds_read_b64_tr_b16 v[134:135], v14 offset:22528
    v_mfma_f32_16x16x32_bf16 v[80:83], v[144:147], v[28:31], v[80:83]
    buffer_load_dwordx4 v[72:75], v1, s[36:39], s80 offen offset:2048 sc1
    ds_read_b64_tr_b16 v[136:137], v11 offset:21504
    v_mfma_f32_16x16x32_bf16 v[84:87], v[148:151], v[28:31], v[84:87]
    ds_read_b64_tr_b16 v[138:139], v15 offset:22528
    ds_read_b64_tr_b16 v[140:141], v10 offset:25088
    ds_read_b64_tr_b16 v[142:143], v14 offset:26112
    v_mfma_f32_16x16x32_bf16 v[88:91], v[152:155], v[28:31], v[88:91]
    buffer_load_dwordx4 v[76:79], v1, s[36:39], s80 offen offset:3072 sc1
    ds_read_b64_tr_b16 v[144:145], v11 offset:25088
    v_mfma_f32_16x16x32_bf16 v[92:95], v[156:159], v[28:31], v[92:95]
    ds_read_b64_tr_b16 v[146:147], v15 offset:26112
    ds_read_b64_tr_b16 v[148:149], v8 offset:25088
    ds_read_b64_tr_b16 v[150:151], v12 offset:26112
    s_waitcnt lgkmcnt(15)
    v_mfma_f32_16x16x32_bf16 v[80:83], v[160:163], v[32:35], v[80:83]
    ds_read_b64_tr_b16 v[152:153], v9 offset:25088
    ds_read_b64_tr_b16 v[154:155], v13 offset:26112
    v_mfma_f32_16x16x32_bf16 v[84:87], v[96:99], v[32:35], v[84:87]
    ds_read_b64_tr_b16 v[156:157], v8 offset:28672
    ds_read_b64_tr_b16 v[158:159], v12 offset:29696
    ds_read_b64_tr_b16 v[160:161], v9 offset:28672
    v_mfma_f32_16x16x32_bf16 v[88:91], v[100:103], v[32:35], v[88:91]
    ds_read_b64_tr_b16 v[162:163], v13 offset:29696
    ds_read_b64_tr_b16 v[96:97], v10 offset:28672
    ds_read_b64_tr_b16 v[98:99], v14 offset:29696
    v_mfma_f32_16x16x32_bf16 v[92:95], v[104:107], v[32:35], v[92:95]
    ds_read_b64_tr_b16 v[100:101], v11 offset:28672
    ds_read_b64_tr_b16 v[102:103], v15 offset:29696
    ds_read_b64_tr_b16 v[104:105], v10 offset:32256
    s_waitcnt lgkmcnt(15)
    v_mfma_f32_16x16x32_bf16 v[80:83], v[108:111], v[36:39], v[80:83]
    ds_read_b64_tr_b16 v[106:107], v14 offset:33280
    ds_read_b64_tr_b16 v[108:109], v11 offset:32256
    v_mfma_f32_16x16x32_bf16 v[84:87], v[112:115], v[36:39], v[84:87]
    s_waitcnt vmcnt(7)
    v_max3_u32 v7, v40, v44, v48
    s_waitcnt vmcnt(5)
    v_max3_u32 v7, v7, v52, v56
    v_cmp_eq_u32 vcc, -1, v7
    v_mfma_f32_16x16x32_bf16 v[88:91], v[116:119], v[36:39], v[88:91]
    ds_read_b64_tr_b16 v[110:111], v15 offset:33280
    ds_read_b64_tr_b16 v[112:113], v8 offset:32256
    ds_read_b64_tr_b16 v[114:115], v12 offset:33280
    v_mfma_f32_16x16x32_bf16 v[92:95], v[120:123], v[36:39], v[92:95]
    s_cbranch_vccnz Lsc_340
Lscd_342:
    ds_read_b64_tr_b16 v[116:117], v9 offset:32256
    ds_read_b64_tr_b16 v[118:119], v13 offset:33280
    v_mfma_f32_16x16x32_bf16 v[80:83], v[124:127], v[40:43], v[80:83]
    ds_read_b64_tr_b16 v[120:121], v8 offset:35840
    ds_read_b64_tr_b16 v[122:123], v12 offset:36864
    ds_read_b64_tr_b16 v[124:125], v9 offset:35840
    v_mfma_f32_16x16x32_bf16 v[84:87], v[128:131], v[40:43], v[84:87]
    ds_read_b64_tr_b16 v[126:127], v13 offset:36864
    ds_read_b64_tr_b16 v[128:129], v10 offset:35840
    ds_read_b64_tr_b16 v[130:131], v14 offset:36864
    v_mfma_f32_16x16x32_bf16 v[88:91], v[132:135], v[40:43], v[88:91]
    ds_read_b64_tr_b16 v[132:133], v11 offset:35840
    ds_read_b64_tr_b16 v[134:135], v15 offset:36864
    v_mfma_f32_16x16x32_bf16 v[92:95], v[136:139], v[40:43], v[92:95]
    ds_read_b64_tr_b16 v[136:137], v10 offset:39424
    ds_read_b64_tr_b16 v[138:139], v14 offset:40448
    s_waitcnt lgkmcnt(15)
    v_mfma_f32_16x16x32_bf16 v[80:83], v[140:143], v[44:47], v[80:83]
    ds_read_b64_tr_b16 v[140:141], v11 offset:39424
    ds_read_b64_tr_b16 v[142:143], v15 offset:40448
    v_mfma_f32_16x16x32_bf16 v[84:87], v[144:147], v[44:47], v[84:87]
    ds_read_b64_tr_b16 v[144:145], v8 offset:39424
    ds_read_b64_tr_b16 v[146:147], v12 offset:40448
    v_mfma_f32_16x16x32_bf16 v[88:91], v[148:151], v[44:47], v[88:91]
    ds_read_b64_tr_b16 v[148:149], v9 offset:39424
    ds_read_b64_tr_b16 v[150:151], v13 offset:40448
    v_mfma_f32_16x16x32_bf16 v[92:95], v[152:155], v[44:47], v[92:95]
    ds_read_b64_tr_b16 v[152:153], v8 offset:43008
    ds_read_b64_tr_b16 v[154:155], v12 offset:44032
    v_mfma_f32_16x16x32_bf16 v[80:83], v[156:159], v[48:51], v[80:83]
    ds_read_b64_tr_b16 v[156:157], v9 offset:43008
    ds_read_b64_tr_b16 v[158:159], v13 offset:44032
    v_mfma_f32_16x16x32_bf16 v[84:87], v[160:163], v[48:51], v[84:87]
    ds_read_b64_tr_b16 v[160:161], v10 offset:43008
    ds_read_b64_tr_b16 v[162:163], v14 offset:44032
    v_mfma_f32_16x16x32_bf16 v[88:91], v[96:99], v[48:51], v[88:91]
    ds_read_b64_tr_b16 v[96:97], v11 offset:43008
    ds_read_b64_tr_b16 v[98:99], v15 offset:44032
    v_mfma_f32_16x16x32_bf16 v[92:95], v[100:103], v[48:51], v[92:95]
    ds_read_b64_tr_b16 v[100:101], v10 offset:46592
    ds_read_b64_tr_b16 v[102:103], v14 offset:47616
    s_waitcnt lgkmcnt(15)
    v_mfma_f32_16x16x32_bf16 v[80:83], v[104:107], v[52:55], v[80:83]
    ds_read_b64_tr_b16 v[104:105], v11 offset:46592
    ds_read_b64_tr_b16 v[106:107], v15 offset:47616
    v_mfma_f32_16x16x32_bf16 v[84:87], v[108:111], v[52:55], v[84:87]
    ds_read_b64_tr_b16 v[108:109], v8 offset:46592
    ds_read_b64_tr_b16 v[110:111], v12 offset:47616
    v_mfma_f32_16x16x32_bf16 v[88:91], v[112:115], v[52:55], v[88:91]
    ds_read_b64_tr_b16 v[112:113], v9 offset:46592
    ds_read_b64_tr_b16 v[114:115], v13 offset:47616
    v_mfma_f32_16x16x32_bf16 v[92:95], v[116:119], v[52:55], v[92:95]
    ds_read_b64_tr_b16 v[116:117], v8 offset:50176
    ds_read_b64_tr_b16 v[118:119], v12 offset:51200
    v_mfma_f32_16x16x32_bf16 v[80:83], v[120:123], v[56:59], v[80:83]
    ds_read_b64_tr_b16 v[120:121], v9 offset:50176
    ds_read_b64_tr_b16 v[122:123], v13 offset:51200
    v_mfma_f32_16x16x32_bf16 v[84:87], v[124:127], v[56:59], v[84:87]
    s_waitcnt vmcnt(2)
    v_max3_u32 v7, v60, v64, v68
    s_waitcnt vmcnt(0)
    v_max3_u32 v7, v7, v72, v76
    v_cmp_eq_u32 vcc, -1, v7
    v_mfma_f32_16x16x32_bf16 v[88:91], v[128:131], v[56:59], v[88:91]
    ds_read_b64_tr_b16 v[124:125], v10 offset:50176
    ds_read_b64_tr_b16 v[126:127], v14 offset:51200
    ds_read_b64_tr_b16 v[128:129], v11 offset:50176
    v_mfma_f32_16x16x32_bf16 v[92:95], v[132:135], v[56:59], v[92:95]
    s_cbranch_vccnz Lsc_353
Lscd_355:
    ds_read_b64_tr_b16 v[130:131], v15 offset:51200
    ds_read_b64_tr_b16 v[132:133], v10 offset:53760
    s_waitcnt lgkmcnt(15)
    v_mfma_f32_16x16x32_bf16 v[80:83], v[136:139], v[60:63], v[80:83]
    ds_read_b64_tr_b16 v[134:135], v14 offset:54784
    ds_read_b64_tr_b16 v[136:137], v11 offset:53760
    v_mfma_f32_16x16x32_bf16 v[84:87], v[140:143], v[60:63], v[84:87]
    ds_read_b64_tr_b16 v[138:139], v15 offset:54784
    ds_read_b64_tr_b16 v[140:141], v8 offset:53760
    ds_read_b64_tr_b16 v[142:143], v12 offset:54784
    v_mfma_f32_16x16x32_bf16 v[88:91], v[144:147], v[60:63], v[88:91]
    ds_read_b64_tr_b16 v[144:145], v9 offset:53760
    ds_read_b64_tr_b16 v[146:147], v13 offset:54784
    v_mfma_f32_16x16x32_bf16 v[92:95], v[148:151], v[60:63], v[92:95]
    v_mfma_f32_16x16x32_bf16 v[80:83], v[152:155], v[64:67], v[80:83]
    v_mfma_f32_16x16x32_bf16 v[84:87], v[156:159], v[64:67], v[84:87]
    v_mfma_f32_16x16x32_bf16 v[88:91], v[160:163], v[64:67], v[88:91]
    v_mfma_f32_16x16x32_bf16 v[92:95], v[96:99], v[64:67], v[92:95]
    s_waitcnt lgkmcnt(15)
    v_mfma_f32_16x16x32_bf16 v[80:83], v[100:103], v[68:71], v[80:83]
    v_mfma_f32_16x16x32_bf16 v[84:87], v[104:107], v[68:71], v[84:87]
    v_mfma_f32_16x16x32_bf16 v[88:91], v[108:111], v[68:71], v[88:91]
    v_mfma_f32_16x16x32_bf16 v[92:95], v[112:115], v[68:71], v[92:95]
    s_waitcnt lgkmcnt(8)
    v_mfma_f32_16x16x32_bf16 v[80:83], v[116:119], v[72:75], v[80:83]
    v_mfma_f32_16x16x32_bf16 v[84:87], v[120:123], v[72:75], v[84:87]
    v_mfma_f32_16x16x32_bf16 v[88:91], v[124:127], v[72:75], v[88:91]
    v_mfma_f32_16x16x32_bf16 v[92:95], v[128:131], v[72:75], v[92:95]
    s_waitcnt lgkmcnt(0)
    v_mfma_f32_16x16x32_bf16 v[80:83], v[132:135], v[76:79], v[80:83]
    v_mfma_f32_16x16x32_bf16 v[84:87], v[136:139], v[76:79], v[84:87]
    v_mfma_f32_16x16x32_bf16 v[88:91], v[140:143], v[76:79], v[88:91]
    v_mfma_f32_16x16x32_bf16 v[92:95], v[144:147], v[76:79], v[92:95]
    s_nop 4
    v_cvt_pk_bf16_f32 v16, v80, v81
    v_cvt_pk_bf16_f32 v17, v82, v83
    v_cvt_pk_bf16_f32 v18, v84, v85
    v_cvt_pk_bf16_f32 v19, v86, v87
    v_cvt_pk_bf16_f32 v20, v88, v89
    v_cvt_pk_bf16_f32 v21, v90, v91
    v_cvt_pk_bf16_f32 v22, v92, v93
    v_cvt_pk_bf16_f32 v23, v94, v95
    v_permlane16_swap_b32 v16, v18
    v_permlane16_swap_b32 v17, v19
    v_permlane16_swap_b32 v20, v22
    v_permlane16_swap_b32 v21, v23
    s_cmp_eq_u32 s4, 0
    s_cbranch_scc0 Lslow_361
    buffer_store_dwordx4 v[16:19], v5, s[36:39], s72 offen
    buffer_store_dwordx4 v[20:23], v5, s[36:39], s72 offen offset:1024
Lsdone_362:
    v_mfma_f32_16x16x32_bf16 v[28:31], v[16:19], v[16:19], 0
    v_mfma_f32_16x16x32_bf16 v[24:27], v[164:167], v[16:19], 0
    v_mfma_f32_16x16x32_bf16 v[28:31], v[20:23], v[20:23], v[28:31]
    v_mfma_f32_16x16x32_bf16 v[24:27], v[164:167], v[20:23], v[24:27]
    s_nop 7
    v_cndmask_b32 v25, 0, v28, s[62:63]
    v_cndmask_b32 v25, v25, v29, s[64:65]
    v_cndmask_b32 v25, v25, v30, s[66:67]
    v_cndmask_b32 v25, v25, v31, s[68:69]
    s_mov_b64 exec, s[70:71]
    s_cmp_eq_u32 s4, 0
    s_cbranch_scc0 Lslow_363
    buffer_store_dwordx2 v[24:25], v168, s[36:39], s73 offen
Lsdone_364:
    s_mov_b64 exec, -1
    s_cmp_eq_u32 s4, 0
    s_cbranch_scc0 Lss_365
Lssd_367:
    s_lshr_b32 s86, s50, 1
    s_mul_i32 s86, s86, 14336
    s_and_b32 s87, s50, 1
    s_lshl_b32 s84, s87, 12
    s_add_u32 s84, s84, s86
    s_mul_i32 s85, s87, 3072
    s_add_u32 s85, s85, s86
    s_add_u32 s85, s85, 8192
    s_add_u32 s86, s55, 170496
    s_cmp_lt_u32 s53, 2
    s_cselect_b32 s31, 28672, 0
    s_add_u32 s86, s86, s31
    s_lshl_b32 s31, s31, 1
    s_lshr_b32 s87, s54, 1
    s_sub_u32 s80, s87, 0
    s_and_b32 s80, s80, 3
    s_mul_i32 s72, s80, 57344
    s_add_u32 s72, s72, s86
    s_sub_u32 s81, s87, 1
    s_and_b32 s81, s81, 3
    s_mul_i32 s73, s81, 57344
    s_add_u32 s73, s73, s86
    s_sub_u32 s82, s87, 2
    s_and_b32 s82, s82, 3
    s_mul_i32 s74, s82, 57344
    s_add_u32 s74, s74, s86
    s_sub_u32 s83, s87, 3
    s_and_b32 s83, s83, 3
    s_mul_i32 s75, s83, 57344
    s_add_u32 s75, s75, s86
    v_bfe_u32 v133, v0, 2, 3
    v_min_u32 v133, 6, v133
    v_and_b32 v132, 3, v0
    v_lshlrev_b32 v133, 11, v133
    v_lshl_add_u32 v133, v132, 7, v133
    v_lshrrev_b32 v9, 1, v2
    v_lshl_add_u32 v133, v9, 30, v133
    s_lshl_b32 s86, s80, 9
    s_add_u32 s95, s55, 491520
    s_add_u32 s86, s86, s95
    v_add_u32 v133, s86, v133
    s_lshl_b32 s87, s50, 9
    s_add_u32 s95, s95, s87
    v_lshlrev_b32 v131, 3, v0
    v_and_b32 v132, 1, v2
    v_lshlrev_b32 v8, 4, v3
    v_lshl_add_u32 v8, v9, 8, v8
    v_mul_u32_u24 v132, 14336, v132
    v_add_u32 v5, v8, v132
    v_add_u32 v8, 91648, v5
    s_lshl2_add_u32 s87, s49, s50
    s_lshl_b32 s87, s87, 10
    v_add_u32 v10, s87, v1
    s_add_u32 s76, s20, 0
    s_lshl_b32 s80, s80, 10
    s_add_u32 s80, s80, 148992
    s_add_u32 s77, s20, 229376
    s_lshl_b32 s81, s81, 10
    s_add_u32 s81, s81, 148992
    s_add_u32 s78, s20, 458752
    s_lshl_b32 s82, s82, 10
    s_add_u32 s82, s82, 148992
    s_add_u32 s79, s20, 688128
    s_lshl_b32 s83, s83, 10
    s_add_u32 s83, s83, 148992
    v_mov_b32 v46, 0
    v_mov_b32 v47, 0
    v_mov_b32 v50, 0
    v_mov_b32 v51, 0
    v_and_b32 v11, 0x1f0, v1
    s_mov_b32 s29, 6
    s_nop 1
Lp3top1:
    buffer_load_dword v130, v133, s[36:39], 0 offen sc1
    s_add_u32 m0, s84, 0
    s_add_u32 s61, s72, m0
    s_add_u32 s61, s61, 91648
    buffer_load_dwordx4 v1, s[36:39], s61 offen offset:0 sc1 lds
    buffer_load_dwordx4 v1, s[36:39], s61 offen offset:1024 sc1 lds
    buffer_load_dwordx4 v1, s[36:39], s61 offen offset:2048 sc1 lds
    buffer_load_dwordx4 v1, s[36:39], s61 offen offset:3072 sc1 lds
    v_min_u32 v9, 27, v0
    v_lshrrev_b32 v4, 2, v9
    s_lshl_b32 s86, s53, 1
    v_add_u32 v4, s86, v4
    v_subrev_u32 v6, 7, v4
    v_min_u32 v4, v4, v6
    v_and_b32 v9, 3, v9
    v_lshlrev_b32 v9, 2, v9
    v_lshl_add_u32 v6, v4, 4, v9
    s_mul_i32 s86, s50, 112
    s_add_u32 s86, s86, s58
    v_add_u32 v6, s86, v6
    v_lshrrev_b32 v4, 1, v4
    v_subrev_u32 v4, s53, v4
    v_and_b32 v4, 3, v4
    v_add_u32 v4, 11, v4
    s_lshl_b32 s88, s53, 13
    s_cmp_ge_u32 s53, 3
    s_cselect_b32 s90, 4294938624, 0
    s_cselect_b32 s89, s77, s76
    s_add_u32 s90, s90, s88
    s_add_u32 s89, s89, s90
    s_add_u32 s89, s89, 4096
    s_add_u32 s90, s90, s77
    s_add_u32 s90, s90, 8192
    s_cmp_ge_u32 s53, 2
    s_cselect_b32 s92, 4294938624, 0
    s_cselect_b32 s91, s78, s77
    s_add_u32 s92, s92, s88
    s_add_u32 s91, s91, s92
    s_add_u32 s91, s91, 12288
    s_add_u32 s92, s92, s78
    s_add_u32 s92, s92, 16384
    s_cmp_ge_u32 s53, 1
    s_cselect_b32 s94, 4294938624, 0
    s_cselect_b32 s93, s79, s78
    s_add_u32 s94, s94, s88
    s_add_u32 s93, s93, s94
    s_add_u32 s93, s93, 20480
    s_add_u32 s94, s94, s79
    s_add_u32 s94, s94, 24576
    s_add_u32 s88, s88, s76
    s_mul_i32 s86, s50, 28672
    v_add_u32 v12, s86, v1
    v_add_u32 v13, 114688, v12
    s_nop 2
    s_mov_b64 exec, 0
    s_cmp_eq_u32 s50, 0
    s_cbranch_scc1 Lcha0
    s_cmp_eq_u32 s50, 1
    s_cbranch_scc1 Lcha1
    s_cmp_eq_u32 s50, 2
    s_cbranch_scc1 Lcha2
    s_branch Lcha3
Lchar:
    s_mov_b64 exec, -1
    s_waitcnt vmcnt(4)
    v_cmp_eq_u32 vcc, -1, v130
    s_nop 0
    s_cbranch_vccnz Lpb_368
Lpbd_370:
    s_add_u32 m0, s85, 0
    s_add_u32 s61, s72, m0
    s_add_u32 s61, s61, 91648
    buffer_load_dwordx4 v1, s[36:39], s61 offen offset:0 sc1 lds
    buffer_load_dwordx4 v1, s[36:39], s61 offen offset:1024 sc1 lds
    buffer_load_dwordx4 v1, s[36:39], s61 offen offset:2048 sc1 lds
    buffer_load_dwordx2 v[116:117], v131, s[36:39], s95 offen offset:0 sc1
    buffer_load_dwordx2 v[118:119], v131, s[36:39], s95 offen offset:2048 sc1
    s_add_u32 s86, s95, 4096
    buffer_load_dwordx2 v[120:121], v131, s[36:39], s86 offen offset:0 sc1
    s_add_u32 s86, s95, 4096
    buffer_load_dwordx2 v[122:123], v131, s[36:39], s86 offen offset:2048 sc1
    s_add_u32 s86, s95, 8192
    buffer_load_dwordx2 v[124:125], v131, s[36:39], s86 offen offset:0 sc1
    s_add_u32 s86, s95, 8192
    buffer_load_dwordx2 v[126:127], v131, s[36:39], s86 offen offset:2048 sc1
    s_add_u32 s86, s95, 12288
    buffer_load_dwordx2 v[128:129], v131, s[36:39], s86 offen offset:0 sc1
    s_waitcnt vmcnt(10)
    s_barrier
    v_add_u32 v8, 0, v5
    ds_read_b128 v[68:71], v8 offset:0
    ds_read_b128 v[72:75], v8 offset:512
    ds_read_b128 v[76:79], v8 offset:1024
    ds_read_b128 v[80:83], v8 offset:1536
    ds_read_b128 v[84:87], v8 offset:2048
    ds_read_b128 v[88:91], v8 offset:2560
    s_waitcnt lgkmcnt(5)
    v_mfma_f32_32x32x16_bf16 v[52:67], a[0:3], v[68:71], 0
    ds_read_b128 v[92:95], v8 offset:3072
    ds_read_b128 v[96:99], v8 offset:3584
    ds_read_b128 v[100:103], v8 offset:4096
    s_waitcnt lgkmcnt(7)
    v_mfma_f32_32x32x16_bf16 v[52:67], a[4:7], v[72:75], v[52:67]
    ds_read_b128 v[104:107], v8 offset:4608
    ds_read_b128 v[108:111], v8 offset:5120
    ds_read_b128 v[112:115], v8 offset:5632
    s_waitcnt lgkmcnt(9)
    v_mfma_f32_32x32x16_bf16 v[52:67], a[8:11], v[76:79], v[52:67]
    s_add_u32 m0, s84, 28672
    s_add_u32 s61, s72, m0
    s_add_u32 s61, s61, 91648
    s_sub_u32 s61, s61, s31
    buffer_load_dwordx4 v1, s[36:39], s61 offen offset:0 sc1 lds
    s_waitcnt lgkmcnt(8)
    v_mfma_f32_32x32x16_bf16 v[52:67], a[12:15], v[80:83], v[52:67]
    ds_read_b128 v[68:71], v8 offset:6144
    ds_read_b128 v[72:75], v8 offset:6656
    ds_read_b128 v[76:79], v8 offset:7168
    s_waitcnt lgkmcnt(7)
    v_mfma_f32_32x32x16_bf16 v[52:67], a[16:19], v[84:87], v[52:67]
    buffer_load_dwordx4 v1, s[36:39], s61 offen offset:1024 sc1 lds
    ds_read_b128 v[80:83], v8 offset:7680
    v_mfma_f32_32x32x16_bf16 v[52:67], a[20:23], v[88:91], v[52:67]
    s_waitcnt vmcnt(7)
    v_add_f32 v116, v116, v118
    v_add_f32 v117, v117, v119
    s_waitcnt vmcnt(6)
    v_add_f32 v116, v116, v120
    v_add_f32 v117, v117, v121
    s_waitcnt vmcnt(5)
    v_add_f32 v116, v116, v122
    v_add_f32 v117, v117, v123
    v_mfma_f32_32x32x16_bf16 v[52:67], a[24:27], v[92:95], v[52:67]
    buffer_load_dwordx4 v1, s[36:39], s61 offen offset:2048 sc1 lds
    s_waitcnt vmcnt(5)
    v_add_f32 v116, v116, v124
    v_add_f32 v117, v117, v125
    s_waitcnt vmcnt(4)
    v_add_f32 v116, v116, v126
    v_mfma_f32_32x32x16_bf16 v[52:67], a[28:31], v[96:99], v[52:67]
    v_add_f32 v117, v117, v127
    s_waitcnt vmcnt(3)
    v_add_f32 v116, v116, v128
    v_add_f32 v117, v117, v129
    v_cmp_u_f32 vcc, v116, v116
    s_nop 0
    s_cbranch_vccnz Lnc_371
Lncd_373:
    v_mul_f32 v116, 0xbb124925, v116
    s_waitcnt lgkmcnt(4)
    v_mfma_f32_32x32x16_bf16 v[52:67], a[32:35], v[100:103], v[52:67]
    s_barrier
    buffer_load_dwordx4 v1, s[36:39], s61 offen offset:3072 sc1 lds
    v_mul_f32 v119, 0x3b124925, v117
    v_mfma_f32_32x32x16_bf16 v[52:67], a[36:39], v[104:107], v[52:67]
    ds_read_b128 v[84:87], v8 offset:8192
    ds_read_b128 v[88:91], v8 offset:8704
    ds_read_b128 v[92:95], v8 offset:9216
    ds_read_b128 v[96:99], v8 offset:9728
    v_mfma_f32_32x32x16_bf16 v[52:67], a[40:43], v[108:111], v[52:67]
    s_add_u32 m0, s85, 28672
    s_add_u32 s61, s72, m0
    s_add_u32 s61, s61, 91648
    s_sub_u32 s61, s61, s31
    buffer_load_dwordx4 v1, s[36:39], s61 offen offset:0 sc1 lds
    v_mfma_f32_32x32x16_bf16 v[52:67], a[44:47], v[112:115], v[52:67]
    ds_read_b128 v[100:103], v8 offset:10240
    ds_read_b128 v[104:107], v8 offset:10752
    ds_read_b128 v[108:111], v8 offset:11264
    ds_read_b128 v[112:115], v8 offset:11776
    s_waitcnt lgkmcnt(8)
    v_mfma_f32_32x32x16_bf16 v[52:67], a[48:51], v[68:71], v[52:67]
    buffer_load_dwordx4 v1, s[36:39], s61 offen offset:1024 sc1 lds
    ds_read_b128 v[68:71], v8 offset:12288
    v_mfma_f32_32x32x16_bf16 v[52:67], a[52:55], v[72:75], v[52:67]
    ds_read_b128 v[72:75], v8 offset:12800
    v_fma_f32 v119, -v116, v116, v119
    v_max_f32 v119, 0, v119
    v_cvt_pk_bf16_f32 v116, v116, v116
    v_cvt_pk_bf16_f32 v119, v119, v119
    v_mfma_f32_32x32x16_bf16 v[52:67], a[56:59], v[76:79], v[52:67]
    buffer_load_dwordx4 v1, s[36:39], s61 offen offset:2048 sc1 lds
    ds_read_b128 v[76:79], v8 offset:13312
    v_lshlrev_b32 v119, 16, v119
    v_mfma_f32_32x32x16_bf16 v[52:67], a[60:63], v[80:83], v[52:67]
    ds_read_b128 v[80:83], v8 offset:13824
    v_add_f32 v119, 0x3727c5ac, v119
    v_cvt_pk_bf16_f32 v119, v119, v119
    v_lshlrev_b32 v119, 16, v119
    s_waitcnt lgkmcnt(8)
    v_mfma_f32_32x32x16_bf16 v[52:67], a[64:67], v[84:87], v[52:67]
    s_add_u32 m0, s84, 57344
    s_add_u32 s61, s73, m0
    s_add_u32 s61, s61, 34304
    buffer_load_dwordx4 v1, s[36:39], s61 offen offset:0 sc1 lds
    v_mfma_f32_32x32x16_bf16 v[52:67], a[68:71], v[88:91], v[52:67]
    v_sqrt_f32 v119, v119
    s_nop 0
    v_cvt_pk_bf16_f32 v119, v119, v119
    v_lshlrev_b32 v119, 16, v119
    v_rcp_f32 v118, v119
    v_mfma_f32_32x32x16_bf16 v[52:67], a[72:75], v[92:95], v[52:67]
    buffer_load_dwordx4 v1, s[36:39], s61 offen offset:1024 sc1 lds
    v_mul_f32 v117, 0xbfb8aa3b, v118
    v_and_b32 v117, 0xffffff7f, v117
    v_mul_f32 v118, v118, v118
    v_mfma_f32_32x32x16_bf16 v[52:67], a[76:79], v[96:99], v[52:67]
    s_lshr_b32 s87, s31, 6
    s_and_b32 s87, s87, 512
    v_xor_b32 v131, s87, v1
    s_lshl_b32 s87, s50, 10
    s_add_u32 s87, s87, 148992
    v_add_u32 v131, s87, v131
    s_waitcnt lgkmcnt(4)
    v_mfma_f32_32x32x16_bf16 v[52:67], a[80:83], v[100:103], v[52:67]
    buffer_load_dwordx4 v1, s[36:39], s61 offen offset:2048 sc1 lds
    v_mfma_f32_32x32x16_bf16 v[52:67], a[84:87], v[104:107], v[52:67]
    ds_write_b128 v131, v[116:119]
    s_waitcnt vmcnt(3) lgkmcnt(0)
    s_barrier
    v_add_u32 v7, s80, v11
    ds_read_b64 v[44:45], v7 offset:0
    v_mfma_f32_32x32x16_bf16 v[52:67], a[88:91], v[108:111], v[52:67]
    v_mov_b32 v7, 10
    s_cmp_eq_u32 s4, 0
    s_cbranch_scc0 Lslow_374
    buffer_store_dword v7, off, s[36:39], s56
Lsdone_375:
    buffer_load_dwordx4 v1, s[36:39], s61 offen offset:3072 sc1 lds
    v_mfma_f32_32x32x16_bf16 v[52:67], a[92:95], v[112:115], v[52:67]
    ds_read_b128 v[84:87], v8 offset:28672
    ds_read_b128 v[88:91], v8 offset:29184
    ds_read_b128 v[92:95], v8 offset:29696
    ds_read_b128 v[96:99], v8 offset:30208
    v_mfma_f32_32x32x16_bf16 v[52:67], a[96:99], v[68:71], v[52:67]
    s_add_u32 m0, s85, 57344
    s_add_u32 s61, s73, m0
    s_add_u32 s61, s61, 34304
    buffer_load_dwordx4 v1, s[36:39], s61 offen offset:0 sc1 lds
    v_mfma_f32_32x32x16_bf16 v[52:67], a[100:103], v[72:75], v[52:67]
    ds_read_b128 v[100:103], v8 offset:30720
    ds_read_b128 v[104:107], v8 offset:31232
    ds_read_b128 v[108:111], v8 offset:31744
    ds_read_b128 v[112:115], v8 offset:32256
    v_mfma_f32_32x32x16_bf16 v[52:67], a[104:107], v[76:79], v[52:67]
    buffer_load_dwordx4 v1, s[36:39], s61 offen offset:1024 sc1 lds
    ds_read_b128 v[68:71], v8 offset:32768
    ds_read_b128 v[72:75], v8 offset:33280
    v_mfma_f32_32x32x16_bf16 v[52:67], a[108:111], v[80:83], v[52:67]
    ds_read_b128 v[76:79], v8 offset:33792
    ds_read_b128 v[80:83], v8 offset:34304
    s_waitcnt lgkmcnt(12)
    v_mfma_f32_32x32x16_bf16 v[52:67], v[172:175], v[44:47], v[52:67]
    buffer_load_dwordx4 v1, s[36:39], s61 offen offset:2048 sc1 lds
    s_waitcnt lgkmcnt(8)
    v_mfma_f32_32x32x16_bf16 v[16:31], a[0:3], v[84:87], 0
    ds_read_b128 v[84:87], v8 offset:34816
    v_mfma_f32_32x32x16_bf16 v[16:31], a[4:7], v[88:91], v[16:31]
    s_add_u32 m0, s84, 91648
    s_add_u32 s61, s73, m0
    s_add_u32 s61, s61, 28672
    s_sub_u32 s61, s61, s31
    buffer_load_dwordx4 v1, s[36:39], s61 offen offset:0 sc1 lds
    v_mfma_f32_32x32x16_bf16 v[16:31], a[8:11], v[92:95], v[16:31]
    ds_read_b128 v[88:91], v8 offset:35328
    ds_read_b128 v[92:95], v8 offset:35840
    v_mul_f32 v32, v45, v52
    v_mul_f32 v33, v45, v53
    v_mfma_f32_32x32x16_bf16 v[16:31], a[12:15], v[96:99], v[16:31]
    buffer_load_dwordx4 v1, s[36:39], s61 offen offset:1024 sc1 lds
    ds_read_b128 v[96:99], v8 offset:36352
    s_waitcnt lgkmcnt(8)
    v_mfma_f32_32x32x16_bf16 v[16:31], a[16:19], v[100:103], v[16:31]
    ds_read_b128 v[100:103], v8 offset:36864
    v_cmp_u_f32 vcc, v52, v52
    s_nop 0
    s_cbranch_vccnz Lnn_376
Lnnd_377:
    v_mfma_f32_32x32x16_bf16 v[16:31], a[20:23], v[104:107], v[16:31]
    buffer_load_dwordx4 v1, s[36:39], s61 offen offset:2048 sc1 lds
    ds_read_b128 v[104:107], v8 offset:37376
    v_exp_f32 v32, v32
    v_mfma_f32_32x32x16_bf16 v[16:31], a[24:27], v[108:111], v[16:31]
    ds_read_b128 v[108:111], v8 offset:37888
    v_mul_f32 v34, v45, v54
    v_mul_f32 v52, v60, v52
    v_exp_f32 v33, v33
    v_mul_f32 v35, v45, v55
    v_mfma_f32_32x32x16_bf16 v[16:31], a[28:31], v[112:115], v[16:31]
    buffer_load_dwordx4 v1, s[36:39], s61 offen offset:3072 sc1 lds
    ds_read_b128 v[112:115], v8 offset:38400
    v_mul_f32 v53, v61, v53
    s_waitcnt lgkmcnt(8)
    v_mfma_f32_32x32x16_bf16 v[16:31], a[32:35], v[68:71], v[16:31]
    ds_read_b128 v[68:71], v8 offset:38912
    v_exp_f32 v34, v34
    v_mul_f32 v36, v45, v56
    v_mul_f32 v54, v62, v54
    v_mfma_f32_32x32x16_bf16 v[16:31], a[36:39], v[72:75], v[16:31]
    s_add_u32 m0, s85, 91648
    s_add_u32 s61, s73, m0
    s_add_u32 s61, s61, 28672
    s_sub_u32 s61, s61, s31
    buffer_load_dwordx4 v1, s[36:39], s61 offen offset:0 sc1 lds
    v_mfma_f32_32x32x16_bf16 v[16:31], a[40:43], v[76:79], v[16:31]
    ds_read_b128 v[72:75], v8 offset:39424
    ds_read_b128 v[76:79], v8 offset:39936
    v_exp_f32 v35, v35
    v_mul_f32 v37, v45, v57
    v_mul_f32 v55, v63, v55
    v_mfma_f32_32x32x16_bf16 v[16:31], a[44:47], v[80:83], v[16:31]
    buffer_load_dwordx4 v1, s[36:39], s61 offen offset:1024 sc1 lds
    ds_read_b128 v[80:83], v8 offset:40448
    v_exp_f32 v36, v36
    s_waitcnt lgkmcnt(8)
    v_mfma_f32_32x32x16_bf16 v[16:31], a[48:51], v[84:87], v[16:31]
    ds_read_b128 v[84:87], v8 offset:40960
    v_mul_f32 v38, v45, v58
    v_mul_f32 v56, v64, v56
    v_exp_f32 v37, v37
    v_mfma_f32_32x32x16_bf16 v[16:31], a[52:55], v[88:91], v[16:31]
    buffer_load_dwordx4 v1, s[36:39], s61 offen offset:2048 sc1 lds
    ds_read_b128 v[88:91], v8 offset:41472
    v_mul_f32 v39, v45, v59
    v_mul_f32 v57, v65, v57
    v_mfma_f32_32x32x16_bf16 v[16:31], a[56:59], v[92:95], v[16:31]
    ds_read_b128 v[92:95], v8 offset:41984
    v_exp_f32 v38, v38
    v_mul_f32 v58, v66, v58
    v_add_f32 v32, 1.0, v32
    v_mfma_f32_32x32x16_bf16 v[16:31], a[60:63], v[96:99], v[16:31]
    s_add_u32 m0, s84, 120320
    s_add_u32 s61, s74, m0
    s_add_u32 s61, s61, 4294938624
    buffer_load_dwordx4 v1, s[36:39], s61 offen offset:0 sc1 lds
    s_waitcnt lgkmcnt(7)
    v_mfma_f32_32x32x16_bf16 v[16:31], a[64:67], v[100:103], v[16:31]
    s_waitcnt vmcnt(8)
    s_barrier
    ds_read_b128 v[96:99], v8 offset:42496
    v_add_u32 v8, 57344, v5
    ds_read_b128 v[100:103], v8 offset:0
    v_mfma_f32_32x32x16_bf16 v[16:31], a[68:71], v[104:107], v[16:31]
    buffer_load_dwordx4 v1, s[36:39], s61 offen offset:1024 sc1 lds
    ds_read_b128 v[104:107], v8 offset:512
    v_exp_f32 v39, v39
    v_mfma_f32_32x32x16_bf16 v[16:31], a[72:75], v[108:111], v[16:31]
    ds_read_b128 v[108:111], v8 offset:1024
    v_mul_f32 v59, v67, v59
    v_add_f32 v33, 1.0, v33
    v_rcp_f32 v32, v32
    v_add_f32 v34, 1.0, v34
    v_mfma_f32_32x32x16_bf16 v[16:31], a[76:79], v[112:115], v[16:31]
    buffer_load_dwordx4 v1, s[36:39], s61 offen offset:2048 sc1 lds
    ds_read_b128 v[112:115], v8 offset:1536
    v_add_f32 v35, 1.0, v35
    s_waitcnt lgkmcnt(8)
    v_mfma_f32_32x32x16_bf16 v[16:31], a[80:83], v[68:71], v[16:31]
    ds_read_b128 v[68:71], v8 offset:2048
    v_rcp_f32 v33, v33
    v_mul_f32 v32, v32, v52
    v_add_f32 v36, 1.0, v36
    v_mfma_f32_32x32x16_bf16 v[16:31], a[84:87], v[72:75], v[16:31]
    v_add_u32 v7, s80, v11
    ds_read_b64 v[48:49], v7 offset:512
    v_min_u32 v136, 55, v0
    v_lshl_add_u32 v136, v136, 3, s58
    buffer_load_dwordx2 v[14:15], v136, s[36:39], 0 offen sc1
    ds_read_b128 v[72:75], v8 offset:2560
    v_mfma_f32_32x32x16_bf16 v[16:31], a[88:91], v[76:79], v[16:31]
    ds_read_b128 v[76:79], v8 offset:3072
    v_rcp_f32 v34, v34
    v_mul_f32 v33, v33, v53
    v_add_f32 v37, 1.0, v37
    v_mfma_f32_32x32x16_bf16 v[16:31], a[92:95], v[80:83], v[16:31]
    buffer_load_dwordx4 v1, s[36:39], s61 offen offset:3072 sc1 lds
    ds_read_b128 v[80:83], v8 offset:3584
    v_rcp_f32 v35, v35
    s_waitcnt lgkmcnt(9)
    v_mfma_f32_32x32x16_bf16 v[16:31], a[96:99], v[84:87], v[16:31]
    ds_read_b128 v[84:87], v8 offset:4096
    v_mul_f32 v34, v34, v54
    v_add_f32 v38, 1.0, v38
    v_rcp_f32 v36, v36
    v_mfma_f32_32x32x16_bf16 v[16:31], a[100:103], v[88:91], v[16:31]
    s_add_u32 m0, s85, 120320
    s_add_u32 s61, s74, m0
    s_add_u32 s61, s61, 4294938624
    buffer_load_dwordx4 v1, s[36:39], s61 offen offset:0 sc1 lds
    v_mul_f32 v35, v35, v55
    v_mfma_f32_32x32x16_bf16 v[16:31], a[104:107], v[92:95], v[16:31]
    ds_read_b128 v[88:91], v8 offset:4608
    ds_read_b128 v[92:95], v8 offset:5120
    v_add_f32 v39, 1.0, v39
    v_rcp_f32 v37, v37
    v_mul_f32 v36, v36, v56
    v_mfma_f32_32x32x16_bf16 v[16:31], a[108:111], v[96:99], v[16:31]
    buffer_load_dwordx4 v1, s[36:39], s61 offen offset:1024 sc1 lds
    ds_read_b128 v[96:99], v8 offset:5632
    v_cvt_pk_bf16_f32 v40, v32, v33
    s_waitcnt lgkmcnt(7)
    v_mfma_f32_32x32x16_bf16 v[16:31], v[172:175], v[48:51], v[16:31]
    v_rcp_f32 v38, v38
    v_mul_f32 v37, v37, v57
    v_cvt_pk_bf16_f32 v41, v34, v35
    v_rcp_f32 v39, v39
    v_mul_f32 v38, v38, v58
    v_cvt_pk_bf16_f32 v42, v36, v37
    v_mul_f32 v39, v39, v59
    v_mfma_f32_32x32x16_bf16 v[52:67], a[0:3], v[100:103], 0
    buffer_load_dwordx4 v1, s[36:39], s61 offen offset:2048 sc1 lds
    ds_read_b128 v[100:103], v8 offset:6144
    v_cvt_pk_bf16_f32 v43, v38, v39
    v_mfma_f32_32x32x16_bf16 v[52:67], a[4:7], v[104:107], v[52:67]
    ds_read_b128 v[104:107], v8 offset:6656
    s_add_u32 s87, s76, 0
    s_cmp_eq_u32 s4, 0
    s_cbranch_scc0 Lslow_378
    buffer_store_dwordx4 v[40:43], v10, s[36:39], s87 offen
Lsdone_379:
    v_mfma_f32_32x32x16_bf16 v[52:67], a[8:11], v[108:111], v[52:67]
    ds_read_b128 v[108:111], v8 offset:7168
    v_mul_f32 v32, v49, v16
    v_mul_f32 v33, v49, v17
    v_mfma_f32_32x32x16_bf16 v[52:67], a[12:15], v[112:115], v[52:67]
    ds_read_b128 v[112:115], v8 offset:7680
    v_cmp_u_f32 vcc, v16, v16
    s_nop 0
    s_cbranch_vccnz Lnn_380
Lnnd_381:
    s_waitcnt lgkmcnt(8)
    v_mfma_f32_32x32x16_bf16 v[52:67], a[16:19], v[68:71], v[52:67]
    ds_read_b128 v[68:71], v8 offset:8192
    v_exp_f32 v32, v32
    v_mul_f32 v34, v49, v18
    v_mfma_f32_32x32x16_bf16 v[52:67], a[20:23], v[72:75], v[52:67]
    ds_read_b128 v[72:75], v8 offset:8704
    v_mul_f32 v16, v24, v16
    v_exp_f32 v33, v33
    v_mul_f32 v35, v49, v19
    v_mfma_f32_32x32x16_bf16 v[52:67], a[24:27], v[76:79], v[52:67]
    ds_read_b128 v[76:79], v8 offset:9216
    v_mul_f32 v17, v25, v17
    v_exp_f32 v34, v34
    v_mul_f32 v36, v49, v20
    v_mfma_f32_32x32x16_bf16 v[52:67], a[28:31], v[80:83], v[52:67]
    ds_read_b128 v[80:83], v8 offset:9728
    v_mul_f32 v18, v26, v18
    v_exp_f32 v35, v35
    v_mul_f32 v37, v49, v21
    s_waitcnt lgkmcnt(8)
    v_mfma_f32_32x32x16_bf16 v[52:67], a[32:35], v[84:87], v[52:67]
    ds_read_b128 v[84:87], v8 offset:10240
    v_mul_f32 v19, v27, v19
    v_exp_f32 v36, v36
    v_mfma_f32_32x32x16_bf16 v[52:67], a[36:39], v[88:91], v[52:67]
    ds_read_b128 v[88:91], v8 offset:10752
    v_mul_f32 v38, v49, v22
    v_mul_f32 v20, v28, v20
    v_exp_f32 v37, v37
    v_mfma_f32_32x32x16_bf16 v[52:67], a[40:43], v[92:95], v[52:67]
    ds_read_b128 v[92:95], v8 offset:11264
    v_mul_f32 v39, v49, v23
    v_mul_f32 v21, v29, v21
    v_exp_f32 v38, v38
    v_mfma_f32_32x32x16_bf16 v[52:67], a[44:47], v[96:99], v[52:67]
    ds_read_b128 v[96:99], v8 offset:11776
    v_mul_f32 v22, v30, v22
    v_add_f32 v32, 1.0, v32
    v_exp_f32 v39, v39
    s_waitcnt lgkmcnt(8)
    v_mfma_f32_32x32x16_bf16 v[52:67], a[48:51], v[100:103], v[52:67]
    ds_read_b128 v[100:103], v8 offset:12288
    v_mul_f32 v23, v31, v23
    v_add_f32 v33, 1.0, v33
    v_mfma_f32_32x32x16_bf16 v[52:67], a[52:55], v[104:107], v[52:67]
    ds_read_b128 v[104:107], v8 offset:12800
    v_rcp_f32 v32, v32
    v_add_f32 v34, 1.0, v34
    v_add_f32 v35, 1.0, v35
    v_mfma_f32_32x32x16_bf16 v[52:67], a[56:59], v[108:111], v[52:67]
    ds_read_b128 v[108:111], v8 offset:13312
    v_rcp_f32 v33, v33
    v_mul_f32 v32, v32, v16
    v_add_f32 v36, 1.0, v36
    v_mfma_f32_32x32x16_bf16 v[52:67], a[60:63], v[112:115], v[52:67]
    s_waitcnt vmcnt(5)
    v_min_u32 v14, v14, v15
    v_cmp_gt_u32 vcc, 10, v14
    s_nop 0
    s_cbranch_vccnz Lps_382
Lpd_383:
    s_waitcnt lgkmcnt(7)
    v_mfma_f32_32x32x16_bf16 v[52:67], a[64:67], v[68:71], v[52:67]
    s_waitcnt vmcnt(1)
    s_barrier
    s_add_u32 m0, s84, 0
    s_add_u32 s61, s74, m0
    s_add_u32 s61, s61, 120320
    s_sub_u32 s61, s61, s31
    buffer_load_dwordx4 v1, s[36:39], s61 offen offset:0 sc1 lds
    v_mfma_f32_32x32x16_bf16 v[52:67], a[68:71], v[72:75], v[52:67]
    ds_read_b128 v[112:115], v8 offset:13824
    ds_read_b128 v[68:71], v8 offset:34304
    ds_read_b128 v[72:75], v8 offset:34816
    v_mfma_f32_32x32x16_bf16 v[52:67], a[72:75], v[76:79], v[52:67]
    buffer_load_dwordx4 v1, s[36:39], s61 offen offset:1024 sc1 lds
    ds_read_b128 v[76:79], v8 offset:35328
    v_mfma_f32_32x32x16_bf16 v[52:67], a[76:79], v[80:83], v[52:67]
    ds_read_b128 v[80:83], v8 offset:35840
    v_rcp_f32 v34, v34
    v_mul_f32 v33, v33, v17
    v_add_f32 v37, 1.0, v37
    s_waitcnt lgkmcnt(8)
    v_mfma_f32_32x32x16_bf16 v[52:67], a[80:83], v[84:87], v[52:67]
    buffer_load_dwordx4 v1, s[36:39], s61 offen offset:2048 sc1 lds
    ds_read_b128 v[84:87], v8 offset:36352
    v_mfma_f32_32x32x16_bf16 v[52:67], a[84:87], v[88:91], v[52:67]
    v_add_u32 v7, s81, v11
    ds_read_b64 v[44:45], v7 offset:0
    ds_read_b128 v[88:91], v8 offset:36864
    v_rcp_f32 v35, v35
    v_mfma_f32_32x32x16_bf16 v[52:67], a[88:91], v[92:95], v[52:67]
    buffer_load_dwordx4 v1, s[36:39], s61 offen offset:3072 sc1 lds
    ds_read_b128 v[92:95], v8 offset:37376
    v_mul_f32 v34, v34, v18
    v_mfma_f32_32x32x16_bf16 v[52:67], a[92:95], v[96:99], v[52:67]
    ds_read_b128 v[96:99], v8 offset:37888
    v_add_f32 v38, 1.0, v38
    v_rcp_f32 v36, v36
    v_mul_f32 v35, v35, v19
    s_waitcnt lgkmcnt(9)
    v_mfma_f32_32x32x16_bf16 v[52:67], a[96:99], v[100:103], v[52:67]
    s_add_u32 m0, s85, 0
    s_add_u32 s61, s74, m0
    s_add_u32 s61, s61, 120320
    s_sub_u32 s61, s61, s31
    buffer_load_dwordx4 v1, s[36:39], s61 offen offset:0 sc1 lds
    v_mfma_f32_32x32x16_bf16 v[52:67], a[100:103], v[104:107], v[52:67]
    ds_read_b128 v[100:103], v8 offset:38400
    ds_read_b128 v[104:107], v8 offset:38912
    v_add_f32 v39, 1.0, v39
    v_rcp_f32 v37, v37
    v_mfma_f32_32x32x16_bf16 v[52:67], a[104:107], v[108:111], v[52:67]
    buffer_load_dwordx4 v1, s[36:39], s61 offen offset:1024 sc1 lds
    ds_read_b128 v[108:111], v8 offset:39424
    v_mul_f32 v36, v36, v20
    v_mfma_f32_32x32x16_bf16 v[52:67], a[108:111], v[112:115], v[52:67]
    ds_read_b128 v[112:115], v8 offset:39936
    v_cvt_pk_bf16_f32 v40, v32, v33
    v_rcp_f32 v38, v38
    v_mul_f32 v37, v37, v21
    s_waitcnt lgkmcnt(7)
    v_mfma_f32_32x32x16_bf16 v[52:67], v[172:175], v[44:47], v[52:67]
    v_cvt_pk_bf16_f32 v41, v34, v35
    v_rcp_f32 v39, v39
    v_mul_f32 v38, v38, v22
    v_cvt_pk_bf16_f32 v42, v36, v37
    v_mul_f32 v39, v39, v23
    buffer_load_dwordx4 v1, s[36:39], s61 offen offset:2048 sc1 lds
    v_mfma_f32_32x32x16_bf16 v[16:31], a[0:3], v[68:71], 0
    ds_read_b128 v[68:71], v8 offset:40448
    v_cvt_pk_bf16_f32 v43, v38, v39
    v_mfma_f32_32x32x16_bf16 v[16:31], a[4:7], v[72:75], v[16:31]
    s_add_u32 m0, s84, 28672
    s_add_u32 s61, s75, m0
    s_add_u32 s61, s61, 62976
    buffer_load_dwordx4 v1, s[36:39], s61 offen offset:0 sc1 lds
    v_mfma_f32_32x32x16_bf16 v[16:31], a[8:11], v[76:79], v[16:31]
    s_add_u32 s87, s76, 114688
    s_cmp_eq_u32 s4, 0
    s_cbranch_scc0 Lslow_385
    buffer_store_dwordx4 v[40:43], v10, s[36:39], s87 offen
Lsdone_386:
    ds_read_b128 v[72:75], v8 offset:40960
    v_mfma_f32_32x32x16_bf16 v[16:31], a[12:15], v[80:83], v[16:31]
    ds_read_b128 v[76:79], v8 offset:41472
    ds_read_b128 v[80:83], v8 offset:41984
    v_mul_f32 v32, v45, v52
    v_mul_f32 v33, v45, v53
    s_waitcnt lgkmcnt(8)
    v_mfma_f32_32x32x16_bf16 v[16:31], a[16:19], v[84:87], v[16:31]
    buffer_load_dwordx4 v1, s[36:39], s61 offen offset:1024 sc1 lds
    ds_read_b128 v[84:87], v8 offset:42496
    v_mfma_f32_32x32x16_bf16 v[16:31], a[20:23], v[88:91], v[16:31]
    ds_read_b128 v[88:91], v8 offset:43008
    v_cmp_u_f32 vcc, v52, v52
    s_nop 0
    s_cbranch_vccnz Lnn_387
Lnnd_388:
    v_mfma_f32_32x32x16_bf16 v[16:31], a[24:27], v[92:95], v[16:31]
    buffer_load_dwordx4 v1, s[36:39], s61 offen offset:2048 sc1 lds
    ds_read_b128 v[92:95], v8 offset:43520
    v_mfma_f32_32x32x16_bf16 v[16:31], a[28:31], v[96:99], v[16:31]
    ds_read_b128 v[96:99], v8 offset:44032
    v_exp_f32 v32, v32
    v_mul_f32 v34, v45, v54
    v_mul_f32 v52, v60, v52
    s_waitcnt lgkmcnt(8)
    v_mfma_f32_32x32x16_bf16 v[16:31], a[32:35], v[100:103], v[16:31]
    buffer_load_dwordx4 v1, s[36:39], s61 offen offset:3072 sc1 lds
    ds_read_b128 v[100:103], v8 offset:44544
    v_mfma_f32_32x32x16_bf16 v[16:31], a[36:39], v[104:107], v[16:31]
    ds_read_b128 v[104:107], v8 offset:45056
    v_exp_f32 v33, v33
    v_mul_f32 v35, v45, v55
    v_mul_f32 v53, v61, v53
    v_mfma_f32_32x32x16_bf16 v[16:31], a[40:43], v[108:111], v[16:31]
    s_add_u32 m0, s85, 28672
    s_add_u32 s61, s75, m0
    s_add_u32 s61, s61, 62976
    buffer_load_dwordx4 v1, s[36:39], s61 offen offset:0 sc1 lds
    v_mfma_f32_32x32x16_bf16 v[16:31], a[44:47], v[112:115], v[16:31]
    ds_read_b128 v[108:111], v8 offset:45568
    ds_read_b128 v[112:115], v8 offset:46080
    v_exp_f32 v34, v34
    v_mul_f32 v36, v45, v56
    s_waitcnt lgkmcnt(8)
    v_mfma_f32_32x32x16_bf16 v[16:31], a[48:51], v[68:71], v[16:31]
    buffer_load_dwordx4 v1, s[36:39], s61 offen offset:1024 sc1 lds
    ds_read_b128 v[68:71], v8 offset:46592
    v_mfma_f32_32x32x16_bf16 v[16:31], a[52:55], v[72:75], v[16:31]
    ds_read_b128 v[72:75], v8 offset:47104
    v_mul_f32 v54, v62, v54
    v_exp_f32 v35, v35
    v_mul_f32 v37, v45, v57
    v_mfma_f32_32x32x16_bf16 v[16:31], a[56:59], v[76:79], v[16:31]
    buffer_load_dwordx4 v1, s[36:39], s61 offen offset:2048 sc1 lds
    ds_read_b128 v[76:79], v8 offset:47616
    v_mul_f32 v55, v63, v55
    v_mfma_f32_32x32x16_bf16 v[16:31], a[60:63], v[80:83], v[16:31]
    ds_read_b128 v[80:83], v8 offset:48128
    v_exp_f32 v36, v36
    v_mul_f32 v38, v45, v58
    v_mul_f32 v56, v64, v56
    s_waitcnt lgkmcnt(8)
    v_mfma_f32_32x32x16_bf16 v[16:31], a[64:67], v[84:87], v[16:31]
    s_waitcnt vmcnt(6)
    v_mov_b32 v7, 11
    s_cmp_eq_u32 s4, 0
    s_cbranch_scc0 Lslow_389
    buffer_store_dword v7, off, s[36:39], s56
Lsdone_390:
    v_mfma_f32_32x32x16_bf16 v[16:31], a[68:71], v[88:91], v[16:31]
    v_add_u32 v8, 120320, v5
    ds_read_b128 v[84:87], v8 offset:0
    ds_read_b128 v[88:91], v8 offset:512
    v_exp_f32 v37, v37
    v_mfma_f32_32x32x16_bf16 v[16:31], a[72:75], v[92:95], v[16:31]
    ds_read_b128 v[92:95], v8 offset:1024
    v_mul_f32 v39, v45, v59
    v_mul_f32 v57, v65, v57
    v_exp_f32 v38, v38
    v_mfma_f32_32x32x16_bf16 v[16:31], a[76:79], v[96:99], v[16:31]
    ds_read_b128 v[96:99], v8 offset:1536
    v_mul_f32 v58, v66, v58
    v_add_f32 v32, 1.0, v32
    v_exp_f32 v39, v39
    s_waitcnt lgkmcnt(8)
    v_mfma_f32_32x32x16_bf16 v[16:31], a[80:83], v[100:103], v[16:31]
    ds_read_b128 v[100:103], v8 offset:2048
    v_mul_f32 v59, v67, v59
    v_add_f32 v33, 1.0, v33
    v_mfma_f32_32x32x16_bf16 v[16:31], a[84:87], v[104:107], v[16:31]
    v_add_u32 v7, s81, v11
    ds_read_b64 v[48:49], v7 offset:512
    ds_read_b128 v[104:107], v8 offset:2560
    v_rcp_f32 v32, v32
    v_mfma_f32_32x32x16_bf16 v[16:31], a[88:91], v[108:111], v[16:31]
    ds_read_b128 v[108:111], v8 offset:3072
    v_add_f32 v34, 1.0, v34
    v_add_f32 v35, 1.0, v35
    v_rcp_f32 v33, v33
    v_mfma_f32_32x32x16_bf16 v[16:31], a[92:95], v[112:115], v[16:31]
    ds_read_b128 v[112:115], v8 offset:3584
    v_mul_f32 v32, v32, v52
    v_add_f32 v36, 1.0, v36
    v_rcp_f32 v34, v34
    s_waitcnt lgkmcnt(9)
    v_mfma_f32_32x32x16_bf16 v[16:31], a[96:99], v[68:71], v[16:31]
    ds_read_b128 v[68:71], v8 offset:4096
    v_mul_f32 v33, v33, v53
    v_add_f32 v37, 1.0, v37
    v_mfma_f32_32x32x16_bf16 v[16:31], a[100:103], v[72:75], v[16:31]
    ds_read_b128 v[72:75], v8 offset:4608
    v_rcp_f32 v35, v35
    v_mul_f32 v34, v34, v54
    v_add_f32 v38, 1.0, v38
    v_mfma_f32_32x32x16_bf16 v[16:31], a[104:107], v[76:79], v[16:31]
    ds_read_b128 v[76:79], v8 offset:5120
    v_rcp_f32 v36, v36
    v_mul_f32 v35, v35, v55
    v_add_f32 v39, 1.0, v39
    v_mfma_f32_32x32x16_bf16 v[16:31], a[108:111], v[80:83], v[16:31]
    ds_read_b128 v[80:83], v8 offset:5632
    v_rcp_f32 v37, v37
    v_mul_f32 v36, v36, v56
    v_cvt_pk_bf16_f32 v40, v32, v33
    s_waitcnt lgkmcnt(7)
    v_mfma_f32_32x32x16_bf16 v[16:31], v[172:175], v[48:51], v[16:31]
    v_rcp_f32 v38, v38
    v_mul_f32 v37, v37, v57
    v_cvt_pk_bf16_f32 v41, v34, v35
    v_rcp_f32 v39, v39
    v_mul_f32 v38, v38, v58
    v_cvt_pk_bf16_f32 v42, v36, v37
    v_mul_f32 v39, v39, v59
    v_mfma_f32_32x32x16_bf16 v[52:67], a[0:3], v[84:87], 0
    ds_read_b128 v[84:87], v8 offset:6144
    v_cvt_pk_bf16_f32 v43, v38, v39
    s_add_u32 s87, s77, 0
    s_cmp_eq_u32 s4, 0
    s_cbranch_scc0 Lslow_391
    buffer_store_dwordx4 v[40:43], v10, s[36:39], s87 offen
Lsdone_392:
    v_mfma_f32_32x32x16_bf16 v[52:67], a[4:7], v[88:91], v[52:67]
    ds_read_b128 v[88:91], v8 offset:6656
    v_mfma_f32_32x32x16_bf16 v[52:67], a[8:11], v[92:95], v[52:67]
    ds_read_b128 v[92:95], v8 offset:7168
    v_mul_f32 v32, v49, v16
    v_mul_f32 v33, v49, v17
    v_cmp_u_f32 vcc, v16, v16
    s_nop 0
    s_cbranch_vccnz Lnn_393
Lnnd_394:
    v_mfma_f32_32x32x16_bf16 v[52:67], a[12:15], v[96:99], v[52:67]
    ds_read_b128 v[96:99], v8 offset:7680
    v_exp_f32 v32, v32
    v_mul_f32 v34, v49, v18
    v_mul_f32 v16, v24, v16
    s_waitcnt lgkmcnt(8)
    v_mfma_f32_32x32x16_bf16 v[52:67], a[16:19], v[100:103], v[52:67]
    ds_read_b128 v[100:103], v8 offset:8192
    v_exp_f32 v33, v33
    v_mul_f32 v35, v49, v19
    v_mul_f32 v17, v25, v17
    v_mfma_f32_32x32x16_bf16 v[52:67], a[20:23], v[104:107], v[52:67]
    ds_read_b128 v[104:107], v8 offset:8704
    v_exp_f32 v34, v34
    v_mul_f32 v36, v49, v20
    v_mul_f32 v18, v26, v18
    v_mfma_f32_32x32x16_bf16 v[52:67], a[24:27], v[108:111], v[52:67]
    ds_read_b128 v[108:111], v8 offset:9216
    v_exp_f32 v35, v35
    v_mul_f32 v37, v49, v21
    v_mul_f32 v19, v27, v19
    v_mfma_f32_32x32x16_bf16 v[52:67], a[28:31], v[112:115], v[52:67]
    ds_read_b128 v[112:115], v8 offset:9728
    v_exp_f32 v36, v36
    v_mul_f32 v38, v49, v22
    v_mul_f32 v20, v28, v20
    s_waitcnt lgkmcnt(8)
    v_mfma_f32_32x32x16_bf16 v[52:67], a[32:35], v[68:71], v[52:67]
    ds_read_b128 v[68:71], v8 offset:10240
    v_exp_f32 v37, v37
    v_mul_f32 v39, v49, v23
    v_mul_f32 v21, v29, v21
    v_mfma_f32_32x32x16_bf16 v[52:67], a[36:39], v[72:75], v[52:67]
    ds_read_b128 v[72:75], v8 offset:10752
    v_exp_f32 v38, v38
    v_mul_f32 v22, v30, v22
    v_add_f32 v32, 1.0, v32
    v_mfma_f32_32x32x16_bf16 v[52:67], a[40:43], v[76:79], v[52:67]
    ds_read_b128 v[76:79], v8 offset:11264
    v_exp_f32 v39, v39
    v_mul_f32 v23, v31, v23
    v_add_f32 v33, 1.0, v33
    v_mfma_f32_32x32x16_bf16 v[52:67], a[44:47], v[80:83], v[52:67]
    ds_read_b128 v[80:83], v8 offset:11776
    v_rcp_f32 v32, v32
    v_add_f32 v34, 1.0, v34
    v_add_f32 v35, 1.0, v35
    s_waitcnt lgkmcnt(8)
    v_mfma_f32_32x32x16_bf16 v[52:67], a[48:51], v[84:87], v[52:67]
    ds_read_b128 v[84:87], v8 offset:12288
    v_rcp_f32 v33, v33
    v_mul_f32 v32, v32, v16
    v_add_f32 v36, 1.0, v36
    v_mfma_f32_32x32x16_bf16 v[52:67], a[52:55], v[88:91], v[52:67]
    ds_read_b128 v[88:91], v8 offset:12800
    v_rcp_f32 v34, v34
    v_mul_f32 v33, v33, v17
    v_add_f32 v37, 1.0, v37
    v_mfma_f32_32x32x16_bf16 v[52:67], a[56:59], v[92:95], v[52:67]
    ds_read_b128 v[92:95], v8 offset:13312
    v_rcp_f32 v35, v35
    v_mul_f32 v34, v34, v18
    v_add_f32 v38, 1.0, v38
    v_mfma_f32_32x32x16_bf16 v[52:67], a[60:63], v[96:99], v[52:67]
    ds_read_b128 v[96:99], v8 offset:13824
    v_rcp_f32 v36, v36
    v_mul_f32 v35, v35, v19
    v_add_f32 v39, 1.0, v39
    s_waitcnt lgkmcnt(8)
    v_mfma_f32_32x32x16_bf16 v[52:67], a[64:67], v[100:103], v[52:67]
    s_waitcnt vmcnt(2)
    s_barrier
    s_add_u32 m0, s84, 57344
    s_add_u32 s61, s75, m0
    s_add_u32 s61, s61, 62976
    s_sub_u32 s61, s61, s31
    buffer_load_dwordx4 v1, s[36:39], s61 offen offset:0 sc1 lds
    v_mfma_f32_32x32x16_bf16 v[52:67], a[68:71], v[104:107], v[52:67]
    v_add_u32 v8, 0, v5
    ds_read_b128 v[100:103], v8 offset:0
    ds_read_b128 v[104:107], v8 offset:512
    v_rcp_f32 v37, v37
    v_mfma_f32_32x32x16_bf16 v[52:67], a[72:75], v[108:111], v[52:67]
    buffer_load_dwordx4 v1, s[36:39], s61 offen offset:1024 sc1 lds
    ds_read_b128 v[108:111], v8 offset:1024
    v_mul_f32 v36, v36, v20
    v_cvt_pk_bf16_f32 v40, v32, v33
    v_mfma_f32_32x32x16_bf16 v[52:67], a[76:79], v[112:115], v[52:67]
    ds_read_b128 v[112:115], v8 offset:1536
    v_rcp_f32 v38, v38
    v_mul_f32 v37, v37, v21
    v_cvt_pk_bf16_f32 v41, v34, v35
    s_waitcnt lgkmcnt(8)
    v_mfma_f32_32x32x16_bf16 v[52:67], a[80:83], v[68:71], v[52:67]
    buffer_load_dwordx4 v1, s[36:39], s61 offen offset:2048 sc1 lds
    ds_read_b128 v[68:71], v8 offset:2048
    v_mfma_f32_32x32x16_bf16 v[52:67], a[84:87], v[72:75], v[52:67]
    v_add_u32 v7, s82, v11
    ds_read_b64 v[44:45], v7 offset:0
    ds_read_b128 v[72:75], v8 offset:2560
    v_rcp_f32 v39, v39
    v_mul_f32 v38, v38, v22
    v_mfma_f32_32x32x16_bf16 v[52:67], a[88:91], v[76:79], v[52:67]
    buffer_load_dwordx4 v1, s[36:39], s61 offen offset:3072 sc1 lds
    ds_read_b128 v[76:79], v8 offset:3072
    v_cvt_pk_bf16_f32 v42, v36, v37
    v_mul_f32 v39, v39, v23
    v_mfma_f32_32x32x16_bf16 v[52:67], a[92:95], v[80:83], v[52:67]
    ds_read_b128 v[80:83], v8 offset:3584
    v_cvt_pk_bf16_f32 v43, v38, v39
    s_add_u32 s87, s77, 114688
    s_cmp_eq_u32 s4, 0
    s_cbranch_scc0 Lslow_395
    buffer_store_dwordx4 v[40:43], v10, s[36:39], s87 offen
Lsdone_396:
    s_waitcnt lgkmcnt(9)
    v_mfma_f32_32x32x16_bf16 v[52:67], a[96:99], v[84:87], v[52:67]
    ds_read_b128 v[84:87], v8 offset:4096
    v_mfma_f32_32x32x16_bf16 v[52:67], a[100:103], v[88:91], v[52:67]
    s_add_u32 m0, s85, 57344
    s_add_u32 s61, s75, m0
    s_add_u32 s61, s61, 62976
    s_sub_u32 s61, s61, s31
    buffer_load_dwordx4 v1, s[36:39], s61 offen offset:0 sc1 lds
    v_mfma_f32_32x32x16_bf16 v[52:67], a[104:107], v[92:95], v[52:67]
    ds_read_b128 v[88:91], v8 offset:4608
    ds_read_b128 v[92:95], v8 offset:5120
    v_mfma_f32_32x32x16_bf16 v[52:67], a[108:111], v[96:99], v[52:67]
    buffer_load_dwordx4 v1, s[36:39], s61 offen offset:1024 sc1 lds
    ds_read_b128 v[96:99], v8 offset:5632
    s_waitcnt lgkmcnt(7)
    v_mfma_f32_32x32x16_bf16 v[52:67], v[172:175], v[44:47], v[52:67]
    v_mfma_f32_32x32x16_bf16 v[16:31], a[0:3], v[100:103], 0
    buffer_load_dwordx4 v1, s[36:39], s61 offen offset:2048 sc1 lds
    ds_read_b128 v[100:103], v8 offset:6144
    v_mfma_f32_32x32x16_bf16 v[16:31], a[4:7], v[104:107], v[16:31]
    ds_read_b128 v[104:107], v8 offset:6656
    v_mfma_f32_32x32x16_bf16 v[16:31], a[8:11], v[108:111], v[16:31]
    ds_read_b128 v[108:111], v8 offset:7168
    s_nop 4
    v_mul_f32 v32, v45, v52
    v_mul_f32 v33, v45, v53
    v_mfma_f32_32x32x16_bf16 v[16:31], a[12:15], v[112:115], v[16:31]
    ds_read_b128 v[112:115], v8 offset:7680
    v_cmp_u_f32 vcc, v52, v52
    s_nop 0
    s_cbranch_vccnz Lnn_397
Lnnd_398:
    s_waitcnt lgkmcnt(8)
    v_mfma_f32_32x32x16_bf16 v[16:31], a[16:19], v[68:71], v[16:31]
    ds_read_b128 v[68:71], v8 offset:8192
    v_exp_f32 v32, v32
    v_mul_f32 v34, v45, v54
    v_mfma_f32_32x32x16_bf16 v[16:31], a[20:23], v[72:75], v[16:31]
    ds_read_b128 v[72:75], v8 offset:8704
    v_mul_f32 v52, v60, v52
    v_exp_f32 v33, v33
    v_mul_f32 v35, v45, v55
    v_mfma_f32_32x32x16_bf16 v[16:31], a[24:27], v[76:79], v[16:31]
    ds_read_b128 v[76:79], v8 offset:9216
    v_mul_f32 v53, v61, v53
    v_exp_f32 v34, v34
    v_mul_f32 v36, v45, v56
    v_mfma_f32_32x32x16_bf16 v[16:31], a[28:31], v[80:83], v[16:31]
    ds_read_b128 v[80:83], v8 offset:9728
    v_mul_f32 v54, v62, v54
    v_exp_f32 v35, v35
    v_mul_f32 v37, v45, v57
    s_waitcnt lgkmcnt(8)
    v_mfma_f32_32x32x16_bf16 v[16:31], a[32:35], v[84:87], v[16:31]
    s_waitcnt vmcnt(3)
    v_mov_b32 v7, 12
    s_cmp_eq_u32 s4, 0
    s_cbranch_scc0 Lslow_399
    buffer_store_dword v7, off, s[36:39], s56
Lsdone_400:
    v_mfma_f32_32x32x16_bf16 v[16:31], a[36:39], v[88:91], v[16:31]
    ds_read_b128 v[84:87], v8 offset:10240
    ds_read_b128 v[88:91], v8 offset:10752
    v_mul_f32 v55, v63, v55
    v_exp_f32 v36, v36
    v_mfma_f32_32x32x16_bf16 v[16:31], a[40:43], v[92:95], v[16:31]
    ds_read_b128 v[92:95], v8 offset:11264
    v_mul_f32 v38, v45, v58
    v_mul_f32 v56, v64, v56
    v_exp_f32 v37, v37
    v_mfma_f32_32x32x16_bf16 v[16:31], a[44:47], v[96:99], v[16:31]
    ds_read_b128 v[96:99], v8 offset:11776
    v_mul_f32 v39, v45, v59
    v_mul_f32 v57, v65, v57
    v_exp_f32 v38, v38
    s_waitcnt lgkmcnt(8)
    v_mfma_f32_32x32x16_bf16 v[16:31], a[48:51], v[100:103], v[16:31]
    ds_read_b128 v[100:103], v8 offset:12288
    v_mul_f32 v58, v66, v58
    v_add_f32 v32, 1.0, v32
    v_mfma_f32_32x32x16_bf16 v[16:31], a[52:55], v[104:107], v[16:31]
    ds_read_b128 v[104:107], v8 offset:12800
    v_exp_f32 v39, v39
    v_mul_f32 v59, v67, v59
    v_add_f32 v33, 1.0, v33
    v_mfma_f32_32x32x16_bf16 v[16:31], a[56:59], v[108:111], v[16:31]
    ds_read_b128 v[108:111], v8 offset:13312
    v_rcp_f32 v32, v32
    v_add_f32 v34, 1.0, v34
    v_add_f32 v35, 1.0, v35
    v_mfma_f32_32x32x16_bf16 v[16:31], a[60:63], v[112:115], v[16:31]
    ds_read_b128 v[112:115], v8 offset:13824
    v_rcp_f32 v33, v33
    v_mul_f32 v32, v32, v52
    v_add_f32 v36, 1.0, v36
    s_waitcnt lgkmcnt(8)
    v_mfma_f32_32x32x16_bf16 v[16:31], a[64:67], v[68:71], v[16:31]
    ds_read_b128 v[68:71], v8 offset:28672
    v_rcp_f32 v34, v34
    v_mul_f32 v33, v33, v53
    v_mfma_f32_32x32x16_bf16 v[16:31], a[68:71], v[72:75], v[16:31]
    ds_read_b128 v[72:75], v8 offset:29184
    v_add_f32 v37, 1.0, v37
    v_rcp_f32 v35, v35
    v_mul_f32 v34, v34, v54
    v_mfma_f32_32x32x16_bf16 v[16:31], a[72:75], v[76:79], v[16:31]
    buffer_load_dword v9, v6, s[36:39], 0 offen sc1
    ds_read_b128 v[76:79], v8 offset:29696
    v_add_f32 v38, 1.0, v38
    v_rcp_f32 v36, v36
    v_mfma_f32_32x32x16_bf16 v[16:31], a[76:79], v[80:83], v[16:31]
    ds_read_b128 v[80:83], v8 offset:30208
    v_mul_f32 v35, v35, v55
    v_add_f32 v39, 1.0, v39
    v_rcp_f32 v37, v37
    s_waitcnt lgkmcnt(8)
    v_mfma_f32_32x32x16_bf16 v[16:31], a[80:83], v[84:87], v[16:31]
    ds_read_b128 v[84:87], v8 offset:30720
    v_mul_f32 v36, v36, v56
    v_cvt_pk_bf16_f32 v40, v32, v33
    v_mfma_f32_32x32x16_bf16 v[16:31], a[84:87], v[88:91], v[16:31]
    v_add_u32 v7, s82, v11
    ds_read_b64 v[48:49], v7 offset:512
    ds_read_b128 v[88:91], v8 offset:31232
    v_rcp_f32 v38, v38
    v_mfma_f32_32x32x16_bf16 v[16:31], a[88:91], v[92:95], v[16:31]
    ds_read_b128 v[92:95], v8 offset:31744
    v_mul_f32 v37, v37, v57
    v_cvt_pk_bf16_f32 v41, v34, v35
    v_rcp_f32 v39, v39
    v_mfma_f32_32x32x16_bf16 v[16:31], a[92:95], v[96:99], v[16:31]
    ds_read_b128 v[96:99], v8 offset:32256
    v_mul_f32 v38, v38, v58
    v_cvt_pk_bf16_f32 v42, v36, v37
    v_mul_f32 v39, v39, v59
    v_cvt_pk_bf16_f32 v43, v38, v39
    s_waitcnt lgkmcnt(9)
    v_mfma_f32_32x32x16_bf16 v[16:31], a[96:99], v[100:103], v[16:31]
    ds_read_b128 v[100:103], v8 offset:32768
    v_mfma_f32_32x32x16_bf16 v[16:31], a[100:103], v[104:107], v[16:31]
    ds_read_b128 v[104:107], v8 offset:33280
    s_add_u32 s87, s78, 0
    s_cmp_eq_u32 s4, 0
    s_cbranch_scc0 Lslow_401
    buffer_store_dwordx4 v[40:43], v10, s[36:39], s87 offen
Lsdone_402:
    v_mfma_f32_32x32x16_bf16 v[16:31], a[104:107], v[108:111], v[16:31]
    ds_read_b128 v[108:111], v8 offset:33792
    v_mfma_f32_32x32x16_bf16 v[16:31], a[108:111], v[112:115], v[16:31]
    ds_read_b128 v[112:115], v8 offset:34304
    s_waitcnt lgkmcnt(7)
    v_mfma_f32_32x32x16_bf16 v[16:31], v[172:175], v[48:51], v[16:31]
    v_mfma_f32_32x32x16_bf16 v[52:67], a[0:3], v[68:71], 0
    ds_read_b128 v[68:71], v8 offset:34816
    v_mfma_f32_32x32x16_bf16 v[52:67], a[4:7], v[72:75], v[52:67]
    ds_read_b128 v[72:75], v8 offset:35328
    v_mfma_f32_32x32x16_bf16 v[52:67], a[8:11], v[76:79], v[52:67]
    ds_read_b128 v[76:79], v8 offset:35840
    s_nop 5
    v_mul_f32 v32, v49, v16
    v_mul_f32 v33, v49, v17
    v_exp_f32 v32, v32
    v_mul_f32 v34, v49, v18
    v_mul_f32 v16, v24, v16
    v_mfma_f32_32x32x16_bf16 v[52:67], a[12:15], v[80:83], v[52:67]
    ds_read_b128 v[80:83], v8 offset:36352
    v_exp_f32 v33, v33
    v_mul_f32 v35, v49, v19
    v_mul_f32 v17, v25, v17
    v_exp_f32 v34, v34
    s_waitcnt lgkmcnt(8)
    v_mfma_f32_32x32x16_bf16 v[52:67], a[16:19], v[84:87], v[52:67]
    ds_read_b128 v[84:87], v8 offset:36864
    v_mul_f32 v36, v49, v20
    v_mul_f32 v18, v26, v18
    v_exp_f32 v35, v35
    v_mul_f32 v37, v49, v21
    v_mfma_f32_32x32x16_bf16 v[52:67], a[20:23], v[88:91], v[52:67]
    ds_read_b128 v[88:91], v8 offset:37376
    v_mul_f32 v19, v27, v19
    v_exp_f32 v36, v36
    v_mul_f32 v38, v49, v22
    v_mul_f32 v20, v28, v20
    v_mfma_f32_32x32x16_bf16 v[52:67], a[24:27], v[92:95], v[52:67]
    ds_read_b128 v[92:95], v8 offset:37888
    v_exp_f32 v37, v37
    v_mul_f32 v39, v49, v23
    v_mul_f32 v21, v29, v21
    v_exp_f32 v38, v38
    v_mfma_f32_32x32x16_bf16 v[52:67], a[28:31], v[96:99], v[52:67]
    s_waitcnt vmcnt(1)
    v_cmp_gt_u32 vcc, v4, v9
    s_nop 0
    s_and_b32 s6, vcc_lo, 0xfff
    s_cbranch_scc1 Lps_403
Lpd_404:
    ds_read_b128 v[96:99], v8 offset:38400
    buffer_load_dwordx4 v[116:119], v12, s[36:39], s88 offen offset:0 sc1
    s_waitcnt lgkmcnt(8)
    v_mfma_f32_32x32x16_bf16 v[52:67], a[32:35], v[100:103], v[52:67]
    ds_read_b128 v[100:103], v8 offset:38912
    buffer_load_dwordx4 v[120:123], v13, s[36:39], s88 offen offset:0 sc1
    v_mul_f32 v22, v30, v22
    v_add_f32 v32, 1.0, v32
    v_mfma_f32_32x32x16_bf16 v[52:67], a[36:39], v[104:107], v[52:67]
    ds_read_b128 v[104:107], v8 offset:39424
    buffer_load_dwordx4 v[124:127], v12, s[36:39], s88 offen offset:1024 sc1
    v_exp_f32 v39, v39
    v_mul_f32 v23, v31, v23
    v_mfma_f32_32x32x16_bf16 v[52:67], a[40:43], v[108:111], v[52:67]
    ds_read_b128 v[108:111], v8 offset:39936
    buffer_load_dwordx4 v[128:131], v13, s[36:39], s88 offen offset:1024 sc1
    v_add_f32 v33, 1.0, v33
    v_rcp_f32 v32, v32
    v_mfma_f32_32x32x16_bf16 v[52:67], a[44:47], v[112:115], v[52:67]
    ds_read_b128 v[112:115], v8 offset:40448
    v_add_f32 v34, 1.0, v34
    v_add_f32 v35, 1.0, v35
    v_rcp_f32 v33, v33
    v_mul_f32 v32, v32, v16
    v_add_f32 v36, 1.0, v36
    s_waitcnt lgkmcnt(8)
    v_mfma_f32_32x32x16_bf16 v[52:67], a[48:51], v[68:71], v[52:67]
    ds_read_b128 v[68:71], v8 offset:40960
    buffer_load_dwordx4 v[132:135], v12, s[36:39], s88 offen offset:2048 sc1
    v_rcp_f32 v34, v34
    v_mfma_f32_32x32x16_bf16 v[52:67], a[52:55], v[72:75], v[52:67]
    ds_read_b128 v[72:75], v8 offset:41472
    v_mul_f32 v33, v33, v17
    v_add_f32 v37, 1.0, v37
    v_rcp_f32 v35, v35
    v_mul_f32 v34, v34, v18
    v_add_f32 v38, 1.0, v38
    v_mfma_f32_32x32x16_bf16 v[52:67], a[56:59], v[76:79], v[52:67]
    ds_read_b128 v[76:79], v8 offset:41984
    buffer_load_dwordx4 v[136:139], v13, s[36:39], s88 offen offset:2048 sc1
    v_rcp_f32 v36, v36
    v_mul_f32 v35, v35, v19
    v_mfma_f32_32x32x16_bf16 v[52:67], a[60:63], v[80:83], v[52:67]
    ds_read_b128 v[80:83], v8 offset:42496
    v_add_f32 v39, 1.0, v39
    v_rcp_f32 v37, v37
    v_mul_f32 v36, v36, v20
    v_cvt_pk_bf16_f32 v40, v32, v33
    s_waitcnt lgkmcnt(8)
    v_mfma_f32_32x32x16_bf16 v[52:67], a[64:67], v[84:87], v[52:67]
    s_barrier
    v_add_u32 v8, 57344, v5
    ds_read_b128 v[84:87], v8 offset:0
    buffer_load_dwordx4 v[140:143], v12, s[36:39], s88 offen offset:3072 sc1
    v_mfma_f32_32x32x16_bf16 v[52:67], a[68:71], v[88:91], v[52:67]
    ds_read_b128 v[88:91], v8 offset:512
    v_rcp_f32 v38, v38
    v_mul_f32 v37, v37, v21
    v_cvt_pk_bf16_f32 v41, v34, v35
    v_rcp_f32 v39, v39
    v_mfma_f32_32x32x16_bf16 v[52:67], a[72:75], v[92:95], v[52:67]
    ds_read_b128 v[92:95], v8 offset:1024
    buffer_load_dwordx4 v[144:147], v13, s[36:39], s88 offen offset:3072 sc1
    v_mul_f32 v38, v38, v22
    v_cvt_pk_bf16_f32 v42, v36, v37
    v_mul_f32 v39, v39, v23
    v_mfma_f32_32x32x16_bf16 v[52:67], a[76:79], v[96:99], v[52:67]
    ds_read_b128 v[96:99], v8 offset:1536
    buffer_load_dwordx4 v[148:151], v12, s[36:39], s89 offen offset:0 sc1
    v_cvt_pk_bf16_f32 v43, v38, v39
    s_waitcnt lgkmcnt(8)
    v_mfma_f32_32x32x16_bf16 v[52:67], a[80:83], v[100:103], v[52:67]
    ds_read_b128 v[100:103], v8 offset:2048
    s_add_u32 s87, s78, 114688
    s_cmp_eq_u32 s4, 0
    s_cbranch_scc0 Lslow_406
    buffer_store_dwordx4 v[40:43], v10, s[36:39], s87 offen
Lsdone_407:
    v_mfma_f32_32x32x16_bf16 v[52:67], a[84:87], v[104:107], v[52:67]
    v_add_u32 v7, s83, v11
    ds_read_b64 v[44:45], v7 offset:0
    ds_read_b128 v[104:107], v8 offset:2560
    buffer_load_dwordx4 v[152:155], v13, s[36:39], s89 offen offset:0 sc1
    v_mfma_f32_32x32x16_bf16 v[52:67], a[88:91], v[108:111], v[52:67]
    ds_read_b128 v[108:111], v8 offset:3072
    v_mfma_f32_32x32x16_bf16 v[52:67], a[92:95], v[112:115], v[52:67]
    ds_read_b128 v[112:115], v8 offset:3584
    buffer_load_dwordx4 v[156:159], v12, s[36:39], s89 offen offset:1024 sc1
    s_waitcnt lgkmcnt(9)
    v_mfma_f32_32x32x16_bf16 v[52:67], a[96:99], v[68:71], v[52:67]
    ds_read_b128 v[68:71], v8 offset:4096
    v_mfma_f32_32x32x16_bf16 v[52:67], a[100:103], v[72:75], v[52:67]
    ds_read_b128 v[72:75], v8 offset:4608
    buffer_load_dwordx4 v[160:163], v13, s[36:39], s89 offen offset:1024 sc1
    v_mfma_f32_32x32x16_bf16 v[52:67], a[104:107], v[76:79], v[52:67]
    ds_read_b128 v[76:79], v8 offset:5120
    v_mfma_f32_32x32x16_bf16 v[52:67], a[108:111], v[80:83], v[52:67]
    ds_read_b128 v[80:83], v8 offset:5632
    buffer_load_dwordx4 v[164:167], v12, s[36:39], s89 offen offset:2048 sc1
    s_waitcnt lgkmcnt(7)
    v_mfma_f32_32x32x16_bf16 v[52:67], v[172:175], v[44:47], v[52:67]
    v_mfma_f32_32x32x16_bf16 v[16:31], a[0:3], v[84:87], 0
    ds_read_b128 v[84:87], v8 offset:6144
    buffer_load_dwordx4 v[168:171], v13, s[36:39], s89 offen offset:2048 sc1
    v_mfma_f32_32x32x16_bf16 v[16:31], a[4:7], v[88:91], v[16:31]
    ds_read_b128 v[88:91], v8 offset:6656
    v_mfma_f32_32x32x16_bf16 v[16:31], a[8:11], v[92:95], v[16:31]
    v_add_u32 v7, s83, v11
    ds_read_b64 v[48:49], v7 offset:512
    ds_read_b128 v[92:95], v8 offset:7168
    buffer_load_dwordx4 a[0:3], v12, s[36:39], s89 offen offset:3072 sc1
    v_mfma_f32_32x32x16_bf16 v[16:31], a[12:15], v[96:99], v[16:31]
    ds_read_b128 v[96:99], v8 offset:7680
    v_mul_f32 v32, v45, v52
    v_mul_f32 v33, v45, v53
    v_exp_f32 v32, v32
    s_waitcnt lgkmcnt(9)
    v_mfma_f32_32x32x16_bf16 v[16:31], a[16:19], v[100:103], v[16:31]
    s_waitcnt vmcnt(6)
    v_mov_b32 v7, 13
    s_cmp_eq_u32 s4, 0
    s_cbranch_scc0 Lslow_408
    buffer_store_dword v7, off, s[36:39], s56
Lsdone_409:
    v_mfma_f32_32x32x16_bf16 v[16:31], a[20:23], v[104:107], v[16:31]
    ds_read_b128 v[100:103], v8 offset:8192
    ds_read_b128 v[104:107], v8 offset:8704
    buffer_load_dwordx4 a[4:7], v13, s[36:39], s89 offen offset:3072 sc1
    v_mfma_f32_32x32x16_bf16 v[16:31], a[24:27], v[108:111], v[16:31]
    ds_read_b128 v[108:111], v8 offset:9216
    buffer_load_dwordx4 a[8:11], v12, s[36:39], s90 offen offset:0 sc1
    v_mul_f32 v34, v45, v54
    v_mfma_f32_32x32x16_bf16 v[16:31], a[28:31], v[112:115], v[16:31]
    ds_read_b128 v[112:115], v8 offset:9728
    buffer_load_dwordx4 a[12:15], v13, s[36:39], s90 offen offset:0 sc1
    v_mul_f32 v52, v60, v52
    s_waitcnt lgkmcnt(9)
    v_mfma_f32_32x32x16_bf16 v[16:31], a[32:35], v[68:71], v[16:31]
    ds_read_b128 v[68:71], v8 offset:10240
    v_exp_f32 v33, v33
    v_mul_f32 v35, v45, v55
    v_mfma_f32_32x32x16_bf16 v[16:31], a[36:39], v[72:75], v[16:31]
    ds_read_b128 v[72:75], v8 offset:10752
    buffer_load_dwordx4 a[16:19], v12, s[36:39], s90 offen offset:1024 sc1
    v_mul_f32 v53, v61, v53
    v_mfma_f32_32x32x16_bf16 v[16:31], a[40:43], v[76:79], v[16:31]
    buffer_load_dword v9, v6, s[36:39], 0 offen sc1
    ds_read_b128 v[76:79], v8 offset:11264
    v_exp_f32 v34, v34
    v_mul_f32 v36, v45, v56
    v_mfma_f32_32x32x16_bf16 v[16:31], a[44:47], v[80:83], v[16:31]
    ds_read_b128 v[80:83], v8 offset:11776
    buffer_load_dwordx4 a[20:23], v13, s[36:39], s90 offen offset:1024 sc1
    v_mul_f32 v54, v62, v54
    s_waitcnt lgkmcnt(8)
    v_mfma_f32_32x32x16_bf16 v[16:31], a[48:51], v[84:87], v[16:31]
    ds_read_b128 v[84:87], v8 offset:12288
    v_exp_f32 v35, v35
    v_mul_f32 v37, v45, v57
    v_mfma_f32_32x32x16_bf16 v[16:31], a[52:55], v[88:91], v[16:31]
    ds_read_b128 v[88:91], v8 offset:12800
    buffer_load_dwordx4 a[24:27], v12, s[36:39], s90 offen offset:2048 sc1
    v_mul_f32 v55, v63, v55
    v_mfma_f32_32x32x16_bf16 v[16:31], a[56:59], v[92:95], v[16:31]
    ds_read_b128 v[92:95], v8 offset:13312
    v_exp_f32 v36, v36
    v_mul_f32 v38, v45, v58
    v_mul_f32 v56, v64, v56
    v_mfma_f32_32x32x16_bf16 v[16:31], a[60:63], v[96:99], v[16:31]
    ds_read_b128 v[96:99], v8 offset:13824
    buffer_load_dwordx4 a[28:31], v13, s[36:39], s90 offen offset:2048 sc1
    s_waitcnt lgkmcnt(8)
    v_mfma_f32_32x32x16_bf16 v[16:31], a[64:67], v[100:103], v[16:31]
    v_exp_f32 v37, v37
    v_mul_f32 v39, v45, v59
    v_mul_f32 v57, v65, v57
    v_mfma_f32_32x32x16_bf16 v[16:31], a[68:71], v[104:107], v[16:31]
    buffer_load_dwordx4 a[32:35], v12, s[36:39], s90 offen offset:3072 sc1
    v_exp_f32 v38, v38
    v_mul_f32 v58, v66, v58
    v_mfma_f32_32x32x16_bf16 v[16:31], a[72:75], v[108:111], v[16:31]
    v_add_f32 v32, 1.0, v32
    v_exp_f32 v39, v39
    v_mul_f32 v59, v67, v59
    v_add_f32 v33, 1.0, v33
    v_mfma_f32_32x32x16_bf16 v[16:31], a[76:79], v[112:115], v[16:31]
    buffer_load_dwordx4 a[36:39], v13, s[36:39], s90 offen offset:3072 sc1
    v_rcp_f32 v32, v32
    v_add_f32 v34, 1.0, v34
    s_waitcnt lgkmcnt(4)
    v_mfma_f32_32x32x16_bf16 v[16:31], a[80:83], v[68:71], v[16:31]
    v_add_f32 v35, 1.0, v35
    v_rcp_f32 v33, v33
    v_mul_f32 v32, v32, v52
    v_add_f32 v36, 1.0, v36
    v_mfma_f32_32x32x16_bf16 v[16:31], a[84:87], v[72:75], v[16:31]
    v_rcp_f32 v34, v34
    v_mul_f32 v33, v33, v53
    v_add_f32 v37, 1.0, v37
    v_rcp_f32 v35, v35
    v_mfma_f32_32x32x16_bf16 v[16:31], a[88:91], v[76:79], v[16:31]
    v_mul_f32 v34, v34, v54
    v_add_f32 v38, 1.0, v38
    v_rcp_f32 v36, v36
    v_mul_f32 v35, v35, v55
    v_add_f32 v39, 1.0, v39
    v_mfma_f32_32x32x16_bf16 v[16:31], a[92:95], v[80:83], v[16:31]
    v_rcp_f32 v37, v37
    v_mul_f32 v36, v36, v56
    v_cvt_pk_bf16_f32 v40, v32, v33
    v_rcp_f32 v38, v38
    s_waitcnt lgkmcnt(0)
    v_mfma_f32_32x32x16_bf16 v[16:31], a[96:99], v[84:87], v[16:31]
    v_mul_f32 v37, v37, v57
    v_cvt_pk_bf16_f32 v41, v34, v35
    v_rcp_f32 v39, v39
    v_mul_f32 v38, v38, v58
    v_mfma_f32_32x32x16_bf16 v[16:31], a[100:103], v[88:91], v[16:31]
    v_cvt_pk_bf16_f32 v42, v36, v37
    v_mul_f32 v39, v39, v59
    v_cvt_pk_bf16_f32 v43, v38, v39
    v_mfma_f32_32x32x16_bf16 v[16:31], a[104:107], v[92:95], v[16:31]
    s_add_u32 s87, s79, 0
    s_cmp_eq_u32 s4, 0
    s_cbranch_scc0 Lslow_410
    buffer_store_dwordx4 v[40:43], v10, s[36:39], s87 offen
Lsdone_411:
    v_mfma_f32_32x32x16_bf16 v[16:31], a[108:111], v[96:99], v[16:31]
    v_mfma_f32_32x32x16_bf16 v[16:31], v[172:175], v[48:51], v[16:31]
    s_waitcnt vmcnt(6)
    v_cmp_gt_u32 vcc, v4, v9
    s_nop 0
    s_and_b32 s6, vcc_lo, 0xff000
    s_cbranch_scc1 Lps_412
Lpd_413:
    buffer_load_dwordx4 a[40:43], v12, s[36:39], s91 offen offset:0 sc1
    v_mfma_f32_32x32x16_bf16 v[52:67], a[112:115], v[116:119], 0
    buffer_load_dwordx4 a[44:47], v12, s[36:39], s91 offen offset:1024 sc1
    v_mfma_f32_32x32x16_bf16 v[68:83], a[116:119], v[116:119], 0
    buffer_load_dwordx4 a[48:51], v12, s[36:39], s91 offen offset:2048 sc1
    s_nop 1
    v_mul_f32 v32, v49, v16
    v_mul_f32 v33, v49, v17
    v_exp_f32 v32, v32
    v_mfma_f32_32x32x16_bf16 v[84:99], a[112:115], v[120:123], 0
    buffer_load_dwordx4 a[52:55], v12, s[36:39], s91 offen offset:3072 sc1
    v_mul_f32 v34, v49, v18
    v_mul_f32 v16, v24, v16
    v_exp_f32 v33, v33
    v_mfma_f32_32x32x16_bf16 v[100:115], a[116:119], v[120:123], 0
    v_mul_f32 v35, v49, v19
    v_mul_f32 v17, v25, v17
    v_exp_f32 v34, v34
    v_mul_f32 v36, v49, v20
    v_mul_f32 v18, v26, v18
    v_mfma_f32_32x32x16_bf16 v[52:67], a[120:123], v[124:127], v[52:67]
    buffer_load_dwordx4 a[56:59], v12, s[36:39], s92 offen offset:0 sc1
    v_exp_f32 v35, v35
    v_mul_f32 v37, v49, v21
    v_mul_f32 v19, v27, v19
    v_mfma_f32_32x32x16_bf16 v[68:83], a[124:127], v[124:127], v[68:83]
    v_exp_f32 v36, v36
    v_mul_f32 v38, v49, v22
    v_mul_f32 v20, v28, v20
    v_exp_f32 v37, v37
    v_mul_f32 v39, v49, v23
    v_mfma_f32_32x32x16_bf16 v[84:99], a[120:123], v[128:131], v[84:99]
    buffer_load_dwordx4 a[60:63], v12, s[36:39], s92 offen offset:1024 sc1
    v_mul_f32 v21, v29, v21
    v_exp_f32 v38, v38
    v_mul_f32 v22, v30, v22
    v_mfma_f32_32x32x16_bf16 v[100:115], a[124:127], v[128:131], v[100:115]
    v_add_f32 v32, 1.0, v32
    v_exp_f32 v39, v39
    v_mul_f32 v23, v31, v23
    v_add_f32 v33, 1.0, v33
    v_rcp_f32 v32, v32
    v_mfma_f32_32x32x16_bf16 v[52:67], a[128:131], v[132:135], v[52:67]
    s_waitcnt vmcnt(6)
    v_mov_b32 v7, 14
    s_cmp_eq_u32 s4, 0
    s_cbranch_scc0 Lslow_415
    buffer_store_dword v7, off, s[36:39], s56
Lsdone_416:
    v_add_f32 v34, 1.0, v34
    v_add_f32 v35, 1.0, v35
    v_mfma_f32_32x32x16_bf16 v[68:83], a[132:135], v[132:135], v[68:83]
    buffer_load_dwordx4 a[64:67], v12, s[36:39], s92 offen offset:2048 sc1
    v_rcp_f32 v33, v33
    v_mul_f32 v32, v32, v16
    v_add_f32 v36, 1.0, v36
    v_mfma_f32_32x32x16_bf16 v[84:99], a[128:131], v[136:139], v[84:99]
    buffer_load_dwordx4 a[68:71], v12, s[36:39], s92 offen offset:3072 sc1
    v_rcp_f32 v34, v34
    v_mul_f32 v33, v33, v17
    v_add_f32 v37, 1.0, v37
    v_mfma_f32_32x32x16_bf16 v[100:115], a[132:135], v[136:139], v[100:115]
    buffer_load_dwordx4 a[72:75], v13, s[36:39], s91 offen offset:0 sc1
    v_rcp_f32 v35, v35
    v_mul_f32 v34, v34, v18
    v_add_f32 v38, 1.0, v38
    v_mfma_f32_32x32x16_bf16 v[52:67], a[136:139], v[140:143], v[52:67]
    v_rcp_f32 v36, v36
    v_mul_f32 v35, v35, v19
    v_add_f32 v39, 1.0, v39
    v_rcp_f32 v37, v37
    v_mul_f32 v36, v36, v20
    v_mfma_f32_32x32x16_bf16 v[68:83], a[140:143], v[140:143], v[68:83]
    buffer_load_dwordx4 a[76:79], v13, s[36:39], s91 offen offset:1024 sc1
    v_cvt_pk_bf16_f32 v40, v32, v33
    v_rcp_f32 v38, v38
    v_mul_f32 v37, v37, v21
    v_mfma_f32_32x32x16_bf16 v[84:99], a[136:139], v[144:147], v[84:99]
    v_cvt_pk_bf16_f32 v41, v34, v35
    v_rcp_f32 v39, v39
    v_mul_f32 v38, v38, v22
    v_cvt_pk_bf16_f32 v42, v36, v37
    v_mul_f32 v39, v39, v23
    v_cvt_pk_bf16_f32 v43, v38, v39
    s_add_u32 s87, s79, 114688
    s_cmp_eq_u32 s4, 0
    s_cbranch_scc0 Lslow_417
    buffer_store_dwordx4 v[40:43], v10, s[36:39], s87 offen
Lsdone_418:
    v_mfma_f32_32x32x16_bf16 v[100:115], a[140:143], v[144:147], v[100:115]
    buffer_load_dwordx4 a[80:83], v13, s[36:39], s91 offen offset:2048 sc1
    v_mfma_f32_32x32x16_bf16 v[52:67], a[144:147], v[148:151], v[52:67]
    v_mfma_f32_32x32x16_bf16 v[68:83], a[148:151], v[148:151], v[68:83]
    buffer_load_dword v9, v6, s[36:39], 0 offen sc1
    v_mfma_f32_32x32x16_bf16 v[84:99], a[144:147], v[152:155], v[84:99]
    buffer_load_dwordx4 a[84:87], v13, s[36:39], s91 offen offset:3072 sc1
    v_mfma_f32_32x32x16_bf16 v[100:115], a[148:151], v[152:155], v[100:115]
    buffer_load_dwordx4 a[88:91], v13, s[36:39], s92 offen offset:0 sc1
    v_mfma_f32_32x32x16_bf16 v[52:67], a[152:155], v[156:159], v[52:67]
    v_mfma_f32_32x32x16_bf16 v[68:83], a[156:159], v[156:159], v[68:83]
    buffer_load_dwordx4 v[128:131], v13, s[36:39], s92 offen offset:1024 sc1
    v_mfma_f32_32x32x16_bf16 v[84:99], a[152:155], v[160:163], v[84:99]
    v_mfma_f32_32x32x16_bf16 v[100:115], a[156:159], v[160:163], v[100:115]
    buffer_load_dwordx4 v[132:135], v13, s[36:39], s92 offen offset:2048 sc1
    v_mfma_f32_32x32x16_bf16 v[52:67], a[160:163], v[164:167], v[52:67]
    v_mfma_f32_32x32x16_bf16 v[68:83], a[164:167], v[164:167], v[68:83]
    buffer_load_dwordx4 v[136:139], v13, s[36:39], s92 offen offset:3072 sc1
    v_mfma_f32_32x32x16_bf16 v[84:99], a[160:163], v[168:171], v[84:99]
    s_waitcnt vmcnt(7)
    v_mov_b32 v7, 15
    s_cmp_eq_u32 s4, 0
    s_cbranch_scc0 Lslow_419
    buffer_store_dword v7, off, s[36:39], s56
Lsdone_420:
    v_mfma_f32_32x32x16_bf16 v[100:115], a[164:167], v[168:171], v[100:115]
    s_and_b32 s74, s60, 14
    s_and_b32 s75, s50, 1
    s_lshl1_add_u32 s77, s54, s75
    s_mul_i32 s72, s74, 14336
    s_lshl_b32 s73, s77, 10
    s_add_u32 s72, s72, s73
    s_add_u32 s95, s72, s55
    v_mfma_f32_32x32x16_bf16 v[52:67], a[168:171], a[0:3], v[52:67]
    s_add_u32 s95, s95, 262144
    v_mfma_f32_32x32x16_bf16 v[68:83], a[172:175], a[0:3], v[68:83]
    s_cmp_eq_u32 s48, 7
    s_cselect_b32 s5, 3, s48
    s_cmp_lt_u32 s54, s5
    s_cselect_b32 s6, 7, 0
    s_sub_u32 s5, s6, s5
    s_lshl_b32 s5, s5, 11
    s_add_u32 s95, s95, s5
    v_mfma_f32_32x32x16_bf16 v[84:99], a[168:171], a[4:7], v[84:99]
    buffer_load_dwordx4 v[16:19], v5, s[36:39], s95 offen sc1
    buffer_load_dwordx4 v[20:23], v5, s[36:39], s95 offen offset:512 sc1
    s_lshl_b32 s74, s74, 8
    v_mfma_f32_32x32x16_bf16 v[100:115], a[172:175], a[4:7], v[100:115]
    s_lshr_b32 s95, s31, 6
    s_and_b32 s95, s95, 512
    s_xor_b32 s95, s95, s74
    s_add_u32 s95, s95, 149000
    v_add_u32 v27, s95, v11
    ds_read_b32 v24, v27
    v_mfma_f32_32x32x16_bf16 v[52:67], a[176:179], a[8:11], v[52:67]
    s_xor_b32 s95, s50, 3
    s_mul_i32 s95, s95, 12288
    s_add_u32 s95, s95, 91648
    v_add_u32 v27, s95, v1
    s_xor_b32 s95, s50, 2
    s_mul_i32 s95, s95, 12288
    s_add_u32 s95, s95, 95744
    v_mfma_f32_32x32x16_bf16 v[68:83], a[180:183], a[8:11], v[68:83]
    s_waitcnt vmcnt(8)
    v_cmp_gt_u32 vcc, v4, v9
    s_nop 0
    s_and_b32 s6, vcc_lo, 0xff00000
    s_cbranch_scc1 Lps_421
Lpd_422:
    buffer_load_dwordx4 a[92:95], v12, s[36:39], s93 offen offset:0 sc1
    v_mfma_f32_32x32x16_bf16 v[84:99], a[176:179], a[12:15], v[84:99]
    buffer_load_dword v9, v6, s[36:39], 0 offen sc1
    v_add_u32 v28, s95, v1
    s_xor_b32 s95, s50, 1
    s_mul_i32 s95, s95, 12288
    s_add_u32 s95, s95, 99840
    v_add_u32 v29, s95, v1
    s_xor_b32 s95, s50, 0
    v_mfma_f32_32x32x16_bf16 v[100:115], a[180:183], a[12:15], v[100:115]
    buffer_load_dwordx4 a[96:99], v12, s[36:39], s93 offen offset:1024 sc1
    s_mul_i32 s95, s95, 12288
    s_add_u32 s95, s95, 91648
    v_add_u32 v30, s95, v1
    s_andn2_b32 s72, s60, 1
    v_mfma_f32_32x32x16_bf16 v[52:67], a[184:187], a[16:19], v[52:67]
    buffer_load_dwordx4 a[100:103], v12, s[36:39], s93 offen offset:2048 sc1
    s_mul_i32 s72, s72, 14336
    s_lshl_b32 s73, s77, 6
    s_add_u32 s72, s72, s73
    v_mul_u32_u24 v26, 56, v11
    v_mfma_f32_32x32x16_bf16 v[68:83], a[188:191], a[16:19], v[68:83]
    buffer_load_dwordx4 a[104:107], v12, s[36:39], s93 offen offset:3072 sc1
    v_lshrrev_b32 v7, 1, v2
    v_lshl_add_u32 v26, v7, 4, v26
    v_mfma_f32_32x32x16_bf16 v[84:99], a[184:187], a[20:23], v[84:99]
    buffer_load_dwordx4 a[108:111], v12, s[36:39], s94 offen offset:0 sc1
    v_mfma_f32_32x32x16_bf16 v[100:115], a[188:191], a[20:23], v[100:115]
    v_mfma_f32_32x32x16_bf16 v[52:67], a[192:195], a[24:27], v[52:67]
    buffer_load_dwordx4 v[116:119], v12, s[36:39], s94 offen offset:1024 sc1
    v_mfma_f32_32x32x16_bf16 v[68:83], a[196:199], a[24:27], v[68:83]
    v_mfma_f32_32x32x16_bf16 v[84:99], a[192:195], a[28:31], v[84:99]
    buffer_load_dwordx4 v[120:123], v12, s[36:39], s94 offen offset:2048 sc1
    v_mfma_f32_32x32x16_bf16 v[100:115], a[196:199], a[28:31], v[100:115]
    v_mfma_f32_32x32x16_bf16 v[52:67], a[200:203], a[32:35], v[52:67]
    buffer_load_dwordx4 v[124:127], v12, s[36:39], s94 offen offset:3072 sc1
    v_mfma_f32_32x32x16_bf16 v[68:83], a[204:207], a[32:35], v[68:83]
    v_mfma_f32_32x32x16_bf16 v[84:99], a[200:203], a[36:39], v[84:99]
    v_mfma_f32_32x32x16_bf16 v[100:115], a[204:207], a[36:39], v[100:115]
    v_mfma_f32_32x32x16_bf16 v[52:67], a[208:211], a[40:43], v[52:67]
    v_mfma_f32_32x32x16_bf16 v[68:83], a[212:215], a[40:43], v[68:83]
    v_mfma_f32_32x32x16_bf16 v[52:67], a[216:219], a[44:47], v[52:67]
    s_waitcnt vmcnt(7)
    v_cmp_gt_u32 vcc, 15, v9
    s_nop 0
    s_and_b32 s6, vcc_lo, 0xff00000
    s_cbranch_scc1 Lps_424
Lpd_425:
    buffer_load_dwordx4 v[140:143], v13, s[36:39], s93 offen offset:0 sc1
    v_mfma_f32_32x32x16_bf16 v[68:83], a[220:223], a[44:47], v[68:83]
    v_mov_b32 v7, 16
    s_cmp_eq_u32 s4, 0
    s_cbranch_scc0 Lslow_427
    buffer_store_dword v7, off, s[36:39], s56
Lsdone_428:
    buffer_load_dwordx4 v[144:147], v13, s[36:39], s93 offen offset:1024 sc1
    v_lshlrev_b32 v32, 16, v16
    v_and_b32 v33, 0xffff0000, v16
    v_lshlrev_b32 v34, 16, v17
    v_and_b32 v35, 0xffff0000, v17
    v_mfma_f32_32x32x16_bf16 v[52:67], a[224:227], a[48:51], v[52:67]
    buffer_load_dwordx4 v[148:151], v13, s[36:39], s93 offen offset:2048 sc1
    v_lshlrev_b32 v36, 16, v18
    v_and_b32 v37, 0xffff0000, v18
    v_lshlrev_b32 v38, 16, v19
    v_and_b32 v39, 0xffff0000, v19
    v_mfma_f32_32x32x16_bf16 v[68:83], a[228:231], a[48:51], v[68:83]
    buffer_load_dwordx4 v[152:155], v13, s[36:39], s93 offen offset:3072 sc1
    v_lshlrev_b32 v40, 16, v20
    v_and_b32 v41, 0xffff0000, v20
    v_lshlrev_b32 v42, 16, v21
    v_and_b32 v43, 0xffff0000, v21
    v_mfma_f32_32x32x16_bf16 v[52:67], a[232:235], a[52:55], v[52:67]
    v_lshlrev_b32 v44, 16, v22
    v_and_b32 v45, 0xffff0000, v22
    v_lshlrev_b32 v46, 16, v23
    v_and_b32 v47, 0xffff0000, v23
    v_mfma_f32_32x32x16_bf16 v[68:83], a[236:239], a[52:55], v[68:83]
    buffer_load_dwordx4 v[156:159], v13, s[36:39], s94 offen offset:0 sc1
    v_mfma_f32_32x32x16_bf16 v[52:67], a[240:243], a[56:59], v[52:67]
    v_mfma_f32_32x32x16_bf16 v[68:83], a[244:247], a[56:59], v[68:83]
    buffer_load_dwordx4 v[160:163], v13, s[36:39], s94 offen offset:1024 sc1
    v_mfma_f32_32x32x16_bf16 v[52:67], a[248:251], a[60:63], v[52:67]
Lwina0:
Lcha0:
Llka0:
    s_cbranch_execz Llka1
    v_mfma_f32_32x32x16_bf16 v[68:83], a[252:255], a[60:63], v[68:83]
    buffer_load_dwordx4 v[164:167], v13, s[36:39], s94 offen offset:2048 sc1
    v_mfma_f32_32x32x16_bf16 v[52:67], v[176:179], a[64:67], v[52:67]
    v_mfma_f32_32x32x16_bf16 v[68:83], v[180:183], a[64:67], v[68:83]
    buffer_load_dwordx4 v[168:171], v13, s[36:39], s94 offen offset:3072 sc1
    v_mfma_f32_32x32x16_bf16 v[52:67], v[184:187], a[68:71], v[52:67]
    v_mfma_f32_32x32x16_bf16 v[68:83], v[188:191], a[68:71], v[68:83]
    v_mfma_f32_32x32x16_bf16 v[84:99], a[208:211], a[72:75], v[84:99]
    v_mfma_f32_32x32x16_bf16 v[100:115], a[212:215], a[72:75], v[100:115]
    v_mfma_f32_32x32x16_bf16 v[84:99], a[216:219], a[76:79], v[84:99]
    v_mfma_f32_32x32x16_bf16 v[100:115], a[220:223], a[76:79], v[100:115]
    v_mfma_f32_32x32x16_bf16 v[84:99], a[224:227], a[80:83], v[84:99]
    v_mfma_f32_32x32x16_bf16 v[100:115], a[228:231], a[80:83], v[100:115]
    v_mfma_f32_32x32x16_bf16 v[84:99], a[232:235], a[84:87], v[84:99]
    v_mfma_f32_32x32x16_bf16 v[100:115], a[236:239], a[84:87], v[100:115]
    v_mfma_f32_32x32x16_bf16 v[84:99], a[240:243], a[88:91], v[84:99]
    v_mfma_f32_32x32x16_bf16 v[100:115], a[244:247], a[88:91], v[100:115]
    v_mfma_f32_32x32x16_bf16 v[52:67], v[192:195], a[92:95], v[52:67]
Llka1:
    s_cbranch_execz Llka2
    v_mfma_f32_32x32x16_bf16 v[68:83], v[196:199], a[92:95], v[68:83]
    s_waitcnt vmcnt(14)
    v_mfma_f32_32x32x16_bf16 v[52:67], v[200:203], a[96:99], v[52:67]
    v_mfma_f32_32x32x16_bf16 v[68:83], v[204:207], a[96:99], v[68:83]
    v_mfma_f32_32x32x16_bf16 v[52:67], v[208:211], a[100:103], v[52:67]
    v_mfma_f32_32x32x16_bf16 v[68:83], v[212:215], a[100:103], v[68:83]
    s_waitcnt vmcnt(12)
    v_mfma_f32_32x32x16_bf16 v[52:67], v[216:219], a[104:107], v[52:67]
    v_mfma_f32_32x32x16_bf16 v[68:83], v[220:223], a[104:107], v[68:83]
    v_mfma_f32_32x32x16_bf16 v[52:67], v[224:227], a[108:111], v[52:67]
    v_mfma_f32_32x32x16_bf16 v[68:83], v[228:231], a[108:111], v[68:83]
    s_waitcnt vmcnt(10)
    v_mfma_f32_32x32x16_bf16 v[52:67], v[232:235], v[116:119], v[52:67]
    v_mfma_f32_32x32x16_bf16 v[68:83], v[236:239], v[116:119], v[68:83]
    v_mfma_f32_32x32x16_bf16 v[52:67], v[240:243], v[120:123], v[52:67]
    v_mfma_f32_32x32x16_bf16 v[68:83], v[244:247], v[120:123], v[68:83]
    s_waitcnt vmcnt(9)
    v_mfma_f32_32x32x16_bf16 v[52:67], v[248:251], v[124:127], v[52:67]
    v_mfma_f32_32x32x16_bf16 v[68:83], v[252:255], v[124:127], v[68:83]
Llka2:
    s_cbranch_execz Lchar
    v_mfma_f32_32x32x16_bf16 v[84:99], a[248:251], v[128:131], v[84:99]
Lcha1:
Llka3:
    s_cbranch_execz Llka4
    v_mfma_f32_32x32x16_bf16 v[84:99], v[176:179], v[132:135], v[84:99]
    s_nop 8
    ds_write_b128 v27, v[52:55] offset:0
    s_waitcnt vmcnt(5)
    v_mfma_f32_32x32x16_bf16 v[84:99], v[184:187], v[136:139], v[84:99]
    ds_write_b128 v27, v[56:59] offset:1024
    v_mfma_f32_32x32x16_bf16 v[84:99], v[192:195], v[140:143], v[84:99]
    ds_write_b128 v27, v[60:63] offset:2048
    v_mfma_f32_32x32x16_bf16 v[84:99], v[200:203], v[144:147], v[84:99]
    ds_write_b128 v27, v[64:67] offset:3072
    v_mfma_f32_32x32x16_bf16 v[84:99], v[208:211], v[148:151], v[84:99]
    s_waitcnt vmcnt(1)
    v_mfma_f32_32x32x16_bf16 v[84:99], v[216:219], v[152:155], v[84:99]
    ds_write_b128 v28, v[68:71] offset:0
    v_mfma_f32_32x32x16_bf16 v[84:99], v[224:227], v[156:159], v[84:99]
    ds_write_b128 v28, v[72:75] offset:1024
    v_mfma_f32_32x32x16_bf16 v[84:99], v[232:235], v[160:163], v[84:99]
    ds_write_b128 v28, v[76:79] offset:2048
    v_mfma_f32_32x32x16_bf16 v[84:99], v[240:243], v[164:167], v[84:99]
    ds_write_b128 v28, v[80:83] offset:3072
    s_waitcnt vmcnt(0)
    v_mfma_f32_32x32x16_bf16 v[84:99], v[248:251], v[168:171], v[84:99]
    v_mfma_f32_32x32x16_bf16 v[100:115], a[252:255], v[128:131], v[100:115]
Llka4:
    s_cbranch_execz Lchar
    v_mfma_f32_32x32x16_bf16 v[100:115], v[180:183], v[132:135], v[100:115]
    s_waitcnt lgkmcnt(0)
    s_barrier
    s_nop 7
    ds_write_b128 v29, v[84:87] offset:0
    ds_read_b128 v[52:55], v30 offset:0
    ds_read_b128 v[56:59], v30 offset:1024
    v_mfma_f32_32x32x16_bf16 v[100:115], v[188:191], v[136:139], v[100:115]
    ds_write_b128 v29, v[88:91] offset:1024
    ds_read_b128 v[60:63], v30 offset:2048
    ds_read_b128 v[64:67], v30 offset:3072
    ds_read_b128 v[68:71], v30 offset:4096
    ds_read_b128 v[72:75], v30 offset:5120
    v_mfma_f32_32x32x16_bf16 v[100:115], v[196:199], v[140:143], v[100:115]
    ds_write_b128 v29, v[92:95] offset:2048
    ds_read_b128 v[76:79], v30 offset:6144
    ds_read_b128 v[80:83], v30 offset:7168
    v_mfma_f32_32x32x16_bf16 v[100:115], v[204:207], v[144:147], v[100:115]
    ds_write_b128 v29, v[96:99] offset:3072
Lcha2:
Llka5:
    s_cbranch_execz Llka6
    v_mfma_f32_32x32x16_bf16 v[100:115], v[212:215], v[148:151], v[100:115]
    s_waitcnt lgkmcnt(10)
    v_fmac_f32 v32, v52, v24
    v_fmac_f32 v33, v53, v24
    v_fmac_f32 v34, v54, v24
    v_fmac_f32 v35, v55, v24
    s_waitcnt lgkmcnt(9)
    v_fmac_f32 v36, v56, v24
    v_fmac_f32 v37, v57, v24
    v_fmac_f32 v38, v58, v24
    v_mfma_f32_32x32x16_bf16 v[100:115], v[220:223], v[152:155], v[100:115]
    s_waitcnt lgkmcnt(0)
    s_barrier
    ds_read_b128 v[84:87], v30 offset:8192
    ds_read_b128 v[88:91], v30 offset:9216
    ds_read_b128 v[92:95], v30 offset:10240
    ds_read_b128 v[96:99], v30 offset:11264
    v_fmac_f32 v39, v59, v24
    v_mfma_f32_32x32x16_bf16 v[100:115], v[228:231], v[156:159], v[100:115]
    v_fmac_f32 v40, v60, v24
    v_fmac_f32 v41, v61, v24
    v_fmac_f32 v42, v62, v24
    v_fmac_f32 v43, v63, v24
    v_fmac_f32 v44, v64, v24
    v_fmac_f32 v45, v65, v24
    v_fmac_f32 v46, v66, v24
    v_mfma_f32_32x32x16_bf16 v[100:115], v[236:239], v[160:163], v[100:115]
    v_fmac_f32 v47, v67, v24
    v_fmac_f32 v32, v68, v24
    v_fmac_f32 v33, v69, v24
    v_fmac_f32 v34, v70, v24
    v_fmac_f32 v35, v71, v24
    v_fmac_f32 v36, v72, v24
    v_fmac_f32 v37, v73, v24
    v_mfma_f32_32x32x16_bf16 v[100:115], v[244:247], v[164:167], v[100:115]
    v_fmac_f32 v38, v74, v24
    v_fmac_f32 v39, v75, v24
Llka6:
    s_cbranch_execz Lchar
    v_fmac_f32 v40, v76, v24
    v_fmac_f32 v41, v77, v24
    v_fmac_f32 v42, v78, v24
    v_fmac_f32 v43, v79, v24
    v_fmac_f32 v44, v80, v24
Lcha3:
Llka7:
    s_cbranch_execz Llka8
    v_mfma_f32_32x32x16_bf16 v[100:115], v[252:255], v[168:171], v[100:115]
    v_fmac_f32 v45, v81, v24
    v_fmac_f32 v46, v82, v24
    v_fmac_f32 v47, v83, v24
    s_waitcnt lgkmcnt(3)
    v_fmac_f32 v32, v84, v24
    v_fmac_f32 v33, v85, v24
    v_fmac_f32 v34, v86, v24
    v_fmac_f32 v35, v87, v24
    s_waitcnt lgkmcnt(2)
    v_fmac_f32 v36, v88, v24
    v_fmac_f32 v37, v89, v24
    v_fmac_f32 v38, v90, v24
    v_fmac_f32 v39, v91, v24
    s_waitcnt lgkmcnt(1)
    v_fmac_f32 v40, v92, v24
    v_fmac_f32 v41, v93, v24
    v_fmac_f32 v42, v94, v24
    v_fmac_f32 v43, v95, v24
    s_waitcnt lgkmcnt(0)
    v_fmac_f32 v44, v96, v24
    v_fmac_f32 v45, v97, v24
    v_fmac_f32 v46, v98, v24
    v_fmac_f32 v47, v99, v24
    v_pk_fma_f32 v[100:101], v[100:101], v[24:25], v[32:33] op_sel_hi:[1,0,1]
    v_pk_fma_f32 v[102:103], v[102:103], v[24:25], v[34:35] op_sel_hi:[1,0,1]
    v_pk_fma_f32 v[104:105], v[104:105], v[24:25], v[36:37] op_sel_hi:[1,0,1]
    v_pk_fma_f32 v[106:107], v[106:107], v[24:25], v[38:39] op_sel_hi:[1,0,1]
    v_pk_fma_f32 v[108:109], v[108:109], v[24:25], v[40:41] op_sel_hi:[1,0,1]
    v_pk_fma_f32 v[110:111], v[110:111], v[24:25], v[42:43] op_sel_hi:[1,0,1]
    v_pk_fma_f32 v[112:113], v[112:113], v[24:25], v[44:45] op_sel_hi:[1,0,1]
    v_pk_fma_f32 v[114:115], v[114:115], v[24:25], v[46:47] op_sel_hi:[1,0,1]
    v_cvt_pk_bf16_f32 v52, v100, v101
    v_cvt_pk_bf16_f32 v53, v102, v103
    v_cvt_pk_bf16_f32 v54, v104, v105
    v_cvt_pk_bf16_f32 v55, v106, v107
    v_cvt_pk_bf16_f32 v56, v108, v109
    v_cvt_pk_bf16_f32 v57, v110, v111
    v_cvt_pk_bf16_f32 v58, v112, v113
Llka8:
    s_cbranch_execz Lchar
    v_cvt_pk_bf16_f32 v59, v114, v115
Lwina1:
    buffer_store_dwordx4 v[52:55], v26, s[32:35], s72 offen
    buffer_store_dwordx4 v[56:59], v26, s[32:35], s72 offen offset:32
    s_nop 1
interleave_layers__sliding_local_dilated__swiglu_ffn__prompt_kernel_end:
    s_endpgm
Lvfs_1:
    s_mov_b32 s5, 0
Lvf_2:
    s_cmp_lg_u32 s5, 16
    s_cbranch_scc1 Lvfk_4
    s_cmp_lg_u32 s50, 0
    s_cbranch_scc1 Lvfk_4
    s_add_u32 s6, s56, 8192
    buffer_store_dwordx4 v[248:251], off, s[36:39], s6 sc1
    s_getreg_b32 s75, hwreg(HW_REG_XCC_ID, 0, 4)
    s_lshl_b32 s6, s75, 3
    s_and_b32 s6, s6, 24
    s_lshl_b32 s6, 1, s6
    v_mov_b32 v7, s6
    s_and_b32 s75, s75, 4
    s_lshl_b32 s6, s48, 3
    s_add_u32 s6, s6, s75
    s_waitcnt vmcnt(0)
    s_mov_b64 exec, 1
    buffer_atomic_add v7, off, s[96:99], s6 sc1
    s_mov_b64 exec, -1
Lvfk_4:
    s_lshl_b32 s6, s48, 3
    s_cmp_lt_u32 s5, 16
    s_cselect_b32 s6, 0x1000, s6
    buffer_load_dwordx2 v[246:247], v252, s[36:39], 0 offen sc1
    buffer_load_dwordx2 v[234:235], off, s[96:99], s6 sc1
    s_waitcnt vmcnt(0)
    v_xor_b32 v246, s0, v246
    v_xor_b32 v247, s61, v247
    v_or_b32 v246, v246, v247
    v_cmp_ne_u32 vcc, 0, v246
    s_nop 1
    s_cmp_eq_u32 vcc_lo, 0
    s_cbranch_scc1 Lvfd_3
    v_sad_u8 v7, v234, 0, 0
    v_sad_u8 v7, v235, 0, v7
    v_cmp_eq_u32 vcc, 32, v7
    s_nop 1
    s_cbranch_vccnz Lvfg_5
    s_add_u32 s5, s5, 1
    s_cmp_lt_u32 s5, 65536
    s_cbranch_scc1 Lvf_2
    s_branch Lvfd_3
Lvfg_5:
    v_or_b32 v7, v234, v235
    v_and_b32 v7, 0x20202020, v7
    v_cmp_ne_u32 vcc, 0, v7
    s_nop 1
    s_cbranch_vccnz Lvfd_3
    s_mov_b32 s4, 1
    s_add_u32 s58, s58, 8192
    s_add_u32 s56, s56, 8192
    s_branch Lvfd_3
Lslow_6:
    buffer_store_dwordx4 v[100:103], v30, s[36:39], s72 offen sc1
    buffer_store_dwordx4 v[104:107], v30, s[36:39], s72 offen offset:512 sc1
    s_branch Lsdone_7
Lss_8:
    s_nop 15
    s_waitcnt vmcnt(0)
    v_mov_b32 v7, 1
    buffer_store_dword v7, off, s[36:39], s56 sc1
    s_lshr_b32 s5, s53, 1
    s_lshl_b32 s5, s5, 8
    s_and_b32 s6, s60, 6
    s_lshl1_add_u32 s5, s6, s5
    s_add_u32 s5, s5, s58
    v_lshl_add_u32 v6, v3, 4, s5
    s_nop 2
    s_mov_b32 s5, 65536
Lssl_9:
    buffer_load_dword v16, v6, s[36:39], 0 offen sc1
    s_waitcnt vmcnt(0)
    v_cmp_gt_u32 vcc, 1, v16
    s_nop 1
    s_cbranch_vccz Lssd_10
    s_sub_u32 s5, s5, 1
    s_cbranch_scc0 Lssl_9
    s_branch Lssd_10
Lsc_11:
    s_mov_b32 s6, 8192
Lscl_12:
    s_waitcnt vmcnt(0)
    s_mov_b32 s100, 0
    v_cmp_eq_u32 vcc, -1, v16
    s_nop 0
    s_cbranch_vccz Lsk_14
    buffer_load_dwordx4 v[16:19], v1, s[36:39], s77 offen offset:0 sc1
    s_mov_b32 s100, 1
Lsk_14:
    v_cmp_eq_u32 vcc, -1, v20
    s_nop 0
    s_cbranch_vccz Lsk_15
    buffer_load_dwordx4 v[20:23], v1, s[36:39], s77 offen offset:1024 sc1
    s_mov_b32 s100, 1
Lsk_15:
    v_cmp_eq_u32 vcc, -1, v24
    s_nop 0
    s_cbranch_vccz Lsk_16
    buffer_load_dwordx4 v[24:27], v1, s[36:39], s77 offen offset:2048 sc1
    s_mov_b32 s100, 1
Lsk_16:
    v_cmp_eq_u32 vcc, -1, v28
    s_nop 0
    s_cbranch_vccz Lsk_17
    buffer_load_dwordx4 v[28:31], v1, s[36:39], s77 offen offset:3072 sc1
    s_mov_b32 s100, 1
Lsk_17:
    v_cmp_eq_u32 vcc, -1, v32
    s_nop 0
    s_cbranch_vccz Lsk_18
    buffer_load_dwordx4 v[32:35], v1, s[36:39], s78 offen offset:0 sc1
    s_mov_b32 s100, 1
Lsk_18:
    v_cmp_eq_u32 vcc, -1, v36
    s_nop 0
    s_cbranch_vccz Lsk_19
    buffer_load_dwordx4 v[36:39], v1, s[36:39], s78 offen offset:1024 sc1
    s_mov_b32 s100, 1
Lsk_19:
    v_cmp_eq_u32 vcc, -1, v40
    s_nop 0
    s_cbranch_vccz Lsk_20
    buffer_load_dwordx4 v[40:43], v1, s[36:39], s78 offen offset:2048 sc1
    s_mov_b32 s100, 1
Lsk_20:
    v_cmp_eq_u32 vcc, -1, v44
    s_nop 0
    s_cbranch_vccz Lsk_21
    buffer_load_dwordx4 v[44:47], v1, s[36:39], s78 offen offset:3072 sc1
    s_mov_b32 s100, 1
Lsk_21:
    v_cmp_eq_u32 vcc, -1, v48
    s_nop 0
    s_cbranch_vccz Lsk_22
    buffer_load_dwordx4 v[48:51], v1, s[36:39], s79 offen offset:0 sc1
    s_mov_b32 s100, 1
Lsk_22:
    s_cmp_eq_u32 s100, 0
    s_cbranch_scc1 Lscd_13
    s_sub_u32 s6, s6, 1
    s_cbranch_scc0 Lscl_12
    s_waitcnt vmcnt(0)
    s_branch Lscd_13
Lsc_23:
    s_mov_b32 s6, 8192
Lscl_24:
    s_waitcnt vmcnt(0)
    s_mov_b32 s100, 0
    v_cmp_eq_u32 vcc, -1, v28
    s_nop 0
    s_cbranch_vccz Lsk_26
    buffer_load_dwordx4 v[28:31], v1, s[36:39], s77 offen offset:3072 sc1
    s_mov_b32 s100, 1
Lsk_26:
    v_cmp_eq_u32 vcc, -1, v32
    s_nop 0
    s_cbranch_vccz Lsk_27
    buffer_load_dwordx4 v[32:35], v1, s[36:39], s78 offen offset:0 sc1
    s_mov_b32 s100, 1
Lsk_27:
    v_cmp_eq_u32 vcc, -1, v36
    s_nop 0
    s_cbranch_vccz Lsk_28
    buffer_load_dwordx4 v[36:39], v1, s[36:39], s78 offen offset:1024 sc1
    s_mov_b32 s100, 1
Lsk_28:
    v_cmp_eq_u32 vcc, -1, v40
    s_nop 0
    s_cbranch_vccz Lsk_29
    buffer_load_dwordx4 v[40:43], v1, s[36:39], s78 offen offset:2048 sc1
    s_mov_b32 s100, 1
Lsk_29:
    v_cmp_eq_u32 vcc, -1, v44
    s_nop 0
    s_cbranch_vccz Lsk_30
    buffer_load_dwordx4 v[44:47], v1, s[36:39], s78 offen offset:3072 sc1
    s_mov_b32 s100, 1
Lsk_30:
    v_cmp_eq_u32 vcc, -1, v48
    s_nop 0
    s_cbranch_vccz Lsk_31
    buffer_load_dwordx4 v[48:51], v1, s[36:39], s79 offen offset:0 sc1
    s_mov_b32 s100, 1
Lsk_31:
    v_cmp_eq_u32 vcc, -1, v52
    s_nop 0
    s_cbranch_vccz Lsk_32
    buffer_load_dwordx4 v[52:55], v1, s[36:39], s79 offen offset:1024 sc1
    s_mov_b32 s100, 1
Lsk_32:
    v_cmp_eq_u32 vcc, -1, v56
    s_nop 0
    s_cbranch_vccz Lsk_33
    buffer_load_dwordx4 v[56:59], v1, s[36:39], s79 offen offset:2048 sc1
    s_mov_b32 s100, 1
Lsk_33:
    v_cmp_eq_u32 vcc, -1, v60
    s_nop 0
    s_cbranch_vccz Lsk_34
    buffer_load_dwordx4 v[60:63], v1, s[36:39], s79 offen offset:3072 sc1
    s_mov_b32 s100, 1
Lsk_34:
    v_cmp_eq_u32 vcc, -1, v64
    s_nop 0
    s_cbranch_vccz Lsk_35
    buffer_load_dwordx4 v[64:67], v1, s[36:39], s80 offen offset:0 sc1
    s_mov_b32 s100, 1
Lsk_35:
    v_cmp_eq_u32 vcc, -1, v68
    s_nop 0
    s_cbranch_vccz Lsk_36
    buffer_load_dwordx4 v[68:71], v1, s[36:39], s80 offen offset:1024 sc1
    s_mov_b32 s100, 1
Lsk_36:
    s_cmp_eq_u32 s100, 0
    s_cbranch_scc1 Lscd_25
    s_sub_u32 s6, s6, 1
    s_cbranch_scc0 Lscl_24
    s_waitcnt vmcnt(0)
    s_branch Lscd_25
Lsc_37:
    s_mov_b32 s6, 8192
Lscl_38:
    s_waitcnt vmcnt(0)
    s_mov_b32 s100, 0
    v_cmp_eq_u32 vcc, -1, v40
    s_nop 0
    s_cbranch_vccz Lsk_40
    buffer_load_dwordx4 v[40:43], v1, s[36:39], s78 offen offset:2048 sc1
    s_mov_b32 s100, 1
Lsk_40:
    v_cmp_eq_u32 vcc, -1, v44
    s_nop 0
    s_cbranch_vccz Lsk_41
    buffer_load_dwordx4 v[44:47], v1, s[36:39], s78 offen offset:3072 sc1
    s_mov_b32 s100, 1
Lsk_41:
    v_cmp_eq_u32 vcc, -1, v48
    s_nop 0
    s_cbranch_vccz Lsk_42
    buffer_load_dwordx4 v[48:51], v1, s[36:39], s79 offen offset:0 sc1
    s_mov_b32 s100, 1
Lsk_42:
    v_cmp_eq_u32 vcc, -1, v52
    s_nop 0
    s_cbranch_vccz Lsk_43
    buffer_load_dwordx4 v[52:55], v1, s[36:39], s79 offen offset:1024 sc1
    s_mov_b32 s100, 1
Lsk_43:
    v_cmp_eq_u32 vcc, -1, v56
    s_nop 0
    s_cbranch_vccz Lsk_44
    buffer_load_dwordx4 v[56:59], v1, s[36:39], s79 offen offset:2048 sc1
    s_mov_b32 s100, 1
Lsk_44:
    v_cmp_eq_u32 vcc, -1, v60
    s_nop 0
    s_cbranch_vccz Lsk_45
    buffer_load_dwordx4 v[60:63], v1, s[36:39], s79 offen offset:3072 sc1
    s_mov_b32 s100, 1
Lsk_45:
    v_cmp_eq_u32 vcc, -1, v64
    s_nop 0
    s_cbranch_vccz Lsk_46
    buffer_load_dwordx4 v[64:67], v1, s[36:39], s80 offen offset:0 sc1
    s_mov_b32 s100, 1
Lsk_46:
    v_cmp_eq_u32 vcc, -1, v68
    s_nop 0
    s_cbranch_vccz Lsk_47
    buffer_load_dwordx4 v[68:71], v1, s[36:39], s80 offen offset:1024 sc1
    s_mov_b32 s100, 1
Lsk_47:
    v_cmp_eq_u32 vcc, -1, v72
    s_nop 0
    s_cbranch_vccz Lsk_48
    buffer_load_dwordx4 v[72:75], v1, s[36:39], s80 offen offset:2048 sc1
    s_mov_b32 s100, 1
Lsk_48:
    v_cmp_eq_u32 vcc, -1, v76
    s_nop 0
    s_cbranch_vccz Lsk_49
    buffer_load_dwordx4 v[76:79], v1, s[36:39], s80 offen offset:3072 sc1
    s_mov_b32 s100, 1
Lsk_49:
    s_cmp_eq_u32 s100, 0
    s_cbranch_scc1 Lscd_39
    s_sub_u32 s6, s6, 1
    s_cbranch_scc0 Lscl_38
    s_waitcnt vmcnt(0)
    s_branch Lscd_39
Lsc_50:
    s_mov_b32 s6, 8192
Lscl_51:
    s_waitcnt vmcnt(0)
    s_mov_b32 s100, 0
    v_cmp_eq_u32 vcc, -1, v60
    s_nop 0
    s_cbranch_vccz Lsk_53
    buffer_load_dwordx4 v[60:63], v1, s[36:39], s79 offen offset:3072 sc1
    s_mov_b32 s100, 1
Lsk_53:
    v_cmp_eq_u32 vcc, -1, v64
    s_nop 0
    s_cbranch_vccz Lsk_54
    buffer_load_dwordx4 v[64:67], v1, s[36:39], s80 offen offset:0 sc1
    s_mov_b32 s100, 1
Lsk_54:
    v_cmp_eq_u32 vcc, -1, v68
    s_nop 0
    s_cbranch_vccz Lsk_55
    buffer_load_dwordx4 v[68:71], v1, s[36:39], s80 offen offset:1024 sc1
    s_mov_b32 s100, 1
Lsk_55:
    v_cmp_eq_u32 vcc, -1, v72
    s_nop 0
    s_cbranch_vccz Lsk_56
    buffer_load_dwordx4 v[72:75], v1, s[36:39], s80 offen offset:2048 sc1
    s_mov_b32 s100, 1
Lsk_56:
    v_cmp_eq_u32 vcc, -1, v76
    s_nop 0
    s_cbranch_vccz Lsk_57
    buffer_load_dwordx4 v[76:79], v1, s[36:39], s80 offen offset:3072 sc1
    s_mov_b32 s100, 1
Lsk_57:
    s_cmp_eq_u32 s100, 0
    s_cbranch_scc1 Lscd_52
    s_sub_u32 s6, s6, 1
    s_cbranch_scc0 Lscl_51
    s_waitcnt vmcnt(0)
    s_branch Lscd_52
Lslow_58:
    buffer_store_dwordx4 v[16:19], v5, s[36:39], s72 offen sc1
    buffer_store_dwordx4 v[20:23], v5, s[36:39], s72 offen offset:1024 sc1
    s_branch Lsdone_59
Lslow_60:
    buffer_store_dwordx2 v[24:25], v168, s[36:39], s73 offen sc1
    s_branch Lsdone_61
Lss_62:
    s_nop 15
    s_waitcnt vmcnt(0)
    v_mov_b32 v7, 2
    buffer_store_dword v7, off, s[36:39], s56 sc1
    v_min_u32 v6, 55, v0
    v_lshl_add_u32 v6, v6, 3, s58
    s_nop 2
    s_mov_b32 s5, 65536
Lssl_63:
    buffer_load_dwordx2 v[116:117], v6, s[36:39], 0 offen sc1
    s_waitcnt vmcnt(0)
    v_min_u32 v116, v116, v117
    v_cmp_gt_u32 vcc, 2, v116
    s_nop 1
    s_cbranch_vccz Lssd_64
    s_sub_u32 s5, s5, 1
    s_cbranch_scc0 Lssl_63
    s_branch Lssd_64
Lmc_65:
    s_mov_b32 s5, 65536
Lmcl_66:
    buffer_load_dword v220, v254, s[36:39], 0 offen sc1
    s_waitcnt vmcnt(0)
    v_cmp_ne_u32 vcc, s0, v220
    s_nop 1
    s_cbranch_vccz Lmcd_67
    s_sub_u32 s5, s5, 1
    s_cbranch_scc0 Lmcl_66
    s_branch Lmcd_67
Lvfs_68:
    s_mov_b32 s5, 0
Lvf_69:
    s_cmp_lg_u32 s5, 16
    s_cbranch_scc1 Lvfk_71
    s_cmp_lg_u32 s50, 0
    s_cbranch_scc1 Lvfk_71
    s_add_u32 s6, s56, 8192
    buffer_store_dwordx4 v[248:251], off, s[36:39], s6 sc1
    s_getreg_b32 s75, hwreg(HW_REG_XCC_ID, 0, 4)
    s_lshl_b32 s6, s75, 3
    s_and_b32 s6, s6, 24
    s_lshl_b32 s6, 1, s6
    v_mov_b32 v7, s6
    s_and_b32 s75, s75, 4
    s_lshl_b32 s6, s48, 3
    s_add_u32 s6, s6, s75
    s_waitcnt vmcnt(0)
    s_mov_b64 exec, 1
    buffer_atomic_add v7, off, s[96:99], s6 sc1
    s_mov_b64 exec, -1
Lvfk_71:
    s_lshl_b32 s6, s48, 3
    s_cmp_lt_u32 s5, 16
    s_cselect_b32 s6, 0x1000, s6
    buffer_load_dwordx2 v[246:247], v252, s[36:39], 0 offen sc1
    buffer_load_dwordx2 v[234:235], off, s[96:99], s6 sc1
    s_waitcnt vmcnt(0)
    v_xor_b32 v246, s0, v246
    v_xor_b32 v247, s61, v247
    v_or_b32 v246, v246, v247
    v_cmp_ne_u32 vcc, 0, v246
    s_nop 1
    s_cmp_eq_u32 vcc_lo, 0
    s_cbranch_scc1 Lvfd_70
    v_sad_u8 v7, v234, 0, 0
    v_sad_u8 v7, v235, 0, v7
    v_cmp_eq_u32 vcc, 32, v7
    s_nop 1
    s_cbranch_vccnz Lvfg_72
    s_add_u32 s5, s5, 1
    s_cmp_lt_u32 s5, 65536
    s_cbranch_scc1 Lvf_69
    s_branch Lvfd_70
Lvfg_72:
    v_or_b32 v7, v234, v235
    v_and_b32 v7, 0x20202020, v7
    v_cmp_ne_u32 vcc, 0, v7
    s_nop 1
    s_cbranch_vccnz Lvfd_70
    s_mov_b32 s4, 1
    s_add_u32 s58, s58, 8192
    s_add_u32 s56, s56, 8192
    s_branch Lvfd_70
Lslow_73:
    buffer_store_dwordx4 v[100:103], v30, s[36:39], s72 offen sc1
    buffer_store_dwordx4 v[104:107], v30, s[36:39], s72 offen offset:512 sc1
    s_branch Lsdone_74
Lmc_75:
    s_mov_b32 s5, 65536
Lmcl_76:
    buffer_load_dword v15, v14, s[36:39], 0 offen sc1
    s_waitcnt vmcnt(0)
    v_cmp_ne_u32 vcc, s0, v15
    s_nop 1
    s_cbranch_vccz Lmcd_77
    s_sub_u32 s5, s5, 1
    s_cbranch_scc0 Lmcl_76
    s_branch Lmcd_77
Lidle0:
    s_cmp_eq_u32 s4, 0
    s_cbranch_scc1 Lidle0f
    s_waitcnt vmcnt(0)
    v_mov_b32 v7, 1
    buffer_store_dword v7, off, s[36:39], s56 sc1
Lidle0f:
    s_sub_u32 s75, s49, 28
    s_lshl2_add_u32 s72, s75, s50
    s_lshl2_add_u32 s75, s48, s75
    v_lshlrev_b32 v23, 7, v0
    v_mov_b32 v9, s0
    v_mov_b32 v16, -1
    v_mov_b32 v17, -1
    v_mov_b32 v18, -1
    v_mov_b32 v19, -1
    v_mov_b32 v24, 0
    s_mul_i32 s73, s48, 28672
    s_add_u32 s73, s73, 42481664
    s_lshl_b32 s74, s48, 8
    s_add_u32 s74, s74, 42729472
    s_cmp_eq_u32 s72, 0
    s_cselect_b32 s73, s73, 2146435072
    s_cselect_b32 s74, s74, 2146435072
    buffer_store_dwordx4 v[16:19], v1, s[36:39], s73 offen offset:0 sc1
    buffer_store_dwordx4 v[16:19], v1, s[36:39], s73 offen offset:1024 sc1
    buffer_store_dwordx4 v[16:19], v1, s[36:39], s73 offen offset:2048 sc1
    buffer_store_dwordx4 v[16:19], v1, s[36:39], s73 offen offset:3072 sc1
    s_add_u32 s73, s73, 4096
    buffer_store_dwordx4 v[16:19], v1, s[36:39], s73 offen offset:0 sc1
    buffer_store_dwordx4 v[16:19], v1, s[36:39], s73 offen offset:1024 sc1
    buffer_store_dwordx4 v[16:19], v1, s[36:39], s73 offen offset:2048 sc1
    buffer_store_dwordx4 v[16:19], v1, s[36:39], s73 offen offset:3072 sc1
    s_add_u32 s73, s73, 4096
    buffer_store_dwordx4 v[16:19], v1, s[36:39], s73 offen offset:0 sc1
    buffer_store_dwordx4 v[16:19], v1, s[36:39], s73 offen offset:1024 sc1
    buffer_store_dwordx4 v[16:19], v1, s[36:39], s73 offen offset:2048 sc1
    buffer_store_dwordx4 v[16:19], v1, s[36:39], s73 offen offset:3072 sc1
    s_add_u32 s73, s73, 4096
    buffer_store_dwordx4 v[16:19], v1, s[36:39], s73 offen offset:0 sc1
    buffer_store_dwordx4 v[16:19], v1, s[36:39], s73 offen offset:1024 sc1
    v_lshlrev_b32 v11, 4, v3
    v_lshl_add_u32 v11, v2, 11, v11
    buffer_store_dwordx4 v[16:19], v11, s[36:39], s74 offen sc1
    s_add_u32 s74, s74, 6144
    buffer_store_dwordx4 v[16:19], v11, s[36:39], s74 offen sc1
    s_lshl_b32 s73, s48, 9
    s_add_u32 s73, s73, 41959680
    s_cmp_eq_u32 s72, 0
    s_cselect_b32 s73, s73, 2146435072
    s_waitcnt vmcnt(0)
    buffer_store_dword v9, off, s[36:39], s73 sc1
    s_cmp_eq_u32 s48, 7
    s_cselect_b32 s5, 3, s48
    s_lshr_b32 s6, s1, 1
    s_lshl_b32 s5, s5, 5
    s_add_u32 s5, s5, s6
    s_add_u32 s5, s5, 140
    s_sub_u32 s6, s5, 224
    s_cselect_b32 s5, s5, s6
    s_mul_i32 s5, s5, 7168
    buffer_load_dword v221, v222, s[40:43], s5 offen
    s_cmp_eq_u32 s48, 7
    s_cselect_b32 s5, 3, s48
    s_lshr_b32 s6, s1, 1
    s_lshl_b32 s5, s5, 5
    s_add_u32 s5, s5, s6
    s_add_u32 s5, s5, 148
    s_sub_u32 s6, s5, 224
    s_cselect_b32 s5, s5, s6
    s_mul_i32 s5, s5, 7168
    buffer_load_dword v221, v222, s[40:43], s5 offen
    s_cmp_eq_u32 s48, 7
    s_cselect_b32 s5, 3, s48
    s_lshr_b32 s6, s1, 1
    s_lshl_b32 s5, s5, 5
    s_add_u32 s5, s5, s6
    s_add_u32 s5, s5, 156
    s_sub_u32 s6, s5, 224
    s_cselect_b32 s5, s5, s6
    s_mul_i32 s5, s5, 7168
    buffer_load_dword v221, v222, s[40:43], s5 offen
    s_cmp_eq_u32 s48, 7
    s_cselect_b32 s5, 3, s48
    s_lshr_b32 s6, s1, 1
    s_lshl_b32 s5, s5, 5
    s_add_u32 s5, s5, s6
    s_add_u32 s5, s5, 164
    s_sub_u32 s6, s5, 224
    s_cselect_b32 s5, s5, s6
    s_mul_i32 s5, s5, 7168
    buffer_load_dword v221, v222, s[40:43], s5 offen
    s_cmp_eq_u32 s48, 7
    s_cselect_b32 s5, 3, s48
    s_lshr_b32 s6, s1, 1
    s_lshl_b32 s5, s5, 5
    s_add_u32 s5, s5, s6
    s_add_u32 s5, s5, 172
    s_sub_u32 s6, s5, 224
    s_cselect_b32 s5, s5, s6
    s_mul_i32 s5, s5, 7168
    buffer_load_dword v221, v222, s[40:43], s5 offen
    s_cmp_eq_u32 s48, 7
    s_cselect_b32 s5, 3, s48
    s_lshr_b32 s6, s1, 1
    s_lshl_b32 s5, s5, 5
    s_add_u32 s5, s5, s6
    s_add_u32 s5, s5, 180
    s_sub_u32 s6, s5, 224
    s_cselect_b32 s5, s5, s6
    s_mul_i32 s5, s5, 7168
    buffer_load_dword v221, v222, s[40:43], s5 offen
    s_lshl_b32 s73, s48, 21
    s_mul_i32 s74, s72, 49152
    s_add_u32 s74, s74, s73
    s_add_u32 s74, s74, 516096
    buffer_store_dwordx4 v[16:19], v1, s[36:39], s74 offen offset:0 sc1
    buffer_store_dwordx4 v[16:19], v1, s[36:39], s74 offen offset:1024 sc1
    buffer_store_dwordx4 v[16:19], v1, s[36:39], s74 offen offset:2048 sc1
    buffer_store_dwordx4 v[16:19], v1, s[36:39], s74 offen offset:3072 sc1
    s_add_u32 s74, s74, 4096
    buffer_store_dwordx4 v[16:19], v1, s[36:39], s74 offen offset:0 sc1
    buffer_store_dwordx4 v[16:19], v1, s[36:39], s74 offen offset:1024 sc1
    buffer_store_dwordx4 v[16:19], v1, s[36:39], s74 offen offset:2048 sc1
    buffer_store_dwordx4 v[16:19], v1, s[36:39], s74 offen offset:3072 sc1
    s_add_u32 s74, s74, 4096
    buffer_store_dwordx4 v[16:19], v1, s[36:39], s74 offen offset:0 sc1
    buffer_store_dwordx4 v[16:19], v1, s[36:39], s74 offen offset:1024 sc1
    buffer_store_dwordx4 v[16:19], v1, s[36:39], s74 offen offset:2048 sc1
    buffer_store_dwordx4 v[16:19], v1, s[36:39], s74 offen offset:3072 sc1
    s_add_u32 s74, s74, 4096
    buffer_store_dwordx4 v[16:19], v1, s[36:39], s74 offen offset:0 sc1
    buffer_store_dwordx4 v[16:19], v1, s[36:39], s74 offen offset:1024 sc1
    buffer_store_dwordx4 v[16:19], v1, s[36:39], s74 offen offset:2048 sc1
    buffer_store_dwordx4 v[16:19], v1, s[36:39], s74 offen offset:3072 sc1
    s_add_u32 s74, s74, 4096
    buffer_store_dwordx4 v[16:19], v1, s[36:39], s74 offen offset:0 sc1
    buffer_store_dwordx4 v[16:19], v1, s[36:39], s74 offen offset:1024 sc1
    buffer_store_dwordx4 v[16:19], v1, s[36:39], s74 offen offset:2048 sc1
    buffer_store_dwordx4 v[16:19], v1, s[36:39], s74 offen offset:3072 sc1
    s_add_u32 s74, s74, 4096
    buffer_store_dwordx4 v[16:19], v1, s[36:39], s74 offen offset:0 sc1
    buffer_store_dwordx4 v[16:19], v1, s[36:39], s74 offen offset:1024 sc1
    buffer_store_dwordx4 v[16:19], v1, s[36:39], s74 offen offset:2048 sc1
    buffer_store_dwordx4 v[16:19], v1, s[36:39], s74 offen offset:3072 sc1
    s_add_u32 s74, s74, 4096
    buffer_store_dwordx4 v[16:19], v1, s[36:39], s74 offen offset:0 sc1
    buffer_store_dwordx4 v[16:19], v1, s[36:39], s74 offen offset:1024 sc1
    buffer_store_dwordx4 v[16:19], v1, s[36:39], s74 offen offset:2048 sc1
    buffer_store_dwordx4 v[16:19], v1, s[36:39], s74 offen offset:3072 sc1
    s_add_u32 s74, s74, 4096
    buffer_store_dwordx4 v[16:19], v1, s[36:39], s74 offen offset:0 sc1
    buffer_store_dwordx4 v[16:19], v1, s[36:39], s74 offen offset:1024 sc1
    buffer_store_dwordx4 v[16:19], v1, s[36:39], s74 offen offset:2048 sc1
    buffer_store_dwordx4 v[16:19], v1, s[36:39], s74 offen offset:3072 sc1
    s_add_u32 s74, s74, 4096
    buffer_store_dwordx4 v[16:19], v1, s[36:39], s74 offen offset:0 sc1
    buffer_store_dwordx4 v[16:19], v1, s[36:39], s74 offen offset:1024 sc1
    buffer_store_dwordx4 v[16:19], v1, s[36:39], s74 offen offset:2048 sc1
    buffer_store_dwordx4 v[16:19], v1, s[36:39], s74 offen offset:3072 sc1
    s_add_u32 s74, s74, 4096
    buffer_store_dwordx4 v[16:19], v1, s[36:39], s74 offen offset:0 sc1
    buffer_store_dwordx4 v[16:19], v1, s[36:39], s74 offen offset:1024 sc1
    buffer_store_dwordx4 v[16:19], v1, s[36:39], s74 offen offset:2048 sc1
    buffer_store_dwordx4 v[16:19], v1, s[36:39], s74 offen offset:3072 sc1
    s_add_u32 s74, s74, 4096
    buffer_store_dwordx4 v[16:19], v1, s[36:39], s74 offen offset:0 sc1
    buffer_store_dwordx4 v[16:19], v1, s[36:39], s74 offen offset:1024 sc1
    buffer_store_dwordx4 v[16:19], v1, s[36:39], s74 offen offset:2048 sc1
    buffer_store_dwordx4 v[16:19], v1, s[36:39], s74 offen offset:3072 sc1
    s_add_u32 s74, s74, 4096
    buffer_store_dwordx4 v[16:19], v1, s[36:39], s74 offen offset:0 sc1
    buffer_store_dwordx4 v[16:19], v1, s[36:39], s74 offen offset:1024 sc1
    buffer_store_dwordx4 v[16:19], v1, s[36:39], s74 offen offset:2048 sc1
    buffer_store_dwordx4 v[16:19], v1, s[36:39], s74 offen offset:3072 sc1
    s_add_u32 s74, s74, 4096
    s_waitcnt vmcnt(0)
    s_lshl_b32 s74, s48, 9
    s_lshl2_add_u32 s74, s72, s74
    s_add_u32 s74, s74, 41959744
    buffer_store_dword v9, off, s[36:39], s74 sc1
    s_add_u32 s73, s73, 516096
    s_mul_i32 s74, s72, 49152
    s_add_u32 s73, s73, s74
    buffer_load_dword v221, v23, s[36:39], s73 offen sc1
    s_add_u32 s73, s73, 8192
    buffer_load_dword v221, v23, s[36:39], s73 offen sc1
    s_add_u32 s73, s73, 8192
    buffer_load_dword v221, v23, s[36:39], s73 offen sc1
    s_add_u32 s73, s73, 8192
    buffer_load_dword v221, v23, s[36:39], s73 offen sc1
    s_add_u32 s73, s73, 8192
    buffer_load_dword v221, v23, s[36:39], s73 offen sc1
    s_add_u32 s73, s73, 8192
    buffer_load_dword v221, v23, s[36:39], s73 offen sc1
    s_lshl2_add_u32 s73, s75, s50
    s_cmp_lg_u32 s73, 127
    s_cbranch_scc1 Lnoep
    v_and_b32 v14, 7, v0
    v_lshlrev_b32 v14, 9, v14
    v_add_u32 v14, 41959680, v14
    buffer_load_dword v15, v14, s[36:39], 0 offen sc1
    s_waitcnt vmcnt(0)
    v_cmp_ne_u32 vcc, s0, v15
    s_nop 0
    s_cbranch_vccnz Lmc_75
Lmcd_77:
    v_add_u32 v10, 16, v9
    s_mov_b32 s73, 41963520
    buffer_store_dword v10, off, s[36:39], s73 sc1
    s_nop 0
Lnoep:
    s_lshl2_add_u32 s80, s52, s50
    s_mul_i32 s80, s80, 28672
    s_add_u32 s80, s80, s21
    s_lshl4_add_u32 s8, s22, s80
    s_lshl4_add_u32 s9, s23, s80
    s_lshl4_add_u32 s10, s24, s80
    s_lshl4_add_u32 s11, s25, s80
    s_lshl4_add_u32 s12, s26, s80
    s_lshl4_add_u32 s13, s27, s80
    s_lshl4_add_u32 s14, s28, s80
    s_lshl_b32 s80, s52, 10
    s_add_u32 s80, s80, s21
    s_add_u32 s80, s80, 229248
    s_lshl_b32 s82, s48, 8
    s_add_u32 s82, s82, 42729344
    s_add_u32 s81, s80, 128
    s_cmp_eq_u32 s48, 0
    s_cselect_b32 s82, s81, s82
    s_lshl_b32 s81, s50, 9
    s_add_u32 s80, s80, s81
    s_add_u32 s81, s50, s52
    s_cmp_eq_u32 s81, 0
    s_cselect_b32 s82, s82, s80
    v_lshl_add_u32 v15, v0, 3, s82
    v_lshl_add_u32 v14, v0, 3, s80
    v_cmp_gt_u32 vcc, 16, v0
    s_lshl_b32 s80, s50, 6
    s_nop 0
    v_cndmask_b32 v14, v14, v15, vcc
    v_add_u32 v15, s80, v0
    v_cmp_gt_u32 vcc, 144, v15
    v_mov_b32 v48, 2146435072
    s_nop 0
    v_cndmask_b32 v14, v48, v14, vcc
    v_lshlrev_b32 v15, 2, v15
    v_add_u32 v15, 159232, v15
    s_add_u32 s46, s50, s57
    s_cmp_eq_u32 s46, 0
    s_cselect_b32 s46, 256, 0
    s_mov_b32 s47, 159232
    s_lshl_b32 s80, s54, 7
    s_mul_i32 s81, s50, 7168
    s_add_u32 s80, s80, s81
    s_cmp_lt_u32 s49, 28
    s_cselect_b32 s15, s80, 2146435072
    s_mul_i32 s80, s52, 100352
    s_add_u32 s80, s80, s21
    s_mul_i32 s44, s48, 28672
    s_add_u32 s44, s44, 42452992
    s_cmp_eq_u32 s48, 0
    s_cselect_b32 s81, 1, s52
    s_cmp_eq_u32 s81, 0
    s_cselect_b32 s44, s44, s80
    v_mov_b32 v6, v14
    s_and_b32 s81, s50, 1
    s_lshl_b32 s81, s81, 10
    s_add_u32 s44, s44, s81
    s_cmp_lt_u32 s50, 2
    s_cselect_b32 s80, s22, s23
    s_lshl4_add_u32 s40, s80, s44
    s_cmp_lt_u32 s50, 2
    s_cselect_b32 s80, s24, s25
    s_lshl4_add_u32 s41, s80, s44
    s_cmp_lt_u32 s50, 2
    s_cselect_b32 s80, s26, s27
    s_lshl4_add_u32 s42, s80, s44
    s_cmp_lt_u32 s50, 2
    s_cselect_b32 s80, s28, s28
    s_lshl4_add_u32 s43, s80, s44
    s_add_u32 s44, s81, 144896
    s_lshl_b32 s45, s50, 10
    s_add_u32 s45, s45, 132608
    s_sub_u32 s30, s45, 40960
    s_add_u32 s55, s21, 245760
    s_add_u32 s20, s20, 8388608
    s_sub_u32 s5, s21, 409600
    s_cmp_eq_u32 s4, 0
    s_cselect_b32 s20, s5, s20
    s_and_b32 s80, s50, 1
    s_lshr_b32 s81, s50, 1
    v_lshrrev_b32 v48, 2, v3
    v_lshlrev_b32 v9, 6, v48
    v_and_b32 v48, 3, v3
    v_lshl_add_u32 v9, v48, 3, v9
    v_lshrrev_b32 v48, 1, v2
    v_lshl_add_u32 v8, v48, 8, v9
    v_xor_b32 v48, v48, v2
    v_and_b32 v48, 1, v48
    v_lshl_add_u32 v8, v48, 5, v8
    v_lshl_add_u32 v10, v2, 8, v9
    v_xor_b32 v48, s80, v2
    v_and_b32 v48, 1, v48
    v_lshl_add_u32 v10, v48, 5, v10
    v_add_u32 v9, 43008, v8
    s_lshl_b32 s82, s81, 10
    v_add_u32 v10, s82, v10
    v_add_u32 v11, 43008, v10
    v_and_b32 v48, 4, v3
    v_lshlrev_b32 v4, 7, v48
    v_lshl_add_u32 v4, v2, 6, v4
    v_and_b32 v48, 8, v3
    v_add_u32 v4, v4, v48
    v_and_b32 v48, 3, v3
    v_lshl_add_u32 v4, v48, 1, v4
    s_mul_i32 s83, s81, 12288
    s_lshl_b32 s82, s80, 8
    s_sub_u32 s82, s82, s83
    s_add_u32 s82, s82, 162304
    v_add_u32 v4, s82, v4
    s_lshl_b32 s82, s80, 9
    s_add_u32 s83, s82, s83
    s_add_u32 s83, s83, 148992
    s_lshl_b32 s82, s50, 11
    s_add_u32 s82, s82, 148992
    v_and_b32 v5, 1, v2
    v_mul_u32_u24 v5, 14336, v5
    v_lshrrev_b32 v48, 1, v2
    v_lshl_add_u32 v5, v48, 8, v5
    v_lshl_add_u32 v5, v3, 4, v5
    v_min_u32 v170, 55, v0
    v_lshl_add_u32 v170, v170, 3, s58
    s_mov_b32 s77, 2146435072
    s_mov_b32 s78, 2146435072
    v_mov_b32 v26, 0
    s_mov_b32 s5, 65536
    s_nop 1
Lwl_78:
    buffer_load_dwordx2 v[16:17], v170, s[36:39], 0 offen sc1
    s_waitcnt vmcnt(0)
    v_min_u32 v16, v16, v17
    v_cmp_gt_u32 vcc, 7, v16
    s_cbranch_vccz Lwd_79
    s_sub_u32 s5, s5, 1
    s_cbranch_scc0 Lwl_78
Lwd_79:
    s_barrier
    s_branch Lp1pre
Lvfs_80:
    s_mov_b32 s5, 0
Lvf_81:
    s_cmp_lg_u32 s5, 16
    s_cbranch_scc1 Lvfk_83
    s_cmp_lg_u32 s50, 0
    s_cbranch_scc1 Lvfk_83
    s_add_u32 s6, s56, 8192
    buffer_store_dwordx4 v[248:251], off, s[36:39], s6 sc1
    s_getreg_b32 s75, hwreg(HW_REG_XCC_ID, 0, 4)
    s_lshl_b32 s6, s75, 3
    s_and_b32 s6, s6, 24
    s_lshl_b32 s6, 1, s6
    v_mov_b32 v7, s6
    s_and_b32 s75, s75, 4
    s_lshl_b32 s6, s48, 3
    s_add_u32 s6, s6, s75
    s_waitcnt vmcnt(0)
    s_mov_b64 exec, 1
    buffer_atomic_add v7, off, s[96:99], s6 sc1
    s_mov_b64 exec, -1
Lvfk_83:
    s_lshl_b32 s6, s48, 3
    s_cmp_lt_u32 s5, 16
    s_cselect_b32 s6, 0x1000, s6
    buffer_load_dwordx2 v[246:247], v252, s[36:39], 0 offen sc1
    buffer_load_dwordx2 v[234:235], off, s[96:99], s6 sc1
    s_waitcnt vmcnt(0)
    v_xor_b32 v246, s0, v246
    v_xor_b32 v247, s61, v247
    v_or_b32 v246, v246, v247
    v_cmp_ne_u32 vcc, 0, v246
    s_nop 1
    s_cmp_eq_u32 vcc_lo, 0
    s_cbranch_scc1 Lvfd_82
    v_sad_u8 v7, v234, 0, 0
    v_sad_u8 v7, v235, 0, v7
    v_cmp_eq_u32 vcc, 32, v7
    s_nop 1
    s_cbranch_vccnz Lvfg_84
    s_add_u32 s5, s5, 1
    s_cmp_lt_u32 s5, 65536
    s_cbranch_scc1 Lvf_81
    s_branch Lvfd_82
Lvfg_84:
    v_or_b32 v7, v234, v235
    v_and_b32 v7, 0x20202020, v7
    v_cmp_ne_u32 vcc, 0, v7
    s_nop 1
    s_cbranch_vccnz Lvfd_82
    s_mov_b32 s4, 1
    s_add_u32 s58, s58, 8192
    s_add_u32 s56, s56, 8192
    s_branch Lvfd_82
Lslow_85:
    buffer_store_dwordx4 v[100:103], v30, s[36:39], s72 offen sc1
    buffer_store_dwordx4 v[104:107], v30, s[36:39], s72 offen offset:512 sc1
    s_branch Lsdone_86
Lss_87:
    s_nop 15
    s_waitcnt vmcnt(0)
    v_mov_b32 v7, 1
    buffer_store_dword v7, off, s[36:39], s56 sc1
    s_lshr_b32 s5, s53, 1
    s_lshl_b32 s5, s5, 8
    s_and_b32 s6, s60, 6
    s_lshl1_add_u32 s5, s6, s5
    s_add_u32 s5, s5, s58
    v_lshl_add_u32 v6, v3, 4, s5
    s_nop 2
    s_mov_b32 s5, 65536
Lssl_88:
    buffer_load_dword v16, v6, s[36:39], 0 offen sc1
    s_waitcnt vmcnt(0)
    v_cmp_gt_u32 vcc, 1, v16
    s_nop 1
    s_cbranch_vccz Lssd_89
    s_sub_u32 s5, s5, 1
    s_cbranch_scc0 Lssl_88
    s_branch Lssd_89
Lsc_90:
    s_mov_b32 s6, 8192
Lscl_91:
    s_waitcnt vmcnt(0)
    s_mov_b32 s100, 0
    v_cmp_eq_u32 vcc, -1, v16
    s_nop 0
    s_cbranch_vccz Lsk_93
    buffer_load_dwordx4 v[16:19], v1, s[36:39], s77 offen offset:0 sc1
    s_mov_b32 s100, 1
Lsk_93:
    v_cmp_eq_u32 vcc, -1, v20
    s_nop 0
    s_cbranch_vccz Lsk_94
    buffer_load_dwordx4 v[20:23], v1, s[36:39], s77 offen offset:1024 sc1
    s_mov_b32 s100, 1
Lsk_94:
    v_cmp_eq_u32 vcc, -1, v24
    s_nop 0
    s_cbranch_vccz Lsk_95
    buffer_load_dwordx4 v[24:27], v1, s[36:39], s77 offen offset:2048 sc1
    s_mov_b32 s100, 1
Lsk_95:
    v_cmp_eq_u32 vcc, -1, v28
    s_nop 0
    s_cbranch_vccz Lsk_96
    buffer_load_dwordx4 v[28:31], v1, s[36:39], s77 offen offset:3072 sc1
    s_mov_b32 s100, 1
Lsk_96:
    v_cmp_eq_u32 vcc, -1, v32
    s_nop 0
    s_cbranch_vccz Lsk_97
    buffer_load_dwordx4 v[32:35], v1, s[36:39], s78 offen offset:0 sc1
    s_mov_b32 s100, 1
Lsk_97:
    v_cmp_eq_u32 vcc, -1, v36
    s_nop 0
    s_cbranch_vccz Lsk_98
    buffer_load_dwordx4 v[36:39], v1, s[36:39], s78 offen offset:1024 sc1
    s_mov_b32 s100, 1
Lsk_98:
    v_cmp_eq_u32 vcc, -1, v40
    s_nop 0
    s_cbranch_vccz Lsk_99
    buffer_load_dwordx4 v[40:43], v1, s[36:39], s78 offen offset:2048 sc1
    s_mov_b32 s100, 1
Lsk_99:
    v_cmp_eq_u32 vcc, -1, v44
    s_nop 0
    s_cbranch_vccz Lsk_100
    buffer_load_dwordx4 v[44:47], v1, s[36:39], s78 offen offset:3072 sc1
    s_mov_b32 s100, 1
Lsk_100:
    v_cmp_eq_u32 vcc, -1, v48
    s_nop 0
    s_cbranch_vccz Lsk_101
    buffer_load_dwordx4 v[48:51], v1, s[36:39], s79 offen offset:0 sc1
    s_mov_b32 s100, 1
Lsk_101:
    s_cmp_eq_u32 s100, 0
    s_cbranch_scc1 Lscd_92
    s_sub_u32 s6, s6, 1
    s_cbranch_scc0 Lscl_91
    s_waitcnt vmcnt(0)
    s_branch Lscd_92
Lsc_102:
    s_mov_b32 s6, 8192
Lscl_103:
    s_waitcnt vmcnt(0)
    s_mov_b32 s100, 0
    v_cmp_eq_u32 vcc, -1, v28
    s_nop 0
    s_cbranch_vccz Lsk_105
    buffer_load_dwordx4 v[28:31], v1, s[36:39], s77 offen offset:3072 sc1
    s_mov_b32 s100, 1
Lsk_105:
    v_cmp_eq_u32 vcc, -1, v32
    s_nop 0
    s_cbranch_vccz Lsk_106
    buffer_load_dwordx4 v[32:35], v1, s[36:39], s78 offen offset:0 sc1
    s_mov_b32 s100, 1
Lsk_106:
    v_cmp_eq_u32 vcc, -1, v36
    s_nop 0
    s_cbranch_vccz Lsk_107
    buffer_load_dwordx4 v[36:39], v1, s[36:39], s78 offen offset:1024 sc1
    s_mov_b32 s100, 1
Lsk_107:
    v_cmp_eq_u32 vcc, -1, v40
    s_nop 0
    s_cbranch_vccz Lsk_108
    buffer_load_dwordx4 v[40:43], v1, s[36:39], s78 offen offset:2048 sc1
    s_mov_b32 s100, 1
Lsk_108:
    v_cmp_eq_u32 vcc, -1, v44
    s_nop 0
    s_cbranch_vccz Lsk_109
    buffer_load_dwordx4 v[44:47], v1, s[36:39], s78 offen offset:3072 sc1
    s_mov_b32 s100, 1
Lsk_109:
    v_cmp_eq_u32 vcc, -1, v48
    s_nop 0
    s_cbranch_vccz Lsk_110
    buffer_load_dwordx4 v[48:51], v1, s[36:39], s79 offen offset:0 sc1
    s_mov_b32 s100, 1
Lsk_110:
    v_cmp_eq_u32 vcc, -1, v52
    s_nop 0
    s_cbranch_vccz Lsk_111
    buffer_load_dwordx4 v[52:55], v1, s[36:39], s79 offen offset:1024 sc1
    s_mov_b32 s100, 1
Lsk_111:
    v_cmp_eq_u32 vcc, -1, v56
    s_nop 0
    s_cbranch_vccz Lsk_112
    buffer_load_dwordx4 v[56:59], v1, s[36:39], s79 offen offset:2048 sc1
    s_mov_b32 s100, 1
Lsk_112:
    v_cmp_eq_u32 vcc, -1, v60
    s_nop 0
    s_cbranch_vccz Lsk_113
    buffer_load_dwordx4 v[60:63], v1, s[36:39], s79 offen offset:3072 sc1
    s_mov_b32 s100, 1
Lsk_113:
    v_cmp_eq_u32 vcc, -1, v64
    s_nop 0
    s_cbranch_vccz Lsk_114
    buffer_load_dwordx4 v[64:67], v1, s[36:39], s80 offen offset:0 sc1
    s_mov_b32 s100, 1
Lsk_114:
    v_cmp_eq_u32 vcc, -1, v68
    s_nop 0
    s_cbranch_vccz Lsk_115
    buffer_load_dwordx4 v[68:71], v1, s[36:39], s80 offen offset:1024 sc1
    s_mov_b32 s100, 1
Lsk_115:
    s_cmp_eq_u32 s100, 0
    s_cbranch_scc1 Lscd_104
    s_sub_u32 s6, s6, 1
    s_cbranch_scc0 Lscl_103
    s_waitcnt vmcnt(0)
    s_branch Lscd_104
Lsc_116:
    s_mov_b32 s6, 8192
Lscl_117:
    s_waitcnt vmcnt(0)
    s_mov_b32 s100, 0
    v_cmp_eq_u32 vcc, -1, v40
    s_nop 0
    s_cbranch_vccz Lsk_119
    buffer_load_dwordx4 v[40:43], v1, s[36:39], s78 offen offset:2048 sc1
    s_mov_b32 s100, 1
Lsk_119:
    v_cmp_eq_u32 vcc, -1, v44
    s_nop 0
    s_cbranch_vccz Lsk_120
    buffer_load_dwordx4 v[44:47], v1, s[36:39], s78 offen offset:3072 sc1
    s_mov_b32 s100, 1
Lsk_120:
    v_cmp_eq_u32 vcc, -1, v48
    s_nop 0
    s_cbranch_vccz Lsk_121
    buffer_load_dwordx4 v[48:51], v1, s[36:39], s79 offen offset:0 sc1
    s_mov_b32 s100, 1
Lsk_121:
    v_cmp_eq_u32 vcc, -1, v52
    s_nop 0
    s_cbranch_vccz Lsk_122
    buffer_load_dwordx4 v[52:55], v1, s[36:39], s79 offen offset:1024 sc1
    s_mov_b32 s100, 1
Lsk_122:
    v_cmp_eq_u32 vcc, -1, v56
    s_nop 0
    s_cbranch_vccz Lsk_123
    buffer_load_dwordx4 v[56:59], v1, s[36:39], s79 offen offset:2048 sc1
    s_mov_b32 s100, 1
Lsk_123:
    v_cmp_eq_u32 vcc, -1, v60
    s_nop 0
    s_cbranch_vccz Lsk_124
    buffer_load_dwordx4 v[60:63], v1, s[36:39], s79 offen offset:3072 sc1
    s_mov_b32 s100, 1
Lsk_124:
    v_cmp_eq_u32 vcc, -1, v64
    s_nop 0
    s_cbranch_vccz Lsk_125
    buffer_load_dwordx4 v[64:67], v1, s[36:39], s80 offen offset:0 sc1
    s_mov_b32 s100, 1
Lsk_125:
    v_cmp_eq_u32 vcc, -1, v68
    s_nop 0
    s_cbranch_vccz Lsk_126
    buffer_load_dwordx4 v[68:71], v1, s[36:39], s80 offen offset:1024 sc1
    s_mov_b32 s100, 1
Lsk_126:
    v_cmp_eq_u32 vcc, -1, v72
    s_nop 0
    s_cbranch_vccz Lsk_127
    buffer_load_dwordx4 v[72:75], v1, s[36:39], s80 offen offset:2048 sc1
    s_mov_b32 s100, 1
Lsk_127:
    v_cmp_eq_u32 vcc, -1, v76
    s_nop 0
    s_cbranch_vccz Lsk_128
    buffer_load_dwordx4 v[76:79], v1, s[36:39], s80 offen offset:3072 sc1
    s_mov_b32 s100, 1
Lsk_128:
    s_cmp_eq_u32 s100, 0
    s_cbranch_scc1 Lscd_118
    s_sub_u32 s6, s6, 1
    s_cbranch_scc0 Lscl_117
    s_waitcnt vmcnt(0)
    s_branch Lscd_118
Lsc_129:
    s_mov_b32 s6, 8192
Lscl_130:
    s_waitcnt vmcnt(0)
    s_mov_b32 s100, 0
    v_cmp_eq_u32 vcc, -1, v60
    s_nop 0
    s_cbranch_vccz Lsk_132
    buffer_load_dwordx4 v[60:63], v1, s[36:39], s79 offen offset:3072 sc1
    s_mov_b32 s100, 1
Lsk_132:
    v_cmp_eq_u32 vcc, -1, v64
    s_nop 0
    s_cbranch_vccz Lsk_133
    buffer_load_dwordx4 v[64:67], v1, s[36:39], s80 offen offset:0 sc1
    s_mov_b32 s100, 1
Lsk_133:
    v_cmp_eq_u32 vcc, -1, v68
    s_nop 0
    s_cbranch_vccz Lsk_134
    buffer_load_dwordx4 v[68:71], v1, s[36:39], s80 offen offset:1024 sc1
    s_mov_b32 s100, 1
Lsk_134:
    v_cmp_eq_u32 vcc, -1, v72
    s_nop 0
    s_cbranch_vccz Lsk_135
    buffer_load_dwordx4 v[72:75], v1, s[36:39], s80 offen offset:2048 sc1
    s_mov_b32 s100, 1
Lsk_135:
    v_cmp_eq_u32 vcc, -1, v76
    s_nop 0
    s_cbranch_vccz Lsk_136
    buffer_load_dwordx4 v[76:79], v1, s[36:39], s80 offen offset:3072 sc1
    s_mov_b32 s100, 1
Lsk_136:
    s_cmp_eq_u32 s100, 0
    s_cbranch_scc1 Lscd_131
    s_sub_u32 s6, s6, 1
    s_cbranch_scc0 Lscl_130
    s_waitcnt vmcnt(0)
    s_branch Lscd_131
Lslow_137:
    buffer_store_dwordx4 v[16:19], v5, s[36:39], s72 offen sc1
    buffer_store_dwordx4 v[20:23], v5, s[36:39], s72 offen offset:1024 sc1
    s_branch Lsdone_138
Lslow_139:
    buffer_store_dwordx2 v[24:25], v168, s[36:39], s73 offen sc1
    s_branch Lsdone_140
Lss_141:
    s_nop 15
    s_waitcnt vmcnt(0)
    v_mov_b32 v7, 2
    buffer_store_dword v7, off, s[36:39], s56 sc1
    v_min_u32 v6, 55, v0
    v_lshl_add_u32 v6, v6, 3, s58
    s_nop 2
    s_mov_b32 s5, 65536
Lssl_142:
    buffer_load_dwordx2 v[116:117], v6, s[36:39], 0 offen sc1
    s_waitcnt vmcnt(0)
    v_min_u32 v116, v116, v117
    v_cmp_gt_u32 vcc, 2, v116
    s_nop 1
    s_cbranch_vccz Lssd_143
    s_sub_u32 s5, s5, 1
    s_cbranch_scc0 Lssl_142
    s_branch Lssd_143
Lmc_144:
    s_mov_b32 s5, 65536
Lmcl_145:
    buffer_load_dword v220, v254, s[36:39], 0 offen sc1
    s_waitcnt vmcnt(0)
    v_cmp_ne_u32 vcc, s0, v220
    s_nop 1
    s_cbranch_vccz Lmcd_146
    s_sub_u32 s5, s5, 1
    s_cbranch_scc0 Lmcl_145
    s_branch Lmcd_146
Lp3redo0:
    s_nop 15
    s_waitcnt vmcnt(0) lgkmcnt(0)
    s_sub_u32 s29, s29, 1
    s_barrier
    s_lshr_b32 s86, s50, 1
    s_mul_i32 s86, s86, 14336
    s_and_b32 s87, s50, 1
    s_lshl_b32 s84, s87, 12
    s_add_u32 s84, s84, s86
    s_mul_i32 s85, s87, 3072
    s_add_u32 s85, s85, s86
    s_add_u32 s85, s85, 8192
    s_add_u32 s86, s55, 170496
    s_cmp_lt_u32 s53, 2
    s_cselect_b32 s31, 28672, 0
    s_add_u32 s86, s86, s31
    s_lshl_b32 s31, s31, 1
    s_lshr_b32 s87, s54, 1
    s_sub_u32 s80, s87, 0
    s_and_b32 s80, s80, 3
    s_mul_i32 s72, s80, 57344
    s_add_u32 s72, s72, s86
    s_sub_u32 s81, s87, 1
    s_and_b32 s81, s81, 3
    s_mul_i32 s73, s81, 57344
    s_add_u32 s73, s73, s86
    s_sub_u32 s82, s87, 2
    s_and_b32 s82, s82, 3
    s_mul_i32 s74, s82, 57344
    s_add_u32 s74, s74, s86
    s_sub_u32 s83, s87, 3
    s_and_b32 s83, s83, 3
    s_mul_i32 s75, s83, 57344
    s_add_u32 s75, s75, s86
    v_bfe_u32 v133, v0, 2, 3
    v_min_u32 v133, 6, v133
    v_and_b32 v132, 3, v0
    v_lshlrev_b32 v133, 11, v133
    v_lshl_add_u32 v133, v132, 7, v133
    v_lshrrev_b32 v9, 1, v2
    v_lshl_add_u32 v133, v9, 30, v133
    s_lshl_b32 s86, s80, 9
    s_add_u32 s95, s55, 491520
    s_add_u32 s86, s86, s95
    v_add_u32 v133, s86, v133
    s_lshl_b32 s87, s50, 9
    s_add_u32 s95, s95, s87
    v_lshlrev_b32 v131, 3, v0
    v_and_b32 v132, 1, v2
    v_lshlrev_b32 v8, 4, v3
    v_lshl_add_u32 v8, v9, 8, v8
    v_mul_u32_u24 v132, 14336, v132
    v_add_u32 v5, v8, v132
    v_add_u32 v8, 91648, v5
    s_lshl2_add_u32 s87, s49, s50
    s_lshl_b32 s87, s87, 10
    v_add_u32 v10, s87, v1
    s_add_u32 s76, s20, 0
    s_lshl_b32 s80, s80, 10
    s_add_u32 s80, s80, 148992
    s_add_u32 s77, s20, 229376
    s_lshl_b32 s81, s81, 10
    s_add_u32 s81, s81, 148992
    s_add_u32 s78, s20, 458752
    s_lshl_b32 s82, s82, 10
    s_add_u32 s82, s82, 148992
    s_add_u32 s79, s20, 688128
    s_cmp_eq_u32 s4, 0
    s_cselect_b32 s79, s55, s79
    s_lshl_b32 s83, s83, 10
    s_add_u32 s83, s83, 148992
    v_mov_b32 v46, 0
    v_mov_b32 v47, 0
    v_mov_b32 v50, 0
    v_mov_b32 v51, 0
    v_and_b32 v11, 0x1f0, v1
    s_nop 2
    s_branch Lp3top0
Lpb_147:
    s_mov_b32 s6, 8192
Lpbl_148:
    buffer_load_dword v130, v133, s[36:39], 0 offen sc1
    s_add_u32 m0, s84, 91648
    s_add_u32 s61, s72, m0
    buffer_load_dwordx4 v1, s[36:39], s61 offen offset:0 sc1 lds
    buffer_load_dwordx4 v1, s[36:39], s61 offen offset:1024 sc1 lds
    buffer_load_dwordx4 v1, s[36:39], s61 offen offset:2048 sc1 lds
    buffer_load_dwordx4 v1, s[36:39], s61 offen offset:3072 sc1 lds
    s_add_u32 m0, s85, 91648
    s_add_u32 s61, s72, m0
    buffer_load_dwordx4 v1, s[36:39], s61 offen offset:0 sc1 lds
    buffer_load_dwordx4 v1, s[36:39], s61 offen offset:1024 sc1 lds
    buffer_load_dwordx4 v1, s[36:39], s61 offen offset:2048 sc1 lds
    s_waitcnt vmcnt(7)
    v_cmp_eq_u32 vcc, -1, v130
    s_sub_u32 s6, s6, 1
    s_cbranch_scc1 Lpbd_149
    s_cbranch_vccnz Lpbl_148
    s_branch Lpbd_149
Lnc_150:
    s_mov_b32 s6, 8192
Lncl_151:
    buffer_load_dwordx2 v[116:117], v131, s[36:39], s95 offen offset:0 sc1
    buffer_load_dwordx2 v[118:119], v131, s[36:39], s95 offen offset:2048 sc1
    s_add_u32 s86, s95, 4096
    buffer_load_dwordx2 v[120:121], v131, s[36:39], s86 offen offset:0 sc1
    s_add_u32 s86, s95, 4096
    buffer_load_dwordx2 v[122:123], v131, s[36:39], s86 offen offset:2048 sc1
    s_add_u32 s86, s95, 8192
    buffer_load_dwordx2 v[124:125], v131, s[36:39], s86 offen offset:0 sc1
    s_add_u32 s86, s95, 8192
    buffer_load_dwordx2 v[126:127], v131, s[36:39], s86 offen offset:2048 sc1
    s_add_u32 s86, s95, 12288
    buffer_load_dwordx2 v[128:129], v131, s[36:39], s86 offen offset:0 sc1
    s_waitcnt vmcnt(5)
    v_add_f32 v116, v116, v118
    v_add_f32 v117, v117, v119
    s_waitcnt vmcnt(4)
    v_add_f32 v116, v116, v120
    v_add_f32 v117, v117, v121
    s_waitcnt vmcnt(3)
    v_add_f32 v116, v116, v122
    v_add_f32 v117, v117, v123
    s_waitcnt vmcnt(2)
    v_add_f32 v116, v116, v124
    v_add_f32 v117, v117, v125
    s_waitcnt vmcnt(1)
    v_add_f32 v116, v116, v126
    v_add_f32 v117, v117, v127
    s_waitcnt vmcnt(0)
    v_add_f32 v116, v116, v128
    v_add_f32 v117, v117, v129
    v_cmp_u_f32 vcc, v116, v116
    s_nop 1
    s_cbranch_vccz Lncd_152
    s_sub_u32 s6, s6, 1
    s_cbranch_scc0 Lncl_151
    s_branch Lncd_152
Lnn_153:
    s_cmp_eq_u32 s29, 0
    s_cbranch_scc1 Lnnd_154
    s_branch Lp3redo0
Lnn_155:
    s_cmp_eq_u32 s29, 0
    s_cbranch_scc1 Lnnd_156
    s_branch Lp3redo0
Lnn_157:
    s_cmp_eq_u32 s29, 0
    s_cbranch_scc1 Lnnd_158
    s_branch Lp3redo0
Lslow_159:
    buffer_store_dword v7, off, s[36:39], s56 sc1
    s_branch Lsdone_160
Lnn_161:
    s_cmp_eq_u32 s29, 0
    s_cbranch_scc1 Lnnd_162
    s_branch Lp3redo0
Lnn_163:
    s_cmp_eq_u32 s29, 0
    s_cbranch_scc1 Lnnd_164
    s_branch Lp3redo0
Lslow_165:
    buffer_store_dword v7, off, s[36:39], s56 sc1
    s_branch Lsdone_166
Lnn_167:
    s_cmp_eq_u32 s29, 0
    s_cbranch_scc1 Lnnd_168
    s_branch Lp3redo0
Lps_169:
    s_mov_b32 s5, 65536
Lpl_171:
    buffer_load_dword v9, v6, s[36:39], 0 offen sc1
    s_waitcnt vmcnt(0)
    v_cmp_gt_u32 vcc, v4, v9
    s_nop 1
    s_and_b32 s6, vcc_lo, 0xff
    s_cbranch_scc0 Lpd_170
    s_sub_u32 s5, s5, 1
    s_cbranch_scc0 Lpl_171
    s_branch Lpd_170
Lnn_172:
    s_cmp_eq_u32 s29, 0
    s_cbranch_scc1 Lnnd_173
    s_branch Lp3redo0
Lmc_174:
    s_mov_b32 s5, 65536
Lmcl_175:
    buffer_load_dword v15, v14, s[36:39], 0 offen sc1
    s_waitcnt vmcnt(0)
    v_cmp_ne_u32 vcc, s0, v15
    s_nop 1
    s_cbranch_vccz Lmcd_176
    s_sub_u32 s5, s5, 1
    s_cbranch_scc0 Lmcl_175
    s_branch Lmcd_176
Lslow_177:
    buffer_store_dword v7, off, s[36:39], s56 sc1
    s_branch Lsdone_178
Lslow_179:
    buffer_store_dwordx4 v[40:43], v10, s[36:39], s87 offen sc1
    s_branch Lsdone_180
Lnn_181:
    s_cmp_eq_u32 s29, 0
    s_cbranch_scc1 Lnnd_182
    s_branch Lp3redo0
Lslow_183:
    buffer_store_dword v7, off, s[36:39], s56 sc1
    s_branch Lsdone_184
Lps_185:
    s_mov_b32 s5, 65536
Lpl_187:
    buffer_load_dword v9, v6, s[36:39], 0 offen sc1
    s_waitcnt vmcnt(0)
    v_cmp_gt_u32 vcc, v4, v9
    s_nop 1
    s_and_b32 s6, vcc_lo, 0xfff00
    s_cbranch_scc0 Lpd_186
    s_sub_u32 s5, s5, 1
    s_cbranch_scc0 Lpl_187
    s_branch Lpd_186
Lslow_188:
    buffer_store_dwordx4 v[40:43], v10, s[36:39], s87 offen sc1
    s_branch Lsdone_189
Lslow_190:
    buffer_store_dword v7, off, s[36:39], s56 sc1
    s_branch Lsdone_191
Lps_192:
    s_mov_b32 s5, 65536
Lpl_194:
    buffer_load_dword v9, v6, s[36:39], 0 offen sc1
    s_waitcnt vmcnt(0)
    v_cmp_gt_u32 vcc, v4, v9
    s_nop 1
    s_and_b32 s6, vcc_lo, 0xff00000
    s_cbranch_scc0 Lpd_193
    s_sub_u32 s5, s5, 1
    s_cbranch_scc0 Lpl_194
    s_branch Lpd_193
Lps_195:
    s_mov_b32 s5, 65536
Lpl_197:
    buffer_load_dword v9, v6, s[36:39], 0 offen sc1
    s_waitcnt vmcnt(0)
    v_cmp_gt_u32 vcc, 7, v9
    s_nop 1
    s_and_b32 s6, vcc_lo, 0xff00000
    s_cbranch_scc0 Lpd_196
    s_sub_u32 s5, s5, 1
    s_cbranch_scc0 Lpl_197
    s_branch Lpd_196
Lslow_198:
    buffer_store_dwordx4 v[140:143], v5, s[36:39], s72 offen sc1
    buffer_store_dwordx4 v[144:147], v5, s[36:39], s72 offen offset:512 sc1
    s_branch Lsdone_199
Lslow_200:
    buffer_store_dword v139, v26, s[36:39], s73 offen sc1
    s_branch Lsdone_201
Lss_202:
    s_nop 15
    s_waitcnt vmcnt(0)
    v_mov_b32 v7, 8
    buffer_store_dword v7, off, s[36:39], s56 sc1
    v_min_u32 v170, 55, v0
    v_lshl_add_u32 v170, v170, 3, s58
    s_nop 2
    s_mov_b32 s5, 65536
Lssl_203:
    buffer_load_dwordx2 v[64:65], v170, s[36:39], 0 offen sc1
    s_waitcnt vmcnt(0)
    v_min_u32 v64, v64, v65
    v_cmp_gt_u32 vcc, 8, v64
    s_nop 1
    s_cbranch_vccz Lssd_204
    s_sub_u32 s5, s5, 1
    s_cbranch_scc0 Lssl_203
    s_branch Lssd_204
Lsc_205:
    s_mov_b32 s6, 8192
Lscl_206:
    s_waitcnt vmcnt(0)
    s_mov_b32 s100, 0
    v_cmp_eq_u32 vcc, -1, v100
    s_nop 0
    s_cbranch_vccz Lsk_208
    buffer_load_dwordx4 v[100:103], v5, s[36:39], s8 offen offset:0 sc1
    s_mov_b32 s100, 1
Lsk_208:
    v_cmp_eq_u32 vcc, -1, v104
    s_nop 0
    s_cbranch_vccz Lsk_209
    buffer_load_dwordx4 v[104:107], v5, s[36:39], s8 offen offset:512 sc1
    s_mov_b32 s100, 1
Lsk_209:
    v_cmp_eq_u32 vcc, -1, v108
    s_nop 0
    s_cbranch_vccz Lsk_210
    buffer_load_dwordx4 v[108:111], v5, s[36:39], s8 offen offset:1024 sc1
    s_mov_b32 s100, 1
Lsk_210:
    v_cmp_eq_u32 vcc, -1, v112
    s_nop 0
    s_cbranch_vccz Lsk_211
    buffer_load_dwordx4 v[112:115], v5, s[36:39], s8 offen offset:1536 sc1
    s_mov_b32 s100, 1
Lsk_211:
    v_cmp_eq_u32 vcc, -1, v116
    s_nop 0
    s_cbranch_vccz Lsk_212
    buffer_load_dwordx4 v[116:119], v5, s[36:39], s9 offen offset:0 sc1
    s_mov_b32 s100, 1
Lsk_212:
    v_cmp_eq_u32 vcc, -1, v120
    s_nop 0
    s_cbranch_vccz Lsk_213
    buffer_load_dwordx4 v[120:123], v5, s[36:39], s9 offen offset:512 sc1
    s_mov_b32 s100, 1
Lsk_213:
    v_cmp_eq_u32 vcc, -1, v124
    s_nop 0
    s_cbranch_vccz Lsk_214
    buffer_load_dwordx4 v[124:127], v5, s[36:39], s9 offen offset:1024 sc1
    s_mov_b32 s100, 1
Lsk_214:
    v_cmp_eq_u32 vcc, -1, v128
    s_nop 0
    s_cbranch_vccz Lsk_215
    buffer_load_dwordx4 v[128:131], v5, s[36:39], s9 offen offset:1536 sc1
    s_mov_b32 s100, 1
Lsk_215:
    s_cmp_eq_u32 s100, 0
    s_cbranch_scc1 Lscd_207
    s_sub_u32 s6, s6, 1
    s_cbranch_scc0 Lscl_206
    s_waitcnt vmcnt(0)
    s_branch Lscd_207
Lsc_216:
    s_mov_b32 s6, 8192
Lscl_217:
    s_waitcnt vmcnt(0)
    s_mov_b32 s100, 0
    v_cmp_eq_u32 vcc, -1, v108
    s_nop 0
    s_cbranch_vccz Lsk_219
    buffer_load_dwordx4 v[108:111], v5, s[36:39], s8 offen offset:1024 sc1
    s_mov_b32 s100, 1
Lsk_219:
    v_cmp_eq_u32 vcc, -1, v112
    s_nop 0
    s_cbranch_vccz Lsk_220
    buffer_load_dwordx4 v[112:115], v5, s[36:39], s8 offen offset:1536 sc1
    s_mov_b32 s100, 1
Lsk_220:
    v_cmp_eq_u32 vcc, -1, v116
    s_nop 0
    s_cbranch_vccz Lsk_221
    buffer_load_dwordx4 v[116:119], v5, s[36:39], s9 offen offset:0 sc1
    s_mov_b32 s100, 1
Lsk_221:
    v_cmp_eq_u32 vcc, -1, v120
    s_nop 0
    s_cbranch_vccz Lsk_222
    buffer_load_dwordx4 v[120:123], v5, s[36:39], s9 offen offset:512 sc1
    s_mov_b32 s100, 1
Lsk_222:
    v_cmp_eq_u32 vcc, -1, v124
    s_nop 0
    s_cbranch_vccz Lsk_223
    buffer_load_dwordx4 v[124:127], v5, s[36:39], s9 offen offset:1024 sc1
    s_mov_b32 s100, 1
Lsk_223:
    v_cmp_eq_u32 vcc, -1, v128
    s_nop 0
    s_cbranch_vccz Lsk_224
    buffer_load_dwordx4 v[128:131], v5, s[36:39], s9 offen offset:1536 sc1
    s_mov_b32 s100, 1
Lsk_224:
    v_cmp_eq_u32 vcc, -1, v132
    s_nop 0
    s_cbranch_vccz Lsk_225
    buffer_load_dwordx4 v[132:135], v5, s[36:39], s10 offen offset:0 sc1
    s_mov_b32 s100, 1
Lsk_225:
    v_cmp_eq_u32 vcc, -1, v136
    s_nop 0
    s_cbranch_vccz Lsk_226
    buffer_load_dwordx4 v[136:139], v5, s[36:39], s10 offen offset:512 sc1
    s_mov_b32 s100, 1
Lsk_226:
    v_cmp_eq_u32 vcc, -1, v140
    s_nop 0
    s_cbranch_vccz Lsk_227
    buffer_load_dwordx4 v[140:143], v5, s[36:39], s10 offen offset:1024 sc1
    s_mov_b32 s100, 1
Lsk_227:
    v_cmp_eq_u32 vcc, -1, v144
    s_nop 0
    s_cbranch_vccz Lsk_228
    buffer_load_dwordx4 v[144:147], v5, s[36:39], s10 offen offset:1536 sc1
    s_mov_b32 s100, 1
Lsk_228:
    s_cmp_eq_u32 s100, 0
    s_cbranch_scc1 Lscd_218
    s_sub_u32 s6, s6, 1
    s_cbranch_scc0 Lscl_217
    s_waitcnt vmcnt(0)
    s_branch Lscd_218
Lsc_229:
    s_mov_b32 s6, 8192
Lscl_230:
    s_waitcnt vmcnt(0)
    s_mov_b32 s100, 0
    v_cmp_eq_u32 vcc, -1, v116
    s_nop 0
    s_cbranch_vccz Lsk_232
    buffer_load_dwordx4 v[116:119], v5, s[36:39], s9 offen offset:0 sc1
    s_mov_b32 s100, 1
Lsk_232:
    v_cmp_eq_u32 vcc, -1, v120
    s_nop 0
    s_cbranch_vccz Lsk_233
    buffer_load_dwordx4 v[120:123], v5, s[36:39], s9 offen offset:512 sc1
    s_mov_b32 s100, 1
Lsk_233:
    v_cmp_eq_u32 vcc, -1, v124
    s_nop 0
    s_cbranch_vccz Lsk_234
    buffer_load_dwordx4 v[124:127], v5, s[36:39], s9 offen offset:1024 sc1
    s_mov_b32 s100, 1
Lsk_234:
    v_cmp_eq_u32 vcc, -1, v128
    s_nop 0
    s_cbranch_vccz Lsk_235
    buffer_load_dwordx4 v[128:131], v5, s[36:39], s9 offen offset:1536 sc1
    s_mov_b32 s100, 1
Lsk_235:
    v_cmp_eq_u32 vcc, -1, v132
    s_nop 0
    s_cbranch_vccz Lsk_236
    buffer_load_dwordx4 v[132:135], v5, s[36:39], s10 offen offset:0 sc1
    s_mov_b32 s100, 1
Lsk_236:
    v_cmp_eq_u32 vcc, -1, v136
    s_nop 0
    s_cbranch_vccz Lsk_237
    buffer_load_dwordx4 v[136:139], v5, s[36:39], s10 offen offset:512 sc1
    s_mov_b32 s100, 1
Lsk_237:
    v_cmp_eq_u32 vcc, -1, v140
    s_nop 0
    s_cbranch_vccz Lsk_238
    buffer_load_dwordx4 v[140:143], v5, s[36:39], s10 offen offset:1024 sc1
    s_mov_b32 s100, 1
Lsk_238:
    v_cmp_eq_u32 vcc, -1, v144
    s_nop 0
    s_cbranch_vccz Lsk_239
    buffer_load_dwordx4 v[144:147], v5, s[36:39], s10 offen offset:1536 sc1
    s_mov_b32 s100, 1
Lsk_239:
    v_cmp_eq_u32 vcc, -1, v100
    s_nop 0
    s_cbranch_vccz Lsk_240
    buffer_load_dwordx4 v[100:103], v5, s[36:39], s11 offen offset:0 sc1
    s_mov_b32 s100, 1
Lsk_240:
    v_cmp_eq_u32 vcc, -1, v104
    s_nop 0
    s_cbranch_vccz Lsk_241
    buffer_load_dwordx4 v[104:107], v5, s[36:39], s11 offen offset:512 sc1
    s_mov_b32 s100, 1
Lsk_241:
    v_cmp_eq_u32 vcc, -1, v108
    s_nop 0
    s_cbranch_vccz Lsk_242
    buffer_load_dwordx4 v[108:111], v5, s[36:39], s11 offen offset:1024 sc1
    s_mov_b32 s100, 1
Lsk_242:
    s_cmp_eq_u32 s100, 0
    s_cbranch_scc1 Lscd_231
    s_sub_u32 s6, s6, 1
    s_cbranch_scc0 Lscl_230
    s_waitcnt vmcnt(0)
    s_branch Lscd_231
Lsc_243:
    s_mov_b32 s6, 8192
Lscl_244:
    s_waitcnt vmcnt(0)
    s_mov_b32 s100, 0
    v_cmp_eq_u32 vcc, -1, v132
    s_nop 0
    s_cbranch_vccz Lsk_246
    buffer_load_dwordx4 v[132:135], v5, s[36:39], s10 offen offset:0 sc1
    s_mov_b32 s100, 1
Lsk_246:
    v_cmp_eq_u32 vcc, -1, v136
    s_nop 0
    s_cbranch_vccz Lsk_247
    buffer_load_dwordx4 v[136:139], v5, s[36:39], s10 offen offset:512 sc1
    s_mov_b32 s100, 1
Lsk_247:
    v_cmp_eq_u32 vcc, -1, v140
    s_nop 0
    s_cbranch_vccz Lsk_248
    buffer_load_dwordx4 v[140:143], v5, s[36:39], s10 offen offset:1024 sc1
    s_mov_b32 s100, 1
Lsk_248:
    v_cmp_eq_u32 vcc, -1, v144
    s_nop 0
    s_cbranch_vccz Lsk_249
    buffer_load_dwordx4 v[144:147], v5, s[36:39], s10 offen offset:1536 sc1
    s_mov_b32 s100, 1
Lsk_249:
    v_cmp_eq_u32 vcc, -1, v100
    s_nop 0
    s_cbranch_vccz Lsk_250
    buffer_load_dwordx4 v[100:103], v5, s[36:39], s11 offen offset:0 sc1
    s_mov_b32 s100, 1
Lsk_250:
    v_cmp_eq_u32 vcc, -1, v104
    s_nop 0
    s_cbranch_vccz Lsk_251
    buffer_load_dwordx4 v[104:107], v5, s[36:39], s11 offen offset:512 sc1
    s_mov_b32 s100, 1
Lsk_251:
    v_cmp_eq_u32 vcc, -1, v108
    s_nop 0
    s_cbranch_vccz Lsk_252
    buffer_load_dwordx4 v[108:111], v5, s[36:39], s11 offen offset:1024 sc1
    s_mov_b32 s100, 1
Lsk_252:
    v_cmp_eq_u32 vcc, -1, v112
    s_nop 0
    s_cbranch_vccz Lsk_253
    buffer_load_dwordx4 v[112:115], v5, s[36:39], s11 offen offset:1536 sc1
    s_mov_b32 s100, 1
Lsk_253:
    v_cmp_eq_u32 vcc, -1, v116
    s_nop 0
    s_cbranch_vccz Lsk_254
    buffer_load_dwordx4 v[116:119], v5, s[36:39], s12 offen offset:0 sc1
    s_mov_b32 s100, 1
Lsk_254:
    v_cmp_eq_u32 vcc, -1, v120
    s_nop 0
    s_cbranch_vccz Lsk_255
    buffer_load_dwordx4 v[120:123], v5, s[36:39], s12 offen offset:512 sc1
    s_mov_b32 s100, 1
Lsk_255:
    s_cmp_eq_u32 s100, 0
    s_cbranch_scc1 Lscd_245
    s_sub_u32 s6, s6, 1
    s_cbranch_scc0 Lscl_244
    s_waitcnt vmcnt(0)
    s_branch Lscd_245
Lsc_256:
    s_mov_b32 s6, 8192
Lscl_257:
    s_waitcnt vmcnt(0)
    s_mov_b32 s100, 0
    v_cmp_eq_u32 vcc, -1, v100
    s_nop 0
    s_cbranch_vccz Lsk_259
    buffer_load_dwordx4 v[100:103], v5, s[36:39], s11 offen offset:0 sc1
    s_mov_b32 s100, 1
Lsk_259:
    v_cmp_eq_u32 vcc, -1, v104
    s_nop 0
    s_cbranch_vccz Lsk_260
    buffer_load_dwordx4 v[104:107], v5, s[36:39], s11 offen offset:512 sc1
    s_mov_b32 s100, 1
Lsk_260:
    v_cmp_eq_u32 vcc, -1, v108
    s_nop 0
    s_cbranch_vccz Lsk_261
    buffer_load_dwordx4 v[108:111], v5, s[36:39], s11 offen offset:1024 sc1
    s_mov_b32 s100, 1
Lsk_261:
    v_cmp_eq_u32 vcc, -1, v112
    s_nop 0
    s_cbranch_vccz Lsk_262
    buffer_load_dwordx4 v[112:115], v5, s[36:39], s11 offen offset:1536 sc1
    s_mov_b32 s100, 1
Lsk_262:
    v_cmp_eq_u32 vcc, -1, v116
    s_nop 0
    s_cbranch_vccz Lsk_263
    buffer_load_dwordx4 v[116:119], v5, s[36:39], s12 offen offset:0 sc1
    s_mov_b32 s100, 1
Lsk_263:
    v_cmp_eq_u32 vcc, -1, v120
    s_nop 0
    s_cbranch_vccz Lsk_264
    buffer_load_dwordx4 v[120:123], v5, s[36:39], s12 offen offset:512 sc1
    s_mov_b32 s100, 1
Lsk_264:
    v_cmp_eq_u32 vcc, -1, v124
    s_nop 0
    s_cbranch_vccz Lsk_265
    buffer_load_dwordx4 v[124:127], v5, s[36:39], s12 offen offset:1024 sc1
    s_mov_b32 s100, 1
Lsk_265:
    v_cmp_eq_u32 vcc, -1, v128
    s_nop 0
    s_cbranch_vccz Lsk_266
    buffer_load_dwordx4 v[128:131], v5, s[36:39], s12 offen offset:1536 sc1
    s_mov_b32 s100, 1
Lsk_266:
    v_cmp_eq_u32 vcc, -1, v132
    s_nop 0
    s_cbranch_vccz Lsk_267
    buffer_load_dwordx4 v[132:135], v5, s[36:39], s13 offen offset:0 sc1
    s_mov_b32 s100, 1
Lsk_267:
    v_cmp_eq_u32 vcc, -1, v136
    s_nop 0
    s_cbranch_vccz Lsk_268
    buffer_load_dwordx4 v[136:139], v5, s[36:39], s13 offen offset:512 sc1
    s_mov_b32 s100, 1
Lsk_268:
    v_cmp_eq_u32 vcc, -1, v140
    s_nop 0
    s_cbranch_vccz Lsk_269
    buffer_load_dwordx4 v[140:143], v5, s[36:39], s13 offen offset:1024 sc1
    s_mov_b32 s100, 1
Lsk_269:
    s_cmp_eq_u32 s100, 0
    s_cbranch_scc1 Lscd_258
    s_sub_u32 s6, s6, 1
    s_cbranch_scc0 Lscl_257
    s_waitcnt vmcnt(0)
    s_branch Lscd_258
Lnc_270:
    s_mov_b32 s6, 8192
Lncl_271:
    buffer_load_dwordx2 v[148:149], v6, s[36:39], 0 offen offset:0 sc1
    buffer_load_dwordx2 v[150:151], v6, s[36:39], 0 offen offset:2048 sc1
    s_mov_b32 s5, 4096
    buffer_load_dwordx2 v[152:153], v6, s[36:39], s5 offen offset:0 sc1
    s_mov_b32 s5, 4096
    buffer_load_dwordx2 v[154:155], v6, s[36:39], s5 offen offset:2048 sc1
    s_mov_b32 s5, 8192
    buffer_load_dwordx2 v[160:161], v6, s[36:39], s5 offen offset:0 sc1
    s_mov_b32 s5, 8192
    buffer_load_dwordx2 v[64:65], v6, s[36:39], s5 offen offset:2048 sc1
    s_mov_b32 s5, 12288
    buffer_load_dwordx2 v[66:67], v6, s[36:39], s5 offen offset:0 sc1
    s_waitcnt vmcnt(5)
    v_add_f32 v148, v148, v150
    v_add_f32 v149, v149, v151
    s_waitcnt vmcnt(4)
    v_add_f32 v148, v148, v152
    v_add_f32 v149, v149, v153
    s_waitcnt vmcnt(3)
    v_add_f32 v148, v148, v154
    v_add_f32 v149, v149, v155
    s_waitcnt vmcnt(2)
    v_add_f32 v148, v148, v160
    v_add_f32 v149, v149, v161
    s_waitcnt vmcnt(1)
    v_add_f32 v148, v148, v64
    v_add_f32 v149, v149, v65
    s_waitcnt vmcnt(0)
    v_add_f32 v148, v148, v66
    v_add_f32 v149, v149, v67
    v_cmp_u_f32 vcc, v148, v148
    s_nop 1
    s_cbranch_vccz Lncd_272
    s_sub_u32 s6, s6, 1
    s_cbranch_scc0 Lncl_271
    s_branch Lncd_272
Lsc_273:
    s_mov_b32 s6, 8192
Lscl_274:
    s_waitcnt vmcnt(0)
    s_mov_b32 s100, 0
    v_cmp_eq_u32 vcc, -1, v116
    s_nop 0
    s_cbranch_vccz Lsk_276
    buffer_load_dwordx4 v[116:119], v5, s[36:39], s12 offen offset:0 sc1
    s_mov_b32 s100, 1
Lsk_276:
    v_cmp_eq_u32 vcc, -1, v120
    s_nop 0
    s_cbranch_vccz Lsk_277
    buffer_load_dwordx4 v[120:123], v5, s[36:39], s12 offen offset:512 sc1
    s_mov_b32 s100, 1
Lsk_277:
    v_cmp_eq_u32 vcc, -1, v124
    s_nop 0
    s_cbranch_vccz Lsk_278
    buffer_load_dwordx4 v[124:127], v5, s[36:39], s12 offen offset:1024 sc1
    s_mov_b32 s100, 1
Lsk_278:
    v_cmp_eq_u32 vcc, -1, v128
    s_nop 0
    s_cbranch_vccz Lsk_279
    buffer_load_dwordx4 v[128:131], v5, s[36:39], s12 offen offset:1536 sc1
    s_mov_b32 s100, 1
Lsk_279:
    v_cmp_eq_u32 vcc, -1, v132
    s_nop 0
    s_cbranch_vccz Lsk_280
    buffer_load_dwordx4 v[132:135], v5, s[36:39], s13 offen offset:0 sc1
    s_mov_b32 s100, 1
Lsk_280:
    v_cmp_eq_u32 vcc, -1, v136
    s_nop 0
    s_cbranch_vccz Lsk_281
    buffer_load_dwordx4 v[136:139], v5, s[36:39], s13 offen offset:512 sc1
    s_mov_b32 s100, 1
Lsk_281:
    v_cmp_eq_u32 vcc, -1, v140
    s_nop 0
    s_cbranch_vccz Lsk_282
    buffer_load_dwordx4 v[140:143], v5, s[36:39], s13 offen offset:1024 sc1
    s_mov_b32 s100, 1
Lsk_282:
    v_cmp_eq_u32 vcc, -1, v144
    s_nop 0
    s_cbranch_vccz Lsk_283
    buffer_load_dwordx4 v[144:147], v5, s[36:39], s13 offen offset:1536 sc1
    s_mov_b32 s100, 1
Lsk_283:
    v_cmp_eq_u32 vcc, -1, v100
    s_nop 0
    s_cbranch_vccz Lsk_284
    buffer_load_dwordx4 v[100:103], v5, s[36:39], s14 offen offset:0 sc1
    s_mov_b32 s100, 1
Lsk_284:
    v_cmp_eq_u32 vcc, -1, v104
    s_nop 0
    s_cbranch_vccz Lsk_285
    buffer_load_dwordx4 v[104:107], v5, s[36:39], s14 offen offset:512 sc1
    s_mov_b32 s100, 1
Lsk_285:
    s_cmp_eq_u32 s100, 0
    s_cbranch_scc1 Lscd_275
    s_sub_u32 s6, s6, 1
    s_cbranch_scc0 Lscl_274
    s_waitcnt vmcnt(0)
    s_branch Lscd_275
Lhc_286:
    s_mov_b32 s6, 8192
Lhcl_287:
    s_add_u32 m0, s45, 0
    s_nop 0
    buffer_load_dwordx4 v1, s[36:39], s40 offen sc1 lds
    s_add_u32 m0, s45, 4096
    s_nop 0
    buffer_load_dwordx4 v1, s[36:39], s41 offen sc1 lds
    s_add_u32 m0, s45, 8192
    s_nop 0
    buffer_load_dwordx4 v1, s[36:39], s42 offen sc1 lds
    s_mov_b32 m0, s44
    s_nop 0
    buffer_load_dwordx4 v1, s[36:39], s43 offen sc1 lds
    s_waitcnt vmcnt(0)
    v_add_u32 v7, s45, v1
    ds_read_b32 v64, v7 offset:0
    ds_read_b32 v65, v7 offset:4096
    ds_read_b32 v66, v7 offset:8192
    v_add_u32 v7, s44, v1
    ds_read_b32 v67, v7
    s_waitcnt lgkmcnt(1)
    v_max3_u32 v64, v64, v65, v66
    s_waitcnt lgkmcnt(0)
    v_max_u32 v64, v64, v67
    v_cmp_eq_u32 vcc, -1, v64
    s_nop 1
    s_cbranch_vccz Lhcd_288
    s_sub_u32 s6, s6, 1
    s_cbranch_scc0 Lhcl_287
    s_branch Lhcd_288
Lsc_289:
    s_mov_b32 s6, 8192
Lscl_290:
    s_waitcnt vmcnt(0)
    s_mov_b32 s100, 0
    v_cmp_eq_u32 vcc, -1, v132
    s_nop 0
    s_cbranch_vccz Lsk_292
    buffer_load_dwordx4 v[132:135], v5, s[36:39], s13 offen offset:0 sc1
    s_mov_b32 s100, 1
Lsk_292:
    v_cmp_eq_u32 vcc, -1, v136
    s_nop 0
    s_cbranch_vccz Lsk_293
    buffer_load_dwordx4 v[136:139], v5, s[36:39], s13 offen offset:512 sc1
    s_mov_b32 s100, 1
Lsk_293:
    v_cmp_eq_u32 vcc, -1, v140
    s_nop 0
    s_cbranch_vccz Lsk_294
    buffer_load_dwordx4 v[140:143], v5, s[36:39], s13 offen offset:1024 sc1
    s_mov_b32 s100, 1
Lsk_294:
    v_cmp_eq_u32 vcc, -1, v144
    s_nop 0
    s_cbranch_vccz Lsk_295
    buffer_load_dwordx4 v[144:147], v5, s[36:39], s13 offen offset:1536 sc1
    s_mov_b32 s100, 1
Lsk_295:
    v_cmp_eq_u32 vcc, -1, v100
    s_nop 0
    s_cbranch_vccz Lsk_296
    buffer_load_dwordx4 v[100:103], v5, s[36:39], s14 offen offset:0 sc1
    s_mov_b32 s100, 1
Lsk_296:
    v_cmp_eq_u32 vcc, -1, v104
    s_nop 0
    s_cbranch_vccz Lsk_297
    buffer_load_dwordx4 v[104:107], v5, s[36:39], s14 offen offset:512 sc1
    s_mov_b32 s100, 1
Lsk_297:
    v_cmp_eq_u32 vcc, -1, v108
    s_nop 0
    s_cbranch_vccz Lsk_298
    buffer_load_dwordx4 v[108:111], v5, s[36:39], s14 offen offset:1024 sc1
    s_mov_b32 s100, 1
Lsk_298:
    v_cmp_eq_u32 vcc, -1, v112
    s_nop 0
    s_cbranch_vccz Lsk_299
    buffer_load_dwordx4 v[112:115], v5, s[36:39], s14 offen offset:1536 sc1
    s_mov_b32 s100, 1
Lsk_299:
    s_cmp_eq_u32 s100, 0
    s_cbranch_scc1 Lscd_291
    s_sub_u32 s6, s6, 1
    s_cbranch_scc0 Lscl_290
    s_waitcnt vmcnt(0)
    s_branch Lscd_291
Lsc_300:
    s_mov_b32 s6, 8192
Lscl_301:
    s_waitcnt vmcnt(0)
    s_mov_b32 s100, 0
    v_cmp_eq_u32 vcc, -1, v100
    s_nop 0
    s_cbranch_vccz Lsk_303
    buffer_load_dwordx4 v[100:103], v5, s[36:39], s14 offen offset:0 sc1
    s_mov_b32 s100, 1
Lsk_303:
    v_cmp_eq_u32 vcc, -1, v104
    s_nop 0
    s_cbranch_vccz Lsk_304
    buffer_load_dwordx4 v[104:107], v5, s[36:39], s14 offen offset:512 sc1
    s_mov_b32 s100, 1
Lsk_304:
    v_cmp_eq_u32 vcc, -1, v108
    s_nop 0
    s_cbranch_vccz Lsk_305
    buffer_load_dwordx4 v[108:111], v5, s[36:39], s14 offen offset:1024 sc1
    s_mov_b32 s100, 1
Lsk_305:
    v_cmp_eq_u32 vcc, -1, v112
    s_nop 0
    s_cbranch_vccz Lsk_306
    buffer_load_dwordx4 v[112:115], v5, s[36:39], s14 offen offset:1536 sc1
    s_mov_b32 s100, 1
Lsk_306:
    s_cmp_eq_u32 s100, 0
    s_cbranch_scc1 Lscd_302
    s_sub_u32 s6, s6, 1
    s_cbranch_scc0 Lscl_301
    s_waitcnt vmcnt(0)
    s_branch Lscd_302
Lslow_307:
    buffer_store_dwordx4 v[100:103], v30, s[36:39], s72 offen sc1
    buffer_store_dwordx4 v[104:107], v30, s[36:39], s72 offen offset:512 sc1
    s_branch Lsdone_308
Lidle1:
    s_cmp_eq_u32 s4, 0
    s_cbranch_scc1 Lidle1f
    s_waitcnt vmcnt(0)
    v_mov_b32 v7, 9
    buffer_store_dword v7, off, s[36:39], s56 sc1
Lidle1f:
    s_sub_u32 s72, s49, 28
    s_lshl2_add_u32 s72, s72, s50
    s_mul_i32 s72, s72, 25600
    s_add_u32 s72, s72, s20
    v_lshlrev_b32 v16, 7, v0
    buffer_load_dword v17, v16, s[36:39], s72 offen sc1
    s_add_u32 s72, s72, 8192
    s_waitcnt vmcnt(0)
    buffer_load_dword v17, v16, s[36:39], s72 offen sc1
    s_add_u32 s72, s72, 8192
    s_waitcnt vmcnt(0)
    buffer_load_dword v17, v16, s[36:39], s72 offen sc1
    s_add_u32 s72, s72, 8192
    s_waitcnt vmcnt(0)
    buffer_load_dword v17, v16, s[36:39], s72 offen sc1
    s_add_u32 s72, s72, 8192
    s_lshl2_add_u32 s72, s49, s50
    s_cmp_lg_u32 s72, 112
    s_cbranch_scc1 interleave_layers__sliding_local_dilated__swiglu_ffn__prompt_kernel_end
    v_min_u32 v170, 55, v0
    v_lshl_add_u32 v170, v170, 3, s58
    s_mov_b32 s5, 65536
    s_nop 1
Lwl_309:
    buffer_load_dwordx2 v[16:17], v170, s[36:39], 0 offen sc1
    s_waitcnt vmcnt(0)
    v_min_u32 v16, v16, v17
    v_cmp_gt_u32 vcc, 16, v16
    s_cbranch_vccz Lwd_310
    s_sub_u32 s5, s5, 1
    s_cbranch_scc0 Lwl_309
Lwd_310:
    buffer_wbl2 sc1
    s_waitcnt vmcnt(0)
    s_branch interleave_layers__sliding_local_dilated__swiglu_ffn__prompt_kernel_end
Lss_311:
    s_nop 15
    s_waitcnt vmcnt(0)
    v_mov_b32 v7, 9
    buffer_store_dword v7, off, s[36:39], s56 sc1
    s_lshr_b32 s5, s53, 1
    s_lshl_b32 s5, s5, 8
    s_and_b32 s6, s60, 6
    s_lshl1_add_u32 s5, s6, s5
    s_add_u32 s5, s5, s58
    v_lshl_add_u32 v6, v3, 4, s5
    s_nop 2
    s_mov_b32 s5, 65536
Lssl_312:
    buffer_load_dword v16, v6, s[36:39], 0 offen sc1
    s_waitcnt vmcnt(0)
    v_cmp_gt_u32 vcc, 9, v16
    s_nop 1
    s_cbranch_vccz Lssd_313
    s_sub_u32 s5, s5, 1
    s_cbranch_scc0 Lssl_312
    s_branch Lssd_313
Lsc_314:
    s_mov_b32 s6, 8192
Lscl_315:
    s_waitcnt vmcnt(0)
    s_mov_b32 s100, 0
    v_cmp_eq_u32 vcc, -1, v16
    s_nop 0
    s_cbranch_vccz Lsk_317
    buffer_load_dwordx4 v[16:19], v1, s[36:39], s77 offen offset:0 sc1
    s_mov_b32 s100, 1
Lsk_317:
    v_cmp_eq_u32 vcc, -1, v20
    s_nop 0
    s_cbranch_vccz Lsk_318
    buffer_load_dwordx4 v[20:23], v1, s[36:39], s77 offen offset:1024 sc1
    s_mov_b32 s100, 1
Lsk_318:
    v_cmp_eq_u32 vcc, -1, v24
    s_nop 0
    s_cbranch_vccz Lsk_319
    buffer_load_dwordx4 v[24:27], v1, s[36:39], s77 offen offset:2048 sc1
    s_mov_b32 s100, 1
Lsk_319:
    v_cmp_eq_u32 vcc, -1, v28
    s_nop 0
    s_cbranch_vccz Lsk_320
    buffer_load_dwordx4 v[28:31], v1, s[36:39], s77 offen offset:3072 sc1
    s_mov_b32 s100, 1
Lsk_320:
    v_cmp_eq_u32 vcc, -1, v32
    s_nop 0
    s_cbranch_vccz Lsk_321
    buffer_load_dwordx4 v[32:35], v1, s[36:39], s78 offen offset:0 sc1
    s_mov_b32 s100, 1
Lsk_321:
    v_cmp_eq_u32 vcc, -1, v36
    s_nop 0
    s_cbranch_vccz Lsk_322
    buffer_load_dwordx4 v[36:39], v1, s[36:39], s78 offen offset:1024 sc1
    s_mov_b32 s100, 1
Lsk_322:
    v_cmp_eq_u32 vcc, -1, v40
    s_nop 0
    s_cbranch_vccz Lsk_323
    buffer_load_dwordx4 v[40:43], v1, s[36:39], s78 offen offset:2048 sc1
    s_mov_b32 s100, 1
Lsk_323:
    v_cmp_eq_u32 vcc, -1, v44
    s_nop 0
    s_cbranch_vccz Lsk_324
    buffer_load_dwordx4 v[44:47], v1, s[36:39], s78 offen offset:3072 sc1
    s_mov_b32 s100, 1
Lsk_324:
    v_cmp_eq_u32 vcc, -1, v48
    s_nop 0
    s_cbranch_vccz Lsk_325
    buffer_load_dwordx4 v[48:51], v1, s[36:39], s79 offen offset:0 sc1
    s_mov_b32 s100, 1
Lsk_325:
    s_cmp_eq_u32 s100, 0
    s_cbranch_scc1 Lscd_316
    s_sub_u32 s6, s6, 1
    s_cbranch_scc0 Lscl_315
    s_waitcnt vmcnt(0)
    s_branch Lscd_316
Lsc_326:
    s_mov_b32 s6, 8192
Lscl_327:
    s_waitcnt vmcnt(0)
    s_mov_b32 s100, 0
    v_cmp_eq_u32 vcc, -1, v28
    s_nop 0
    s_cbranch_vccz Lsk_329
    buffer_load_dwordx4 v[28:31], v1, s[36:39], s77 offen offset:3072 sc1
    s_mov_b32 s100, 1
Lsk_329:
    v_cmp_eq_u32 vcc, -1, v32
    s_nop 0
    s_cbranch_vccz Lsk_330
    buffer_load_dwordx4 v[32:35], v1, s[36:39], s78 offen offset:0 sc1
    s_mov_b32 s100, 1
Lsk_330:
    v_cmp_eq_u32 vcc, -1, v36
    s_nop 0
    s_cbranch_vccz Lsk_331
    buffer_load_dwordx4 v[36:39], v1, s[36:39], s78 offen offset:1024 sc1
    s_mov_b32 s100, 1
Lsk_331:
    v_cmp_eq_u32 vcc, -1, v40
    s_nop 0
    s_cbranch_vccz Lsk_332
    buffer_load_dwordx4 v[40:43], v1, s[36:39], s78 offen offset:2048 sc1
    s_mov_b32 s100, 1
Lsk_332:
    v_cmp_eq_u32 vcc, -1, v44
    s_nop 0
    s_cbranch_vccz Lsk_333
    buffer_load_dwordx4 v[44:47], v1, s[36:39], s78 offen offset:3072 sc1
    s_mov_b32 s100, 1
Lsk_333:
    v_cmp_eq_u32 vcc, -1, v48
    s_nop 0
    s_cbranch_vccz Lsk_334
    buffer_load_dwordx4 v[48:51], v1, s[36:39], s79 offen offset:0 sc1
    s_mov_b32 s100, 1
Lsk_334:
    v_cmp_eq_u32 vcc, -1, v52
    s_nop 0
    s_cbranch_vccz Lsk_335
    buffer_load_dwordx4 v[52:55], v1, s[36:39], s79 offen offset:1024 sc1
    s_mov_b32 s100, 1
Lsk_335:
    v_cmp_eq_u32 vcc, -1, v56
    s_nop 0
    s_cbranch_vccz Lsk_336
    buffer_load_dwordx4 v[56:59], v1, s[36:39], s79 offen offset:2048 sc1
    s_mov_b32 s100, 1
Lsk_336:
    v_cmp_eq_u32 vcc, -1, v60
    s_nop 0
    s_cbranch_vccz Lsk_337
    buffer_load_dwordx4 v[60:63], v1, s[36:39], s79 offen offset:3072 sc1
    s_mov_b32 s100, 1
Lsk_337:
    v_cmp_eq_u32 vcc, -1, v64
    s_nop 0
    s_cbranch_vccz Lsk_338
    buffer_load_dwordx4 v[64:67], v1, s[36:39], s80 offen offset:0 sc1
    s_mov_b32 s100, 1
Lsk_338:
    v_cmp_eq_u32 vcc, -1, v68
    s_nop 0
    s_cbranch_vccz Lsk_339
    buffer_load_dwordx4 v[68:71], v1, s[36:39], s80 offen offset:1024 sc1
    s_mov_b32 s100, 1
Lsk_339:
    s_cmp_eq_u32 s100, 0
    s_cbranch_scc1 Lscd_328
    s_sub_u32 s6, s6, 1
    s_cbranch_scc0 Lscl_327
    s_waitcnt vmcnt(0)
    s_branch Lscd_328
Lsc_340:
    s_mov_b32 s6, 8192
Lscl_341:
    s_waitcnt vmcnt(0)
    s_mov_b32 s100, 0
    v_cmp_eq_u32 vcc, -1, v40
    s_nop 0
    s_cbranch_vccz Lsk_343
    buffer_load_dwordx4 v[40:43], v1, s[36:39], s78 offen offset:2048 sc1
    s_mov_b32 s100, 1
Lsk_343:
    v_cmp_eq_u32 vcc, -1, v44
    s_nop 0
    s_cbranch_vccz Lsk_344
    buffer_load_dwordx4 v[44:47], v1, s[36:39], s78 offen offset:3072 sc1
    s_mov_b32 s100, 1
Lsk_344:
    v_cmp_eq_u32 vcc, -1, v48
    s_nop 0
    s_cbranch_vccz Lsk_345
    buffer_load_dwordx4 v[48:51], v1, s[36:39], s79 offen offset:0 sc1
    s_mov_b32 s100, 1
Lsk_345:
    v_cmp_eq_u32 vcc, -1, v52
    s_nop 0
    s_cbranch_vccz Lsk_346
    buffer_load_dwordx4 v[52:55], v1, s[36:39], s79 offen offset:1024 sc1
    s_mov_b32 s100, 1
Lsk_346:
    v_cmp_eq_u32 vcc, -1, v56
    s_nop 0
    s_cbranch_vccz Lsk_347
    buffer_load_dwordx4 v[56:59], v1, s[36:39], s79 offen offset:2048 sc1
    s_mov_b32 s100, 1
Lsk_347:
    v_cmp_eq_u32 vcc, -1, v60
    s_nop 0
    s_cbranch_vccz Lsk_348
    buffer_load_dwordx4 v[60:63], v1, s[36:39], s79 offen offset:3072 sc1
    s_mov_b32 s100, 1
Lsk_348:
    v_cmp_eq_u32 vcc, -1, v64
    s_nop 0
    s_cbranch_vccz Lsk_349
    buffer_load_dwordx4 v[64:67], v1, s[36:39], s80 offen offset:0 sc1
    s_mov_b32 s100, 1
Lsk_349:
    v_cmp_eq_u32 vcc, -1, v68
    s_nop 0
    s_cbranch_vccz Lsk_350
    buffer_load_dwordx4 v[68:71], v1, s[36:39], s80 offen offset:1024 sc1
    s_mov_b32 s100, 1
Lsk_350:
    v_cmp_eq_u32 vcc, -1, v72
    s_nop 0
    s_cbranch_vccz Lsk_351
    buffer_load_dwordx4 v[72:75], v1, s[36:39], s80 offen offset:2048 sc1
    s_mov_b32 s100, 1
Lsk_351:
    v_cmp_eq_u32 vcc, -1, v76
    s_nop 0
    s_cbranch_vccz Lsk_352
    buffer_load_dwordx4 v[76:79], v1, s[36:39], s80 offen offset:3072 sc1
    s_mov_b32 s100, 1
Lsk_352:
    s_cmp_eq_u32 s100, 0
    s_cbranch_scc1 Lscd_342
    s_sub_u32 s6, s6, 1
    s_cbranch_scc0 Lscl_341
    s_waitcnt vmcnt(0)
    s_branch Lscd_342
Lsc_353:
    s_mov_b32 s6, 8192
Lscl_354:
    s_waitcnt vmcnt(0)
    s_mov_b32 s100, 0
    v_cmp_eq_u32 vcc, -1, v60
    s_nop 0
    s_cbranch_vccz Lsk_356
    buffer_load_dwordx4 v[60:63], v1, s[36:39], s79 offen offset:3072 sc1
    s_mov_b32 s100, 1
Lsk_356:
    v_cmp_eq_u32 vcc, -1, v64
    s_nop 0
    s_cbranch_vccz Lsk_357
    buffer_load_dwordx4 v[64:67], v1, s[36:39], s80 offen offset:0 sc1
    s_mov_b32 s100, 1
Lsk_357:
    v_cmp_eq_u32 vcc, -1, v68
    s_nop 0
    s_cbranch_vccz Lsk_358
    buffer_load_dwordx4 v[68:71], v1, s[36:39], s80 offen offset:1024 sc1
    s_mov_b32 s100, 1
Lsk_358:
    v_cmp_eq_u32 vcc, -1, v72
    s_nop 0
    s_cbranch_vccz Lsk_359
    buffer_load_dwordx4 v[72:75], v1, s[36:39], s80 offen offset:2048 sc1
    s_mov_b32 s100, 1
Lsk_359:
    v_cmp_eq_u32 vcc, -1, v76
    s_nop 0
    s_cbranch_vccz Lsk_360
    buffer_load_dwordx4 v[76:79], v1, s[36:39], s80 offen offset:3072 sc1
    s_mov_b32 s100, 1
Lsk_360:
    s_cmp_eq_u32 s100, 0
    s_cbranch_scc1 Lscd_355
    s_sub_u32 s6, s6, 1
    s_cbranch_scc0 Lscl_354
    s_waitcnt vmcnt(0)
    s_branch Lscd_355
Lslow_361:
    buffer_store_dwordx4 v[16:19], v5, s[36:39], s72 offen sc1
    buffer_store_dwordx4 v[20:23], v5, s[36:39], s72 offen offset:1024 sc1
    s_branch Lsdone_362
Lslow_363:
    buffer_store_dwordx2 v[24:25], v168, s[36:39], s73 offen sc1
    s_branch Lsdone_364
Lss_365:
    s_nop 15
    s_waitcnt vmcnt(0)
    v_mov_b32 v7, 10
    buffer_store_dword v7, off, s[36:39], s56 sc1
    v_min_u32 v6, 55, v0
    v_lshl_add_u32 v6, v6, 3, s58
    s_nop 2
    s_mov_b32 s5, 65536
Lssl_366:
    buffer_load_dwordx2 v[116:117], v6, s[36:39], 0 offen sc1
    s_waitcnt vmcnt(0)
    v_min_u32 v116, v116, v117
    v_cmp_gt_u32 vcc, 10, v116
    s_nop 1
    s_cbranch_vccz Lssd_367
    s_sub_u32 s5, s5, 1
    s_cbranch_scc0 Lssl_366
    s_branch Lssd_367
Lp3redo1:
    s_nop 15
    s_waitcnt vmcnt(0) lgkmcnt(0)
    s_sub_u32 s29, s29, 1
    s_barrier
    s_lshr_b32 s86, s50, 1
    s_mul_i32 s86, s86, 14336
    s_and_b32 s87, s50, 1
    s_lshl_b32 s84, s87, 12
    s_add_u32 s84, s84, s86
    s_mul_i32 s85, s87, 3072
    s_add_u32 s85, s85, s86
    s_add_u32 s85, s85, 8192
    s_add_u32 s86, s55, 170496
    s_cmp_lt_u32 s53, 2
    s_cselect_b32 s31, 28672, 0
    s_add_u32 s86, s86, s31
    s_lshl_b32 s31, s31, 1
    s_lshr_b32 s87, s54, 1
    s_sub_u32 s80, s87, 0
    s_and_b32 s80, s80, 3
    s_mul_i32 s72, s80, 57344
    s_add_u32 s72, s72, s86
    s_sub_u32 s81, s87, 1
    s_and_b32 s81, s81, 3
    s_mul_i32 s73, s81, 57344
    s_add_u32 s73, s73, s86
    s_sub_u32 s82, s87, 2
    s_and_b32 s82, s82, 3
    s_mul_i32 s74, s82, 57344
    s_add_u32 s74, s74, s86
    s_sub_u32 s83, s87, 3
    s_and_b32 s83, s83, 3
    s_mul_i32 s75, s83, 57344
    s_add_u32 s75, s75, s86
    v_bfe_u32 v133, v0, 2, 3
    v_min_u32 v133, 6, v133
    v_and_b32 v132, 3, v0
    v_lshlrev_b32 v133, 11, v133
    v_lshl_add_u32 v133, v132, 7, v133
    v_lshrrev_b32 v9, 1, v2
    v_lshl_add_u32 v133, v9, 30, v133
    s_lshl_b32 s86, s80, 9
    s_add_u32 s95, s55, 491520
    s_add_u32 s86, s86, s95
    v_add_u32 v133, s86, v133
    s_lshl_b32 s87, s50, 9
    s_add_u32 s95, s95, s87
    v_lshlrev_b32 v131, 3, v0
    v_and_b32 v132, 1, v2
    v_lshlrev_b32 v8, 4, v3
    v_lshl_add_u32 v8, v9, 8, v8
    v_mul_u32_u24 v132, 14336, v132
    v_add_u32 v5, v8, v132
    v_add_u32 v8, 91648, v5
    s_lshl2_add_u32 s87, s49, s50
    s_lshl_b32 s87, s87, 10
    v_add_u32 v10, s87, v1
    s_add_u32 s76, s20, 0
    s_lshl_b32 s80, s80, 10
    s_add_u32 s80, s80, 148992
    s_add_u32 s77, s20, 229376
    s_lshl_b32 s81, s81, 10
    s_add_u32 s81, s81, 148992
    s_add_u32 s78, s20, 458752
    s_lshl_b32 s82, s82, 10
    s_add_u32 s82, s82, 148992
    s_add_u32 s79, s20, 688128
    s_lshl_b32 s83, s83, 10
    s_add_u32 s83, s83, 148992
    v_mov_b32 v46, 0
    v_mov_b32 v47, 0
    v_mov_b32 v50, 0
    v_mov_b32 v51, 0
    v_and_b32 v11, 0x1f0, v1
    s_nop 2
    s_branch Lp3top1
Lpb_368:
    s_mov_b32 s6, 8192
Lpbl_369:
    buffer_load_dword v130, v133, s[36:39], 0 offen sc1
    s_add_u32 m0, s84, 0
    s_add_u32 s61, s72, m0
    s_add_u32 s61, s61, 91648
    buffer_load_dwordx4 v1, s[36:39], s61 offen offset:0 sc1 lds
    buffer_load_dwordx4 v1, s[36:39], s61 offen offset:1024 sc1 lds
    buffer_load_dwordx4 v1, s[36:39], s61 offen offset:2048 sc1 lds
    buffer_load_dwordx4 v1, s[36:39], s61 offen offset:3072 sc1 lds
    s_waitcnt vmcnt(4)
    v_cmp_eq_u32 vcc, -1, v130
    s_sub_u32 s6, s6, 1
    s_cbranch_scc1 Lpbd_370
    s_cbranch_vccnz Lpbl_369
    s_branch Lpbd_370
Lnc_371:
    s_mov_b32 s6, 8192
Lncl_372:
    buffer_load_dwordx2 v[116:117], v131, s[36:39], s95 offen offset:0 sc1
    buffer_load_dwordx2 v[118:119], v131, s[36:39], s95 offen offset:2048 sc1
    s_add_u32 s86, s95, 4096
    buffer_load_dwordx2 v[120:121], v131, s[36:39], s86 offen offset:0 sc1
    s_add_u32 s86, s95, 4096
    buffer_load_dwordx2 v[122:123], v131, s[36:39], s86 offen offset:2048 sc1
    s_add_u32 s86, s95, 8192
    buffer_load_dwordx2 v[124:125], v131, s[36:39], s86 offen offset:0 sc1
    s_add_u32 s86, s95, 8192
    buffer_load_dwordx2 v[126:127], v131, s[36:39], s86 offen offset:2048 sc1
    s_add_u32 s86, s95, 12288
    buffer_load_dwordx2 v[128:129], v131, s[36:39], s86 offen offset:0 sc1
    s_waitcnt vmcnt(5)
    v_add_f32 v116, v116, v118
    v_add_f32 v117, v117, v119
    s_waitcnt vmcnt(4)
    v_add_f32 v116, v116, v120
    v_add_f32 v117, v117, v121
    s_waitcnt vmcnt(3)
    v_add_f32 v116, v116, v122
    v_add_f32 v117, v117, v123
    s_waitcnt vmcnt(2)
    v_add_f32 v116, v116, v124
    v_add_f32 v117, v117, v125
    s_waitcnt vmcnt(1)
    v_add_f32 v116, v116, v126
    v_add_f32 v117, v117, v127
    s_waitcnt vmcnt(0)
    v_add_f32 v116, v116, v128
    v_add_f32 v117, v117, v129
    v_cmp_u_f32 vcc, v116, v116
    s_nop 1
    s_cbranch_vccz Lncd_373
    s_sub_u32 s6, s6, 1
    s_cbranch_scc0 Lncl_372
    s_branch Lncd_373
Lslow_374:
    buffer_store_dword v7, off, s[36:39], s56 sc1
    s_branch Lsdone_375
Lnn_376:
    s_cmp_eq_u32 s29, 0
    s_cbranch_scc1 Lnnd_377
    s_branch Lp3redo1
Lslow_378:
    buffer_store_dwordx4 v[40:43], v10, s[36:39], s87 offen sc1
    s_branch Lsdone_379
Lnn_380:
    s_cmp_eq_u32 s29, 0
    s_cbranch_scc1 Lnnd_381
    s_branch Lp3redo1
Lps_382:
    s_mov_b32 s5, 65536
Lpl_384:
    buffer_load_dwordx2 v[14:15], v136, s[36:39], 0 offen sc1
    s_waitcnt vmcnt(0)
    v_min_u32 v14, v14, v15
    v_cmp_gt_u32 vcc, 10, v14
    s_nop 1
    s_cbranch_vccz Lpd_383
    s_sub_u32 s5, s5, 1
    s_cbranch_scc0 Lpl_384
    s_branch Lpd_383
Lslow_385:
    buffer_store_dwordx4 v[40:43], v10, s[36:39], s87 offen sc1
    s_branch Lsdone_386
Lnn_387:
    s_cmp_eq_u32 s29, 0
    s_cbranch_scc1 Lnnd_388
    s_branch Lp3redo1
Lslow_389:
    buffer_store_dword v7, off, s[36:39], s56 sc1
    s_branch Lsdone_390
Lslow_391:
    buffer_store_dwordx4 v[40:43], v10, s[36:39], s87 offen sc1
    s_branch Lsdone_392
Lnn_393:
    s_cmp_eq_u32 s29, 0
    s_cbranch_scc1 Lnnd_394
    s_branch Lp3redo1
Lslow_395:
    buffer_store_dwordx4 v[40:43], v10, s[36:39], s87 offen sc1
    s_branch Lsdone_396
Lnn_397:
    s_cmp_eq_u32 s29, 0
    s_cbranch_scc1 Lnnd_398
    s_branch Lp3redo1
Lslow_399:
    buffer_store_dword v7, off, s[36:39], s56 sc1
    s_branch Lsdone_400
Lslow_401:
    buffer_store_dwordx4 v[40:43], v10, s[36:39], s87 offen sc1
    s_branch Lsdone_402
Lps_403:
    s_mov_b32 s5, 65536
Lpl_405:
    buffer_load_dword v9, v6, s[36:39], 0 offen sc1
    s_waitcnt vmcnt(0)
    v_cmp_gt_u32 vcc, v4, v9
    s_nop 1
    s_and_b32 s6, vcc_lo, 0xfff
    s_cbranch_scc0 Lpd_404
    s_sub_u32 s5, s5, 1
    s_cbranch_scc0 Lpl_405
    s_branch Lpd_404
Lslow_406:
    buffer_store_dwordx4 v[40:43], v10, s[36:39], s87 offen sc1
    s_branch Lsdone_407
Lslow_408:
    buffer_store_dword v7, off, s[36:39], s56 sc1
    s_branch Lsdone_409
Lslow_410:
    buffer_store_dwordx4 v[40:43], v10, s[36:39], s87 offen sc1
    s_branch Lsdone_411
Lps_412:
    s_mov_b32 s5, 65536
Lpl_414:
    buffer_load_dword v9, v6, s[36:39], 0 offen sc1
    s_waitcnt vmcnt(0)
    v_cmp_gt_u32 vcc, v4, v9
    s_nop 1
    s_and_b32 s6, vcc_lo, 0xff000
    s_cbranch_scc0 Lpd_413
    s_sub_u32 s5, s5, 1
    s_cbranch_scc0 Lpl_414
    s_branch Lpd_413
Lslow_415:
    buffer_store_dword v7, off, s[36:39], s56 sc1
    s_branch Lsdone_416
Lslow_417:
    buffer_store_dwordx4 v[40:43], v10, s[36:39], s87 offen sc1
    s_branch Lsdone_418
Lslow_419:
    buffer_store_dword v7, off, s[36:39], s56 sc1
    s_branch Lsdone_420
Lps_421:
    s_mov_b32 s5, 65536
Lpl_423:
    buffer_load_dword v9, v6, s[36:39], 0 offen sc1
    s_waitcnt vmcnt(0)
    v_cmp_gt_u32 vcc, v4, v9
    s_nop 1
    s_and_b32 s6, vcc_lo, 0xff00000
    s_cbranch_scc0 Lpd_422
    s_sub_u32 s5, s5, 1
    s_cbranch_scc0 Lpl_423
    s_branch Lpd_422
Lps_424:
    s_mov_b32 s5, 65536
Lpl_426:
    buffer_load_dword v9, v6, s[36:39], 0 offen sc1
    s_waitcnt vmcnt(0)
    v_cmp_gt_u32 vcc, 15, v9
    s_nop 1
    s_and_b32 s6, vcc_lo, 0xff00000
    s_cbranch_scc0 Lpd_425
    s_sub_u32 s5, s5, 1
    s_cbranch_scc0 Lpl_426
    s_branch Lpd_425
Lslow_427:
    buffer_store_dword v7, off, s[36:39], s56 sc1
    s_branch Lsdone_428
    s_endpgm
Lcode_end:
.section .rodata,"a"
.p2align 6
.amdhsa_kernel interleave_layers__sliding_local_dilated__swiglu_ffn__prompt_kernel
  .amdhsa_next_free_vgpr 512
  .amdhsa_next_free_sgpr 102
  .amdhsa_accum_offset 256
  .amdhsa_group_segment_fixed_size 0
  .amdhsa_kernarg_size 80
  .amdhsa_user_sgpr_count 2
  .amdhsa_user_sgpr_kernarg_segment_ptr 1
  .amdhsa_system_sgpr_workgroup_id_x 1
  .amdhsa_float_denorm_mode_32 3
.end_amdhsa_kernel
```
